```python
import torch

def _softmax(x, axis=-1):
    return torch.softmax(x, dim=axis)
def _gelu(x):
    return torch.nn.functional.gelu(x, approximate="tanh")
def _silu(x):
    return torch.nn.functional.silu(x)
def _sigmoid(x):
    return torch.sigmoid(x)
def _layernorm(x, axis=-1, eps=1e-5):
    m = x.mean(dim=axis, keepdim=True)
    v = x.var(dim=axis, keepdim=True, unbiased=False)
    return (x - m) / torch.sqrt(v + eps)
def _scatter_add(tgt, idx, src, axis=0):
    return tgt.clone().index_add_(axis, idx, src)
def _segment_sum(src, seg, n):
    out = torch.zeros((n,) + src.shape[1:], dtype=src.dtype)
    return out.index_add_(0, seg, src)
def _pad(x, pw):
    flat = tuple(v for pair in reversed(pw) for v in pair)
    return torch.nn.functional.pad(x, flat)

kernel_name = 'standalone__mha_softmax__near_ridge'

def setup_inputs():

    _w = (lambda a: (lambda t: t.to(torch.bfloat16) if t.is_floating_point() else t)(torch.as_tensor(a)))
    B, H, Sq, Sk, D = 16, 32, 848, 512, 128
    return {
        "q": _w((lambda *s: torch.randn(*s, dtype=torch.bfloat16) * 0.8)(B, H, Sq, D)),
        "k": _w((lambda *s: torch.randn(*s, dtype=torch.bfloat16) * 0.8)(B, H, Sk, D)),
        "v": _w((lambda *s: torch.randn(*s, dtype=torch.bfloat16) * 0.05)(B, H, Sk, D)),
    }

def reference(q, k, v):
    scale = q.shape[-1] ** -0.5
    scores = torch.einsum("bhqd,bhkd->bhqk", q, k) * scale
    p = _softmax(scores, axis=-1)
    return torch.einsum("bhqk,bhkd->bhqd", p, v)
```

```asm
; @launch grid=(256,1,1) block=(256,1,1) lds=163840
.amdgcn_target "amdgcn-amd-amdhsa--gfx950"
.text
.globl standalone__mha_softmax__near_ridge_kernel
.p2align 8
.type standalone__mha_softmax__near_ridge_kernel,@function
standalone__mha_softmax__near_ridge_kernel:
    s_cmp_ge_u32 s2, 256
    s_cbranch_scc1 L_end
    s_load_dwordx4 s[80:83], s[0:1], 0
    s_load_dwordx4 s[84:87], s[0:1], 16
    s_getpc_b64 s[40:41]
L_pc:
    s_lshr_b32 s68, s2, 3
    s_mul_i32 s68, s68, 1792
    s_min_u32 s68, s68, L_end-L_pc-1792
    v_min_u32 v1, 13, v0
    v_lshl_add_u32 v1, v1, 7, s68
    v_mov_b32 v3, s41
    v_add_co_u32 v2, vcc, s40, v1
    s_nop 1
    v_addc_co_u32 v3, vcc, 0, v3, vcc
    global_load_dword v55, v[2:3], off
    v_lshrrev_b32 v1, 6, v0
    v_and_b32 v0, 63, v0
    v_readfirstlane_b32 s61, v1
    s_and_b32 s68, s2, 7
    s_lshr_b32 s69, s2, 3
    s_bfe_u32 s66, s69, 0x10002
    s_and_b32 s70, s69, 3
    s_lshr_b32 s69, s69, 3
    s_lshl_b32 s69, s69, 2
    s_or_b32 s69, s69, s70
    s_lshl_b32 s68, s68, 6
    s_lshl_b32 s69, s69, 2
    s_add_u32 s67, s68, s69
    v_lshrrev_b32 v2, 5, v0
    v_bfe_u32 v3, v0, 3, 2
    v_and_b32 v4, 3, v0
    v_xor_b32 v4, v4, v3
    v_bfe_u32 v5, v0, 2, 3
    v_lshlrev_b32 v6, 8, v5
    v_lshl_add_u32 v6, v2, 6, v6
    v_lshl_add_u32 v49, v4, 4, v6
    v_lshl_add_u32 v9, v5, 2, v4
    v_lshlrev_b32 v9, 4, v9
    v_lshl_add_u32 v9, v2, 12, v9
    v_lshrrev_b32 v2, 4, v0
    v_bfe_u32 v3, v0, 1, 2
    v_xor_b32 v2, v2, v3
    v_and_b32 v3, 7, v0
    v_lshl_add_u32 v2, v3, 2, v2
    v_lshlrev_b32 v2, 4, v2
    v_bfe_u32 v3, v0, 3, 1
    v_lshl_add_u32 v11, v3, 12, v2
    v_lshl_add_u32 v10, v3, 11, v2
    s_and_b32 s68, s61, 1
    s_lshr_b32 s69, s61, 1
    s_xor_b32 s70, s68, 0
    s_xor_b32 s71, s69, 0
    s_lshl_b32 s70, s70, 14
    s_lshl_b32 s71, s71, 13
    s_add_u32 s70, s70, s71
    v_add_u32 v56, s70, v11
    v_add_u32 v60, s70, v9
    s_xor_b32 s70, s68, 0
    s_xor_b32 s71, s69, 1
    s_lshl_b32 s70, s70, 14
    s_lshl_b32 s71, s71, 13
    s_add_u32 s70, s70, s71
    v_add_u32 v57, s70, v11
    v_add_u32 v61, s70, v9
    s_xor_b32 s70, s68, 1
    s_xor_b32 s71, s69, 0
    s_lshl_b32 s70, s70, 14
    s_lshl_b32 s71, s71, 13
    s_add_u32 s70, s70, s71
    v_add_u32 v58, s70, v11
    v_add_u32 v62, s70, v9
    s_xor_b32 s70, s68, 1
    s_xor_b32 s71, s69, 1
    s_lshl_b32 s70, s70, 14
    s_lshl_b32 s71, s71, 13
    s_add_u32 s70, s70, s71
    v_add_u32 v59, s70, v11
    v_add_u32 v63, s70, v9
    s_mul_i32 s54, s61, 24576
    s_add_u32 s54, s54, 65536
    v_add_u32 v50, s54, v10
    v_lshl_add_u32 v51, v0, 4, s54
    s_lshl_b32 s50, s61, 12
    s_add_u32 s51, s50, 16384
    s_add_u32 s52, s50, 32768
    s_add_u32 s53, s50, 49152
    s_lshl_b32 s44, s67, 17
    s_add_u32 s70, s44, 524288
    s_lshl_b32 s45, s68, 14
    s_lshl_b32 s69, s61, 11
    s_add_u32 s44, s44, s69
    s_add_u32 s69, s67, s66
    s_mul_i32 s69, s69, 217088
    s_mul_i32 s71, s61, 28672
    s_add_u32 s62, s69, s71
    s_add_u32 s64, s62, 24576
    s_xor_b32 s69, s66, 1
    s_add_u32 s69, s67, s69
    s_mul_i32 s69, s69, 217088
    s_add_u32 s65, s69, 212992
    s_mul_i32 s71, s61, 24576
    s_add_u32 s69, s69, s71
    s_add_u32 s63, s69, 114688
    s_waitcnt lgkmcnt(0)
    s_mov_b32 s4, s82
    s_mov_b32 s5, s83
    s_add_u32 s6, s70, 0
    s_mov_b32 s7, 0x20000
    s_sub_u32 s8, s82, 896
    s_subb_u32 s9, s83, 0
    s_add_u32 s10, s70, 896
    s_mov_b32 s11, 0x20000
    s_sub_u32 s12, s84, 2048
    s_subb_u32 s13, s85, 0
    s_add_u32 s14, s70, 2048
    s_mov_b32 s15, 0x20000
    s_sub_u32 s16, s84, 2944
    s_subb_u32 s17, s85, 0
    s_add_u32 s18, s70, 2944
    s_mov_b32 s19, 0x20000
    s_mov_b32 m0, s50
    s_nop 0
    buffer_load_dwordx4 v49, s[4:7], s44 offen offset:0 lds
    buffer_load_dwordx4 v49, s[8:11], s44 offen offset:1024 lds
    buffer_load_dwordx4 v49, s[12:15], s44 offen offset:2048 lds
    buffer_load_dwordx4 v49, s[16:19], s44 offen offset:3072 lds
    s_add_u32 s44, s44, 8192
    s_mov_b32 m0, s51
    s_nop 0
    buffer_load_dwordx4 v49, s[4:7], s44 offen offset:0 lds
    buffer_load_dwordx4 v49, s[8:11], s44 offen offset:1024 lds
    buffer_load_dwordx4 v49, s[12:15], s44 offen offset:2048 lds
    buffer_load_dwordx4 v49, s[16:19], s44 offen offset:3072 lds
    s_add_u32 s44, s44, 8192
    s_mov_b32 s20, s80
    s_mov_b32 s21, s81
    s_mov_b32 s22, 111149056
    s_mov_b32 s23, 0x20000
    s_sub_u32 s24, s80, 896
    s_subb_u32 s25, s81, 0
    s_mov_b32 s26, 111149952
    s_mov_b32 s27, 0x20000
    s_mov_b32 s36, s86
    s_mov_b32 s37, s87
    s_mov_b32 s38, 111149056
    s_mov_b32 s39, 0x20000
    s_cmp_eq_u32 s66, 0
    s_cselect_b64 s[32:33], s[82:83], s[84:85]
    s_mov_b32 s34, s70
    s_mov_b32 s35, 0x20000
    s_cselect_b32 s80, s62, s63
    s_cselect_b32 s81, s64, s65
    s_cselect_b32 s46, s63, s62
    s_cselect_b32 s47, s65, s64
    s_add_u32 m0, s54, 0
    s_nop 0
    buffer_load_dwordx4 v49, s[20:23], s80 offen offset:0 nt lds
    buffer_load_dwordx4 v49, s[24:27], s80 offen offset:1024 nt lds
    buffer_load_dwordx4 v49, s[20:23], s80 offen offset:2048 nt lds
    buffer_load_dwordx4 v49, s[24:27], s80 offen offset:3072 nt lds
    s_add_u32 s80, s80, 4096
    s_add_u32 m0, s54, 4096
    s_nop 0
    buffer_load_dwordx4 v49, s[20:23], s80 offen offset:0 nt lds
    buffer_load_dwordx4 v49, s[24:27], s80 offen offset:1024 nt lds
    buffer_load_dwordx4 v49, s[20:23], s80 offen offset:2048 nt lds
    buffer_load_dwordx4 v49, s[24:27], s80 offen offset:3072 nt lds
    s_add_u32 s80, s80, 4096
    s_add_u32 s71, s61, 4
    s_lshl_b32 s71, s71, 13
    s_lshl_b32 s69, s67, 17
    s_add_u32 s71, s71, s69
    s_mov_b32 s57, 0x3e0293ee
    s_mov_b32 s58, 0x33800000
    s_mov_b32 s59, 0x57800000
    s_mov_b32 s60, 0
    s_mov_b32 s28, 9
    v_lshlrev_b32 v54, 7, v0
    s_lshr_b32 s30, s2, 3
    s_mul_i32 s29, s30, 1152
    s_add_u32 s29, s29, L_A_S0-L_pc
    s_min_u32 s29, s29, L_end-L_pc-1152
    s_mul_i32 s30, s30, 448
    s_add_u32 s30, s30, L_tail_A-L_pc
    s_min_u32 s30, s30, L_end-L_pc-1152
    s_sub_u32 s30, s30, s29
    v_min_u32 v12, 8, v0
    v_lshl_add_u32 v12, v12, 7, s29
    v_mov_b32 v53, s41
    v_add_co_u32 v52, vcc, s40, v12
    s_nop 1
    v_addc_co_u32 v53, vcc, 0, v53, vcc
    s_mov_b32 s56, 0
    s_mov_b32 s55, 2
    s_mov_b32 s48, 0x80000000
    s_mov_b32 s49, s54
    v_lshrrev_b32 v12, 5, v0
    v_and_b32 v13, 1, v0
    v_xor_b32 v12, v12, v13
    v_add_u32 v12, -1, v12
    v_and_b32 v28, 0x3f803f80, v12
    v_and_b32 v29, 0x3f803f80, v12
    v_and_b32 v30, 0x3f803f80, v12
    v_and_b32 v31, 0x3f803f80, v12
    v_bfe_u32 v13, v0, 1, 1
    v_mul_u32_u24 v13, 0xaaaa, v13
    v_add_u32 v48, 0x4444, v13
    v_mov_b32 v32, 0
    v_mov_b32 v33, 0
    v_mov_b32 v34, 0
    v_mov_b32 v35, 0
    v_mov_b32 v36, 0
    v_mov_b32 v37, 0
    v_mov_b32 v38, 0
    v_mov_b32 v39, 0
    v_mov_b32 v40, 0
    v_mov_b32 v41, 0
    v_mov_b32 v42, 0
    v_mov_b32 v43, 0
    v_mov_b32 v44, 0
    v_mov_b32 v45, 0
    v_mov_b32 v46, 0
    v_mov_b32 v47, 0
    v_mov_b32 v24, 0
    v_mov_b32 v20, 0
    v_mov_b32 v25, 0
    v_mov_b32 v21, 0
    v_mov_b32 v26, 0
    v_mov_b32 v22, 0
    v_mov_b32 v27, 0
    v_mov_b32 v23, 0
    s_mov_b32 m0, s52
    s_nop 0
    buffer_load_dwordx4 v49, s[4:7], s44 offen offset:0 lds
    buffer_load_dwordx4 v49, s[8:11], s44 offen offset:1024 lds
    buffer_load_dwordx4 v49, s[12:15], s44 offen offset:2048 lds
    buffer_load_dwordx4 v49, s[16:19], s44 offen offset:3072 lds
    s_add_u32 s44, s44, 8192
    s_mov_b32 m0, s53
    s_nop 0
    buffer_load_dwordx4 v49, s[4:7], s44 offen offset:0 lds
    buffer_load_dwordx4 v49, s[8:11], s44 offen offset:1024 lds
    buffer_load_dwordx4 v49, s[12:15], s44 offen offset:2048 lds
    buffer_load_dwordx4 v49, s[16:19], s44 offen offset:3072 lds
    s_add_u32 s44, s44, 8192
    s_waitcnt vmcnt(16)
    s_barrier
    ds_read_b128 a[144:147], v56 offset:0
    ds_read_b128 a[148:151], v56 offset:512
    ds_read_b128 a[152:155], v56 offset:1024
    ds_read_b128 a[156:159], v56 offset:1536
    ds_read_b128 a[160:163], v57 offset:0
    ds_read_b128 a[164:167], v57 offset:512
    ds_read_b128 a[168:171], v57 offset:1024
    ds_read_b128 a[172:175], v57 offset:1536
    ds_read_b64_tr_b16 a[176:177], v60 offset:2048
    ds_read_b64_tr_b16 a[178:179], v61 offset:2048
    ds_read_b64_tr_b16 a[180:181], v60 offset:2056
    ds_read_b64_tr_b16 a[182:183], v61 offset:2056
    ds_read_b64_tr_b16 a[184:185], v60 offset:2560
    ds_read_b64_tr_b16 a[186:187], v61 offset:2560
    ds_read_b64_tr_b16 a[188:189], v60 offset:2568
    ds_read_b64_tr_b16 a[190:191], v61 offset:2568
    ds_read_b64_tr_b16 a[192:193], v60 offset:3072
    ds_read_b64_tr_b16 a[194:195], v61 offset:3072
    ds_read_b64_tr_b16 a[196:197], v60 offset:3080
    ds_read_b64_tr_b16 a[198:199], v61 offset:3080
    ds_read_b64_tr_b16 a[200:201], v60 offset:3584
    ds_read_b64_tr_b16 a[202:203], v61 offset:3584
    ds_read_b64_tr_b16 a[204:205], v60 offset:3592
    ds_read_b64_tr_b16 a[206:207], v61 offset:3592
    s_waitcnt vmcnt(12)
    ds_read_b128 a[0:3], v50 offset:0
    ds_read_b128 a[4:7], v50 offset:512
    ds_read_b128 a[8:11], v50 offset:1024
    ds_read_b128 a[12:15], v50 offset:1536
    s_add_u32 m0, s54, 8192
    s_waitcnt lgkmcnt(0)
    v_mfma_f32_16x16x32_bf16 v[0:3], a[144:147], a[0:3], 0
    v_mfma_f32_16x16x32_bf16 v[0:3], a[148:151], a[4:7], v[0:3]
    v_mfma_f32_16x16x32_bf16 v[0:3], a[152:155], a[8:11], v[0:3]
    v_mfma_f32_16x16x32_bf16 v[0:3], a[156:159], a[12:15], v[0:3]
    v_mfma_f32_16x16x32_bf16 v[4:7], a[172:175], a[12:15], 0
    v_mfma_f32_16x16x32_bf16 v[4:7], a[168:171], a[8:11], v[4:7]
    v_mfma_f32_16x16x32_bf16 v[4:7], a[164:167], a[4:7], v[4:7]
    v_mfma_f32_16x16x32_bf16 v[4:7], a[160:163], a[0:3], v[4:7]
    buffer_load_dwordx4 v49, s[20:23], s80 offen offset:0 nt lds
    ds_read_b64_tr_b16 a[208:209], v62 offset:2048
    ds_read_b64_tr_b16 a[210:211], v63 offset:2048
    ds_read_b64_tr_b16 a[212:213], v62 offset:2056
    ds_read_b64_tr_b16 a[214:215], v63 offset:2056
    ds_read_b64_tr_b16 a[216:217], v62 offset:2560
    ds_read_b64_tr_b16 a[218:219], v63 offset:2560
    ds_read_b64_tr_b16 a[220:221], v62 offset:2568
    ds_read_b64_tr_b16 a[222:223], v63 offset:2568
    ds_read_b64_tr_b16 a[224:225], v62 offset:3072
    ds_read_b64_tr_b16 a[226:227], v63 offset:3072
    ds_read_b64_tr_b16 a[228:229], v62 offset:3080
    ds_read_b64_tr_b16 a[230:231], v63 offset:3080
    ds_read_b64_tr_b16 a[232:233], v62 offset:3584
    ds_read_b64_tr_b16 a[234:235], v63 offset:3584
    ds_read_b64_tr_b16 a[236:237], v62 offset:3592
    ds_read_b64_tr_b16 a[238:239], v63 offset:3592
    buffer_load_dwordx4 v49, s[24:27], s80 offen offset:1024 nt lds
    v_mul_f32 v0, s57, v0
    v_mul_f32 v1, s57, v1
    v_mul_f32 v2, s57, v2
    v_mul_f32 v3, s57, v3
    v_mul_f32 v4, s57, v4
    v_mul_f32 v5, s57, v5
    v_mul_f32 v6, s57, v6
    v_mul_f32 v7, s57, v7
    v_exp_f32 v0, v0
    v_exp_f32 v1, v1
    v_exp_f32 v2, v2
    v_exp_f32 v3, v3
    v_exp_f32 v4, v4
    v_exp_f32 v5, v5
    v_exp_f32 v6, v6
    v_exp_f32 v7, v7
    buffer_load_dwordx4 v49, s[20:23], s80 offen offset:2048 nt lds
    v_cvt_pk_bf16_f32 v16, v0, v1
    v_cvt_pk_bf16_f32 v17, v2, v3
    v_cvt_pk_bf16_f32 v18, v4, v5
    v_cvt_pk_bf16_f32 v19, v6, v7
    buffer_load_dwordx4 v49, s[24:27], s80 offen offset:3072 nt lds
    s_add_u32 s80, s80, 4096
    s_waitcnt vmcnt(12)
    ds_read_b128 a[16:19], v50 offset:4096
    ds_read_b128 a[20:23], v50 offset:4608
    ds_read_b128 a[24:27], v50 offset:5120
    ds_read_b128 a[28:31], v50 offset:5632
    s_waitcnt lgkmcnt(0)
    v_mfma_f32_16x16x32_bf16 v[8:11], a[144:147], a[16:19], 0
    v_mfma_f32_16x16x32_bf16 v[8:11], a[148:151], a[20:23], v[8:11]
    v_mfma_f32_16x16x32_bf16 v[8:11], a[152:155], a[24:27], v[8:11]
    v_mfma_f32_16x16x32_bf16 v[8:11], a[156:159], a[28:31], v[8:11]
    v_mfma_f32_16x16x32_bf16 v[12:15], a[172:175], a[28:31], 0
    v_mfma_f32_16x16x32_bf16 v[12:15], a[168:171], a[24:27], v[12:15]
    v_mfma_f32_16x16x32_bf16 v[12:15], a[164:167], a[20:23], v[12:15]
    v_mfma_f32_16x16x32_bf16 v[12:15], a[160:163], a[16:19], v[12:15]
    ds_read_b128 a[144:147], v58 offset:0
    ds_read_b128 a[148:151], v58 offset:512
    ds_read_b128 a[152:155], v58 offset:1024
    ds_read_b128 a[156:159], v58 offset:1536
    ds_read_b128 a[160:163], v59 offset:0
    ds_read_b128 a[164:167], v59 offset:512
    ds_read_b128 a[168:171], v59 offset:1024
    ds_read_b128 a[172:175], v59 offset:1536
    v_mul_f32_e64 v8, s57, v8
    s_waitcnt lgkmcnt(0)
    s_cmp_eq_u32 s66, 0
    s_cbranch_scc0 L_B_start
    v_mfma_f32_16x16x32_bf16 v[0:3], a[144:147], a[0:3], 0
    s_add_u32 m0, s54, 12288
    v_mul_f32 v9, s57, v9
    v_mfma_f32_16x16x32_bf16 v[0:3], a[148:151], a[4:7], v[0:3]
    buffer_load_dwordx4 v49, s[20:23], s80 offen offset:0 nt lds
    v_mfma_f32_16x16x32_bf16 v[0:3], a[152:155], a[8:11], v[0:3]
    v_exp_f32 v9, v9
    v_mfma_f32_16x16x32_bf16 v[0:3], a[156:159], a[12:15], v[0:3]
    v_exp_f32 v8, v8
    v_mul_f32 v10, s57, v10
    v_mfma_f32_16x16x32_bf16 v[4:7], a[172:175], a[12:15], 0
    v_exp_f32 v10, v10
    v_mfma_f32_16x16x32_bf16 v[4:7], a[168:171], a[8:11], v[4:7]
    v_cvt_pk_bf16_f32 v20, v8, v9
    v_mul_f32 v11, s57, v11
    v_mfma_f32_16x16x32_bf16 v[4:7], a[164:167], a[4:7], v[4:7]
    v_exp_f32 v11, v11
    v_mfma_f32_16x16x32_bf16 v[4:7], a[160:163], a[0:3], v[4:7]
    v_mul_f32 v12, s57, v12
    v_cvt_pk_bf16_f32 v21, v10, v11
    v_mfma_f32_16x16x32_bf16 v[64:67], a[176:179], v[16:19], 0
    v_exp_f32 v12, v12
    v_mul_f32 v13, s57, v13
    v_mfma_f32_16x16x32_bf16 v[68:71], a[180:183], v[16:19], 0
    v_exp_f32 v13, v13
    v_mfma_f32_16x16x32_bf16 v[72:75], a[184:187], v[16:19], 0
    v_mul_f32 v14, s57, v14
    v_cvt_pk_bf16_f32 v22, v12, v13
    v_mfma_f32_16x16x32_bf16 v[76:79], a[188:191], v[16:19], 0
    buffer_load_dwordx4 v49, s[24:27], s80 offen offset:1024 nt lds
    v_mfma_f32_16x16x32_bf16 v[80:83], a[192:195], v[16:19], 0
    v_exp_f32 v14, v14
    v_mfma_f32_16x16x32_bf16 v[84:87], a[196:199], v[16:19], 0
    v_mul_f32 v15, s57, v15
    v_mul_f32 v1, s57, v1
    v_mfma_f32_16x16x32_bf16 v[88:91], a[200:203], v[16:19], 0
    v_exp_f32 v15, v15
    v_mul_f32 v0, s57, v0
    v_mfma_f32_16x16x32_bf16 v[92:95], a[204:207], v[16:19], 0
    v_cvt_pk_bf16_f32 v23, v14, v15
    v_exp_f32 v0, v0
    v_mfma_f32_16x16x32_bf16 v[8:11], a[144:147], a[16:19], 0
    s_waitcnt vmcnt(6)
    s_barrier
    v_mfma_f32_16x16x32_bf16 v[8:11], a[148:151], a[20:23], v[8:11]
    ds_read_b128 a[144:147], v56 offset:32768
    ds_read_b128 a[148:151], v56 offset:33280
    v_mfma_f32_16x16x32_bf16 v[8:11], a[152:155], a[24:27], v[8:11]
    v_exp_f32 v1, v1
    v_mfma_f32_16x16x32_bf16 v[8:11], a[156:159], a[28:31], v[8:11]
    ds_read_b128 a[152:155], v56 offset:33792
    ds_read_b128 a[156:159], v56 offset:34304
    v_mul_f32 v2, s57, v2
    v_smfmac_f32_16x16x64_bf16 v[32:35], v[28:31], v[16:23], v48
    v_cvt_pk_bf16_f32 v16, v0, v1
    v_exp_f32 v2, v2
    v_mfma_f32_16x16x32_bf16 v[12:15], a[172:175], a[28:31], 0
    buffer_load_dwordx4 v49, s[20:23], s80 offen offset:2048 nt lds
    v_mul_f32 v3, s57, v3
    v_mfma_f32_16x16x32_bf16 v[12:15], a[168:171], a[24:27], v[12:15]
    ds_read_b128 a[172:175], v57 offset:34304
    v_exp_f32 v3, v3
    v_mfma_f32_16x16x32_bf16 v[12:15], a[164:167], a[20:23], v[12:15]
    v_mul_f32 v4, s57, v4
    v_cvt_pk_bf16_f32 v17, v2, v3
    v_mfma_f32_16x16x32_bf16 v[12:15], a[160:163], a[16:19], v[12:15]
    ds_read_b128 a[168:171], v57 offset:33792
    ds_read_b128 a[164:167], v57 offset:33280
    v_mul_f32 v5, s57, v5
    v_mfma_f32_16x16x32_bf16 v[96:99], a[176:179], v[20:23], 0
    ds_read_b64_tr_b16 a[176:177], v60 offset:34816
    v_exp_f32 v4, v4
    v_mfma_f32_16x16x32_bf16 v[100:103], a[180:183], v[20:23], 0
    v_exp_f32 v5, v5
    v_mfma_f32_16x16x32_bf16 v[104:107], a[184:187], v[20:23], 0
    ds_read_b64_tr_b16 a[178:179], v61 offset:34816
    v_mul_f32 v6, s57, v6
    v_cvt_pk_bf16_f32 v18, v4, v5
    v_mfma_f32_16x16x32_bf16 v[108:111], a[188:191], v[20:23], 0
    v_exp_f32 v6, v6
    v_mul_f32 v7, s57, v7
    v_mfma_f32_16x16x32_bf16 v[112:115], a[192:195], v[20:23], 0
    ds_read_b128 a[160:163], v57 offset:32768
    v_exp_f32 v7, v7
    v_mfma_f32_16x16x32_bf16 v[116:119], a[196:199], v[20:23], 0
    ds_read_b64_tr_b16 a[180:181], v60 offset:34824
    ds_read_b64_tr_b16 a[182:183], v61 offset:34824
    v_cvt_pk_bf16_f32 v19, v6, v7
    v_mfma_f32_16x16x32_bf16 v[120:123], a[200:203], v[20:23], 0
    buffer_load_dwordx4 v49, s[24:27], s80 offen offset:3072 nt lds
    v_mul_f32 v8, s57, v8
    v_mfma_f32_16x16x32_bf16 v[124:127], a[204:207], v[20:23], 0
    ds_read_b64_tr_b16 a[186:187], v61 offset:35328
    s_waitcnt lgkmcnt(9)
    s_add_u32 s80, s80, 4096
    v_mfma_f32_16x16x32_bf16 v[0:3], a[144:147], a[0:3], 0
    v_exp_f32 v8, v8
    v_mfma_f32_16x16x32_bf16 v[0:3], a[148:151], a[4:7], v[0:3]
    ds_read_b64_tr_b16 a[188:189], v60 offset:35336
    ds_read_b64_tr_b16 a[190:191], v61 offset:35336
    v_mul_f32 v9, s57, v9
    v_mfma_f32_16x16x32_bf16 v[0:3], a[152:155], a[8:11], v[0:3]
    ds_read_b64_tr_b16 a[192:193], v60 offset:35840
    v_exp_f32 v9, v9
    v_mfma_f32_16x16x32_bf16 v[0:3], a[156:159], a[12:15], v[0:3]
    s_waitcnt lgkmcnt(6)
    v_mul_f32 v10, s57, v10
    v_cvt_pk_bf16_f32 v20, v8, v9
    v_mfma_f32_16x16x32_bf16 v[4:7], a[172:175], a[12:15], 0
    ds_read_b64_tr_b16 a[184:185], v60 offset:35328
    v_exp_f32 v10, v10
    v_mfma_f32_16x16x32_bf16 v[4:7], a[168:171], a[8:11], v[4:7]
    ds_read_b64_tr_b16 a[196:197], v60 offset:35848
    ds_read_b64_tr_b16 a[198:199], v61 offset:35848
    v_mul_f32 v11, s57, v11
    v_mfma_f32_16x16x32_bf16 v[4:7], a[164:167], a[4:7], v[4:7]
    s_add_u32 m0, s54, 16384
    v_exp_f32 v11, v11
    v_mfma_f32_16x16x32_bf16 v[4:7], a[160:163], a[0:3], v[4:7]
    ds_read_b64_tr_b16 a[200:201], v60 offset:36352
    v_mul_f32 v12, s57, v12
    v_cvt_pk_bf16_f32 v21, v10, v11
    v_mfma_f32_16x16x32_bf16 v[64:67], a[208:211], v[16:19], v[64:67]
    buffer_load_dwordx4 v49, s[20:23], s80 offen offset:0 nt lds
    v_mfma_f32_16x16x32_bf16 v[68:71], a[212:215], v[16:19], v[68:71]
    v_exp_f32 v12, v12
    v_mul_f32 v13, s57, v13
    v_mfma_f32_16x16x32_bf16 v[72:75], a[216:219], v[16:19], v[72:75]
    ds_read_b64_tr_b16 a[194:195], v61 offset:35840
    v_exp_f32 v13, v13
    v_mfma_f32_16x16x32_bf16 v[76:79], a[220:223], v[16:19], v[76:79]
    ds_read_b64_tr_b16 a[202:203], v61 offset:36352
    ds_read_b64_tr_b16 a[206:207], v61 offset:36360
    v_mul_f32 v14, s57, v14
    v_mfma_f32_16x16x32_bf16 v[80:83], a[224:227], v[16:19], v[80:83]
    v_cvt_pk_bf16_f32 v22, v12, v13
    v_exp_f32 v14, v14
    v_mfma_f32_16x16x32_bf16 v[84:87], a[228:231], v[16:19], v[84:87]
    ds_read_b64_tr_b16 a[204:205], v60 offset:36360
    v_mul_f32 v15, s57, v15
    v_mfma_f32_16x16x32_bf16 v[88:91], a[232:235], v[16:19], v[88:91]
    v_exp_f32 v15, v15
    v_mfma_f32_16x16x32_bf16 v[92:95], a[236:239], v[16:19], v[92:95]
    v_mul_f32 v0, s57, v0
    v_cvt_pk_bf16_f32 v23, v14, v15
    v_mfma_f32_16x16x32_bf16 v[8:11], a[144:147], a[16:19], 0
    v_exp_f32 v0, v0
    v_mfma_f32_16x16x32_bf16 v[8:11], a[148:151], a[20:23], v[8:11]
    ds_read_b128 a[144:147], v58 offset:32768
    v_mul_f32 v1, s57, v1
    v_mfma_f32_16x16x32_bf16 v[8:11], a[152:155], a[24:27], v[8:11]
    buffer_load_dwordx4 v49, s[24:27], s80 offen offset:1024 nt lds
    v_mul_f32 v2, s57, v2
    v_mfma_f32_16x16x32_bf16 v[8:11], a[156:159], a[28:31], v[8:11]
    ds_read_b128 a[148:151], v58 offset:33280
    v_exp_f32 v1, v1
    v_smfmac_f32_16x16x64_bf16 v[32:35], v[28:31], v[16:23], v48
    ds_read_b128 a[152:155], v58 offset:33792
    ds_read_b128 a[156:159], v58 offset:34304
    v_cvt_pk_bf16_f32 v16, v0, v1
    v_mfma_f32_16x16x32_bf16 v[12:15], a[172:175], a[28:31], 0
    v_exp_f32 v2, v2
    v_mul_f32 v3, s57, v3
    v_mfma_f32_16x16x32_bf16 v[12:15], a[168:171], a[24:27], v[12:15]
    ds_read_b128 a[172:175], v59 offset:34304
    v_exp_f32 v3, v3
    v_mfma_f32_16x16x32_bf16 v[12:15], a[164:167], a[20:23], v[12:15]
    ds_read_b128 a[164:167], v59 offset:33280
    v_mul_f32 v4, s57, v4
    v_cvt_pk_bf16_f32 v17, v2, v3
    v_mfma_f32_16x16x32_bf16 v[12:15], a[160:163], a[16:19], v[12:15]
    ds_read_b128 a[168:171], v59 offset:33792
    v_exp_f32 v4, v4
    v_mfma_f32_16x16x32_bf16 v[96:99], a[208:211], v[20:23], v[96:99]
    ds_read_b128 a[160:163], v59 offset:32768
    v_mul_f32 v5, s57, v5
    v_mfma_f32_16x16x32_bf16 v[100:103], a[212:215], v[20:23], v[100:103]
    ds_read_b64_tr_b16 a[210:211], v63 offset:34816
    v_exp_f32 v5, v5
    v_mfma_f32_16x16x32_bf16 v[104:107], a[216:219], v[20:23], v[104:107]
    ds_read_b64_tr_b16 a[208:209], v62 offset:34816
    v_cvt_pk_bf16_f32 v18, v4, v5
    v_mfma_f32_16x16x32_bf16 v[108:111], a[220:223], v[20:23], v[108:111]
    buffer_load_dwordx4 v49, s[20:23], s80 offen offset:2048 nt lds
    v_mul_f32 v6, s57, v6
    v_mfma_f32_16x16x32_bf16 v[112:115], a[224:227], v[20:23], v[112:115]
    v_exp_f32 v6, v6
    v_mul_f32 v7, s57, v7
    v_mfma_f32_16x16x32_bf16 v[116:119], a[228:231], v[20:23], v[116:119]
    ds_read_b64_tr_b16 a[214:215], v63 offset:34824
    v_exp_f32 v7, v7
    v_mfma_f32_16x16x32_bf16 v[120:123], a[232:235], v[20:23], v[120:123]
    ds_read_b64_tr_b16 a[218:219], v63 offset:35328
    v_cvt_pk_bf16_f32 v19, v6, v7
    v_mul_f32 v8, s57, v8
    v_mfma_f32_16x16x32_bf16 v[124:127], a[236:239], v[20:23], v[124:127]
    ds_read_b64_tr_b16 a[212:213], v62 offset:34824
    ds_read_b64_tr_b16 a[216:217], v62 offset:35328
    s_waitcnt lgkmcnt(10)
    v_mfma_f32_16x16x32_bf16 v[0:3], a[144:147], a[0:3], 0
    v_exp_f32 v8, v8
    v_mul_f32 v9, s57, v9
    v_mfma_f32_16x16x32_bf16 v[0:3], a[148:151], a[4:7], v[0:3]
    v_exp_f32 v9, v9
    v_mul_f32 v10, s57, v10
    v_mfma_f32_16x16x32_bf16 v[0:3], a[152:155], a[8:11], v[0:3]
    ds_read_b64_tr_b16 a[224:225], v62 offset:35840
    v_exp_f32 v10, v10
    v_mfma_f32_16x16x32_bf16 v[0:3], a[156:159], a[12:15], v[0:3]
    ds_read_b64_tr_b16 a[222:223], v63 offset:35336
    s_waitcnt lgkmcnt(8)
    v_cvt_pk_bf16_f32 v20, v8, v9
    v_mfma_f32_16x16x32_bf16 v[4:7], a[172:175], a[12:15], 0
    ds_read_b64_tr_b16 a[220:221], v62 offset:35336
    ds_read_b64_tr_b16 a[228:229], v62 offset:35848
    v_mfma_f32_16x16x32_bf16 v[4:7], a[168:171], a[8:11], v[4:7]
    buffer_load_dwordx4 v49, s[24:27], s80 offen offset:3072 nt lds
    v_mul_f32 v11, s57, v11
    v_mfma_f32_16x16x32_bf16 v[4:7], a[164:167], a[4:7], v[4:7]
    ds_read_b64_tr_b16 a[232:233], v62 offset:36352
    ds_read_b64_tr_b16 a[234:235], v63 offset:36352
    s_add_u32 s80, s80, 4096
    v_mfma_f32_16x16x32_bf16 v[4:7], a[160:163], a[0:3], v[4:7]
    s_waitcnt lgkmcnt(15)
    v_exp_f32 v11, v11
    v_mfma_f32_16x16x32_bf16 v[64:67], a[176:179], v[16:19], v[64:67]
    ds_read_b64_tr_b16 a[230:231], v63 offset:35848
    v_mul_f32 v12, s57, v12
    v_cvt_pk_bf16_f32 v21, v10, v11
    v_mfma_f32_16x16x32_bf16 v[68:71], a[180:183], v[16:19], v[68:71]
    v_exp_f32 v12, v12
    v_mul_f32 v13, s57, v13
    v_mfma_f32_16x16x32_bf16 v[72:75], a[184:187], v[16:19], v[72:75]
    ds_read_b64_tr_b16 a[238:239], v63 offset:36360
    v_exp_f32 v13, v13
    v_mfma_f32_16x16x32_bf16 v[76:79], a[188:191], v[16:19], v[76:79]
    v_mul_f32 v14, s57, v14
    v_cvt_pk_bf16_f32 v22, v12, v13
    v_mfma_f32_16x16x32_bf16 v[80:83], a[192:195], v[16:19], v[80:83]
    ds_read_b64_tr_b16 a[236:237], v62 offset:36360
    v_exp_f32 v14, v14
    v_mfma_f32_16x16x32_bf16 v[84:87], a[196:199], v[16:19], v[84:87]
    ds_read_b64_tr_b16 a[226:227], v63 offset:35840
    v_mul_f32 v15, s57, v15
    v_mul_f32 v0, s57, v0
    v_mfma_f32_16x16x32_bf16 v[88:91], a[200:203], v[16:19], v[88:91]
    s_add_u32 m0, s54, 20480
    v_exp_f32 v15, v15
    v_mfma_f32_16x16x32_bf16 v[92:95], a[204:207], v[16:19], v[92:95]
    buffer_load_dwordx4 v49, s[20:23], s80 offen offset:0 nt lds
    v_cvt_pk_bf16_f32 v23, v14, v15
    v_mfma_f32_16x16x32_bf16 v[8:11], a[144:147], a[16:19], 0
    v_exp_f32 v0, v0
    v_mfma_f32_16x16x32_bf16 v[8:11], a[148:151], a[20:23], v[8:11]
    ds_read_b128 a[144:147], v56 offset:0
    ds_read_b128 a[148:151], v56 offset:512
    v_mul_f32 v1, s57, v1
    v_mfma_f32_16x16x32_bf16 v[8:11], a[152:155], a[24:27], v[8:11]
    v_exp_f32 v1, v1
    v_mul_f32 v2, s57, v2
    v_mfma_f32_16x16x32_bf16 v[8:11], a[156:159], a[28:31], v[8:11]
    ds_read_b128 a[156:159], v56 offset:1536
    v_exp_f32 v2, v2
    v_smfmac_f32_16x16x64_bf16 v[32:35], v[28:31], v[16:23], v48
    v_cvt_pk_bf16_f32 v16, v0, v1
    v_mul_f32 v3, s57, v3
    v_mul_f32 v4, s57, v4
    v_mfma_f32_16x16x32_bf16 v[12:15], a[172:175], a[28:31], 0
    s_waitcnt vmcnt(9)
    v_exp_f32 v4, v4
    v_mfma_f32_16x16x32_bf16 v[12:15], a[168:171], a[24:27], v[12:15]
    ds_read_b128 a[32:35], v50 offset:8192
    v_exp_f32 v3, v3
    v_mfma_f32_16x16x32_bf16 v[12:15], a[164:167], a[20:23], v[12:15]
    ds_read_b128 a[172:175], v57 offset:1536
    ds_read_b128 a[40:43], v50 offset:9216
    v_cvt_pk_bf16_f32 v17, v2, v3
    v_mfma_f32_16x16x32_bf16 v[12:15], a[160:163], a[16:19], v[12:15]
    ds_read_b128 a[152:155], v56 offset:1024
    ds_read_b128 a[36:39], v50 offset:8704
    ds_read_b128 a[44:47], v50 offset:9728
    v_mfma_f32_16x16x32_bf16 v[96:99], a[176:179], v[20:23], v[96:99]
    buffer_load_dwordx4 v49, s[24:27], s80 offen offset:1024 nt lds
    v_mul_f32 v5, s57, v5
    v_mfma_f32_16x16x32_bf16 v[100:103], a[180:183], v[20:23], v[100:103]
    v_exp_f32 v5, v5
    v_mul_f32 v6, s57, v6
    v_mfma_f32_16x16x32_bf16 v[104:107], a[184:187], v[20:23], v[104:107]
    v_cvt_pk_bf16_f32 v18, v4, v5
    v_exp_f32 v6, v6
    v_mfma_f32_16x16x32_bf16 v[108:111], a[188:191], v[20:23], v[108:111]
    ds_read_b128 a[168:171], v57 offset:1024
    ds_read_b128 a[164:167], v57 offset:512
    ds_read_b64_tr_b16 a[178:179], v61 offset:2048
    v_mfma_f32_16x16x32_bf16 v[112:115], a[192:195], v[20:23], v[112:115]
    ds_read_b128 a[160:163], v57 offset:0
    ds_read_b64_tr_b16 a[180:181], v60 offset:2056
    v_mul_f32 v7, s57, v7
    v_mfma_f32_16x16x32_bf16 v[116:119], a[196:199], v[20:23], v[116:119]
    ds_read_b64_tr_b16 a[182:183], v61 offset:2056
    v_exp_f32 v7, v7
    v_mfma_f32_16x16x32_bf16 v[120:123], a[200:203], v[20:23], v[120:123]
    ds_read_b64_tr_b16 a[192:193], v60 offset:3072
    v_cvt_pk_bf16_f32 v19, v6, v7
    v_mul_f32 v8, s57, v8
    v_mfma_f32_16x16x32_bf16 v[124:127], a[204:207], v[20:23], v[124:127]
    ds_read_b64_tr_b16 a[194:195], v61 offset:3072
    s_waitcnt lgkmcnt(10)
    s_waitcnt lgkmcnt(8)
    v_mfma_f32_16x16x32_bf16 v[0:3], a[144:147], a[32:35], 0
    ds_read_b64_tr_b16 a[176:177], v60 offset:2048
    ds_read_b64_tr_b16 a[188:189], v60 offset:2568
    ds_read_b64_tr_b16 a[198:199], v61 offset:3080
    v_mfma_f32_16x16x32_bf16 v[0:3], a[148:151], a[36:39], v[0:3]
    v_exp_f32 v8, v8
    v_mul_f32 v9, s57, v9
    v_mfma_f32_16x16x32_bf16 v[0:3], a[152:155], a[40:43], v[0:3]
    buffer_load_dwordx4 v49, s[20:23], s80 offen offset:2048 nt lds
    v_mul_f32 v10, s57, v10
    v_mfma_f32_16x16x32_bf16 v[0:3], a[156:159], a[44:47], v[0:3]
    s_waitcnt lgkmcnt(7)
    v_exp_f32 v9, v9
    v_mfma_f32_16x16x32_bf16 v[4:7], a[172:175], a[44:47], 0
    s_waitcnt vmcnt(7)
    v_cvt_pk_bf16_f32 v20, v8, v9
    v_mul_f32 v11, s57, v11
    v_mfma_f32_16x16x32_bf16 v[4:7], a[168:171], a[40:43], v[4:7]
    ds_read_b64_tr_b16 a[202:203], v61 offset:3584
    v_exp_f32 v11, v11
    v_mfma_f32_16x16x32_bf16 v[4:7], a[164:167], a[36:39], v[4:7]
    ds_read_b128 a[52:55], v50 offset:12800
    ds_read_b128 a[60:63], v50 offset:13824
    v_mul_f32 v12, s57, v12
    v_mfma_f32_16x16x32_bf16 v[4:7], a[160:163], a[32:35], v[4:7]
    s_waitcnt lgkmcnt(15)
    v_exp_f32 v10, v10
    v_mfma_f32_16x16x32_bf16 v[64:67], a[208:211], v[16:19], v[64:67]
    ds_read_b128 a[48:51], v50 offset:12288
    ds_read_b128 a[56:59], v50 offset:13312
    v_mfma_f32_16x16x32_bf16 v[68:71], a[212:215], v[16:19], v[68:71]
    v_exp_f32 v12, v12
    v_mul_f32 v13, s57, v13
    v_mfma_f32_16x16x32_bf16 v[72:75], a[216:219], v[16:19], v[72:75]
    ds_read_b64_tr_b16 a[206:207], v61 offset:3592
    v_cvt_pk_bf16_f32 v21, v10, v11
    v_mul_f32 v14, s57, v14
    v_mfma_f32_16x16x32_bf16 v[76:79], a[220:223], v[16:19], v[76:79]
    ds_read_b64_tr_b16 a[200:201], v60 offset:3584
    v_exp_f32 v13, v13
    v_mfma_f32_16x16x32_bf16 v[80:83], a[224:227], v[16:19], v[80:83]
    buffer_load_dwordx4 v49, s[24:27], s80 offen offset:3072 nt lds
    v_cvt_pk_bf16_f32 v22, v12, v13
    v_mfma_f32_16x16x32_bf16 v[84:87], a[228:231], v[16:19], v[84:87]
    v_exp_f32 v14, v14
    v_mul_f32 v15, s57, v15
    v_mfma_f32_16x16x32_bf16 v[88:91], a[232:235], v[16:19], v[88:91]
    v_exp_f32 v15, v15
    v_mul_f32 v0, s57, v0
    v_mfma_f32_16x16x32_bf16 v[92:95], a[236:239], v[16:19], v[92:95]
    ds_read_b64_tr_b16 a[196:197], v60 offset:3080
    s_waitcnt lgkmcnt(3)
    v_cvt_pk_bf16_f32 v23, v14, v15
    v_mfma_f32_16x16x32_bf16 v[8:11], a[144:147], a[48:51], 0
    ds_read_b64_tr_b16 a[186:187], v61 offset:2560
    ds_read_b64_tr_b16 a[190:191], v61 offset:2568
    v_mul_f32 v1, s57, v1
    v_mfma_f32_16x16x32_bf16 v[8:11], a[148:151], a[52:55], v[8:11]
    ds_read_b64_tr_b16 a[204:205], v60 offset:3592
    ds_read_b128 a[144:147], v58 offset:0
    ds_read_b128 a[148:151], v58 offset:512
    v_mfma_f32_16x16x32_bf16 v[8:11], a[152:155], a[56:59], v[8:11]
    ds_read_b128 a[152:155], v58 offset:1024
    v_exp_f32 v1, v1
    v_mfma_f32_16x16x32_bf16 v[8:11], a[156:159], a[60:63], v[8:11]
    v_exp_f32 v0, v0
    v_mul_f32 v2, s57, v2
    v_smfmac_f32_16x16x64_bf16 v[32:35], v[28:31], v[16:23], v48
    v_cvt_pk_bf16_f32 v16, v0, v1
    v_exp_f32 v2, v2
    v_mfma_f32_16x16x32_bf16 v[12:15], a[172:175], a[60:63], 0
    ds_read_b128 a[156:159], v58 offset:1536
    s_add_u32 m0, s54, 8192
    v_mul_f32 v3, s57, v3
    v_mfma_f32_16x16x32_bf16 v[12:15], a[168:171], a[56:59], v[12:15]
    buffer_load_dwordx4 v49, s[20:23], s81 offen offset:0 nt lds
    v_mul_f32 v4, s57, v4
    v_mfma_f32_16x16x32_bf16 v[12:15], a[164:167], a[52:55], v[12:15]
    ds_read_b128 a[168:171], v59 offset:1024
    v_exp_f32 v3, v3
    v_mfma_f32_16x16x32_bf16 v[12:15], a[160:163], a[48:51], v[12:15]
    ds_read_b64_tr_b16 a[184:185], v60 offset:2560
    v_exp_f32 v4, v4
    v_mfma_f32_16x16x32_bf16 v[96:99], a[208:211], v[20:23], v[96:99]
    ds_read_b128 a[172:175], v59 offset:1536
    v_cvt_pk_bf16_f32 v17, v2, v3
    v_mul_f32 v5, s57, v5
    v_mfma_f32_16x16x32_bf16 v[100:103], a[212:215], v[20:23], v[100:103]
    ds_read_b128 a[164:167], v59 offset:512
    v_exp_f32 v5, v5
    v_mfma_f32_16x16x32_bf16 v[104:107], a[216:219], v[20:23], v[104:107]
    ds_read_b64_tr_b16 a[208:209], v62 offset:2048
    v_mul_f32 v6, s57, v6
    v_cvt_pk_bf16_f32 v18, v4, v5
    v_mfma_f32_16x16x32_bf16 v[108:111], a[220:223], v[20:23], v[108:111]
    v_exp_f32 v6, v6
    v_mfma_f32_16x16x32_bf16 v[112:115], a[224:227], v[20:23], v[112:115]
    ds_read_b128 a[160:163], v59 offset:0
    ds_read_b64_tr_b16 a[212:213], v62 offset:2056
    v_mul_f32 v7, s57, v7
    v_mfma_f32_16x16x32_bf16 v[116:119], a[228:231], v[20:23], v[116:119]
    v_exp_f32 v7, v7
    v_mfma_f32_16x16x32_bf16 v[120:123], a[232:235], v[20:23], v[120:123]
    ds_read_b64_tr_b16 a[214:215], v63 offset:2056
    v_cvt_pk_bf16_f32 v19, v6, v7
    v_mul_f32 v8, s57, v8
    v_mfma_f32_16x16x32_bf16 v[124:127], a[236:239], v[20:23], v[124:127]
    buffer_load_dwordx4 v49, s[24:27], s81 offen offset:1024 nt lds
    s_waitcnt lgkmcnt(8)
    v_mfma_f32_16x16x32_bf16 v[0:3], a[144:147], a[32:35], 0
    ds_read_b64_tr_b16 a[220:221], v62 offset:2568
    v_exp_f32 v8, v8
    v_mfma_f32_16x16x32_bf16 v[0:3], a[148:151], a[36:39], v[0:3]
    ds_read_b64_tr_b16 a[210:211], v63 offset:2048
    ds_read_b64_tr_b16 a[226:227], v63 offset:3072
    v_mul_f32 v9, s57, v9
    v_mfma_f32_16x16x32_bf16 v[0:3], a[152:155], a[40:43], v[0:3]
    v_exp_f32 v9, v9
    v_mul_f32 v10, s57, v10
    v_mfma_f32_16x16x32_bf16 v[0:3], a[156:159], a[44:47], v[0:3]
    s_waitcnt lgkmcnt(5)
    v_cvt_pk_bf16_f32 v20, v8, v9
    v_mfma_f32_16x16x32_bf16 v[4:7], a[172:175], a[44:47], 0
    ds_read_b64_tr_b16 a[218:219], v63 offset:2560
    ds_read_b64_tr_b16 a[222:223], v63 offset:2568
    ds_read_b64_tr_b16 a[228:229], v62 offset:3080
    v_mfma_f32_16x16x32_bf16 v[4:7], a[168:171], a[40:43], v[4:7]
    v_exp_f32 v10, v10
    v_mul_f32 v11, s57, v11
    v_mfma_f32_16x16x32_bf16 v[4:7], a[164:167], a[36:39], v[4:7]
    ds_read_b64_tr_b16 a[232:233], v62 offset:3584
    v_exp_f32 v11, v11
    v_mfma_f32_16x16x32_bf16 v[4:7], a[160:163], a[32:35], v[4:7]
    s_waitcnt lgkmcnt(13)
    v_mul_f32 v12, s57, v12
    v_cvt_pk_bf16_f32 v21, v10, v11
    v_mfma_f32_16x16x32_bf16 v[128:131], a[176:179], v[16:19], 0
    ds_read_b64_tr_b16 a[216:217], v62 offset:2560
    v_exp_f32 v12, v12
    v_mfma_f32_16x16x32_bf16 v[132:135], a[180:183], v[16:19], 0
    buffer_load_dwordx4 v49, s[20:23], s81 offen offset:2048 nt lds
    v_mul_f32 v13, s57, v13
    v_mfma_f32_16x16x32_bf16 v[136:139], a[184:187], v[16:19], 0
    ds_read_b64_tr_b16 a[234:235], v63 offset:3584
    v_exp_f32 v13, v13
    v_mfma_f32_16x16x32_bf16 v[140:143], a[188:191], v[16:19], 0
    v_mul_f32 v14, s57, v14
    v_cvt_pk_bf16_f32 v22, v12, v13
    v_mfma_f32_16x16x32_bf16 v[144:147], a[192:195], v[16:19], 0
    v_exp_f32 v14, v14
    v_mfma_f32_16x16x32_bf16 v[148:151], a[196:199], v[16:19], 0
    ds_read_b64_tr_b16 a[230:231], v63 offset:3080
    ds_read_b64_tr_b16 a[236:237], v62 offset:3592
    v_mul_f32 v15, s57, v15
    v_mfma_f32_16x16x32_bf16 v[152:155], a[200:203], v[16:19], 0
    v_exp_f32 v15, v15
    v_mul_f32 v0, s57, v0
    v_mfma_f32_16x16x32_bf16 v[156:159], a[204:207], v[16:19], 0
    ds_read_b64_tr_b16 a[238:239], v63 offset:3592
    v_cvt_pk_bf16_f32 v23, v14, v15
    v_mfma_f32_16x16x32_bf16 v[8:11], a[144:147], a[48:51], 0
    v_exp_f32 v0, v0
    v_mfma_f32_16x16x32_bf16 v[8:11], a[148:151], a[52:55], v[8:11]
    ds_read_b64_tr_b16 a[224:225], v62 offset:3072
    ds_read_b128 a[144:147], v56 offset:32768
    v_mul_f32 v1, s57, v1
    v_mfma_f32_16x16x32_bf16 v[8:11], a[152:155], a[56:59], v[8:11]
    ds_read_b128 a[148:151], v56 offset:33280
    v_exp_f32 v1, v1
    v_mfma_f32_16x16x32_bf16 v[8:11], a[156:159], a[60:63], v[8:11]
    buffer_load_dwordx4 v49, s[24:27], s81 offen offset:3072 nt lds
    v_mul_f32 v2, s57, v2
    v_smfmac_f32_16x16x64_bf16 v[36:39], v[28:31], v[16:23], v48
    v_cvt_pk_bf16_f32 v16, v0, v1
    v_exp_f32 v2, v2
    v_mfma_f32_16x16x32_bf16 v[12:15], a[172:175], a[60:63], 0
    ds_read_b128 a[156:159], v56 offset:34304
    v_mul_f32 v3, s57, v3
    v_mfma_f32_16x16x32_bf16 v[12:15], a[168:171], a[56:59], v[12:15]
    ds_read_b128 a[152:155], v56 offset:33792
    v_exp_f32 v3, v3
    v_mfma_f32_16x16x32_bf16 v[12:15], a[164:167], a[52:55], v[12:15]
    ds_read_b128 a[172:175], v57 offset:34304
    v_mul_f32 v4, s57, v4
    v_cvt_pk_bf16_f32 v17, v2, v3
    v_mfma_f32_16x16x32_bf16 v[12:15], a[160:163], a[48:51], v[12:15]
    ds_read_b128 a[168:171], v57 offset:33792
    ds_read_b128 a[164:167], v57 offset:33280
    ds_read_b128 a[160:163], v57 offset:32768
    v_mfma_f32_16x16x32_bf16 v[160:163], a[176:179], v[20:23], 0
    v_exp_f32 v4, v4
    v_mul_f32 v5, s57, v5
    v_mfma_f32_16x16x32_bf16 v[164:167], a[180:183], v[20:23], 0
    ds_read_b64_tr_b16 a[176:177], v60 offset:34816
    v_exp_f32 v5, v5
    v_mfma_f32_16x16x32_bf16 v[168:171], a[184:187], v[20:23], 0
    ds_read_b64_tr_b16 a[182:183], v61 offset:34824
    v_mul_f32 v6, s57, v6
    v_cvt_pk_bf16_f32 v18, v4, v5
    v_mfma_f32_16x16x32_bf16 v[172:175], a[188:191], v[20:23], 0
    ds_read_b64_tr_b16 a[180:181], v60 offset:34824
    v_exp_f32 v6, v6
    v_mfma_f32_16x16x32_bf16 v[176:179], a[192:195], v[20:23], 0
    ds_read_b64_tr_b16 a[178:179], v61 offset:34816
    v_mul_f32 v7, s57, v7
    v_mfma_f32_16x16x32_bf16 v[180:183], a[196:199], v[20:23], 0
    ds_read_b64_tr_b16 a[184:185], v60 offset:35328
    v_exp_f32 v7, v7
    v_mfma_f32_16x16x32_bf16 v[184:187], a[200:203], v[20:23], 0
    ds_read_b64_tr_b16 a[188:189], v60 offset:35336
    ds_read_b64_tr_b16 a[192:193], v60 offset:35840
    v_mul_f32 v8, s57, v8
    v_mfma_f32_16x16x32_bf16 v[188:191], a[204:207], v[20:23], 0
    s_waitcnt lgkmcnt(11)
    v_cvt_pk_bf16_f32 v19, v6, v7
    v_mfma_f32_16x16x32_bf16 v[0:3], a[144:147], a[32:35], 0
    ds_read_b64_tr_b16 a[186:187], v61 offset:35328
    v_exp_f32 v8, v8
    v_mfma_f32_16x16x32_bf16 v[0:3], a[148:151], a[36:39], v[0:3]
    ds_read_b64_tr_b16 a[190:191], v61 offset:35336
    v_mul_f32 v9, s57, v9
    v_mfma_f32_16x16x32_bf16 v[0:3], a[152:155], a[40:43], v[0:3]
    ds_read_b64_tr_b16 a[198:199], v61 offset:35848
    v_exp_f32 v9, v9
    v_mfma_f32_16x16x32_bf16 v[0:3], a[156:159], a[44:47], v[0:3]
    s_waitcnt lgkmcnt(10)
    v_mul_f32 v10, s57, v10
    v_cvt_pk_bf16_f32 v20, v8, v9
    v_mfma_f32_16x16x32_bf16 v[4:7], a[172:175], a[44:47], 0
    v_exp_f32 v10, v10
    v_mfma_f32_16x16x32_bf16 v[4:7], a[168:171], a[40:43], v[4:7]
    ds_read_b64_tr_b16 a[194:195], v61 offset:35840
    ds_read_b64_tr_b16 a[200:201], v60 offset:36352
    v_mul_f32 v11, s57, v11
    v_mfma_f32_16x16x32_bf16 v[4:7], a[164:167], a[36:39], v[4:7]
    v_exp_f32 v11, v11
    v_mul_f32 v12, s57, v12
    v_mfma_f32_16x16x32_bf16 v[4:7], a[160:163], a[32:35], v[4:7]
    ds_read_b64_tr_b16 a[202:203], v61 offset:36352
    s_waitcnt lgkmcnt(15)
    v_cvt_pk_bf16_f32 v21, v10, v11
    v_mfma_f32_16x16x32_bf16 v[128:131], a[208:211], v[16:19], v[128:131]
    v_exp_f32 v12, v12
    v_mfma_f32_16x16x32_bf16 v[132:135], a[212:215], v[16:19], v[132:135]
    ds_read_b64_tr_b16 a[204:205], v60 offset:36360
    ds_read_b64_tr_b16 a[206:207], v61 offset:36360
    v_mul_f32 v13, s57, v13
    v_mfma_f32_16x16x32_bf16 v[136:139], a[216:219], v[16:19], v[136:139]
    v_exp_f32 v13, v13
    v_mfma_f32_16x16x32_bf16 v[140:143], a[220:223], v[16:19], v[140:143]
    v_mul_f32 v14, s57, v14
    v_cvt_pk_bf16_f32 v22, v12, v13
    v_mfma_f32_16x16x32_bf16 v[144:147], a[224:227], v[16:19], v[144:147]
    v_exp_f32 v14, v14
    v_mfma_f32_16x16x32_bf16 v[148:151], a[228:231], v[16:19], v[148:151]
    ds_read_b64_tr_b16 a[196:197], v60 offset:35848
    v_mul_f32 v15, s57, v15
    v_mfma_f32_16x16x32_bf16 v[152:155], a[232:235], v[16:19], v[152:155]
    v_exp_f32 v15, v15
    v_mfma_f32_16x16x32_bf16 v[156:159], a[236:239], v[16:19], v[156:159]
    v_mul_f32 v0, s57, v0
    v_cvt_pk_bf16_f32 v23, v14, v15
    v_mfma_f32_16x16x32_bf16 v[8:11], a[144:147], a[48:51], 0
    v_exp_f32 v0, v0
    v_mfma_f32_16x16x32_bf16 v[8:11], a[148:151], a[52:55], v[8:11]
    ds_read_b128 a[144:147], v58 offset:32768
    v_mul_f32 v1, s57, v1
    v_mfma_f32_16x16x32_bf16 v[8:11], a[152:155], a[56:59], v[8:11]
    ds_read_b128 a[148:151], v58 offset:33280
    v_exp_f32 v1, v1
    v_mfma_f32_16x16x32_bf16 v[8:11], a[156:159], a[60:63], v[8:11]
    ds_read_b128 a[152:155], v58 offset:33792
    v_mul_f32 v2, s57, v2
    v_smfmac_f32_16x16x64_bf16 v[36:39], v[28:31], v[16:23], v48
    v_cvt_pk_bf16_f32 v16, v0, v1
    v_exp_f32 v2, v2
    v_mfma_f32_16x16x32_bf16 v[12:15], a[172:175], a[60:63], 0
    ds_read_b128 a[156:159], v58 offset:34304
    v_mul_f32 v3, s57, v3
    v_mfma_f32_16x16x32_bf16 v[12:15], a[168:171], a[56:59], v[12:15]
    ds_read_b128 a[172:175], v59 offset:34304
    v_exp_f32 v3, v3
    v_mfma_f32_16x16x32_bf16 v[12:15], a[164:167], a[52:55], v[12:15]
    ds_read_b128 a[168:171], v59 offset:33792
    v_mul_f32 v4, s57, v4
    v_cvt_pk_bf16_f32 v17, v2, v3
    v_mfma_f32_16x16x32_bf16 v[12:15], a[160:163], a[48:51], v[12:15]
    ds_read_b128 a[164:167], v59 offset:33280
    v_exp_f32 v4, v4
    v_mfma_f32_16x16x32_bf16 v[160:163], a[208:211], v[20:23], v[160:163]
    ds_read_b128 a[160:163], v59 offset:32768
    v_mul_f32 v5, s57, v5
    v_mfma_f32_16x16x32_bf16 v[164:167], a[212:215], v[20:23], v[164:167]
    buffer_load_dword v55, v54, s[32:35], s71 offen
    v_mfma_f32_16x16x32_bf16 v[168:171], a[216:219], v[20:23], v[168:171]
    v_exp_f32 v5, v5
    v_mul_f32 v6, s57, v6
    v_mfma_f32_16x16x32_bf16 v[172:175], a[220:223], v[20:23], v[172:175]
    ds_read_b64_tr_b16 a[208:209], v62 offset:34816
    v_exp_f32 v6, v6
    v_mfma_f32_16x16x32_bf16 v[176:179], a[224:227], v[20:23], v[176:179]
    ds_read_b64_tr_b16 a[214:215], v63 offset:34824
    v_cvt_pk_bf16_f32 v18, v4, v5
    v_mul_f32 v7, s57, v7
    v_mfma_f32_16x16x32_bf16 v[180:183], a[228:231], v[20:23], v[180:183]
    ds_read_b64_tr_b16 a[218:219], v63 offset:35328
    v_exp_f32 v7, v7
    v_mfma_f32_16x16x32_bf16 v[184:187], a[232:235], v[20:23], v[184:187]
    v_cvt_pk_bf16_f32 v19, v6, v7
    v_mul_f32 v8, s57, v8
    v_mfma_f32_16x16x32_bf16 v[188:191], a[236:239], v[20:23], v[188:191]
    ds_read_b64_tr_b16 a[212:213], v62 offset:34824
    ds_read_b64_tr_b16 a[216:217], v62 offset:35328
    s_waitcnt lgkmcnt(9)
    v_mfma_f32_16x16x32_bf16 v[0:3], a[144:147], a[32:35], 0
    v_exp_f32 v8, v8
    v_mul_f32 v9, s57, v9
    v_mfma_f32_16x16x32_bf16 v[0:3], a[148:151], a[36:39], v[0:3]
    ds_read_b64_tr_b16 a[220:221], v62 offset:35336
    ds_read_b64_tr_b16 a[222:223], v63 offset:35336
    v_mfma_f32_16x16x32_bf16 v[0:3], a[152:155], a[40:43], v[0:3]
    ds_read_b64_tr_b16 a[226:227], v63 offset:35840
    v_exp_f32 v9, v9
    v_mfma_f32_16x16x32_bf16 v[0:3], a[156:159], a[44:47], v[0:3]
    s_waitcnt lgkmcnt(8)
    v_mul_f32 v10, s57, v10
    v_cvt_pk_bf16_f32 v20, v8, v9
    v_mfma_f32_16x16x32_bf16 v[4:7], a[172:175], a[44:47], 0
    ds_read_b64_tr_b16 a[224:225], v62 offset:35840
    v_exp_f32 v10, v10
    v_mfma_f32_16x16x32_bf16 v[4:7], a[168:171], a[40:43], v[4:7]
    ds_read_b64_tr_b16 a[228:229], v62 offset:35848
    ds_read_b64_tr_b16 a[230:231], v63 offset:35848
    v_mul_f32 v11, s57, v11
    v_mfma_f32_16x16x32_bf16 v[4:7], a[164:167], a[36:39], v[4:7]
    ds_read_b64_tr_b16 a[232:233], v62 offset:36352
    v_exp_f32 v11, v11
    v_mfma_f32_16x16x32_bf16 v[4:7], a[160:163], a[32:35], v[4:7]
    s_waitcnt lgkmcnt(15)
    v_mul_f32 v12, s57, v12
    v_cvt_pk_bf16_f32 v21, v10, v11
    v_mfma_f32_16x16x32_bf16 v[128:131], a[176:179], v[16:19], v[128:131]
    ds_read_b64_tr_b16 a[210:211], v63 offset:34816
    v_exp_f32 v12, v12
    v_mfma_f32_16x16x32_bf16 v[132:135], a[180:183], v[16:19], v[132:135]
    ds_read_b64_tr_b16 a[234:235], v63 offset:36352
    v_mul_f32 v13, s57, v13
    v_mfma_f32_16x16x32_bf16 v[136:139], a[184:187], v[16:19], v[136:139]
    ds_read_b64_tr_b16 a[238:239], v63 offset:36360
    v_exp_f32 v13, v13
    v_mfma_f32_16x16x32_bf16 v[140:143], a[188:191], v[16:19], v[140:143]
    ds_read_b64_tr_b16 a[236:237], v62 offset:36360
    v_mul_f32 v14, s57, v14
    v_cvt_pk_bf16_f32 v22, v12, v13
    v_mfma_f32_16x16x32_bf16 v[144:147], a[192:195], v[16:19], v[144:147]
    v_exp_f32 v14, v14
    v_mfma_f32_16x16x32_bf16 v[148:151], a[196:199], v[16:19], v[148:151]
    v_mul_f32 v15, s57, v15
    v_mul_f32 v0, s57, v0
    v_mfma_f32_16x16x32_bf16 v[152:155], a[200:203], v[16:19], v[152:155]
    v_exp_f32 v15, v15
    v_mfma_f32_16x16x32_bf16 v[156:159], a[204:207], v[16:19], v[156:159]
    v_cvt_pk_bf16_f32 v23, v14, v15
    v_mul_f32 v1, s57, v1
    v_mfma_f32_16x16x32_bf16 v[8:11], a[144:147], a[48:51], 0
    v_exp_f32 v0, v0
    v_mfma_f32_16x16x32_bf16 v[8:11], a[148:151], a[52:55], v[8:11]
    ds_read_b128 a[144:147], v56 offset:0
    ds_read_b128 a[148:151], v56 offset:512
    v_mfma_f32_16x16x32_bf16 v[8:11], a[152:155], a[56:59], v[8:11]
    ds_read_b128 a[152:155], v56 offset:1024
    v_exp_f32 v1, v1
    v_mfma_f32_16x16x32_bf16 v[8:11], a[156:159], a[60:63], v[8:11]
    ds_read_b128 a[156:159], v56 offset:1536
    v_mul_f32 v2, s57, v2
    v_mul_f32 v3, s57, v3
    v_smfmac_f32_16x16x64_bf16 v[36:39], v[28:31], v[16:23], v48
    v_cvt_pk_bf16_f32 v16, v0, v1
    v_exp_f32 v2, v2
    v_mfma_f32_16x16x32_bf16 v[12:15], a[172:175], a[60:63], 0
    s_waitcnt vmcnt(9)
    v_exp_f32 v3, v3
    v_mfma_f32_16x16x32_bf16 v[12:15], a[168:171], a[56:59], v[12:15]
    ds_read_b128 a[172:175], v57 offset:1536
    ds_read_b128 a[64:67], v50 offset:16384
    ds_read_b128 a[68:71], v50 offset:16896
    v_mfma_f32_16x16x32_bf16 v[12:15], a[164:167], a[52:55], v[12:15]
    ds_read_b128 a[72:75], v50 offset:17408
    v_mul_f32 v4, s57, v4
    v_cvt_pk_bf16_f32 v17, v2, v3
    v_mfma_f32_16x16x32_bf16 v[12:15], a[160:163], a[48:51], v[12:15]
    ds_read_b128 a[76:79], v50 offset:17920
    v_exp_f32 v4, v4
    v_mfma_f32_16x16x32_bf16 v[160:163], a[176:179], v[20:23], v[160:163]
    ds_read_b128 a[168:171], v57 offset:1024
    v_mul_f32 v5, s57, v5
    v_mfma_f32_16x16x32_bf16 v[164:167], a[180:183], v[20:23], v[164:167]
    ds_read_b64_tr_b16 a[178:179], v61 offset:2048
    v_exp_f32 v5, v5
    v_mfma_f32_16x16x32_bf16 v[168:171], a[184:187], v[20:23], v[168:171]
    ds_read_b64_tr_b16 a[176:177], v60 offset:2048
    v_mul_f32 v6, s57, v6
    v_mfma_f32_16x16x32_bf16 v[172:175], a[188:191], v[20:23], v[172:175]
    ds_read_b128 a[164:167], v57 offset:512
    ds_read_b128 a[160:163], v57 offset:0
    v_cvt_pk_bf16_f32 v18, v4, v5
    v_mfma_f32_16x16x32_bf16 v[176:179], a[192:195], v[20:23], v[176:179]
    v_exp_f32 v6, v6
    v_mul_f32 v7, s57, v7
    v_mfma_f32_16x16x32_bf16 v[180:183], a[196:199], v[20:23], v[180:183]
    ds_read_b64_tr_b16 a[182:183], v61 offset:2056
    v_exp_f32 v7, v7
    v_mfma_f32_16x16x32_bf16 v[184:187], a[200:203], v[20:23], v[184:187]
    v_cvt_pk_bf16_f32 v19, v6, v7
    v_mul_f32 v8, s57, v8
    v_mfma_f32_16x16x32_bf16 v[188:191], a[204:207], v[20:23], v[188:191]
    ds_read_b64_tr_b16 a[188:189], v60 offset:2568
    s_waitcnt lgkmcnt(12)
    s_waitcnt lgkmcnt(7)
    v_mfma_f32_16x16x32_bf16 v[0:3], a[144:147], a[64:67], 0
    v_exp_f32 v8, v8
    v_mfma_f32_16x16x32_bf16 v[0:3], a[148:151], a[68:71], v[0:3]
    ds_read_b64_tr_b16 a[184:185], v60 offset:2560
    ds_read_b64_tr_b16 a[190:191], v61 offset:2568
    v_mul_f32 v9, s57, v9
    v_mfma_f32_16x16x32_bf16 v[0:3], a[152:155], a[72:75], v[0:3]
    ds_read_b64_tr_b16 a[180:181], v60 offset:2056
    v_exp_f32 v9, v9
    v_mfma_f32_16x16x32_bf16 v[0:3], a[156:159], a[76:79], v[0:3]
    s_waitcnt lgkmcnt(5)
    v_mul_f32 v10, s57, v10
    v_cvt_pk_bf16_f32 v20, v8, v9
    v_mfma_f32_16x16x32_bf16 v[4:7], a[172:175], a[76:79], 0
    s_waitcnt vmcnt(5)
    v_exp_f32 v10, v10
    v_mfma_f32_16x16x32_bf16 v[4:7], a[168:171], a[72:75], v[4:7]
    ds_read_b64_tr_b16 a[194:195], v61 offset:3072
    ds_read_b128 a[80:83], v50 offset:20480
    v_mul_f32 v11, s57, v11
    v_mfma_f32_16x16x32_bf16 v[4:7], a[164:167], a[68:71], v[4:7]
    ds_read_b64_tr_b16 a[196:197], v60 offset:3080
    v_exp_f32 v11, v11
    v_mfma_f32_16x16x32_bf16 v[4:7], a[160:163], a[64:67], v[4:7]
    s_waitcnt lgkmcnt(15)
    v_mul_f32 v12, s57, v12
    v_cvt_pk_bf16_f32 v21, v10, v11
    v_mfma_f32_16x16x32_bf16 v[128:131], a[208:211], v[16:19], v[128:131]
    ds_read_b128 a[84:87], v50 offset:20992
    ds_read_b128 a[88:91], v50 offset:21504
    ds_read_b128 a[92:95], v50 offset:22016
    v_mfma_f32_16x16x32_bf16 v[132:135], a[212:215], v[16:19], v[132:135]
    v_exp_f32 v12, v12
    v_mul_f32 v13, s57, v13
    v_mfma_f32_16x16x32_bf16 v[136:139], a[216:219], v[16:19], v[136:139]
    v_exp_f32 v13, v13
    v_mul_f32 v14, s57, v14
    v_mfma_f32_16x16x32_bf16 v[140:143], a[220:223], v[16:19], v[140:143]
    ds_read_b64_tr_b16 a[198:199], v61 offset:3080
    ds_read_b64_tr_b16 a[200:201], v60 offset:3584
    v_cvt_pk_bf16_f32 v22, v12, v13
    v_mfma_f32_16x16x32_bf16 v[144:147], a[224:227], v[16:19], v[144:147]
    ds_read_b64_tr_b16 a[206:207], v61 offset:3592
    v_exp_f32 v14, v14
    v_mfma_f32_16x16x32_bf16 v[148:151], a[228:231], v[16:19], v[148:151]
    ds_read_b64_tr_b16 a[202:203], v61 offset:3584
    v_mul_f32 v15, s57, v15
    v_mfma_f32_16x16x32_bf16 v[152:155], a[232:235], v[16:19], v[152:155]
    v_exp_f32 v15, v15
    v_mul_f32 v0, s57, v0
    v_mfma_f32_16x16x32_bf16 v[156:159], a[236:239], v[16:19], v[156:159]
    s_waitcnt lgkmcnt(4)
    v_cvt_pk_bf16_f32 v23, v14, v15
    v_mfma_f32_16x16x32_bf16 v[8:11], a[144:147], a[80:83], 0
    ds_read_b64_tr_b16 a[192:193], v60 offset:3072
    v_exp_f32 v0, v0
    v_mfma_f32_16x16x32_bf16 v[8:11], a[148:151], a[84:87], v[8:11]
    ds_read_b64_tr_b16 a[204:205], v60 offset:3592
    v_mul_f32 v1, s57, v1
    v_mfma_f32_16x16x32_bf16 v[8:11], a[152:155], a[88:91], v[8:11]
    v_exp_f32 v1, v1
    v_mfma_f32_16x16x32_bf16 v[8:11], a[156:159], a[92:95], v[8:11]
    ds_read_b64_tr_b16 a[186:187], v61 offset:2560
    v_mul_f32 v2, s57, v2
    v_smfmac_f32_16x16x64_bf16 v[36:39], v[28:31], v[16:23], v48
    v_cvt_pk_bf16_f32 v16, v0, v1
    v_exp_f32 v2, v2
    v_mfma_f32_16x16x32_bf16 v[12:15], a[172:175], a[92:95], 0
    s_waitcnt vmcnt(1)
    ds_read_b128 a[100:103], v50 offset:8704
    v_mul_f32 v3, s57, v3
    v_mfma_f32_16x16x32_bf16 v[12:15], a[168:171], a[88:91], v[12:15]
    ds_read_b128 a[96:99], v50 offset:8192
    v_exp_f32 v3, v3
    v_mfma_f32_16x16x32_bf16 v[12:15], a[164:167], a[84:87], v[12:15]
    v_mul_f32 v4, s57, v4
    v_cvt_pk_bf16_f32 v17, v2, v3
    v_mfma_f32_16x16x32_bf16 v[12:15], a[160:163], a[80:83], v[12:15]
    ds_read_b128 a[108:111], v50 offset:9728
    v_exp_f32 v4, v4
    v_mfma_f32_16x16x32_bf16 v[160:163], a[208:211], v[20:23], v[160:163]
    ds_read_b128 a[104:107], v50 offset:9216
    v_mul_f32 v5, s57, v5
    v_mfma_f32_16x16x32_bf16 v[164:167], a[212:215], v[20:23], v[164:167]
    v_exp_f32 v5, v5
    v_mfma_f32_16x16x32_bf16 v[168:171], a[216:219], v[20:23], v[168:171]
    ds_read_b64_tr_b16 a[208:209], v62 offset:2048
    v_mul_f32 v6, s57, v6
    v_cvt_pk_bf16_f32 v18, v4, v5
    v_mfma_f32_16x16x32_bf16 v[172:175], a[220:223], v[20:23], v[172:175]
    ds_read_b64_tr_b16 a[210:211], v63 offset:2048
    v_exp_f32 v6, v6
    v_mfma_f32_16x16x32_bf16 v[176:179], a[224:227], v[20:23], v[176:179]
    ds_read_b64_tr_b16 a[212:213], v62 offset:2056
    ds_read_b64_tr_b16 a[214:215], v63 offset:2056
    v_mul_f32 v7, s57, v7
    v_mfma_f32_16x16x32_bf16 v[180:183], a[228:231], v[20:23], v[180:183]
    ds_read_b64_tr_b16 a[216:217], v62 offset:2560
    v_exp_f32 v7, v7
    v_mfma_f32_16x16x32_bf16 v[184:187], a[232:235], v[20:23], v[184:187]
    v_cvt_pk_bf16_f32 v19, v6, v7
    v_mul_f32 v8, s57, v8
    v_mfma_f32_16x16x32_bf16 v[188:191], a[236:239], v[20:23], v[188:191]
    ds_read_b64_tr_b16 a[218:219], v63 offset:2560
    s_waitcnt lgkmcnt(6)
    v_mfma_f32_16x16x32_bf16 v[0:3], a[144:147], a[96:99], 0
    ds_read_b64_tr_b16 a[220:221], v62 offset:2568
    v_exp_f32 v8, v8
    v_mfma_f32_16x16x32_bf16 v[0:3], a[148:151], a[100:103], v[0:3]
    ds_read_b128 a[144:147], v58 offset:0
    ds_read_b128 a[148:151], v58 offset:512
    v_mul_f32 v9, s57, v9
    v_mfma_f32_16x16x32_bf16 v[0:3], a[152:155], a[104:107], v[0:3]
    ds_read_b64_tr_b16 a[228:229], v62 offset:3080
    v_exp_f32 v9, v9
    v_mfma_f32_16x16x32_bf16 v[0:3], a[156:159], a[108:111], v[0:3]
    ds_read_b128 a[152:155], v58 offset:1024
    ds_read_b64_tr_b16 a[226:227], v63 offset:3072
    v_mul_f32 v10, s57, v10
    v_mfma_f32_16x16x32_bf16 v[4:7], a[172:175], a[108:111], 0
    ds_read_b128 a[156:159], v58 offset:1536
    v_cvt_pk_bf16_f32 v20, v8, v9
    v_mul_f32 v11, s57, v11
    v_mfma_f32_16x16x32_bf16 v[4:7], a[168:171], a[104:107], v[4:7]
    ds_read_b64_tr_b16 a[230:231], v63 offset:3080
    v_exp_f32 v10, v10
    v_mfma_f32_16x16x32_bf16 v[4:7], a[164:167], a[100:103], v[4:7]
    ds_read_b128 a[168:171], v59 offset:1024
    v_exp_f32 v11, v11
    v_mfma_f32_16x16x32_bf16 v[4:7], a[160:163], a[96:99], v[4:7]
    s_waitcnt lgkmcnt(15)
    v_mul_f32 v12, s57, v12
    v_cvt_pk_bf16_f32 v21, v10, v11
    v_mfma_f32_16x16x32_bf16 v[192:195], a[176:179], v[16:19], 0
    ds_read_b128 a[160:163], v59 offset:0
    v_exp_f32 v12, v12
    v_mfma_f32_16x16x32_bf16 v[196:199], a[180:183], v[16:19], 0
    ds_read_b64_tr_b16 a[222:223], v63 offset:2568
    ds_read_b128 a[164:167], v59 offset:512
    v_mul_f32 v13, s57, v13
    v_mfma_f32_16x16x32_bf16 v[200:203], a[184:187], v[16:19], 0
    ds_read_b128 a[172:175], v59 offset:1536
    v_exp_f32 v13, v13
    v_mfma_f32_16x16x32_bf16 v[204:207], a[188:191], v[16:19], 0
    ds_read_b64_tr_b16 a[236:237], v62 offset:3592
    v_mul_f32 v14, s57, v14
    v_mfma_f32_16x16x32_bf16 v[208:211], a[192:195], v[16:19], 0
    v_exp_f32 v14, v14
    v_mfma_f32_16x16x32_bf16 v[212:215], a[196:199], v[16:19], 0
    v_cvt_pk_bf16_f32 v22, v12, v13
    v_mul_f32 v15, s57, v15
    v_mfma_f32_16x16x32_bf16 v[216:219], a[200:203], v[16:19], 0
    v_exp_f32 v15, v15
    v_mul_f32 v0, s57, v0
    v_mfma_f32_16x16x32_bf16 v[220:223], a[204:207], v[16:19], 0
    s_waitcnt lgkmcnt(7)
    v_cvt_pk_bf16_f32 v23, v14, v15
    v_mfma_f32_16x16x32_bf16 v[8:11], a[144:147], a[64:67], 0
    ds_read_b64_tr_b16 a[232:233], v62 offset:3584
    v_exp_f32 v0, v0
    v_mfma_f32_16x16x32_bf16 v[8:11], a[148:151], a[68:71], v[8:11]
    ds_read_b64_tr_b16 a[224:225], v62 offset:3072
    v_mul_f32 v1, s57, v1
    v_mfma_f32_16x16x32_bf16 v[8:11], a[152:155], a[72:75], v[8:11]
    ds_read_b64_tr_b16 a[238:239], v63 offset:3592
    v_mul_f32 v2, s57, v2
    v_mfma_f32_16x16x32_bf16 v[8:11], a[156:159], a[76:79], v[8:11]
    v_exp_f32 v1, v1
    v_smfmac_f32_16x16x64_bf16 v[40:43], v[28:31], v[16:23], v48
    s_waitcnt lgkmcnt(4)
    v_cvt_pk_bf16_f32 v24, v0, v1
    v_mfma_f32_16x16x32_bf16 v[12:15], a[172:175], a[76:79], 0
    v_exp_f32 v2, v2
    v_mul_f32 v3, s57, v3
    v_mfma_f32_16x16x32_bf16 v[12:15], a[168:171], a[72:75], v[12:15]
    v_exp_f32 v3, v3
    v_mfma_f32_16x16x32_bf16 v[12:15], a[164:167], a[68:71], v[12:15]
    v_mul_f32 v4, s57, v4
    v_cvt_pk_bf16_f32 v25, v2, v3
    v_mfma_f32_16x16x32_bf16 v[12:15], a[160:163], a[64:67], v[12:15]
    v_exp_f32 v4, v4
    v_mfma_f32_16x16x32_bf16 v[224:227], a[176:179], v[20:23], 0
    ds_read_b64_tr_b16 a[234:235], v63 offset:3584
    v_mul_f32 v5, s57, v5
    v_mfma_f32_16x16x32_bf16 v[228:231], a[180:183], v[20:23], 0
    v_exp_f32 v5, v5
    v_mul_f32 v6, s57, v6
    v_mfma_f32_16x16x32_bf16 v[232:235], a[184:187], v[20:23], 0
    v_exp_f32 v6, v6
    v_mfma_f32_16x16x32_bf16 v[236:239], a[188:191], v[20:23], 0
    s_mov_b32 m0, s50
    v_cvt_pk_bf16_f32 v26, v4, v5
    v_mfma_f32_16x16x32_bf16 v[240:243], a[192:195], v[20:23], 0
    v_mul_f32 v7, s57, v7
    v_mul_f32 v9, s57, v9
    v_mfma_f32_16x16x32_bf16 v[244:247], a[196:199], v[20:23], 0
    v_exp_f32 v7, v7
    v_mfma_f32_16x16x32_bf16 v[248:251], a[200:203], v[20:23], 0
    v_cvt_pk_bf16_f32 v27, v6, v7
    v_mul_f32 v8, s57, v8
    v_mfma_f32_16x16x32_bf16 v[252:255], a[204:207], v[20:23], 0
    v_exp_f32 v8, v8
    v_mfma_f32_16x16x32_bf16 v[0:3], a[144:147], a[80:83], 0
    s_waitcnt lgkmcnt(0)
    s_barrier
    v_mfma_f32_16x16x32_bf16 v[0:3], a[148:151], a[84:87], v[0:3]
    v_exp_f32 v9, v9
    v_mfma_f32_16x16x32_bf16 v[0:3], a[152:155], a[88:91], v[0:3]
    buffer_load_dwordx4 v49, s[4:7], s44 offen offset:0 lds
    v_mfma_f32_16x16x32_bf16 v[0:3], a[156:159], a[92:95], v[0:3]
    v_mul_f32 v10, s57, v10
    v_cvt_pk_bf16_f32 v16, v8, v9
    v_smfmac_f32_16x16x64_bf16 v[44:47], v[28:31], v[20:27], v48
    v_exp_f32 v10, v10
    v_mfma_f32_16x16x32_bf16 v[4:7], a[172:175], a[92:95], 0
    v_mul_f32 v11, s57, v11
    v_mul_f32 v14, s57, v14
    v_mfma_f32_16x16x32_bf16 v[4:7], a[168:171], a[88:91], v[4:7]
    v_exp_f32 v11, v11
    v_mul_f32 v12, s57, v12
    v_mfma_f32_16x16x32_bf16 v[4:7], a[164:167], a[84:87], v[4:7]
    buffer_load_dwordx4 v49, s[8:11], s44 offen offset:1024 lds
    v_cvt_pk_bf16_f32 v17, v10, v11
    v_mfma_f32_16x16x32_bf16 v[4:7], a[160:163], a[80:83], v[4:7]
    v_exp_f32 v12, v12
    v_mfma_f32_16x16x32_bf16 a[112:115], a[176:179], v[24:27], 0
    ds_read_b64_tr_b16 a[176:177], v60 offset:34816
    v_mul_f32 v13, s57, v13
    v_mfma_f32_16x16x32_bf16 a[116:119], a[180:183], v[24:27], 0
    v_exp_f32 v13, v13
    v_mfma_f32_16x16x32_bf16 a[120:123], a[184:187], v[24:27], 0
    v_cvt_pk_bf16_f32 v18, v12, v13
    v_exp_f32 v14, v14
    v_mfma_f32_16x16x32_bf16 a[124:127], a[188:191], v[24:27], 0
    buffer_load_dwordx4 v49, s[12:15], s44 offen offset:2048 lds
    v_mfma_f32_16x16x32_bf16 a[128:131], a[192:195], v[24:27], 0
    ds_read_b64_tr_b16 a[180:181], v60 offset:34824
    ds_read_b64_tr_b16 a[188:189], v60 offset:35336
    v_mul_f32 v15, s57, v15
    v_mfma_f32_16x16x32_bf16 a[132:135], a[196:199], v[24:27], 0
    ds_read_b64_tr_b16 a[182:183], v61 offset:34824
    v_exp_f32 v15, v15
    v_mfma_f32_16x16x32_bf16 a[136:139], a[200:203], v[24:27], 0
    v_cvt_pk_bf16_f32 v19, v14, v15
    v_mul_f32 v0, s57, v0
    v_mul_f32 v6, s57, v6
    v_mfma_f32_16x16x32_bf16 a[140:143], a[204:207], v[24:27], 0
    v_exp_f32 v0, v0
    v_mul_f32 v1, s57, v1
    v_mfma_f32_16x16x32_bf16 v[8:11], a[144:147], a[96:99], 0
    buffer_load_dwordx4 v49, s[16:19], s44 offen offset:3072 lds
    s_add_u32 s44, s44, 8192
    v_mfma_f32_16x16x32_bf16 v[8:11], a[148:151], a[100:103], v[8:11]
    ds_read_b64_tr_b16 a[190:191], v61 offset:35336
    v_exp_f32 v1, v1
    v_mfma_f32_16x16x32_bf16 v[8:11], a[152:155], a[104:107], v[8:11]
    ds_read_b128 a[144:147], v56 offset:32768
    v_exp_f32 v6, v6
    v_mfma_f32_16x16x32_bf16 v[8:11], a[156:159], a[108:111], v[8:11]
    ds_read_b128 a[152:155], v56 offset:33792
    v_mul_f32 v2, s57, v2
    v_cvt_pk_bf16_f32 v20, v0, v1
    v_mfma_f32_16x16x32_bf16 v[12:15], a[172:175], a[108:111], 0
    s_mov_b32 m0, s51
    v_exp_f32 v2, v2
    v_mfma_f32_16x16x32_bf16 v[12:15], a[168:171], a[104:107], v[12:15]
    ds_read_b128 a[148:151], v56 offset:33280
    ds_read_b128 a[156:159], v56 offset:34304
    ds_read_b128 a[168:171], v57 offset:33792
    v_mfma_f32_16x16x32_bf16 v[12:15], a[164:167], a[100:103], v[12:15]
    buffer_load_dwordx4 v49, s[4:7], s44 offen offset:0 lds
    v_mul_f32 v3, s57, v3
    v_mfma_f32_16x16x32_bf16 v[12:15], a[160:163], a[96:99], v[12:15]
    ds_read_b64_tr_b16 a[202:203], v61 offset:36352
    s_waitcnt lgkmcnt(11)
    v_mul_f32 v4, s57, v4
    v_mfma_f32_16x16x32_bf16 v[192:195], a[208:211], v[16:19], v[192:195]
    ds_read_b64_tr_b16 a[204:205], v60 offset:36360
    v_exp_f32 v3, v3
    v_mfma_f32_16x16x32_bf16 v[196:199], a[212:215], v[16:19], v[196:199]
    v_exp_f32 v4, v4
    v_mul_f32 v5, s57, v5
    v_mfma_f32_16x16x32_bf16 v[200:203], a[216:219], v[16:19], v[200:203]
    v_cvt_pk_bf16_f32 v21, v2, v3
    v_exp_f32 v5, v5
    v_mfma_f32_16x16x32_bf16 v[204:207], a[220:223], v[16:19], v[204:207]
    buffer_load_dwordx4 v49, s[8:11], s44 offen offset:1024 lds
    v_cvt_pk_bf16_f32 v22, v4, v5
    v_mfma_f32_16x16x32_bf16 v[208:211], a[224:227], v[16:19], v[208:211]
    ds_read_b64_tr_b16 a[178:179], v61 offset:34816
    ds_read_b64_tr_b16 a[198:199], v61 offset:35848
    ds_read_b128 a[160:163], v57 offset:32768
    v_mfma_f32_16x16x32_bf16 v[212:215], a[228:231], v[16:19], v[212:215]
    ds_read_b128 a[172:175], v57 offset:34304
    ds_read_b128 a[164:167], v57 offset:33280
    v_mul_f32 v7, s57, v7
    v_mfma_f32_16x16x32_bf16 v[216:219], a[232:235], v[16:19], v[216:219]
    v_exp_f32 v7, v7
    v_mul_f32 v8, s57, v8
    v_mfma_f32_16x16x32_bf16 v[220:223], a[236:239], v[16:19], v[220:223]
    ds_read_b64_tr_b16 a[186:187], v61 offset:35328
    ds_read_b64_tr_b16 a[200:201], v60 offset:36352
    s_waitcnt lgkmcnt(10)
    v_mfma_f32_16x16x32_bf16 v[0:3], a[144:147], a[64:67], 0
    buffer_load_dwordx4 v49, s[12:15], s44 offen offset:2048 lds
    v_cvt_pk_bf16_f32 v23, v6, v7
    v_mfma_f32_16x16x32_bf16 v[0:3], a[148:151], a[68:71], v[0:3]
    v_exp_f32 v8, v8
    v_mul_f32 v9, s57, v9
    v_mfma_f32_16x16x32_bf16 v[0:3], a[152:155], a[72:75], v[0:3]
    ds_read_b64_tr_b16 a[196:197], v60 offset:35848
    v_exp_f32 v9, v9
    v_mfma_f32_16x16x32_bf16 v[0:3], a[156:159], a[76:79], v[0:3]
    ds_read_b64_tr_b16 a[192:193], v60 offset:35840
    v_mul_f32 v10, s57, v10
    v_cvt_pk_bf16_f32 v24, v8, v9
    v_smfmac_f32_16x16x64_bf16 v[40:43], v[28:31], v[16:23], v48
    ds_read_b64_tr_b16 a[184:185], v60 offset:35328
    ds_read_b64_tr_b16 a[194:195], v61 offset:35840
    s_waitcnt lgkmcnt(6)
    v_mfma_f32_16x16x32_bf16 v[4:7], a[172:175], a[76:79], 0
    buffer_load_dwordx4 v49, s[16:19], s44 offen offset:3072 lds
    v_mul_f32 v11, s57, v11
    v_mfma_f32_16x16x32_bf16 v[4:7], a[168:171], a[72:75], v[4:7]
    s_add_u32 s44, s44, 8192
    v_exp_f32 v11, v11
    v_mfma_f32_16x16x32_bf16 v[4:7], a[164:167], a[68:71], v[4:7]
    v_exp_f32 v10, v10
    v_mul_f32 v12, s57, v12
    v_mfma_f32_16x16x32_bf16 v[4:7], a[160:163], a[64:67], v[4:7]
    v_cvt_pk_bf16_f32 v25, v10, v11
    v_exp_f32 v12, v12
    v_mfma_f32_16x16x32_bf16 v[224:227], a[208:211], v[20:23], v[224:227]
    s_mov_b32 m0, s49
    v_mul_f32 v13, s57, v13
    v_mfma_f32_16x16x32_bf16 v[228:231], a[212:215], v[20:23], v[228:231]
    buffer_load_dwordx4 v49, s[20:23], s46 offen offset:0 nt lds
    v_mfma_f32_16x16x32_bf16 v[232:235], a[216:219], v[20:23], v[232:235]
    v_exp_f32 v13, v13
    v_mfma_f32_16x16x32_bf16 v[236:239], a[220:223], v[20:23], v[236:239]
    v_mul_f32 v14, s57, v14
    v_mul_f32 v15, s57, v15
    v_mfma_f32_16x16x32_bf16 v[240:243], a[224:227], v[20:23], v[240:243]
    v_cvt_pk_bf16_f32 v26, v12, v13
    v_exp_f32 v14, v14
    v_mfma_f32_16x16x32_bf16 v[244:247], a[228:231], v[20:23], v[244:247]
    v_exp_f32 v15, v15
    v_mfma_f32_16x16x32_bf16 v[248:251], a[232:235], v[20:23], v[248:251]
    buffer_load_dwordx4 v49, s[24:27], s46 offen offset:1024 nt lds
    v_mul_f32 v0, s57, v0
    v_mfma_f32_16x16x32_bf16 v[252:255], a[236:239], v[20:23], v[252:255]
    ds_read_b64_tr_b16 a[206:207], v61 offset:36360
    v_cvt_pk_bf16_f32 v27, v14, v15
    v_mfma_f32_16x16x32_bf16 v[8:11], a[144:147], a[80:83], 0
    v_exp_f32 v0, v0
    v_mfma_f32_16x16x32_bf16 v[8:11], a[148:151], a[84:87], v[8:11]
    v_mul_f32 v1, s57, v1
    v_mul_f32 v2, s57, v2
    v_mfma_f32_16x16x32_bf16 v[8:11], a[152:155], a[88:91], v[8:11]
    v_exp_f32 v1, v1
    v_mfma_f32_16x16x32_bf16 v[8:11], a[156:159], a[92:95], v[8:11]
    buffer_load_dwordx4 v49, s[20:23], s46 offen offset:2048 nt lds
    v_cvt_pk_bf16_f32 v16, v0, v1
    v_smfmac_f32_16x16x64_bf16 v[44:47], v[28:31], v[20:27], v48
    v_mul_f32 v3, s57, v3
    v_mfma_f32_16x16x32_bf16 v[12:15], a[172:175], a[92:95], 0
    v_exp_f32 v2, v2
    v_mfma_f32_16x16x32_bf16 v[12:15], a[168:171], a[88:91], v[12:15]
    v_exp_f32 v3, v3
    v_mul_f32 v4, s57, v4
    v_mfma_f32_16x16x32_bf16 v[12:15], a[164:167], a[84:87], v[12:15]
    v_cvt_pk_bf16_f32 v17, v2, v3
    v_exp_f32 v4, v4
    v_mfma_f32_16x16x32_bf16 v[12:15], a[160:163], a[80:83], v[12:15]
    buffer_load_dwordx4 v49, s[24:27], s46 offen offset:3072 nt lds
    s_add_u32 s49, s49, 6144
    v_mfma_f32_16x16x32_bf16 a[112:115], a[208:211], v[24:27], a[112:115]
    s_add_u32 s46, s46, 4096
    v_mul_f32 v5, s57, v5
    v_mul_f32 v6, s57, v6
    v_mfma_f32_16x16x32_bf16 a[116:119], a[212:215], v[24:27], a[116:119]
    v_exp_f32 v5, v5
    v_mfma_f32_16x16x32_bf16 a[120:123], a[216:219], v[24:27], a[120:123]
    s_add_u32 m0, s54, 4096
    v_cvt_pk_bf16_f32 v18, v4, v5
    v_mfma_f32_16x16x32_bf16 a[124:127], a[220:223], v[24:27], a[124:127]
    ds_read_b64_tr_b16 a[208:209], v62 offset:34816
    v_exp_f32 v6, v6
    v_mfma_f32_16x16x32_bf16 a[128:131], a[224:227], v[24:27], a[128:131]
    buffer_load_dwordx4 v49, s[20:23], s46 offen offset:0 nt lds
    v_mul_f32 v7, s57, v7
    v_mfma_f32_16x16x32_bf16 a[132:135], a[228:231], v[24:27], a[132:135]
    ds_read_b64_tr_b16 a[214:215], v63 offset:34824
    v_exp_f32 v7, v7
    v_mfma_f32_16x16x32_bf16 a[136:139], a[232:235], v[24:27], a[136:139]
    v_cvt_pk_bf16_f32 v19, v6, v7
    v_mul_f32 v8, s57, v8
    v_mfma_f32_16x16x32_bf16 a[140:143], a[236:239], v[24:27], a[140:143]
    ds_read_b64_tr_b16 a[216:217], v62 offset:35328
    ds_read_b64_tr_b16 a[226:227], v63 offset:35840
    v_mul_f32 v9, s57, v9
    v_mfma_f32_16x16x32_bf16 v[0:3], a[144:147], a[96:99], 0
    ds_read_b64_tr_b16 a[212:213], v62 offset:34824
    v_exp_f32 v8, v8
    v_mfma_f32_16x16x32_bf16 v[0:3], a[148:151], a[100:103], v[0:3]
    buffer_load_dwordx4 v49, s[24:27], s46 offen offset:1024 nt lds
    s_add_u32 s46, s46, 2048
    v_mfma_f32_16x16x32_bf16 v[0:3], a[152:155], a[104:107], v[0:3]
    ds_read_b128 a[148:151], v58 offset:33280
    v_exp_f32 v9, v9
    v_mfma_f32_16x16x32_bf16 v[0:3], a[156:159], a[108:111], v[0:3]
    ds_read_b128 a[144:147], v58 offset:32768
    v_mul_f32 v10, s57, v10
    v_cvt_pk_bf16_f32 v20, v8, v9
    v_mfma_f32_16x16x32_bf16 v[4:7], a[172:175], a[108:111], 0
    ds_read_b128 a[152:155], v58 offset:33792
    v_exp_f32 v10, v10
    v_mfma_f32_16x16x32_bf16 v[4:7], a[168:171], a[104:107], v[4:7]
    ds_read_b128 a[156:159], v58 offset:34304
    ds_read_b128 a[172:175], v59 offset:34304
    v_mul_f32 v11, s57, v11
    v_mfma_f32_16x16x32_bf16 v[4:7], a[164:167], a[100:103], v[4:7]
    ds_read_b64_tr_b16 a[228:229], v62 offset:35848
    v_exp_f32 v11, v11
    v_mfma_f32_16x16x32_bf16 v[4:7], a[160:163], a[96:99], v[4:7]
    s_waitcnt lgkmcnt(11)
    v_mul_f32 v12, s57, v12
    v_cvt_pk_bf16_f32 v21, v10, v11
    v_mfma_f32_16x16x32_bf16 v[192:195], a[176:179], v[16:19], v[192:195]
    ds_read_b64_tr_b16 a[222:223], v63 offset:35336
    ds_read_b64_tr_b16 a[234:235], v63 offset:36352
    ds_read_b128 a[160:163], v59 offset:32768
    v_mfma_f32_16x16x32_bf16 v[196:199], a[180:183], v[16:19], v[196:199]
    ds_read_b128 a[168:171], v59 offset:33792
    ds_read_b64_tr_b16 a[232:233], v62 offset:36352
    v_mul_f32 v13, s57, v13
    v_mfma_f32_16x16x32_bf16 v[200:203], a[184:187], v[16:19], v[200:203]
    ds_read_b64_tr_b16 a[218:219], v63 offset:35328
    v_exp_f32 v12, v12
    v_mfma_f32_16x16x32_bf16 v[204:207], a[188:191], v[16:19], v[204:207]
    v_exp_f32 v13, v13
    v_mul_f32 v14, s57, v14
    v_mfma_f32_16x16x32_bf16 v[208:211], a[192:195], v[16:19], v[208:211]
    v_cvt_pk_bf16_f32 v22, v12, v13
    v_exp_f32 v14, v14
    v_mfma_f32_16x16x32_bf16 v[212:215], a[196:199], v[16:19], v[212:215]
    ds_read_b64_tr_b16 a[230:231], v63 offset:35848
    ds_read_b128 a[164:167], v59 offset:33280
    ds_read_b64_tr_b16 a[236:237], v62 offset:36360
    v_mfma_f32_16x16x32_bf16 v[216:219], a[200:203], v[16:19], v[216:219]
    ds_read_b64_tr_b16 a[224:225], v62 offset:35840
    v_mul_f32 v15, s57, v15
    v_mul_f32 v0, s57, v0
    v_mfma_f32_16x16x32_bf16 v[220:223], a[204:207], v[16:19], v[220:223]
    s_waitcnt lgkmcnt(12)
    v_exp_f32 v15, v15
    v_mfma_f32_16x16x32_bf16 v[8:11], a[144:147], a[64:67], 0
    v_cvt_pk_bf16_f32 v23, v14, v15
    v_exp_f32 v0, v0
    v_mfma_f32_16x16x32_bf16 v[8:11], a[148:151], a[68:71], v[8:11]
    ds_read_b64_tr_b16 a[220:221], v62 offset:35336
    v_mul_f32 v1, s57, v1
    v_mfma_f32_16x16x32_bf16 v[8:11], a[152:155], a[72:75], v[8:11]
    v_exp_f32 v1, v1
    v_mfma_f32_16x16x32_bf16 v[8:11], a[156:159], a[76:79], v[8:11]
    v_mul_f32 v2, s57, v2
    v_cvt_pk_bf16_f32 v24, v0, v1
    v_smfmac_f32_16x16x64_bf16 v[40:43], v[28:31], v[16:23], v48
    s_waitcnt lgkmcnt(3)
    v_mfma_f32_16x16x32_bf16 v[12:15], a[172:175], a[76:79], 0
    ds_read_b64_tr_b16 a[238:239], v63 offset:36360
    v_mul_f32 v3, s57, v3
    v_mfma_f32_16x16x32_bf16 v[12:15], a[168:171], a[72:75], v[12:15]
    v_exp_f32 v2, v2
    v_mfma_f32_16x16x32_bf16 v[12:15], a[164:167], a[68:71], v[12:15]
    v_exp_f32 v3, v3
    v_mfma_f32_16x16x32_bf16 v[12:15], a[160:163], a[64:67], v[12:15]
    v_mul_f32 v4, s57, v4
    v_cvt_pk_bf16_f32 v25, v2, v3
    v_mfma_f32_16x16x32_bf16 v[224:227], a[176:179], v[20:23], v[224:227]
    ds_read_b64_tr_b16 a[210:211], v63 offset:34816
    v_mul_f32 v5, s57, v5
    v_mfma_f32_16x16x32_bf16 v[228:231], a[180:183], v[20:23], v[228:231]
    v_mul_f32 v6, s57, v6
    v_mul_f32 v7, s57, v7
    v_mfma_f32_16x16x32_bf16 v[232:235], a[184:187], v[20:23], v[232:235]
    v_exp_f32 v5, v5
    v_mfma_f32_16x16x32_bf16 v[236:239], a[188:191], v[20:23], v[236:239]
    v_exp_f32 v6, v6
    v_mfma_f32_16x16x32_bf16 v[240:243], a[192:195], v[20:23], v[240:243]
    v_exp_f32 v4, v4
    v_mfma_f32_16x16x32_bf16 v[244:247], a[196:199], v[20:23], v[244:247]
    v_cvt_pk_bf16_f32 v26, v4, v5
    v_exp_f32 v7, v7
    v_mfma_f32_16x16x32_bf16 v[248:251], a[200:203], v[20:23], v[248:251]
    v_cvt_pk_bf16_f32 v27, v6, v7
    v_mul_f32 v8, s57, v8
    v_mfma_f32_16x16x32_bf16 v[252:255], a[204:207], v[20:23], v[252:255]
    v_exp_f32 v8, v8
    v_mfma_f32_16x16x32_bf16 v[0:3], a[144:147], a[80:83], 0
    s_waitcnt vmcnt(6)
    s_waitcnt lgkmcnt(0)
    s_barrier
    v_mfma_f32_16x16x32_bf16 v[0:3], a[148:151], a[84:87], v[0:3]
    s_mov_b32 m0, s52
    v_mul_f32 v9, s57, v9
    v_mfma_f32_16x16x32_bf16 v[0:3], a[152:155], a[88:91], v[0:3]
    buffer_load_dwordx4 v49, s[4:7], s44 offen offset:0 lds
    v_mfma_f32_16x16x32_bf16 v[0:3], a[156:159], a[92:95], v[0:3]
    v_exp_f32 v9, v9
    v_smfmac_f32_16x16x64_bf16 v[44:47], v[28:31], v[20:27], v48
    v_mul_f32 v10, s57, v10
    v_cvt_pk_bf16_f32 v16, v8, v9
    v_mfma_f32_16x16x32_bf16 v[4:7], a[172:175], a[92:95], 0
    v_exp_f32 v10, v10
    v_mul_f32 v11, s57, v11
    v_mfma_f32_16x16x32_bf16 v[4:7], a[168:171], a[88:91], v[4:7]
    v_exp_f32 v11, v11
    v_mfma_f32_16x16x32_bf16 v[4:7], a[164:167], a[84:87], v[4:7]
    buffer_load_dwordx4 v49, s[8:11], s44 offen offset:1024 lds
    v_mul_f32 v12, s57, v12
    v_mfma_f32_16x16x32_bf16 v[4:7], a[160:163], a[80:83], v[4:7]
    v_cvt_pk_bf16_f32 v17, v10, v11
    v_exp_f32 v12, v12
    v_mfma_f32_16x16x32_bf16 a[112:115], a[176:179], v[24:27], a[112:115]
    ds_read_b64_tr_b16 a[178:179], v61 offset:2048
    v_mul_f32 v13, s57, v13
    v_mul_f32 v14, s57, v14
    v_mfma_f32_16x16x32_bf16 a[116:119], a[180:183], v[24:27], a[116:119]
    ds_read_b64_tr_b16 a[176:177], v60 offset:2048
    v_exp_f32 v13, v13
    v_mfma_f32_16x16x32_bf16 a[120:123], a[184:187], v[24:27], a[120:123]
    v_cvt_pk_bf16_f32 v18, v12, v13
    v_exp_f32 v14, v14
    v_mfma_f32_16x16x32_bf16 a[124:127], a[188:191], v[24:27], a[124:127]
    buffer_load_dwordx4 v49, s[12:15], s44 offen offset:2048 lds
    v_mul_f32 v15, s57, v15
    v_mfma_f32_16x16x32_bf16 a[128:131], a[192:195], v[24:27], a[128:131]
    ds_read_b64_tr_b16 a[180:181], v60 offset:2056
    ds_read_b64_tr_b16 a[190:191], v61 offset:2568
    v_mul_f32 v0, s57, v0
    v_mfma_f32_16x16x32_bf16 a[132:135], a[196:199], v[24:27], a[132:135]
    v_exp_f32 v15, v15
    v_mul_f32 v2, s57, v2
    v_mfma_f32_16x16x32_bf16 a[136:139], a[200:203], v[24:27], a[136:139]
    v_cvt_pk_bf16_f32 v19, v14, v15
    v_exp_f32 v0, v0
    v_mfma_f32_16x16x32_bf16 a[140:143], a[204:207], v[24:27], a[140:143]
    ds_read_b64_tr_b16 a[186:187], v61 offset:2560
    v_exp_f32 v2, v2
    v_mfma_f32_16x16x32_bf16 v[8:11], a[144:147], a[96:99], 0
    buffer_load_dwordx4 v49, s[16:19], s44 offen offset:3072 lds
    s_add_u32 s44, s44, 8192
    v_mfma_f32_16x16x32_bf16 v[8:11], a[148:151], a[100:103], v[8:11]
    ds_read_b64_tr_b16 a[188:189], v60 offset:2568
    ds_read_b128 a[144:147], v56 offset:0
    v_mul_f32 v1, s57, v1
    v_mfma_f32_16x16x32_bf16 v[8:11], a[152:155], a[104:107], v[8:11]
    v_exp_f32 v1, v1
    v_mul_f32 v3, s57, v3
    v_mfma_f32_16x16x32_bf16 v[8:11], a[156:159], a[108:111], v[8:11]
    v_cvt_pk_bf16_f32 v20, v0, v1
    v_exp_f32 v3, v3
    v_mfma_f32_16x16x32_bf16 v[12:15], a[172:175], a[108:111], 0
    ds_read_b128 a[148:151], v56 offset:512
    ds_read_b128 a[152:155], v56 offset:1024
    s_mov_b32 m0, s53
    v_mfma_f32_16x16x32_bf16 v[12:15], a[168:171], a[104:107], v[12:15]
    buffer_load_dwordx4 v49, s[4:7], s44 offen offset:0 lds
    v_mul_f32 v4, s57, v4
    v_mfma_f32_16x16x32_bf16 v[12:15], a[164:167], a[100:103], v[12:15]
    ds_read_b128 a[156:159], v56 offset:1536
    ds_read_b64_tr_b16 a[196:197], v60 offset:3080
    v_cvt_pk_bf16_f32 v21, v2, v3
    v_mfma_f32_16x16x32_bf16 v[12:15], a[160:163], a[96:99], v[12:15]
    ds_read_b128 a[172:175], v57 offset:1536
    s_waitcnt lgkmcnt(12)
    v_mul_f32 v5, s57, v5
    v_mfma_f32_16x16x32_bf16 v[192:195], a[208:211], v[16:19], v[192:195]
    ds_read_b64_tr_b16 a[192:193], v60 offset:3072
    v_exp_f32 v4, v4
    v_mfma_f32_16x16x32_bf16 v[196:199], a[212:215], v[16:19], v[196:199]
    ds_read_b128 a[160:163], v57 offset:0
    v_exp_f32 v5, v5
    v_mfma_f32_16x16x32_bf16 v[200:203], a[216:219], v[16:19], v[200:203]
    buffer_load_dwordx4 v49, s[8:11], s44 offen offset:1024 lds
    v_mul_f32 v6, s57, v6
    v_mfma_f32_16x16x32_bf16 v[204:207], a[220:223], v[16:19], v[204:207]
    ds_read_b64_tr_b16 a[184:185], v60 offset:2560
    ds_read_b128 a[168:171], v57 offset:1024
    v_cvt_pk_bf16_f32 v22, v4, v5
    v_mfma_f32_16x16x32_bf16 v[208:211], a[224:227], v[16:19], v[208:211]
    ds_read_b64_tr_b16 a[200:201], v60 offset:3584
    ds_read_b128 a[164:167], v57 offset:512
    ds_read_b64_tr_b16 a[206:207], v61 offset:3592
    v_mfma_f32_16x16x32_bf16 v[212:215], a[228:231], v[16:19], v[212:215]
    v_exp_f32 v6, v6
    v_mul_f32 v7, s57, v7
    v_mfma_f32_16x16x32_bf16 v[216:219], a[232:235], v[16:19], v[216:219]
    v_exp_f32 v7, v7
    v_mul_f32 v8, s57, v8
    v_mfma_f32_16x16x32_bf16 v[220:223], a[236:239], v[16:19], v[220:223]
    buffer_load_dwordx4 v49, s[12:15], s44 offen offset:2048 lds
    s_waitcnt lgkmcnt(9)
    v_mfma_f32_16x16x32_bf16 v[0:3], a[144:147], a[0:3], 0
    v_cvt_pk_bf16_f32 v23, v6, v7
    v_exp_f32 v8, v8
    v_mfma_f32_16x16x32_bf16 v[0:3], a[148:151], a[4:7], v[0:3]
    ds_read_b64_tr_b16 a[182:183], v61 offset:2056
    ds_read_b64_tr_b16 a[202:203], v61 offset:3584
    v_mul_f32 v9, s57, v9
    v_mfma_f32_16x16x32_bf16 v[0:3], a[152:155], a[8:11], v[0:3]
    ds_read_b64_tr_b16 a[194:195], v61 offset:3072
    v_exp_f32 v9, v9
    v_mfma_f32_16x16x32_bf16 v[0:3], a[156:159], a[12:15], v[0:3]
    v_mul_f32 v10, s57, v10
    v_cvt_pk_bf16_f32 v24, v8, v9
    v_smfmac_f32_16x16x64_bf16 v[40:43], v[28:31], v[16:23], v48
    buffer_load_dwordx4 v49, s[16:19], s44 offen offset:3072 lds
    s_waitcnt lgkmcnt(4)
    v_mfma_f32_16x16x32_bf16 v[4:7], a[172:175], a[12:15], 0
    ds_read_b64_tr_b16 a[198:199], v61 offset:3080
    s_add_u32 s44, s44, 8192
    v_mul_f32 v11, s57, v11
    v_mfma_f32_16x16x32_bf16 v[4:7], a[168:171], a[8:11], v[4:7]
    v_exp_f32 v11, v11
    v_mfma_f32_16x16x32_bf16 v[4:7], a[164:167], a[4:7], v[4:7]
    ds_read_b64_tr_b16 a[204:205], v60 offset:3592
    v_mul_f32 v12, s57, v12
    v_mfma_f32_16x16x32_bf16 v[4:7], a[160:163], a[0:3], v[4:7]
    v_exp_f32 v10, v10
    v_mfma_f32_16x16x32_bf16 v[224:227], a[208:211], v[20:23], v[224:227]
    v_exp_f32 v12, v12
    v_mul_f32 v13, s57, v13
    v_mfma_f32_16x16x32_bf16 v[228:231], a[212:215], v[20:23], v[228:231]
    v_cvt_pk_bf16_f32 v25, v10, v11
    v_exp_f32 v13, v13
    v_mfma_f32_16x16x32_bf16 v[232:235], a[216:219], v[20:23], v[232:235]
    v_mul_f32 v14, s57, v14
    v_cvt_pk_bf16_f32 v26, v12, v13
    v_mfma_f32_16x16x32_bf16 v[236:239], a[220:223], v[20:23], v[236:239]
    v_exp_f32 v14, v14
    v_mfma_f32_16x16x32_bf16 v[240:243], a[224:227], v[20:23], v[240:243]
    v_mul_f32 v15, s57, v15
    v_mul_f32 v0, s57, v0
    v_mfma_f32_16x16x32_bf16 v[244:247], a[228:231], v[20:23], v[244:247]
    v_exp_f32 v15, v15
    v_mfma_f32_16x16x32_bf16 v[248:251], a[232:235], v[20:23], v[248:251]
    s_waitcnt lgkmcnt(0)
    v_cvt_pk_bf16_f32 v27, v14, v15
    v_mfma_f32_16x16x32_bf16 v[252:255], a[236:239], v[20:23], v[252:255]
    s_branch L_A_T4
L_B_start:
    v_mfma_f32_16x16x32_bf16 v[0:3], a[144:147], a[0:3], 0
    s_add_u32 m0, s54, 12288
    v_exp_f32 v8, v8
    v_mfma_f32_16x16x32_bf16 v[0:3], a[148:151], a[4:7], v[0:3]
    buffer_load_dwordx4 v49, s[20:23], s80 offen offset:0 nt lds
    v_mfma_f32_16x16x32_bf16 v[0:3], a[152:155], a[8:11], v[0:3]
    v_mul_f32 v9, s57, v9
    v_mul_f32 v10, s57, v10
    v_mfma_f32_16x16x32_bf16 v[0:3], a[156:159], a[12:15], v[0:3]
    v_exp_f32 v9, v9
    v_mfma_f32_16x16x32_bf16 v[4:7], a[172:175], a[12:15], 0
    v_cvt_pk_bf16_f32 v20, v8, v9
    v_mul_f32 v11, s57, v11
    v_mfma_f32_16x16x32_bf16 v[4:7], a[168:171], a[8:11], v[4:7]
    v_exp_f32 v10, v10
    v_mfma_f32_16x16x32_bf16 v[4:7], a[164:167], a[4:7], v[4:7]
    v_exp_f32 v11, v11
    v_mul_f32 v12, s57, v12
    v_mfma_f32_16x16x32_bf16 v[4:7], a[160:163], a[0:3], v[4:7]
    v_cvt_pk_bf16_f32 v21, v10, v11
    v_mul_f32 v15, s57, v15
    v_mfma_f32_16x16x32_bf16 v[64:67], a[176:179], v[16:19], 0
    v_exp_f32 v12, v12
    v_mfma_f32_16x16x32_bf16 v[68:71], a[180:183], v[16:19], 0
    v_mul_f32 v13, s57, v13
    v_mul_f32 v14, s57, v14
    v_mfma_f32_16x16x32_bf16 v[72:75], a[184:187], v[16:19], 0
    v_exp_f32 v13, v13
    v_mfma_f32_16x16x32_bf16 v[76:79], a[188:191], v[16:19], 0
    buffer_load_dwordx4 v49, s[24:27], s80 offen offset:1024 nt lds
    v_mfma_f32_16x16x32_bf16 v[80:83], a[192:195], v[16:19], 0
    v_cvt_pk_bf16_f32 v22, v12, v13
    v_exp_f32 v14, v14
    v_mfma_f32_16x16x32_bf16 v[84:87], a[196:199], v[16:19], 0
    v_exp_f32 v15, v15
    v_mfma_f32_16x16x32_bf16 v[88:91], a[200:203], v[16:19], 0
    v_mul_f32 v0, s57, v0
    v_cvt_pk_bf16_f32 v23, v14, v15
    v_mfma_f32_16x16x32_bf16 v[92:95], a[204:207], v[16:19], 0
    v_exp_f32 v0, v0
    v_mfma_f32_16x16x32_bf16 v[8:11], a[144:147], a[16:19], 0
    s_waitcnt vmcnt(6)
    s_barrier
    v_mfma_f32_16x16x32_bf16 v[8:11], a[148:151], a[20:23], v[8:11]
    ds_read_b128 a[144:147], v56 offset:32768
    v_mul_f32 v1, s57, v1
    v_mfma_f32_16x16x32_bf16 v[8:11], a[152:155], a[24:27], v[8:11]
    ds_read_b128 a[148:151], v56 offset:33280
    v_exp_f32 v1, v1
    v_mfma_f32_16x16x32_bf16 v[8:11], a[156:159], a[28:31], v[8:11]
    ds_read_b128 a[152:155], v56 offset:33792
    ds_read_b128 a[156:159], v56 offset:34304
    v_mul_f32 v2, s57, v2
    v_smfmac_f32_16x16x64_bf16 v[32:35], v[28:31], v[16:23], v48
    v_cvt_pk_bf16_f32 v16, v0, v1
    v_exp_f32 v2, v2
    v_mfma_f32_16x16x32_bf16 v[12:15], a[172:175], a[28:31], 0
    buffer_load_dwordx4 v49, s[20:23], s80 offen offset:2048 nt lds
    v_mul_f32 v3, s57, v3
    v_mfma_f32_16x16x32_bf16 v[12:15], a[168:171], a[24:27], v[12:15]
    ds_read_b128 a[172:175], v57 offset:34304
    v_exp_f32 v3, v3
    v_mfma_f32_16x16x32_bf16 v[12:15], a[164:167], a[20:23], v[12:15]
    ds_read_b128 a[168:171], v57 offset:33792
    v_mul_f32 v4, s57, v4
    v_cvt_pk_bf16_f32 v17, v2, v3
    v_mfma_f32_16x16x32_bf16 v[12:15], a[160:163], a[16:19], v[12:15]
    ds_read_b128 a[160:163], v57 offset:32768
    v_exp_f32 v4, v4
    v_mfma_f32_16x16x32_bf16 v[96:99], a[176:179], v[20:23], 0
    ds_read_b128 a[164:167], v57 offset:33280
    ds_read_b64_tr_b16 a[178:179], v61 offset:34816
    v_mul_f32 v5, s57, v5
    v_mfma_f32_16x16x32_bf16 v[100:103], a[180:183], v[20:23], 0
    ds_read_b64_tr_b16 a[176:177], v60 offset:34816
    v_exp_f32 v5, v5
    v_mfma_f32_16x16x32_bf16 v[104:107], a[184:187], v[20:23], 0
    v_mul_f32 v6, s57, v6
    v_cvt_pk_bf16_f32 v18, v4, v5
    v_mfma_f32_16x16x32_bf16 v[108:111], a[188:191], v[20:23], 0
    ds_read_b64_tr_b16 a[182:183], v61 offset:34824
    v_exp_f32 v6, v6
    v_mfma_f32_16x16x32_bf16 v[112:115], a[192:195], v[20:23], 0
    ds_read_b64_tr_b16 a[180:181], v60 offset:34824
    ds_read_b64_tr_b16 a[184:185], v60 offset:35328
    v_mul_f32 v7, s57, v7
    v_mfma_f32_16x16x32_bf16 v[116:119], a[196:199], v[20:23], 0
    v_exp_f32 v7, v7
    v_mul_f32 v8, s57, v8
    v_mfma_f32_16x16x32_bf16 v[120:123], a[200:203], v[20:23], 0
    buffer_load_dwordx4 v49, s[24:27], s80 offen offset:3072 nt lds
    v_cvt_pk_bf16_f32 v19, v6, v7
    v_mfma_f32_16x16x32_bf16 v[124:127], a[204:207], v[20:23], 0
    s_waitcnt lgkmcnt(9)
    s_add_u32 s80, s80, 4096
    v_mfma_f32_16x16x32_bf16 v[0:3], a[144:147], a[0:3], 0
    ds_read_b64_tr_b16 a[188:189], v60 offset:35336
    v_exp_f32 v8, v8
    v_mfma_f32_16x16x32_bf16 v[0:3], a[148:151], a[4:7], v[0:3]
    ds_read_b64_tr_b16 a[190:191], v61 offset:35336
    ds_read_b64_tr_b16 a[192:193], v60 offset:35840
    v_mul_f32 v9, s57, v9
    v_mfma_f32_16x16x32_bf16 v[0:3], a[152:155], a[8:11], v[0:3]
    ds_read_b64_tr_b16 a[194:195], v61 offset:35840
    v_exp_f32 v9, v9
    v_mfma_f32_16x16x32_bf16 v[0:3], a[156:159], a[12:15], v[0:3]
    s_waitcnt lgkmcnt(9)
    v_mul_f32 v10, s57, v10
    v_cvt_pk_bf16_f32 v20, v8, v9
    v_mfma_f32_16x16x32_bf16 v[4:7], a[172:175], a[12:15], 0
    ds_read_b64_tr_b16 a[198:199], v61 offset:35848
    v_exp_f32 v10, v10
    v_mfma_f32_16x16x32_bf16 v[4:7], a[168:171], a[8:11], v[4:7]
    ds_read_b64_tr_b16 a[186:187], v61 offset:35328
    ds_read_b64_tr_b16 a[200:201], v60 offset:36352
    v_mul_f32 v11, s57, v11
    v_mfma_f32_16x16x32_bf16 v[4:7], a[164:167], a[4:7], v[4:7]
    ds_read_b64_tr_b16 a[206:207], v61 offset:36360
    v_exp_f32 v11, v11
    v_mfma_f32_16x16x32_bf16 v[4:7], a[160:163], a[0:3], v[4:7]
    s_add_u32 m0, s54, 16384
    v_mul_f32 v12, s57, v12
    v_cvt_pk_bf16_f32 v21, v10, v11
    v_mfma_f32_16x16x32_bf16 v[64:67], a[208:211], v[16:19], v[64:67]
    buffer_load_dwordx4 v49, s[20:23], s80 offen offset:0 nt lds
    v_mfma_f32_16x16x32_bf16 v[68:71], a[212:215], v[16:19], v[68:71]
    v_exp_f32 v12, v12
    v_mul_f32 v13, s57, v13
    v_mfma_f32_16x16x32_bf16 v[72:75], a[216:219], v[16:19], v[72:75]
    ds_read_b64_tr_b16 a[202:203], v61 offset:36352
    v_exp_f32 v13, v13
    v_mfma_f32_16x16x32_bf16 v[76:79], a[220:223], v[16:19], v[76:79]
    ds_read_b64_tr_b16 a[196:197], v60 offset:35848
    v_mul_f32 v14, s57, v14
    v_cvt_pk_bf16_f32 v22, v12, v13
    v_mfma_f32_16x16x32_bf16 v[80:83], a[224:227], v[16:19], v[80:83]
    ds_read_b64_tr_b16 a[204:205], v60 offset:36360
    v_mul_f32 v15, s57, v15
    v_mfma_f32_16x16x32_bf16 v[84:87], a[228:231], v[16:19], v[84:87]
    v_exp_f32 v14, v14
    v_mfma_f32_16x16x32_bf16 v[88:91], a[232:235], v[16:19], v[88:91]
    v_exp_f32 v15, v15
    v_mul_f32 v0, s57, v0
    v_mfma_f32_16x16x32_bf16 v[92:95], a[236:239], v[16:19], v[92:95]
    v_cvt_pk_bf16_f32 v23, v14, v15
    v_mul_f32 v1, s57, v1
    v_mfma_f32_16x16x32_bf16 v[8:11], a[144:147], a[16:19], 0
    v_exp_f32 v0, v0
    v_mfma_f32_16x16x32_bf16 v[8:11], a[148:151], a[20:23], v[8:11]
    ds_read_b128 a[144:147], v58 offset:32768
    ds_read_b128 a[148:151], v58 offset:33280
    v_mfma_f32_16x16x32_bf16 v[8:11], a[152:155], a[24:27], v[8:11]
    buffer_load_dwordx4 v49, s[24:27], s80 offen offset:1024 nt lds
    v_mfma_f32_16x16x32_bf16 v[8:11], a[156:159], a[28:31], v[8:11]
    v_exp_f32 v1, v1
    v_mul_f32 v2, s57, v2
    v_smfmac_f32_16x16x64_bf16 v[32:35], v[28:31], v[16:23], v48
    v_cvt_pk_bf16_f32 v16, v0, v1
    v_exp_f32 v2, v2
    v_mfma_f32_16x16x32_bf16 v[12:15], a[172:175], a[28:31], 0
    ds_read_b128 a[156:159], v58 offset:34304
    v_mul_f32 v3, s57, v3
    v_mfma_f32_16x16x32_bf16 v[12:15], a[168:171], a[24:27], v[12:15]
    ds_read_b128 a[152:155], v58 offset:33792
    v_exp_f32 v3, v3
    v_mfma_f32_16x16x32_bf16 v[12:15], a[164:167], a[20:23], v[12:15]
    ds_read_b128 a[164:167], v59 offset:33280
    v_mul_f32 v4, s57, v4
    v_cvt_pk_bf16_f32 v17, v2, v3
    v_mfma_f32_16x16x32_bf16 v[12:15], a[160:163], a[16:19], v[12:15]
    ds_read_b128 a[168:171], v59 offset:33792
    v_exp_f32 v4, v4
    v_mfma_f32_16x16x32_bf16 v[96:99], a[208:211], v[20:23], v[96:99]
    ds_read_b128 a[172:175], v59 offset:34304
    ds_read_b128 a[160:163], v59 offset:32768
    v_mul_f32 v5, s57, v5
    v_mfma_f32_16x16x32_bf16 v[100:103], a[212:215], v[20:23], v[100:103]
    ds_read_b64_tr_b16 a[208:209], v62 offset:34816
    v_exp_f32 v5, v5
    v_mfma_f32_16x16x32_bf16 v[104:107], a[216:219], v[20:23], v[104:107]
    v_mul_f32 v6, s57, v6
    v_cvt_pk_bf16_f32 v18, v4, v5
    v_mfma_f32_16x16x32_bf16 v[108:111], a[220:223], v[20:23], v[108:111]
    buffer_load_dwordx4 v49, s[20:23], s80 offen offset:2048 nt lds
    v_mul_f32 v7, s57, v7
    v_mfma_f32_16x16x32_bf16 v[112:115], a[224:227], v[20:23], v[112:115]
    ds_read_b64_tr_b16 a[210:211], v63 offset:34816
    v_exp_f32 v6, v6
    v_mfma_f32_16x16x32_bf16 v[116:119], a[228:231], v[20:23], v[116:119]
    ds_read_b64_tr_b16 a[216:217], v62 offset:35328
    v_exp_f32 v7, v7
    v_mfma_f32_16x16x32_bf16 v[120:123], a[232:235], v[20:23], v[120:123]
    v_cvt_pk_bf16_f32 v19, v6, v7
    v_mul_f32 v8, s57, v8
    v_mfma_f32_16x16x32_bf16 v[124:127], a[236:239], v[20:23], v[124:127]
    ds_read_b64_tr_b16 a[212:213], v62 offset:34824
    ds_read_b64_tr_b16 a[224:225], v62 offset:35840
    s_waitcnt lgkmcnt(9)
    v_mfma_f32_16x16x32_bf16 v[0:3], a[144:147], a[0:3], 0
    ds_read_b64_tr_b16 a[222:223], v63 offset:35336
    v_exp_f32 v8, v8
    v_mfma_f32_16x16x32_bf16 v[0:3], a[148:151], a[4:7], v[0:3]
    ds_read_b64_tr_b16 a[218:219], v63 offset:35328
    ds_read_b64_tr_b16 a[220:221], v62 offset:35336
    v_mul_f32 v9, s57, v9
    v_mfma_f32_16x16x32_bf16 v[0:3], a[152:155], a[8:11], v[0:3]
    v_exp_f32 v9, v9
    v_mfma_f32_16x16x32_bf16 v[0:3], a[156:159], a[12:15], v[0:3]
    s_waitcnt lgkmcnt(8)
    v_mul_f32 v10, s57, v10
    v_cvt_pk_bf16_f32 v20, v8, v9
    v_mfma_f32_16x16x32_bf16 v[4:7], a[172:175], a[12:15], 0
    ds_read_b64_tr_b16 a[228:229], v62 offset:35848
    v_exp_f32 v10, v10
    v_mfma_f32_16x16x32_bf16 v[4:7], a[168:171], a[8:11], v[4:7]
    buffer_load_dwordx4 v49, s[24:27], s80 offen offset:3072 nt lds
    v_mul_f32 v11, s57, v11
    v_mfma_f32_16x16x32_bf16 v[4:7], a[164:167], a[4:7], v[4:7]
    s_add_u32 s80, s80, 4096
    v_exp_f32 v11, v11
    v_mfma_f32_16x16x32_bf16 v[4:7], a[160:163], a[0:3], v[4:7]
    s_waitcnt lgkmcnt(15)
    v_mul_f32 v12, s57, v12
    v_cvt_pk_bf16_f32 v21, v10, v11
    v_mfma_f32_16x16x32_bf16 v[64:67], a[176:179], v[16:19], v[64:67]
    ds_read_b64_tr_b16 a[214:215], v63 offset:34824
    v_exp_f32 v12, v12
    v_mfma_f32_16x16x32_bf16 v[68:71], a[180:183], v[16:19], v[68:71]
    ds_read_b64_tr_b16 a[232:233], v62 offset:36352
    ds_read_b64_tr_b16 a[238:239], v63 offset:36360
    v_mul_f32 v13, s57, v13
    v_mfma_f32_16x16x32_bf16 v[72:75], a[184:187], v[16:19], v[72:75]
    v_exp_f32 v13, v13
    v_mul_f32 v14, s57, v14
    v_mfma_f32_16x16x32_bf16 v[76:79], a[188:191], v[16:19], v[76:79]
    v_cvt_pk_bf16_f32 v22, v12, v13
    v_exp_f32 v14, v14
    v_mfma_f32_16x16x32_bf16 v[80:83], a[192:195], v[16:19], v[80:83]
    ds_read_b64_tr_b16 a[230:231], v63 offset:35848
    ds_read_b64_tr_b16 a[236:237], v62 offset:36360
    v_mul_f32 v15, s57, v15
    v_mfma_f32_16x16x32_bf16 v[84:87], a[196:199], v[16:19], v[84:87]
    s_add_u32 m0, s54, 20480
    v_exp_f32 v15, v15
    v_mfma_f32_16x16x32_bf16 v[88:91], a[200:203], v[16:19], v[88:91]
    ds_read_b64_tr_b16 a[226:227], v63 offset:35840
    v_mul_f32 v0, s57, v0
    v_mfma_f32_16x16x32_bf16 v[92:95], a[204:207], v[16:19], v[92:95]
    buffer_load_dwordx4 v49, s[20:23], s80 offen offset:0 nt lds
    v_cvt_pk_bf16_f32 v23, v14, v15
    v_mfma_f32_16x16x32_bf16 v[8:11], a[144:147], a[16:19], 0
    v_exp_f32 v0, v0
    v_mul_f32 v1, s57, v1
    v_mfma_f32_16x16x32_bf16 v[8:11], a[148:151], a[20:23], v[8:11]
    ds_read_b64_tr_b16 a[234:235], v63 offset:36352
    ds_read_b128 a[144:147], v56 offset:0
    v_mul_f32 v5, s57, v5
    v_mfma_f32_16x16x32_bf16 v[8:11], a[152:155], a[24:27], v[8:11]
    ds_read_b128 a[148:151], v56 offset:512
    v_exp_f32 v1, v1
    v_mfma_f32_16x16x32_bf16 v[8:11], a[156:159], a[28:31], v[8:11]
    v_mul_f32 v2, s57, v2
    v_exp_f32 v5, v5
    v_smfmac_f32_16x16x64_bf16 v[32:35], v[28:31], v[16:23], v48
    v_cvt_pk_bf16_f32 v16, v0, v1
    v_exp_f32 v2, v2
    v_mfma_f32_16x16x32_bf16 v[12:15], a[172:175], a[28:31], 0
    ds_read_b128 a[172:175], v57 offset:1536
    s_waitcnt vmcnt(9)
    v_mul_f32 v3, s57, v3
    v_mfma_f32_16x16x32_bf16 v[12:15], a[168:171], a[24:27], v[12:15]
    ds_read_b128 a[152:155], v56 offset:1024
    ds_read_b128 a[156:159], v56 offset:1536
    ds_read_b128 a[36:39], v50 offset:8704
    v_mfma_f32_16x16x32_bf16 v[12:15], a[164:167], a[20:23], v[12:15]
    v_exp_f32 v3, v3
    v_mul_f32 v4, s57, v4
    v_mfma_f32_16x16x32_bf16 v[12:15], a[160:163], a[16:19], v[12:15]
    ds_read_b128 a[40:43], v50 offset:9216
    ds_read_b128 a[44:47], v50 offset:9728
    v_cvt_pk_bf16_f32 v17, v2, v3
    v_mfma_f32_16x16x32_bf16 v[96:99], a[176:179], v[20:23], v[96:99]
    ds_read_b128 a[32:35], v50 offset:8192
    v_exp_f32 v4, v4
    v_mfma_f32_16x16x32_bf16 v[100:103], a[180:183], v[20:23], v[100:103]
    buffer_load_dwordx4 v49, s[24:27], s80 offen offset:1024 nt lds
    v_mul_f32 v6, s57, v6
    v_mfma_f32_16x16x32_bf16 v[104:107], a[184:187], v[20:23], v[104:107]
    ds_read_b128 a[160:163], v57 offset:0
    ds_read_b64_tr_b16 a[176:177], v60 offset:2048
    v_cvt_pk_bf16_f32 v18, v4, v5
    v_mfma_f32_16x16x32_bf16 v[108:111], a[188:191], v[20:23], v[108:111]
    ds_read_b128 a[168:171], v57 offset:1024
    ds_read_b128 a[164:167], v57 offset:512
    ds_read_b64_tr_b16 a[178:179], v61 offset:2048
    v_mfma_f32_16x16x32_bf16 v[112:115], a[192:195], v[20:23], v[112:115]
    v_exp_f32 v6, v6
    v_mul_f32 v7, s57, v7
    v_mfma_f32_16x16x32_bf16 v[116:119], a[196:199], v[20:23], v[116:119]
    v_exp_f32 v7, v7
    v_mfma_f32_16x16x32_bf16 v[120:123], a[200:203], v[20:23], v[120:123]
    ds_read_b64_tr_b16 a[182:183], v61 offset:2056
    v_cvt_pk_bf16_f32 v19, v6, v7
    v_mul_f32 v8, s57, v8
    v_mfma_f32_16x16x32_bf16 v[124:127], a[204:207], v[20:23], v[124:127]
    ds_read_b64_tr_b16 a[184:185], v60 offset:2560
    s_waitcnt lgkmcnt(11)
    s_waitcnt lgkmcnt(7)
    v_mfma_f32_16x16x32_bf16 v[0:3], a[144:147], a[32:35], 0
    v_exp_f32 v8, v8
    v_mul_f32 v9, s57, v9
    v_mfma_f32_16x16x32_bf16 v[0:3], a[148:151], a[36:39], v[0:3]
    ds_read_b64_tr_b16 a[186:187], v61 offset:2560
    v_exp_f32 v9, v9
    v_mfma_f32_16x16x32_bf16 v[0:3], a[152:155], a[40:43], v[0:3]
    buffer_load_dwordx4 v49, s[20:23], s80 offen offset:2048 nt lds
    v_cvt_pk_bf16_f32 v20, v8, v9
    v_mfma_f32_16x16x32_bf16 v[0:3], a[156:159], a[44:47], v[0:3]
    s_waitcnt lgkmcnt(4)
    v_mul_f32 v10, s57, v10
    v_mul_f32 v12, s57, v12
    v_mfma_f32_16x16x32_bf16 v[4:7], a[172:175], a[44:47], 0
    s_waitcnt vmcnt(7)
    v_exp_f32 v10, v10
    v_mfma_f32_16x16x32_bf16 v[4:7], a[168:171], a[40:43], v[4:7]
    v_mul_f32 v11, s57, v11
    v_exp_f32 v12, v12
    v_mfma_f32_16x16x32_bf16 v[4:7], a[164:167], a[36:39], v[4:7]
    ds_read_b64_tr_b16 a[192:193], v60 offset:3072
    ds_read_b64_tr_b16 a[198:199], v61 offset:3080
    ds_read_b128 a[60:63], v50 offset:13824
    v_mfma_f32_16x16x32_bf16 v[4:7], a[160:163], a[32:35], v[4:7]
    ds_read_b128 a[52:55], v50 offset:12800
    ds_read_b128 a[56:59], v50 offset:13312
    s_waitcnt lgkmcnt(15)
    v_mfma_f32_16x16x32_bf16 v[64:67], a[208:211], v[16:19], v[64:67]
    ds_read_b128 a[48:51], v50 offset:12288
    v_exp_f32 v11, v11
    v_mfma_f32_16x16x32_bf16 v[68:71], a[212:215], v[16:19], v[68:71]
    ds_read_b64_tr_b16 a[200:201], v60 offset:3584
    v_cvt_pk_bf16_f32 v21, v10, v11
    v_mul_f32 v13, s57, v13
    v_mfma_f32_16x16x32_bf16 v[72:75], a[216:219], v[16:19], v[72:75]
    v_exp_f32 v13, v13
    v_mul_f32 v14, s57, v14
    v_mfma_f32_16x16x32_bf16 v[76:79], a[220:223], v[16:19], v[76:79]
    v_cvt_pk_bf16_f32 v22, v12, v13
    v_exp_f32 v14, v14
    v_mfma_f32_16x16x32_bf16 v[80:83], a[224:227], v[16:19], v[80:83]
    buffer_load_dwordx4 v49, s[24:27], s80 offen offset:3072 nt lds
    v_mul_f32 v15, s57, v15
    v_mfma_f32_16x16x32_bf16 v[84:87], a[228:231], v[16:19], v[84:87]
    ds_read_b64_tr_b16 a[180:181], v60 offset:2056
    ds_read_b64_tr_b16 a[206:207], v61 offset:3592
    v_mul_f32 v0, s57, v0
    v_mfma_f32_16x16x32_bf16 v[88:91], a[232:235], v[16:19], v[88:91]
    ds_read_b64_tr_b16 a[196:197], v60 offset:3080
    v_exp_f32 v15, v15
    v_mfma_f32_16x16x32_bf16 v[92:95], a[236:239], v[16:19], v[92:95]
    ds_read_b64_tr_b16 a[204:205], v60 offset:3592
    s_waitcnt lgkmcnt(5)
    v_cvt_pk_bf16_f32 v23, v14, v15
    v_mfma_f32_16x16x32_bf16 v[8:11], a[144:147], a[48:51], 0
    ds_read_b64_tr_b16 a[188:189], v60 offset:2568
    v_exp_f32 v0, v0
    v_mfma_f32_16x16x32_bf16 v[8:11], a[148:151], a[52:55], v[8:11]
    ds_read_b64_tr_b16 a[194:195], v61 offset:3072
    ds_read_b64_tr_b16 a[202:203], v61 offset:3584
    v_mul_f32 v1, s57, v1
    v_mfma_f32_16x16x32_bf16 v[8:11], a[152:155], a[56:59], v[8:11]
    ds_read_b64_tr_b16 a[190:191], v61 offset:2568
    v_exp_f32 v1, v1
    v_mfma_f32_16x16x32_bf16 v[8:11], a[156:159], a[60:63], v[8:11]
    ds_read_b128 a[144:147], v58 offset:0
    ds_read_b128 a[152:155], v58 offset:1024
    v_mul_f32 v2, s57, v2
    v_smfmac_f32_16x16x64_bf16 v[32:35], v[28:31], v[16:23], v48
    ds_read_b128 a[148:151], v58 offset:512
    v_exp_f32 v2, v2
    v_mfma_f32_16x16x32_bf16 v[12:15], a[172:175], a[60:63], 0
    ds_read_b128 a[172:175], v59 offset:1536
    s_add_u32 m0, s54, 8192
    v_mul_f32 v3, s57, v3
    v_mfma_f32_16x16x32_bf16 v[12:15], a[168:171], a[56:59], v[12:15]
    buffer_load_dwordx4 v49, s[20:23], s81 offen offset:0 nt lds
    v_cvt_pk_bf16_f32 v16, v0, v1
    v_mfma_f32_16x16x32_bf16 v[12:15], a[164:167], a[52:55], v[12:15]
    ds_read_b128 a[156:159], v58 offset:1536
    ds_read_b128 a[168:171], v59 offset:1024
    v_mul_f32 v4, s57, v4
    v_mfma_f32_16x16x32_bf16 v[12:15], a[160:163], a[48:51], v[12:15]
    ds_read_b128 a[160:163], v59 offset:0
    v_exp_f32 v4, v4
    v_mfma_f32_16x16x32_bf16 v[96:99], a[208:211], v[20:23], v[96:99]
    v_exp_f32 v3, v3
    v_mul_f32 v5, s57, v5
    v_mfma_f32_16x16x32_bf16 v[100:103], a[212:215], v[20:23], v[100:103]
    ds_read_b128 a[164:167], v59 offset:512
    v_exp_f32 v5, v5
    v_mfma_f32_16x16x32_bf16 v[104:107], a[216:219], v[20:23], v[104:107]
    v_cvt_pk_bf16_f32 v17, v2, v3
    v_mul_f32 v6, s57, v6
    v_cvt_pk_bf16_f32 v18, v4, v5
    v_mfma_f32_16x16x32_bf16 v[108:111], a[220:223], v[20:23], v[108:111]
    v_exp_f32 v6, v6
    v_mfma_f32_16x16x32_bf16 v[112:115], a[224:227], v[20:23], v[112:115]
    ds_read_b64_tr_b16 a[212:213], v62 offset:2056
    ds_read_b64_tr_b16 a[216:217], v62 offset:2560
    v_mul_f32 v7, s57, v7
    v_mfma_f32_16x16x32_bf16 v[116:119], a[228:231], v[20:23], v[116:119]
    ds_read_b64_tr_b16 a[208:209], v62 offset:2048
    v_exp_f32 v7, v7
    v_mfma_f32_16x16x32_bf16 v[120:123], a[232:235], v[20:23], v[120:123]
    v_cvt_pk_bf16_f32 v19, v6, v7
    v_mul_f32 v8, s57, v8
    v_mfma_f32_16x16x32_bf16 v[124:127], a[236:239], v[20:23], v[124:127]
    buffer_load_dwordx4 v49, s[24:27], s81 offen offset:1024 nt lds
    s_waitcnt lgkmcnt(6)
    v_mfma_f32_16x16x32_bf16 v[0:3], a[144:147], a[32:35], 0
    ds_read_b64_tr_b16 a[210:211], v63 offset:2048
    v_exp_f32 v8, v8
    v_mfma_f32_16x16x32_bf16 v[0:3], a[148:151], a[36:39], v[0:3]
    ds_read_b64_tr_b16 a[220:221], v62 offset:2568
    ds_read_b64_tr_b16 a[226:227], v63 offset:3072
    v_mul_f32 v9, s57, v9
    v_mfma_f32_16x16x32_bf16 v[0:3], a[152:155], a[40:43], v[0:3]
    ds_read_b64_tr_b16 a[224:225], v62 offset:3072
    v_exp_f32 v9, v9
    v_mfma_f32_16x16x32_bf16 v[0:3], a[156:159], a[44:47], v[0:3]
    s_waitcnt lgkmcnt(7)
    v_mul_f32 v10, s57, v10
    v_cvt_pk_bf16_f32 v20, v8, v9
    v_mfma_f32_16x16x32_bf16 v[4:7], a[172:175], a[44:47], 0
    ds_read_b64_tr_b16 a[230:231], v63 offset:3080
    v_exp_f32 v10, v10
    v_mfma_f32_16x16x32_bf16 v[4:7], a[168:171], a[40:43], v[4:7]
    ds_read_b64_tr_b16 a[232:233], v62 offset:3584
    v_mul_f32 v11, s57, v11
    v_mfma_f32_16x16x32_bf16 v[4:7], a[164:167], a[36:39], v[4:7]
    v_exp_f32 v11, v11
    v_mfma_f32_16x16x32_bf16 v[4:7], a[160:163], a[32:35], v[4:7]
    s_waitcnt lgkmcnt(15)
    v_mul_f32 v12, s57, v12
    v_cvt_pk_bf16_f32 v21, v10, v11
    v_mfma_f32_16x16x32_bf16 v[128:131], a[176:179], v[16:19], 0
    ds_read_b64_tr_b16 a[222:223], v63 offset:2568
    v_exp_f32 v12, v12
    v_mfma_f32_16x16x32_bf16 v[132:135], a[180:183], v[16:19], 0
    buffer_load_dwordx4 v49, s[20:23], s81 offen offset:2048 nt lds
    v_mul_f32 v13, s57, v13
    v_mfma_f32_16x16x32_bf16 v[136:139], a[184:187], v[16:19], 0
    ds_read_b64_tr_b16 a[234:235], v63 offset:3584
    v_exp_f32 v13, v13
    v_mfma_f32_16x16x32_bf16 v[140:143], a[188:191], v[16:19], 0
    ds_read_b64_tr_b16 a[214:215], v63 offset:2056
    ds_read_b64_tr_b16 a[236:237], v62 offset:3592
    v_mul_f32 v14, s57, v14
    v_mfma_f32_16x16x32_bf16 v[144:147], a[192:195], v[16:19], 0
    v_cvt_pk_bf16_f32 v22, v12, v13
    v_exp_f32 v14, v14
    v_mfma_f32_16x16x32_bf16 v[148:151], a[196:199], v[16:19], 0
    ds_read_b64_tr_b16 a[218:219], v63 offset:2560
    v_mul_f32 v15, s57, v15
    v_mfma_f32_16x16x32_bf16 v[152:155], a[200:203], v[16:19], 0
    v_exp_f32 v15, v15
    v_mul_f32 v0, s57, v0
    v_mfma_f32_16x16x32_bf16 v[156:159], a[204:207], v[16:19], 0
    ds_read_b64_tr_b16 a[228:229], v62 offset:3080
    v_cvt_pk_bf16_f32 v23, v14, v15
    v_mfma_f32_16x16x32_bf16 v[8:11], a[144:147], a[48:51], 0
    v_exp_f32 v0, v0
    v_mfma_f32_16x16x32_bf16 v[8:11], a[148:151], a[52:55], v[8:11]
    ds_read_b64_tr_b16 a[238:239], v63 offset:3592
    ds_read_b128 a[144:147], v56 offset:32768
    v_mul_f32 v1, s57, v1
    v_mfma_f32_16x16x32_bf16 v[8:11], a[152:155], a[56:59], v[8:11]
    ds_read_b128 a[148:151], v56 offset:33280
    v_exp_f32 v1, v1
    v_mfma_f32_16x16x32_bf16 v[8:11], a[156:159], a[60:63], v[8:11]
    buffer_load_dwordx4 v49, s[24:27], s81 offen offset:3072 nt lds
    v_mul_f32 v2, s57, v2
    v_smfmac_f32_16x16x64_bf16 v[36:39], v[28:31], v[16:23], v48
    v_cvt_pk_bf16_f32 v16, v0, v1
    v_exp_f32 v2, v2
    v_mfma_f32_16x16x32_bf16 v[12:15], a[172:175], a[60:63], 0
    ds_read_b128 a[152:155], v56 offset:33792
    v_mul_f32 v3, s57, v3
    v_mfma_f32_16x16x32_bf16 v[12:15], a[168:171], a[56:59], v[12:15]
    ds_read_b128 a[156:159], v56 offset:34304
    v_exp_f32 v3, v3
    v_mfma_f32_16x16x32_bf16 v[12:15], a[164:167], a[52:55], v[12:15]
    ds_read_b128 a[164:167], v57 offset:33280
    v_mul_f32 v4, s57, v4
    v_cvt_pk_bf16_f32 v17, v2, v3
    v_mfma_f32_16x16x32_bf16 v[12:15], a[160:163], a[48:51], v[12:15]
    ds_read_b128 a[168:171], v57 offset:33792
    v_exp_f32 v4, v4
    v_mfma_f32_16x16x32_bf16 v[160:163], a[176:179], v[20:23], 0
    ds_read_b128 a[160:163], v57 offset:32768
    v_mul_f32 v5, s57, v5
    v_mfma_f32_16x16x32_bf16 v[164:167], a[180:183], v[20:23], 0
    ds_read_b64_tr_b16 a[180:181], v60 offset:34824
    v_exp_f32 v5, v5
    v_mfma_f32_16x16x32_bf16 v[168:171], a[184:187], v[20:23], 0
    ds_read_b128 a[172:175], v57 offset:34304
    ds_read_b64_tr_b16 a[178:179], v61 offset:34816
    v_mul_f32 v6, s57, v6
    v_mfma_f32_16x16x32_bf16 v[172:175], a[188:191], v[20:23], 0
    v_exp_f32 v6, v6
    v_mul_f32 v7, s57, v7
    v_mfma_f32_16x16x32_bf16 v[176:179], a[192:195], v[20:23], 0
    ds_read_b64_tr_b16 a[176:177], v60 offset:34816
    v_cvt_pk_bf16_f32 v18, v4, v5
    v_mfma_f32_16x16x32_bf16 v[180:183], a[196:199], v[20:23], 0
    v_exp_f32 v7, v7
    v_mfma_f32_16x16x32_bf16 v[184:187], a[200:203], v[20:23], 0
    v_cvt_pk_bf16_f32 v19, v6, v7
    v_mul_f32 v8, s57, v8
    v_mfma_f32_16x16x32_bf16 v[188:191], a[204:207], v[20:23], 0
    ds_read_b64_tr_b16 a[184:185], v60 offset:35328
    ds_read_b64_tr_b16 a[188:189], v60 offset:35336
    s_waitcnt lgkmcnt(9)
    v_mfma_f32_16x16x32_bf16 v[0:3], a[144:147], a[32:35], 0
    ds_read_b64_tr_b16 a[190:191], v61 offset:35336
    v_exp_f32 v8, v8
    v_mfma_f32_16x16x32_bf16 v[0:3], a[148:151], a[36:39], v[0:3]
    ds_read_b64_tr_b16 a[182:183], v61 offset:34824
    ds_read_b64_tr_b16 a[186:187], v61 offset:35328
    v_mul_f32 v9, s57, v9
    v_mfma_f32_16x16x32_bf16 v[0:3], a[152:155], a[40:43], v[0:3]
    v_exp_f32 v9, v9
    v_mul_f32 v10, s57, v10
    v_mfma_f32_16x16x32_bf16 v[0:3], a[156:159], a[44:47], v[0:3]
    ds_read_b64_tr_b16 a[192:193], v60 offset:35840
    s_waitcnt lgkmcnt(8)
    v_cvt_pk_bf16_f32 v20, v8, v9
    v_mfma_f32_16x16x32_bf16 v[4:7], a[172:175], a[44:47], 0
    v_exp_f32 v10, v10
    v_mfma_f32_16x16x32_bf16 v[4:7], a[168:171], a[40:43], v[4:7]
    ds_read_b64_tr_b16 a[194:195], v61 offset:35840
    ds_read_b64_tr_b16 a[196:197], v60 offset:35848
    v_mul_f32 v11, s57, v11
    v_mfma_f32_16x16x32_bf16 v[4:7], a[164:167], a[36:39], v[4:7]
    ds_read_b64_tr_b16 a[202:203], v61 offset:36352
    v_exp_f32 v11, v11
    v_mfma_f32_16x16x32_bf16 v[4:7], a[160:163], a[32:35], v[4:7]
    s_waitcnt lgkmcnt(15)
    v_mul_f32 v12, s57, v12
    v_cvt_pk_bf16_f32 v21, v10, v11
    v_mfma_f32_16x16x32_bf16 v[128:131], a[208:211], v[16:19], v[128:131]
    ds_read_b64_tr_b16 a[200:201], v60 offset:36352
    v_exp_f32 v12, v12
    v_mfma_f32_16x16x32_bf16 v[132:135], a[212:215], v[16:19], v[132:135]
    ds_read_b64_tr_b16 a[206:207], v61 offset:36360
    v_mul_f32 v13, s57, v13
    v_mfma_f32_16x16x32_bf16 v[136:139], a[216:219], v[16:19], v[136:139]
    v_exp_f32 v13, v13
    v_mfma_f32_16x16x32_bf16 v[140:143], a[220:223], v[16:19], v[140:143]
    v_mul_f32 v14, s57, v14
    v_cvt_pk_bf16_f32 v22, v12, v13
    v_mfma_f32_16x16x32_bf16 v[144:147], a[224:227], v[16:19], v[144:147]
    v_exp_f32 v14, v14
    v_mfma_f32_16x16x32_bf16 v[148:151], a[228:231], v[16:19], v[148:151]
    ds_read_b64_tr_b16 a[204:205], v60 offset:36360
    v_mul_f32 v15, s57, v15
    v_mfma_f32_16x16x32_bf16 v[152:155], a[232:235], v[16:19], v[152:155]
    v_exp_f32 v15, v15
    v_mul_f32 v0, s57, v0
    v_mfma_f32_16x16x32_bf16 v[156:159], a[236:239], v[16:19], v[156:159]
    ds_read_b64_tr_b16 a[198:199], v61 offset:35848
    v_cvt_pk_bf16_f32 v23, v14, v15
    v_mfma_f32_16x16x32_bf16 v[8:11], a[144:147], a[48:51], 0
    v_exp_f32 v0, v0
    v_mfma_f32_16x16x32_bf16 v[8:11], a[148:151], a[52:55], v[8:11]
    ds_read_b128 a[144:147], v58 offset:32768
    v_mul_f32 v1, s57, v1
    v_mfma_f32_16x16x32_bf16 v[8:11], a[152:155], a[56:59], v[8:11]
    v_exp_f32 v1, v1
    v_mfma_f32_16x16x32_bf16 v[8:11], a[156:159], a[60:63], v[8:11]
    ds_read_b128 a[148:151], v58 offset:33280
    ds_read_b128 a[152:155], v58 offset:33792
    v_mul_f32 v2, s57, v2
    v_smfmac_f32_16x16x64_bf16 v[36:39], v[28:31], v[16:23], v48
    v_cvt_pk_bf16_f32 v16, v0, v1
    v_exp_f32 v2, v2
    v_mfma_f32_16x16x32_bf16 v[12:15], a[172:175], a[60:63], 0
    ds_read_b128 a[156:159], v58 offset:34304
    v_mul_f32 v3, s57, v3
    v_mfma_f32_16x16x32_bf16 v[12:15], a[168:171], a[56:59], v[12:15]
    ds_read_b128 a[168:171], v59 offset:33792
    v_exp_f32 v3, v3
    v_mfma_f32_16x16x32_bf16 v[12:15], a[164:167], a[52:55], v[12:15]
    ds_read_b128 a[172:175], v59 offset:34304
    v_mul_f32 v4, s57, v4
    v_cvt_pk_bf16_f32 v17, v2, v3
    v_mfma_f32_16x16x32_bf16 v[12:15], a[160:163], a[48:51], v[12:15]
    v_exp_f32 v4, v4
    v_mul_f32 v5, s57, v5
    v_mfma_f32_16x16x32_bf16 v[160:163], a[208:211], v[20:23], v[160:163]
    ds_read_b128 a[164:167], v59 offset:33280
    v_exp_f32 v5, v5
    v_mfma_f32_16x16x32_bf16 v[164:167], a[212:215], v[20:23], v[164:167]
    buffer_load_dword v55, v54, s[32:35], s71 offen
    v_mfma_f32_16x16x32_bf16 v[168:171], a[216:219], v[20:23], v[168:171]
    ds_read_b128 a[160:163], v59 offset:32768
    v_mul_f32 v6, s57, v6
    v_cvt_pk_bf16_f32 v18, v4, v5
    v_mfma_f32_16x16x32_bf16 v[172:175], a[220:223], v[20:23], v[172:175]
    ds_read_b64_tr_b16 a[212:213], v62 offset:34824
    v_exp_f32 v6, v6
    v_mfma_f32_16x16x32_bf16 v[176:179], a[224:227], v[20:23], v[176:179]
    ds_read_b64_tr_b16 a[216:217], v62 offset:35328
    v_mul_f32 v7, s57, v7
    v_mfma_f32_16x16x32_bf16 v[180:183], a[228:231], v[20:23], v[180:183]
    ds_read_b64_tr_b16 a[214:215], v63 offset:34824
    v_exp_f32 v7, v7
    v_mfma_f32_16x16x32_bf16 v[184:187], a[232:235], v[20:23], v[184:187]
    v_cvt_pk_bf16_f32 v19, v6, v7
    v_mul_f32 v8, s57, v8
    v_mfma_f32_16x16x32_bf16 v[188:191], a[236:239], v[20:23], v[188:191]
    ds_read_b64_tr_b16 a[208:209], v62 offset:34816
    ds_read_b64_tr_b16 a[218:219], v63 offset:35328
    s_waitcnt lgkmcnt(9)
    v_mfma_f32_16x16x32_bf16 v[0:3], a[144:147], a[32:35], 0
    ds_read_b64_tr_b16 a[210:211], v63 offset:34816
    ds_read_b64_tr_b16 a[222:223], v63 offset:35336
    ds_read_b64_tr_b16 a[224:225], v62 offset:35840
    v_mfma_f32_16x16x32_bf16 v[0:3], a[148:151], a[36:39], v[0:3]
    v_exp_f32 v8, v8
    v_mul_f32 v9, s57, v9
    v_mfma_f32_16x16x32_bf16 v[0:3], a[152:155], a[40:43], v[0:3]
    ds_read_b64_tr_b16 a[228:229], v62 offset:35848
    v_exp_f32 v9, v9
    v_mfma_f32_16x16x32_bf16 v[0:3], a[156:159], a[44:47], v[0:3]
    s_waitcnt lgkmcnt(9)
    v_mul_f32 v10, s57, v10
    v_cvt_pk_bf16_f32 v20, v8, v9
    v_mfma_f32_16x16x32_bf16 v[4:7], a[172:175], a[44:47], 0
    ds_read_b64_tr_b16 a[226:227], v63 offset:35840
    v_exp_f32 v10, v10
    v_mfma_f32_16x16x32_bf16 v[4:7], a[168:171], a[40:43], v[4:7]
    ds_read_b64_tr_b16 a[220:221], v62 offset:35336
    v_mul_f32 v11, s57, v11
    v_mfma_f32_16x16x32_bf16 v[4:7], a[164:167], a[36:39], v[4:7]
    ds_read_b64_tr_b16 a[230:231], v63 offset:35848
    v_exp_f32 v11, v11
    v_mfma_f32_16x16x32_bf16 v[4:7], a[160:163], a[32:35], v[4:7]
    ds_read_b64_tr_b16 a[234:235], v63 offset:36352
    s_waitcnt lgkmcnt(15)
    v_mul_f32 v12, s57, v12
    v_mfma_f32_16x16x32_bf16 v[128:131], a[176:179], v[16:19], v[128:131]
    v_cvt_pk_bf16_f32 v21, v10, v11
    v_exp_f32 v12, v12
    v_mfma_f32_16x16x32_bf16 v[132:135], a[180:183], v[16:19], v[132:135]
    ds_read_b64_tr_b16 a[232:233], v62 offset:36352
    ds_read_b64_tr_b16 a[238:239], v63 offset:36360
    v_mul_f32 v13, s57, v13
    v_mfma_f32_16x16x32_bf16 v[136:139], a[184:187], v[16:19], v[136:139]
    v_exp_f32 v13, v13
    v_mfma_f32_16x16x32_bf16 v[140:143], a[188:191], v[16:19], v[140:143]
    v_mul_f32 v14, s57, v14
    v_cvt_pk_bf16_f32 v22, v12, v13
    v_mfma_f32_16x16x32_bf16 v[144:147], a[192:195], v[16:19], v[144:147]
    v_exp_f32 v14, v14
    v_mfma_f32_16x16x32_bf16 v[148:151], a[196:199], v[16:19], v[148:151]
    v_mul_f32 v15, s57, v15
    v_mul_f32 v0, s57, v0
    v_mfma_f32_16x16x32_bf16 v[152:155], a[200:203], v[16:19], v[152:155]
    v_exp_f32 v15, v15
    v_mfma_f32_16x16x32_bf16 v[156:159], a[204:207], v[16:19], v[156:159]
    ds_read_b64_tr_b16 a[236:237], v62 offset:36360
    v_cvt_pk_bf16_f32 v23, v14, v15
    v_mfma_f32_16x16x32_bf16 v[8:11], a[144:147], a[48:51], 0
    ds_read_b128 a[144:147], v56 offset:0
    v_exp_f32 v0, v0
    v_mfma_f32_16x16x32_bf16 v[8:11], a[148:151], a[52:55], v[8:11]
    ds_read_b128 a[148:151], v56 offset:512
    v_mul_f32 v1, s57, v1
    v_mfma_f32_16x16x32_bf16 v[8:11], a[152:155], a[56:59], v[8:11]
    v_exp_f32 v1, v1
    v_mul_f32 v2, s57, v2
    v_mfma_f32_16x16x32_bf16 v[8:11], a[156:159], a[60:63], v[8:11]
    ds_read_b128 a[152:155], v56 offset:1024
    v_exp_f32 v2, v2
    v_smfmac_f32_16x16x64_bf16 v[36:39], v[28:31], v[16:23], v48
    ds_read_b128 a[156:159], v56 offset:1536
    v_cvt_pk_bf16_f32 v16, v0, v1
    v_mul_f32 v3, s57, v3
    v_mfma_f32_16x16x32_bf16 v[12:15], a[172:175], a[60:63], 0
    ds_read_b128 a[172:175], v57 offset:1536
    s_waitcnt vmcnt(9)
    ds_read_b128 a[64:67], v50 offset:16384
    v_mfma_f32_16x16x32_bf16 v[12:15], a[168:171], a[56:59], v[12:15]
    ds_read_b128 a[68:71], v50 offset:16896
    v_exp_f32 v3, v3
    v_mfma_f32_16x16x32_bf16 v[12:15], a[164:167], a[52:55], v[12:15]
    ds_read_b128 a[72:75], v50 offset:17408
    v_mul_f32 v4, s57, v4
    v_cvt_pk_bf16_f32 v17, v2, v3
    v_mfma_f32_16x16x32_bf16 v[12:15], a[160:163], a[48:51], v[12:15]
    ds_read_b128 a[76:79], v50 offset:17920
    v_exp_f32 v4, v4
    v_mfma_f32_16x16x32_bf16 v[160:163], a[176:179], v[20:23], v[160:163]
    ds_read_b128 a[160:163], v57 offset:0
    v_mul_f32 v5, s57, v5
    v_mfma_f32_16x16x32_bf16 v[164:167], a[180:183], v[20:23], v[164:167]
    v_exp_f32 v5, v5
    v_mul_f32 v6, s57, v6
    v_mfma_f32_16x16x32_bf16 v[168:171], a[184:187], v[20:23], v[168:171]
    ds_read_b128 a[168:171], v57 offset:1024
    ds_read_b128 a[164:167], v57 offset:512
    v_cvt_pk_bf16_f32 v18, v4, v5
    v_mfma_f32_16x16x32_bf16 v[172:175], a[188:191], v[20:23], v[172:175]
    ds_read_b64_tr_b16 a[188:189], v60 offset:2568
    v_exp_f32 v6, v6
    v_mfma_f32_16x16x32_bf16 v[176:179], a[192:195], v[20:23], v[176:179]
    ds_read_b64_tr_b16 a[176:177], v60 offset:2048
    ds_read_b64_tr_b16 a[180:181], v60 offset:2056
    v_mul_f32 v7, s57, v7
    v_mfma_f32_16x16x32_bf16 v[180:183], a[196:199], v[20:23], v[180:183]
    ds_read_b64_tr_b16 a[182:183], v61 offset:2056
    v_exp_f32 v7, v7
    v_mfma_f32_16x16x32_bf16 v[184:187], a[200:203], v[20:23], v[184:187]
    v_cvt_pk_bf16_f32 v19, v6, v7
    v_mul_f32 v8, s57, v8
    v_mfma_f32_16x16x32_bf16 v[188:191], a[204:207], v[20:23], v[188:191]
    ds_read_b64_tr_b16 a[186:187], v61 offset:2560
    s_waitcnt lgkmcnt(13)
    s_waitcnt lgkmcnt(8)
    v_mfma_f32_16x16x32_bf16 v[0:3], a[144:147], a[64:67], 0
    ds_read_b64_tr_b16 a[184:185], v60 offset:2560
    v_exp_f32 v8, v8
    v_mfma_f32_16x16x32_bf16 v[0:3], a[148:151], a[68:71], v[0:3]
    ds_read_b64_tr_b16 a[178:179], v61 offset:2048
    ds_read_b64_tr_b16 a[190:191], v61 offset:2568
    v_mul_f32 v9, s57, v9
    v_mfma_f32_16x16x32_bf16 v[0:3], a[152:155], a[72:75], v[0:3]
    ds_read_b64_tr_b16 a[192:193], v60 offset:3072
    v_exp_f32 v9, v9
    v_mfma_f32_16x16x32_bf16 v[0:3], a[156:159], a[76:79], v[0:3]
    s_waitcnt lgkmcnt(9)
    v_mul_f32 v10, s57, v10
    v_cvt_pk_bf16_f32 v20, v8, v9
    v_mfma_f32_16x16x32_bf16 v[4:7], a[172:175], a[76:79], 0
    s_waitcnt vmcnt(5)
    v_exp_f32 v10, v10
    v_mfma_f32_16x16x32_bf16 v[4:7], a[168:171], a[72:75], v[4:7]
    ds_read_b64_tr_b16 a[198:199], v61 offset:3080
    ds_read_b128 a[84:87], v50 offset:20992
    v_mul_f32 v11, s57, v11
    v_mfma_f32_16x16x32_bf16 v[4:7], a[164:167], a[68:71], v[4:7]
    ds_read_b128 a[92:95], v50 offset:22016
    v_exp_f32 v11, v11
    v_mfma_f32_16x16x32_bf16 v[4:7], a[160:163], a[64:67], v[4:7]
    s_waitcnt lgkmcnt(15)
    v_mul_f32 v12, s57, v12
    v_cvt_pk_bf16_f32 v21, v10, v11
    v_mfma_f32_16x16x32_bf16 v[128:131], a[208:211], v[16:19], v[128:131]
    ds_read_b128 a[80:83], v50 offset:20480
    ds_read_b128 a[88:91], v50 offset:21504
    v_mfma_f32_16x16x32_bf16 v[132:135], a[212:215], v[16:19], v[132:135]
    ds_read_b64_tr_b16 a[200:201], v60 offset:3584
    ds_read_b64_tr_b16 a[204:205], v60 offset:3592
    ds_read_b64_tr_b16 a[206:207], v61 offset:3592
    v_mfma_f32_16x16x32_bf16 v[136:139], a[216:219], v[16:19], v[136:139]
    v_exp_f32 v12, v12
    v_mul_f32 v13, s57, v13
    v_mfma_f32_16x16x32_bf16 v[140:143], a[220:223], v[16:19], v[140:143]
    v_exp_f32 v13, v13
    v_mul_f32 v14, s57, v14
    v_mfma_f32_16x16x32_bf16 v[144:147], a[224:227], v[16:19], v[144:147]
    v_cvt_pk_bf16_f32 v22, v12, v13
    v_exp_f32 v14, v14
    v_mfma_f32_16x16x32_bf16 v[148:151], a[228:231], v[16:19], v[148:151]
    ds_read_b64_tr_b16 a[194:195], v61 offset:3072
    ds_read_b64_tr_b16 a[196:197], v60 offset:3080
    v_mul_f32 v15, s57, v15
    v_mfma_f32_16x16x32_bf16 v[152:155], a[232:235], v[16:19], v[152:155]
    v_exp_f32 v15, v15
    v_mul_f32 v0, s57, v0
    v_mfma_f32_16x16x32_bf16 v[156:159], a[236:239], v[16:19], v[156:159]
    s_waitcnt lgkmcnt(5)
    v_cvt_pk_bf16_f32 v23, v14, v15
    v_mfma_f32_16x16x32_bf16 v[8:11], a[144:147], a[80:83], 0
    ds_read_b64_tr_b16 a[202:203], v61 offset:3584
    v_mul_f32 v1, s57, v1
    v_mfma_f32_16x16x32_bf16 v[8:11], a[148:151], a[84:87], v[8:11]
    v_exp_f32 v0, v0
    v_mfma_f32_16x16x32_bf16 v[8:11], a[152:155], a[88:91], v[8:11]
    v_exp_f32 v1, v1
    v_mul_f32 v2, s57, v2
    v_mfma_f32_16x16x32_bf16 v[8:11], a[156:159], a[92:95], v[8:11]
    v_exp_f32 v2, v2
    v_smfmac_f32_16x16x64_bf16 v[36:39], v[28:31], v[16:23], v48
    v_cvt_pk_bf16_f32 v16, v0, v1
    v_mul_f32 v3, s57, v3
    v_mfma_f32_16x16x32_bf16 v[12:15], a[172:175], a[92:95], 0
    s_waitcnt vmcnt(1)
    ds_read_b128 a[96:99], v50 offset:8192
    ds_read_b128 a[100:103], v50 offset:8704
    v_mfma_f32_16x16x32_bf16 v[12:15], a[168:171], a[88:91], v[12:15]
    ds_read_b128 a[172:175], v59 offset:1536
    v_exp_f32 v3, v3
    v_mfma_f32_16x16x32_bf16 v[12:15], a[164:167], a[84:87], v[12:15]
    ds_read_b128 a[104:107], v50 offset:9216
    v_mul_f32 v4, s57, v4
    v_cvt_pk_bf16_f32 v17, v2, v3
    v_mfma_f32_16x16x32_bf16 v[12:15], a[160:163], a[80:83], v[12:15]
    ds_read_b128 a[164:167], v59 offset:512
    v_exp_f32 v4, v4
    v_mfma_f32_16x16x32_bf16 v[160:163], a[208:211], v[20:23], v[160:163]
    ds_read_b128 a[108:111], v50 offset:9728
    v_mul_f32 v5, s57, v5
    v_mfma_f32_16x16x32_bf16 v[164:167], a[212:215], v[20:23], v[164:167]
    ds_read_b128 a[160:163], v59 offset:0
    v_exp_f32 v5, v5
    v_mfma_f32_16x16x32_bf16 v[168:171], a[216:219], v[20:23], v[168:171]
    ds_read_b128 a[168:171], v59 offset:1024
    v_mul_f32 v6, s57, v6
    v_cvt_pk_bf16_f32 v18, v4, v5
    v_mfma_f32_16x16x32_bf16 v[172:175], a[220:223], v[20:23], v[172:175]
    ds_read_b64_tr_b16 a[216:217], v62 offset:2560
    v_exp_f32 v6, v6
    v_mfma_f32_16x16x32_bf16 v[176:179], a[224:227], v[20:23], v[176:179]
    ds_read_b64_tr_b16 a[208:209], v62 offset:2048
    ds_read_b64_tr_b16 a[210:211], v63 offset:2048
    v_mul_f32 v7, s57, v7
    v_mfma_f32_16x16x32_bf16 v[180:183], a[228:231], v[20:23], v[180:183]
    ds_read_b64_tr_b16 a[214:215], v63 offset:2056
    v_exp_f32 v7, v7
    v_mfma_f32_16x16x32_bf16 v[184:187], a[232:235], v[20:23], v[184:187]
    v_cvt_pk_bf16_f32 v19, v6, v7
    v_mul_f32 v8, s57, v8
    v_mfma_f32_16x16x32_bf16 v[188:191], a[236:239], v[20:23], v[188:191]
    ds_read_b64_tr_b16 a[212:213], v62 offset:2056
    s_waitcnt lgkmcnt(7)
    v_mfma_f32_16x16x32_bf16 v[0:3], a[144:147], a[96:99], 0
    v_exp_f32 v8, v8
    v_mul_f32 v9, s57, v9
    v_mfma_f32_16x16x32_bf16 v[0:3], a[148:151], a[100:103], v[0:3]
    ds_read_b128 a[144:147], v58 offset:0
    v_exp_f32 v9, v9
    v_mfma_f32_16x16x32_bf16 v[0:3], a[152:155], a[104:107], v[0:3]
    ds_read_b128 a[148:151], v58 offset:512
    v_mul_f32 v10, s57, v10
    v_cvt_pk_bf16_f32 v20, v8, v9
    v_mfma_f32_16x16x32_bf16 v[0:3], a[156:159], a[108:111], v[0:3]
    ds_read_b128 a[152:155], v58 offset:1024
    s_waitcnt lgkmcnt(15)
    v_mul_f32 v11, s57, v11
    v_mfma_f32_16x16x32_bf16 v[192:195], a[176:179], v[16:19], 0
    ds_read_b128 a[156:159], v58 offset:1536
    v_exp_f32 v10, v10
    v_mfma_f32_16x16x32_bf16 v[196:199], a[180:183], v[16:19], 0
    v_exp_f32 v11, v11
    v_mul_f32 v12, s57, v12
    v_mfma_f32_16x16x32_bf16 v[200:203], a[184:187], v[16:19], 0
    v_exp_f32 v12, v12
    v_mul_f32 v13, s57, v13
    v_mfma_f32_16x16x32_bf16 v[204:207], a[188:191], v[16:19], 0
    v_cvt_pk_bf16_f32 v21, v10, v11
    v_exp_f32 v13, v13
    v_mfma_f32_16x16x32_bf16 v[208:211], a[192:195], v[16:19], 0
    ds_read_b64_tr_b16 a[234:235], v63 offset:3584
    v_mul_f32 v14, s57, v14
    v_cvt_pk_bf16_f32 v22, v12, v13
    v_mfma_f32_16x16x32_bf16 v[212:215], a[196:199], v[16:19], 0
    v_exp_f32 v14, v14
    v_mul_f32 v15, s57, v15
    v_mfma_f32_16x16x32_bf16 v[216:219], a[200:203], v[16:19], 0
    v_exp_f32 v15, v15
    v_mul_f32 v0, s57, v0
    v_mfma_f32_16x16x32_bf16 v[220:223], a[204:207], v[16:19], 0
    s_waitcnt lgkmcnt(1)
    v_cvt_pk_bf16_f32 v23, v14, v15
    v_mfma_f32_16x16x32_bf16 v[8:11], a[144:147], a[64:67], 0
    ds_read_b64_tr_b16 a[218:219], v63 offset:2560
    ds_read_b64_tr_b16 a[238:239], v63 offset:3592
    v_mfma_f32_16x16x32_bf16 v[8:11], a[148:151], a[68:71], v[8:11]
    v_exp_f32 v0, v0
    v_mfma_f32_16x16x32_bf16 v[8:11], a[152:155], a[72:75], v[8:11]
    ds_read_b64_tr_b16 a[226:227], v63 offset:3072
    ds_read_b64_tr_b16 a[236:237], v62 offset:3592
    v_mfma_f32_16x16x32_bf16 v[8:11], a[156:159], a[76:79], v[8:11]
    ds_read_b64_tr_b16 a[228:229], v62 offset:3080
    v_mul_f32 v1, s57, v1
    v_smfmac_f32_16x16x64_bf16 v[40:43], v[28:31], v[16:23], v48
    s_waitcnt lgkmcnt(6)
    v_mfma_f32_16x16x32_bf16 v[12:15], a[172:175], a[76:79], 0
    v_exp_f32 v1, v1
    v_mfma_f32_16x16x32_bf16 v[12:15], a[168:171], a[72:75], v[12:15]
    ds_read_b64_tr_b16 a[232:233], v62 offset:3584
    v_cvt_pk_bf16_f32 v24, v0, v1
    v_mfma_f32_16x16x32_bf16 v[12:15], a[164:167], a[68:71], v[12:15]
    ds_read_b64_tr_b16 a[224:225], v62 offset:3072
    v_mul_f32 v2, s57, v2
    v_mfma_f32_16x16x32_bf16 v[12:15], a[160:163], a[64:67], v[12:15]
    ds_read_b64_tr_b16 a[220:221], v62 offset:2568
    ds_read_b64_tr_b16 a[222:223], v63 offset:2568
    v_mfma_f32_16x16x32_bf16 v[224:227], a[176:179], v[20:23], 0
    ds_read_b64_tr_b16 a[230:231], v63 offset:3080
    v_mul_f32 v3, s57, v3
    v_mfma_f32_16x16x32_bf16 v[228:231], a[180:183], v[20:23], 0
    v_exp_f32 v2, v2
    v_mfma_f32_16x16x32_bf16 v[232:235], a[184:187], v[20:23], 0
    v_exp_f32 v3, v3
    v_mfma_f32_16x16x32_bf16 v[236:239], a[188:191], v[20:23], 0
    v_cvt_pk_bf16_f32 v25, v2, v3
    v_mul_f32 v9, s57, v9
    v_mfma_f32_16x16x32_bf16 v[240:243], a[192:195], v[20:23], 0
    v_mul_f32 v8, s57, v8
    v_mul_f32 v13, s57, v13
    v_mfma_f32_16x16x32_bf16 v[244:247], a[196:199], v[20:23], 0
    v_exp_f32 v8, v8
    v_mfma_f32_16x16x32_bf16 v[248:251], a[200:203], v[20:23], 0
    s_mov_b32 m0, s50
    v_exp_f32 v9, v9
    v_mfma_f32_16x16x32_bf16 v[252:255], a[204:207], v[20:23], 0
    v_exp_f32 v13, v13
    v_mfma_f32_16x16x32_bf16 v[0:3], a[144:147], a[80:83], 0
    ds_read_b128 a[144:147], v56 offset:32768
    s_waitcnt lgkmcnt(1)
    s_barrier
    v_mfma_f32_16x16x32_bf16 v[0:3], a[148:151], a[84:87], v[0:3]
    ds_read_b128 a[148:151], v56 offset:33280
    v_mul_f32 v11, s57, v11
    v_mfma_f32_16x16x32_bf16 v[0:3], a[152:155], a[88:91], v[0:3]
    buffer_load_dwordx4 v49, s[4:7], s44 offen offset:0 lds
    v_mfma_f32_16x16x32_bf16 v[0:3], a[156:159], a[92:95], v[0:3]
    ds_read_b128 a[156:159], v56 offset:34304
    v_mul_f32 v10, s57, v10
    v_cvt_pk_bf16_f32 v16, v8, v9
    v_smfmac_f32_16x16x64_bf16 v[44:47], v[28:31], v[20:27], v48
    ds_read_b128 a[152:155], v56 offset:33792
    v_exp_f32 v10, v10
    v_mfma_f32_16x16x32_bf16 v[4:7], a[172:175], a[92:95], 0
    v_exp_f32 v11, v11
    v_mul_f32 v15, s57, v15
    v_mfma_f32_16x16x32_bf16 v[4:7], a[168:171], a[88:91], v[4:7]
    v_cvt_pk_bf16_f32 v17, v10, v11
    v_exp_f32 v15, v15
    v_mfma_f32_16x16x32_bf16 v[4:7], a[164:167], a[84:87], v[4:7]
    buffer_load_dwordx4 v49, s[8:11], s44 offen offset:1024 lds
    v_mul_f32 v12, s57, v12
    v_mfma_f32_16x16x32_bf16 v[4:7], a[160:163], a[80:83], v[4:7]
    ds_read_b128 a[168:171], v57 offset:33792
    v_exp_f32 v12, v12
    v_mfma_f32_16x16x16_bf16 a[112:115], a[176:177], v[24:25], 0
    ds_read_b128 a[172:175], v57 offset:34304
    ds_read_b128 a[160:163], v57 offset:32768
    v_mul_f32 v14, s57, v14
    v_mfma_f32_16x16x16_bf16 a[116:119], a[180:181], v[24:25], 0
    ds_read_b128 a[164:167], v57 offset:33280
    v_exp_f32 v14, v14
    v_mfma_f32_16x16x16_bf16 a[120:123], a[184:185], v[24:25], 0
    ds_read_b64_tr_b16 a[176:177], v60 offset:34816
    ds_read_b64_tr_b16 a[178:179], v61 offset:34816
    v_cvt_pk_bf16_f32 v18, v12, v13
    v_mfma_f32_16x16x16_bf16 a[124:127], a[188:189], v[24:25], 0
    buffer_load_dwordx4 v49, s[12:15], s44 offen offset:2048 lds
    v_mul_f32 v0, s57, v0
    v_mfma_f32_16x16x16_bf16 a[128:131], a[192:193], v[24:25], 0
    v_exp_f32 v0, v0
    v_mul_f32 v1, s57, v1
    v_mfma_f32_16x16x16_bf16 a[132:135], a[196:197], v[24:25], 0
    ds_read_b64_tr_b16 a[182:183], v61 offset:34824
    v_exp_f32 v1, v1
    v_mfma_f32_16x16x16_bf16 a[136:139], a[200:201], v[24:25], 0
    ds_read_b64_tr_b16 a[184:185], v60 offset:35328
    v_cvt_pk_bf16_f32 v19, v14, v15
    v_mul_f32 v2, s57, v2
    v_mfma_f32_16x16x16_bf16 a[140:143], a[204:205], v[24:25], 0
    s_waitcnt lgkmcnt(8)
    v_exp_f32 v2, v2
    v_mfma_f32_16x16x32_bf16 v[8:11], a[144:147], a[64:67], 0
    buffer_load_dwordx4 v49, s[16:19], s44 offen offset:3072 lds
    v_mfma_f32_16x16x32_bf16 v[8:11], a[148:151], a[68:71], v[8:11]
    ds_read_b64_tr_b16 a[180:181], v60 offset:34824
    ds_read_b64_tr_b16 a[188:189], v60 offset:35336
    s_add_u32 s44, s44, 8192
    v_mfma_f32_16x16x32_bf16 v[8:11], a[152:155], a[72:75], v[8:11]
    ds_read_b64_tr_b16 a[186:187], v61 offset:35328
    ds_read_b64_tr_b16 a[190:191], v61 offset:35336
    ds_read_b64_tr_b16 a[192:193], v60 offset:35840
    v_mfma_f32_16x16x32_bf16 v[8:11], a[156:159], a[76:79], v[8:11]
    ds_read_b64_tr_b16 a[194:195], v61 offset:35840
    s_waitcnt lgkmcnt(10)
    v_cvt_pk_bf16_f32 v20, v0, v1
    v_mfma_f32_16x16x32_bf16 v[12:15], a[172:175], a[76:79], 0
    ds_read_b64_tr_b16 a[198:199], v61 offset:35848
    s_mov_b32 m0, s51
    v_mfma_f32_16x16x32_bf16 v[12:15], a[168:171], a[72:75], v[12:15]
    buffer_load_dwordx4 v49, s[4:7], s44 offen offset:0 lds
    v_mul_f32 v3, s57, v3
    v_mfma_f32_16x16x32_bf16 v[12:15], a[164:167], a[68:71], v[12:15]
    ds_read_b64_tr_b16 a[200:201], v60 offset:36352
    v_exp_f32 v3, v3
    v_mfma_f32_16x16x32_bf16 v[12:15], a[160:163], a[64:67], v[12:15]
    ds_read_b64_tr_b16 a[202:203], v61 offset:36352
    s_waitcnt lgkmcnt(15)
    v_mul_f32 v4, s57, v4
    v_mfma_f32_16x16x32_bf16 v[192:195], a[208:211], v[16:19], v[192:195]
    v_cvt_pk_bf16_f32 v21, v2, v3
    v_exp_f32 v4, v4
    v_mfma_f32_16x16x32_bf16 v[196:199], a[212:215], v[16:19], v[196:199]
    ds_read_b64_tr_b16 a[206:207], v61 offset:36360
    v_mul_f32 v5, s57, v5
    v_mul_f32 v6, s57, v6
    v_mfma_f32_16x16x32_bf16 v[200:203], a[216:219], v[16:19], v[200:203]
    buffer_load_dwordx4 v49, s[8:11], s44 offen offset:1024 lds
    v_mfma_f32_16x16x32_bf16 v[204:207], a[220:223], v[16:19], v[204:207]
    ds_read_b64_tr_b16 a[196:197], v60 offset:35848
    v_exp_f32 v5, v5
    v_mfma_f32_16x16x32_bf16 v[208:211], a[224:227], v[16:19], v[208:211]
    v_cvt_pk_bf16_f32 v22, v4, v5
    v_exp_f32 v6, v6
    v_mfma_f32_16x16x32_bf16 v[212:215], a[228:231], v[16:19], v[212:215]
    ds_read_b64_tr_b16 a[204:205], v60 offset:36360
    v_mul_f32 v7, s57, v7
    v_mfma_f32_16x16x32_bf16 v[216:219], a[232:235], v[16:19], v[216:219]
    v_exp_f32 v7, v7
    v_mul_f32 v8, s57, v8
    v_mfma_f32_16x16x32_bf16 v[220:223], a[236:239], v[16:19], v[220:223]
    buffer_load_dwordx4 v49, s[12:15], s44 offen offset:2048 lds
    v_cvt_pk_bf16_f32 v23, v6, v7
    v_mfma_f32_16x16x32_bf16 v[0:3], a[144:147], a[80:83], 0
    v_exp_f32 v8, v8
    v_mfma_f32_16x16x32_bf16 v[0:3], a[148:151], a[84:87], v[0:3]
    v_mul_f32 v9, s57, v9
    v_mul_f32 v10, s57, v10
    v_mfma_f32_16x16x32_bf16 v[0:3], a[152:155], a[88:91], v[0:3]
    v_exp_f32 v9, v9
    v_mfma_f32_16x16x32_bf16 v[0:3], a[156:159], a[92:95], v[0:3]
    v_exp_f32 v10, v10
    v_mul_f32 v11, s57, v11
    v_smfmac_f32_16x16x64_bf16 v[40:43], v[28:31], v[16:23], v48
    buffer_load_dwordx4 v49, s[16:19], s44 offen offset:3072 lds
    v_cvt_pk_bf16_f32 v16, v8, v9
    v_mfma_f32_16x16x32_bf16 v[4:7], a[172:175], a[92:95], 0
    ds_read_b128 a[172:175], v59 offset:34304
    s_add_u32 s44, s44, 8192
    v_mul_f32 v13, s57, v13
    v_mfma_f32_16x16x32_bf16 v[4:7], a[168:171], a[88:91], v[4:7]
    v_exp_f32 v11, v11
    v_mul_f32 v12, s57, v12
    v_mfma_f32_16x16x32_bf16 v[4:7], a[164:167], a[84:87], v[4:7]
    ds_read_b128 a[168:171], v59 offset:33792
    ds_read_b128 a[164:167], v59 offset:33280
    v_cvt_pk_bf16_f32 v17, v10, v11
    v_mfma_f32_16x16x32_bf16 v[4:7], a[160:163], a[80:83], v[4:7]
    ds_read_b128 a[160:163], v59 offset:32768
    v_exp_f32 v12, v12
    v_mfma_f32_16x16x32_bf16 v[224:227], a[208:211], v[20:23], v[224:227]
    s_mov_b32 m0, s49
    v_exp_f32 v13, v13
    v_mfma_f32_16x16x32_bf16 v[228:231], a[212:215], v[20:23], v[228:231]
    buffer_load_dwordx4 v49, s[20:23], s46 offen offset:0 nt lds
    v_mul_f32 v14, s57, v14
    v_mfma_f32_16x16x32_bf16 v[232:235], a[216:219], v[20:23], v[232:235]
    v_cvt_pk_bf16_f32 v18, v12, v13
    v_exp_f32 v14, v14
    v_mfma_f32_16x16x32_bf16 v[236:239], a[220:223], v[20:23], v[236:239]
    ds_read_b64_tr_b16 a[210:211], v63 offset:34816
    ds_read_b64_tr_b16 a[214:215], v63 offset:34824
    v_mul_f32 v0, s57, v0
    v_mfma_f32_16x16x32_bf16 v[240:243], a[224:227], v[20:23], v[240:243]
    v_mul_f32 v15, s57, v15
    v_exp_f32 v0, v0
    v_mfma_f32_16x16x32_bf16 v[244:247], a[228:231], v[20:23], v[244:247]
    ds_read_b64_tr_b16 a[216:217], v62 offset:35328
    v_exp_f32 v15, v15
    v_mfma_f32_16x16x32_bf16 v[248:251], a[232:235], v[20:23], v[248:251]
    buffer_load_dwordx4 v49, s[24:27], s46 offen offset:1024 nt lds
    v_cvt_pk_bf16_f32 v19, v14, v15
    v_mfma_f32_16x16x32_bf16 v[252:255], a[236:239], v[20:23], v[252:255]
    ds_read_b64_tr_b16 a[218:219], v63 offset:35328
    ds_read_b64_tr_b16 a[224:225], v62 offset:35840
    v_mul_f32 v2, s57, v2
    v_mfma_f32_16x16x32_bf16 v[8:11], a[144:147], a[96:99], 0
    ds_read_b128 a[144:147], v58 offset:32768
    ds_read_b64_tr_b16 a[228:229], v62 offset:35848
    v_mul_f32 v1, s57, v1
    v_mfma_f32_16x16x32_bf16 v[8:11], a[148:151], a[100:103], v[8:11]
    ds_read_b128 a[148:151], v58 offset:33280
    v_exp_f32 v1, v1
    v_mfma_f32_16x16x32_bf16 v[8:11], a[152:155], a[104:107], v[8:11]
    ds_read_b128 a[152:155], v58 offset:33792
    v_cvt_pk_bf16_f32 v20, v0, v1
    v_mul_f32 v3, s57, v3
    v_mfma_f32_16x16x32_bf16 v[8:11], a[156:159], a[108:111], v[8:11]
    buffer_load_dwordx4 v49, s[20:23], s46 offen offset:2048 nt lds
    s_waitcnt lgkmcnt(13)
    v_mfma_f32_16x16x32_bf16 v[192:195], a[176:179], v[16:19], v[192:195]
    ds_read_b128 a[156:159], v58 offset:34304
    v_exp_f32 v2, v2
    v_mfma_f32_16x16x32_bf16 v[196:199], a[180:183], v[16:19], v[196:199]
    v_exp_f32 v3, v3
    v_mul_f32 v4, s57, v4
    v_mfma_f32_16x16x32_bf16 v[200:203], a[184:187], v[16:19], v[200:203]
    v_exp_f32 v4, v4
    v_mul_f32 v5, s57, v5
    v_mfma_f32_16x16x32_bf16 v[204:207], a[188:191], v[16:19], v[204:207]
    v_cvt_pk_bf16_f32 v21, v2, v3
    v_exp_f32 v5, v5
    v_mfma_f32_16x16x32_bf16 v[208:211], a[192:195], v[16:19], v[208:211]
    buffer_load_dwordx4 v49, s[24:27], s46 offen offset:3072 nt lds
    v_mul_f32 v6, s57, v6
    v_mfma_f32_16x16x32_bf16 v[212:215], a[196:199], v[16:19], v[212:215]
    s_add_u32 s49, s49, 6144
    s_add_u32 s46, s46, 4096
    v_mul_f32 v7, s57, v7
    v_mfma_f32_16x16x32_bf16 v[216:219], a[200:203], v[16:19], v[216:219]
    v_exp_f32 v6, v6
    v_mul_f32 v8, s57, v8
    v_mfma_f32_16x16x32_bf16 v[220:223], a[204:207], v[16:19], v[220:223]
    s_waitcnt lgkmcnt(0)
    v_exp_f32 v7, v7
    v_mfma_f32_16x16x32_bf16 v[0:3], a[144:147], a[64:67], 0
    ds_read_b64_tr_b16 a[208:209], v62 offset:34816
    s_add_u32 m0, s54, 4096
    v_cvt_pk_bf16_f32 v23, v6, v7
    v_mfma_f32_16x16x32_bf16 v[0:3], a[148:151], a[68:71], v[0:3]
    buffer_load_dwordx4 v49, s[20:23], s46 offen offset:0 nt lds
    v_cvt_pk_bf16_f32 v22, v4, v5
    v_mfma_f32_16x16x32_bf16 v[0:3], a[152:155], a[72:75], v[0:3]
    ds_read_b64_tr_b16 a[230:231], v63 offset:35848
    v_exp_f32 v8, v8
    v_mfma_f32_16x16x32_bf16 v[0:3], a[156:159], a[76:79], v[0:3]
    ds_read_b64_tr_b16 a[220:221], v62 offset:35336
    ds_read_b64_tr_b16 a[226:227], v63 offset:35840
    v_mul_f32 v9, s57, v9
    v_smfmac_f32_16x16x64_bf16 v[40:43], v[28:31], v[16:23], v48
    ds_read_b64_tr_b16 a[236:237], v62 offset:36360
    ds_read_b64_tr_b16 a[238:239], v63 offset:36360
    s_waitcnt lgkmcnt(6)
    v_mfma_f32_16x16x32_bf16 v[4:7], a[172:175], a[76:79], 0
    ds_read_b64_tr_b16 a[222:223], v63 offset:35336
    v_exp_f32 v9, v9
    v_mfma_f32_16x16x32_bf16 v[4:7], a[168:171], a[72:75], v[4:7]
    buffer_load_dwordx4 v49, s[24:27], s46 offen offset:1024 nt lds
    v_cvt_pk_bf16_f32 v24, v8, v9
    v_mfma_f32_16x16x32_bf16 v[4:7], a[164:167], a[68:71], v[4:7]
    s_add_u32 s46, s46, 2048
    v_mul_f32 v10, s57, v10
    v_mfma_f32_16x16x32_bf16 v[4:7], a[160:163], a[64:67], v[4:7]
    v_exp_f32 v10, v10
    v_mfma_f32_16x16x32_bf16 v[224:227], a[176:179], v[20:23], v[224:227]
    ds_read_b64_tr_b16 a[232:233], v62 offset:36352
    v_mul_f32 v11, s57, v11
    v_mfma_f32_16x16x32_bf16 v[228:231], a[180:183], v[20:23], v[228:231]
    ds_read_b64_tr_b16 a[212:213], v62 offset:34824
    ds_read_b64_tr_b16 a[234:235], v63 offset:36352
    v_mfma_f32_16x16x32_bf16 v[232:235], a[184:187], v[20:23], v[232:235]
    v_exp_f32 v11, v11
    v_mfma_f32_16x16x32_bf16 v[236:239], a[188:191], v[20:23], v[236:239]
    v_mul_f32 v2, s57, v2
    v_mul_f32 v3, s57, v3
    v_mfma_f32_16x16x32_bf16 v[240:243], a[192:195], v[20:23], v[240:243]
    v_cvt_pk_bf16_f32 v25, v10, v11
    v_mul_f32 v1, s57, v1
    v_mfma_f32_16x16x32_bf16 v[244:247], a[196:199], v[20:23], v[244:247]
    v_mul_f32 v0, s57, v0
    v_exp_f32 v2, v2
    v_mfma_f32_16x16x32_bf16 v[248:251], a[200:203], v[20:23], v[248:251]
    v_exp_f32 v3, v3
    v_mfma_f32_16x16x32_bf16 v[252:255], a[204:207], v[20:23], v[252:255]
    s_mov_b32 m0, s52
    v_exp_f32 v0, v0
    v_mfma_f32_16x16x32_bf16 v[8:11], a[144:147], a[80:83], 0
    s_waitcnt vmcnt(6)
    s_waitcnt lgkmcnt(0)
    s_barrier
    v_mfma_f32_16x16x32_bf16 v[8:11], a[148:151], a[84:87], v[8:11]
    ds_read_b128 a[148:151], v56 offset:512
    v_exp_f32 v1, v1
    v_mfma_f32_16x16x32_bf16 v[8:11], a[152:155], a[88:91], v[8:11]
    buffer_load_dwordx4 v49, s[4:7], s44 offen offset:0 lds
    v_cvt_pk_bf16_f32 v16, v0, v1
    v_mfma_f32_16x16x32_bf16 v[8:11], a[156:159], a[92:95], v[8:11]
    ds_read_b128 a[144:147], v56 offset:0
    ds_read_b128 a[152:155], v56 offset:1024
    ds_read_b128 a[156:159], v56 offset:1536
    v_smfmac_f32_16x16x64_bf16 v[44:47], v[28:31], v[20:27], v48
    v_cvt_pk_bf16_f32 v17, v2, v3
    v_mul_f32 v5, s57, v5
    v_mul_f32 v7, s57, v7
    v_mfma_f32_16x16x32_bf16 v[12:15], a[172:175], a[92:95], 0
    ds_read_b128 a[172:175], v57 offset:1536
    v_exp_f32 v7, v7
    v_mfma_f32_16x16x32_bf16 v[12:15], a[168:171], a[88:91], v[12:15]
    ds_read_b128 a[168:171], v57 offset:1024
    v_exp_f32 v5, v5
    v_mfma_f32_16x16x32_bf16 v[12:15], a[164:167], a[84:87], v[12:15]
    buffer_load_dwordx4 v49, s[8:11], s44 offen offset:1024 lds
    v_mul_f32 v4, s57, v4
    v_mfma_f32_16x16x32_bf16 v[12:15], a[160:163], a[80:83], v[12:15]
    v_exp_f32 v4, v4
    v_mul_f32 v6, s57, v6
    v_mfma_f32_16x16x16_bf16 a[112:115], a[176:177], v[24:25], a[112:115]
    ds_read_b128 a[164:167], v57 offset:512
    v_exp_f32 v6, v6
    v_mfma_f32_16x16x16_bf16 a[116:119], a[180:181], v[24:25], a[116:119]
    ds_read_b64_tr_b16 a[176:177], v60 offset:2048
    ds_read_b64_tr_b16 a[180:181], v60 offset:2056
    ds_read_b64_tr_b16 a[182:183], v61 offset:2056
    v_mfma_f32_16x16x16_bf16 a[120:123], a[184:185], v[24:25], a[120:123]
    ds_read_b128 a[160:163], v57 offset:0
    ds_read_b64_tr_b16 a[178:179], v61 offset:2048
    v_cvt_pk_bf16_f32 v18, v4, v5
    v_mfma_f32_16x16x16_bf16 a[124:127], a[188:189], v[24:25], a[124:127]
    buffer_load_dwordx4 v49, s[12:15], s44 offen offset:2048 lds
    v_mul_f32 v8, s57, v8
    v_mfma_f32_16x16x16_bf16 a[128:131], a[192:193], v[24:25], a[128:131]
    ds_read_b64_tr_b16 a[186:187], v61 offset:2560
    ds_read_b64_tr_b16 a[190:191], v61 offset:2568
    ds_read_b64_tr_b16 a[194:195], v61 offset:3072
    v_mfma_f32_16x16x16_bf16 a[132:135], a[196:197], v[24:25], a[132:135]
    ds_read_b64_tr_b16 a[196:197], v60 offset:3080
    v_exp_f32 v8, v8
    v_mfma_f32_16x16x16_bf16 a[136:139], a[200:201], v[24:25], a[136:139]
    ds_read_b64_tr_b16 a[188:189], v60 offset:2568
    ds_read_b64_tr_b16 a[198:199], v61 offset:3080
    v_cvt_pk_bf16_f32 v19, v6, v7
    v_mfma_f32_16x16x16_bf16 a[140:143], a[204:205], v[24:25], a[140:143]
    buffer_load_dwordx4 v49, s[16:19], s44 offen offset:3072 lds
    s_waitcnt lgkmcnt(14)
    v_mfma_f32_16x16x32_bf16 v[0:3], a[144:147], a[0:3], 0
    ds_read_b64_tr_b16 a[184:185], v60 offset:2560
    ds_read_b64_tr_b16 a[192:193], v60 offset:3072
    ds_read_b64_tr_b16 a[202:203], v61 offset:3584
    v_mfma_f32_16x16x32_bf16 v[0:3], a[148:151], a[4:7], v[0:3]
    ds_read_b64_tr_b16 a[200:201], v60 offset:3584
    s_add_u32 s44, s44, 8192
    v_mul_f32 v9, s57, v9
    v_mfma_f32_16x16x32_bf16 v[0:3], a[152:155], a[8:11], v[0:3]
    v_exp_f32 v9, v9
    v_mul_f32 v10, s57, v10
    v_mfma_f32_16x16x32_bf16 v[0:3], a[156:159], a[12:15], v[0:3]
    s_waitcnt lgkmcnt(11)
    v_exp_f32 v10, v10
    v_mfma_f32_16x16x32_bf16 v[4:7], a[172:175], a[12:15], 0
    ds_read_b64_tr_b16 a[204:205], v60 offset:3592
    s_mov_b32 m0, s53
    v_cvt_pk_bf16_f32 v20, v8, v9
    v_mfma_f32_16x16x32_bf16 v[4:7], a[168:171], a[8:11], v[4:7]
    buffer_load_dwordx4 v49, s[4:7], s44 offen offset:0 lds
    v_mul_f32 v11, s57, v11
    v_mfma_f32_16x16x32_bf16 v[4:7], a[164:167], a[4:7], v[4:7]
    ds_read_b64_tr_b16 a[206:207], v61 offset:3592
    v_mul_f32 v12, s57, v12
    v_mul_f32 v14, s57, v14
    v_mfma_f32_16x16x32_bf16 v[4:7], a[160:163], a[0:3], v[4:7]
    s_waitcnt lgkmcnt(15)
    v_exp_f32 v11, v11
    v_mfma_f32_16x16x32_bf16 v[192:195], a[208:211], v[16:19], v[192:195]
    buffer_load_dwordx4 v49, s[8:11], s44 offen offset:1024 lds
    v_cvt_pk_bf16_f32 v21, v10, v11
    v_mfma_f32_16x16x32_bf16 v[196:199], a[212:215], v[16:19], v[196:199]
    v_exp_f32 v12, v12
    v_mul_f32 v13, s57, v13
    v_mfma_f32_16x16x32_bf16 v[200:203], a[216:219], v[16:19], v[200:203]
    v_exp_f32 v13, v13
    v_mul_f32 v15, s57, v15
    v_mfma_f32_16x16x32_bf16 v[204:207], a[220:223], v[16:19], v[204:207]
    buffer_load_dwordx4 v49, s[12:15], s44 offen offset:2048 lds
    v_cvt_pk_bf16_f32 v22, v12, v13
    v_mfma_f32_16x16x32_bf16 v[208:211], a[224:227], v[16:19], v[208:211]
    v_exp_f32 v14, v14
    v_exp_f32 v15, v15
    v_mfma_f32_16x16x32_bf16 v[212:215], a[228:231], v[16:19], v[212:215]
    s_waitcnt lgkmcnt(0)
    v_cvt_pk_bf16_f32 v23, v14, v15
    v_mul_f32 v0, s57, v0
    v_mfma_f32_16x16x32_bf16 v[216:219], a[232:235], v[16:19], v[216:219]
    buffer_load_dwordx4 v49, s[16:19], s44 offen offset:3072 lds
    s_add_u32 s44, s44, 8192
    v_mfma_f32_16x16x32_bf16 v[220:223], a[236:239], v[16:19], v[220:223]
    s_branch L_B_T4
L_A_S0:
    v_mfma_f32_16x16x32_bf16 v[8:11], a[144:147], a[16:19], 0
    v_exp_f32 v0, v0
    v_mfma_f32_16x16x32_bf16 v[8:11], a[148:151], a[20:23], v[8:11]
    v_mul_f32 v1, s57, v1
    v_mfma_f32_16x16x32_bf16 v[8:11], a[152:155], a[24:27], v[8:11]
    v_exp_f32 v1, v1
    v_mfma_f32_16x16x32_bf16 v[8:11], a[156:159], a[28:31], v[8:11]
    v_mul_f32 v2, s57, v2
    v_mul_f32 v3, s57, v3
    v_smfmac_f32_16x16x64_bf16 v[40:43], v[28:31], v[16:23], v48
    v_cvt_pk_bf16_f32 v16, v0, v1
    v_mfma_f32_16x16x32_bf16 v[12:15], a[172:175], a[28:31], 0
    v_exp_f32 v2, v2
    v_mfma_f32_16x16x32_bf16 v[12:15], a[168:171], a[24:27], v[12:15]
    v_exp_f32 v3, v3
    v_mfma_f32_16x16x32_bf16 v[12:15], a[164:167], a[20:23], v[12:15]
    v_mul_f32 v4, s57, v4
    v_cvt_pk_bf16_f32 v17, v2, v3
    v_mfma_f32_16x16x32_bf16 v[12:15], a[160:163], a[16:19], v[12:15]
    v_exp_f32 v4, v4
    v_mfma_f32_16x16x32_bf16 v[224:227], a[208:211], v[20:23], v[224:227]
    v_mul_f32 v5, s57, v5
    v_mfma_f32_16x16x32_bf16 v[228:231], a[212:215], v[20:23], v[228:231]
    v_exp_f32 v5, v5
    v_mfma_f32_16x16x32_bf16 v[232:235], a[216:219], v[20:23], v[232:235]
    v_mul_f32 v6, s57, v6
    v_cvt_pk_bf16_f32 v18, v4, v5
    v_mfma_f32_16x16x32_bf16 v[236:239], a[220:223], v[20:23], v[236:239]
    v_exp_f32 v6, v6
    v_mfma_f32_16x16x32_bf16 v[240:243], a[224:227], v[20:23], v[240:243]
    v_mul_f32 v7, s57, v7
    v_mfma_f32_16x16x32_bf16 v[244:247], a[228:231], v[20:23], v[244:247]
    v_exp_f32 v7, v7
    v_mfma_f32_16x16x32_bf16 v[248:251], a[232:235], v[20:23], v[248:251]
    v_cvt_pk_bf16_f32 v19, v6, v7
    v_mul_f32 v8, s57, v8
    v_mfma_f32_16x16x32_bf16 v[252:255], a[236:239], v[20:23], v[252:255]
    s_sub_u32 s68, 86016, s54
    s_lshl_b32 s69, s61, 11
    s_sub_u32 s69, s69, 16384
    v_add_u32 v26, s68, v51
    v_add_u32 v27, 0x12000, v26
    v_add_u32 v24, s69, v26
    v_add_u32 v25, s69, v27
    s_barrier
    v_pk_add_f32 v[34:35], v[32:33], v[34:35]
    v_pk_add_f32 v[38:39], v[36:37], v[38:39]
    v_pk_add_f32 v[42:43], v[40:41], v[42:43]
    v_rcp_f32 v32, v34
    v_rcp_f32 v33, v35
    v_rcp_f32 v36, v38
    v_rcp_f32 v37, v39
    v_rcp_f32 v40, v42
    v_rcp_f32 v41, v43
    v_max3_u32 v54, v34, v35, v38
    v_max3_u32 v54, v54, v39, v42
    v_min3_u32 v55, v34, v35, v38
    v_min3_u32 v55, v55, v39, v42
    v_pk_mul_f32 v[160:161], v[160:161], v[36:37] op_sel:[0,1] op_sel_hi:[1,1]
    v_pk_mul_f32 v[162:163], v[162:163], v[36:37] op_sel:[0,1] op_sel_hi:[1,1]
    v_pk_mul_f32 v[164:165], v[164:165], v[36:37] op_sel:[0,1] op_sel_hi:[1,1]
    v_pk_mul_f32 v[166:167], v[166:167], v[36:37] op_sel:[0,1] op_sel_hi:[1,1]
    v_cvt_pk_bf16_f32 v160, v160, v161
    v_cvt_pk_bf16_f32 v161, v162, v163
    v_cvt_pk_bf16_f32 v162, v164, v165
    v_cvt_pk_bf16_f32 v163, v166, v167
    ds_write_b128 v50, v[160:163] offset:12288
    v_pk_mul_f32 v[168:169], v[168:169], v[36:37] op_sel:[0,1] op_sel_hi:[1,1]
    v_pk_mul_f32 v[170:171], v[170:171], v[36:37] op_sel:[0,1] op_sel_hi:[1,1]
    v_pk_mul_f32 v[172:173], v[172:173], v[36:37] op_sel:[0,1] op_sel_hi:[1,1]
    v_pk_mul_f32 v[174:175], v[174:175], v[36:37] op_sel:[0,1] op_sel_hi:[1,1]
    v_cvt_pk_bf16_f32 v168, v168, v169
    v_cvt_pk_bf16_f32 v169, v170, v171
    v_cvt_pk_bf16_f32 v170, v172, v173
    v_cvt_pk_bf16_f32 v171, v174, v175
    ds_write_b128 v50, v[168:171] offset:12800
    v_pk_mul_f32 v[176:177], v[176:177], v[36:37] op_sel:[0,1] op_sel_hi:[1,1]
    v_pk_mul_f32 v[178:179], v[178:179], v[36:37] op_sel:[0,1] op_sel_hi:[1,1]
    v_pk_mul_f32 v[180:181], v[180:181], v[36:37] op_sel:[0,1] op_sel_hi:[1,1]
    v_pk_mul_f32 v[182:183], v[182:183], v[36:37] op_sel:[0,1] op_sel_hi:[1,1]
    v_cvt_pk_bf16_f32 v176, v176, v177
    v_cvt_pk_bf16_f32 v177, v178, v179
    v_cvt_pk_bf16_f32 v178, v180, v181
    v_cvt_pk_bf16_f32 v179, v182, v183
    ds_write_b128 v50, v[176:179] offset:13312
    v_pk_mul_f32 v[184:185], v[184:185], v[36:37] op_sel:[0,1] op_sel_hi:[1,1]
    v_pk_mul_f32 v[186:187], v[186:187], v[36:37] op_sel:[0,1] op_sel_hi:[1,1]
    v_pk_mul_f32 v[188:189], v[188:189], v[36:37] op_sel:[0,1] op_sel_hi:[1,1]
    v_pk_mul_f32 v[190:191], v[190:191], v[36:37] op_sel:[0,1] op_sel_hi:[1,1]
    v_cvt_pk_bf16_f32 v184, v184, v185
    v_cvt_pk_bf16_f32 v185, v186, v187
    v_cvt_pk_bf16_f32 v186, v188, v189
    v_cvt_pk_bf16_f32 v187, v190, v191
    ds_write_b128 v50, v[184:187] offset:13824
    ds_read_b128 v[160:163], v24 offset:0
    ds_read_b128 v[164:167], v24 offset:1024
    ds_read_b128 v[168:171], v24 offset:24576
    ds_read_b128 v[172:175], v24 offset:25600
    ds_read_b128 v[176:179], v24 offset:49152
    ds_read_b128 v[180:183], v24 offset:50176
    ds_read_b128 v[184:187], v25 offset:0
    ds_read_b128 v[188:191], v25 offset:1024
    ds_read_b32 v44, v26 offset:0
    ds_read_b32 v45, v26 offset:24576
    ds_read_b32 v46, v26 offset:49152
    ds_read_b32 v47, v27
    v_pk_mul_f32 v[192:193], v[192:193], v[40:41] op_sel:[0,0] op_sel_hi:[1,0]
    v_pk_mul_f32 v[194:195], v[194:195], v[40:41] op_sel:[0,0] op_sel_hi:[1,0]
    v_pk_mul_f32 v[196:197], v[196:197], v[40:41] op_sel:[0,0] op_sel_hi:[1,0]
    v_pk_mul_f32 v[198:199], v[198:199], v[40:41] op_sel:[0,0] op_sel_hi:[1,0]
    v_cvt_pk_bf16_f32 v192, v192, v193
    v_cvt_pk_bf16_f32 v193, v194, v195
    v_cvt_pk_bf16_f32 v194, v196, v197
    v_cvt_pk_bf16_f32 v195, v198, v199
    ds_write_b128 v50, v[192:195] offset:16384
    v_pk_mul_f32 v[200:201], v[200:201], v[40:41] op_sel:[0,0] op_sel_hi:[1,0]
    v_pk_mul_f32 v[202:203], v[202:203], v[40:41] op_sel:[0,0] op_sel_hi:[1,0]
    v_pk_mul_f32 v[204:205], v[204:205], v[40:41] op_sel:[0,0] op_sel_hi:[1,0]
    v_pk_mul_f32 v[206:207], v[206:207], v[40:41] op_sel:[0,0] op_sel_hi:[1,0]
    v_cvt_pk_bf16_f32 v200, v200, v201
    v_cvt_pk_bf16_f32 v201, v202, v203
    v_cvt_pk_bf16_f32 v202, v204, v205
    v_cvt_pk_bf16_f32 v203, v206, v207
    ds_write_b128 v50, v[200:203] offset:16896
    v_pk_mul_f32 v[208:209], v[208:209], v[40:41] op_sel:[0,0] op_sel_hi:[1,0]
    v_pk_mul_f32 v[210:211], v[210:211], v[40:41] op_sel:[0,0] op_sel_hi:[1,0]
    v_pk_mul_f32 v[212:213], v[212:213], v[40:41] op_sel:[0,0] op_sel_hi:[1,0]
    v_pk_mul_f32 v[214:215], v[214:215], v[40:41] op_sel:[0,0] op_sel_hi:[1,0]
    v_cvt_pk_bf16_f32 v208, v208, v209
    v_cvt_pk_bf16_f32 v209, v210, v211
    v_cvt_pk_bf16_f32 v210, v212, v213
    v_cvt_pk_bf16_f32 v211, v214, v215
    ds_write_b128 v50, v[208:211] offset:17408
    v_pk_mul_f32 v[216:217], v[216:217], v[40:41] op_sel:[0,0] op_sel_hi:[1,0]
    v_pk_mul_f32 v[218:219], v[218:219], v[40:41] op_sel:[0,0] op_sel_hi:[1,0]
    v_pk_mul_f32 v[220:221], v[220:221], v[40:41] op_sel:[0,0] op_sel_hi:[1,0]
    v_pk_mul_f32 v[222:223], v[222:223], v[40:41] op_sel:[0,0] op_sel_hi:[1,0]
    v_cvt_pk_bf16_f32 v216, v216, v217
    v_cvt_pk_bf16_f32 v217, v218, v219
    v_cvt_pk_bf16_f32 v218, v220, v221
    v_cvt_pk_bf16_f32 v219, v222, v223
    ds_write_b128 v50, v[216:219] offset:17920
    s_waitcnt lgkmcnt(4)
    s_barrier
    v_pk_add_f32 v[46:47], v[44:45], v[46:47]
    v_pk_add_f32 v[160:161], v[160:161], v[168:169]
    v_pk_add_f32 v[162:163], v[162:163], v[170:171]
    v_pk_add_f32 v[164:165], v[164:165], v[172:173]
    v_pk_add_f32 v[166:167], v[166:167], v[174:175]
    v_pk_add_f32 v[176:177], v[176:177], v[184:185]
    v_pk_add_f32 v[178:179], v[178:179], v[186:187]
    v_pk_add_f32 v[180:181], v[180:181], v[188:189]
    v_pk_add_f32 v[182:183], v[182:183], v[190:191]
    v_add_f32 v47, v46, v47
    v_rcp_f32 v45, v47
    v_pk_add_f32 v[160:161], v[160:161], v[176:177]
    v_pk_add_f32 v[162:163], v[162:163], v[178:179]
    v_pk_add_f32 v[164:165], v[164:165], v[180:181]
    v_pk_add_f32 v[166:167], v[166:167], v[182:183]
    v_pk_mul_f32 v[160:161], v[160:161], v[44:45] op_sel:[0,1] op_sel_hi:[1,1]
    v_pk_mul_f32 v[162:163], v[162:163], v[44:45] op_sel:[0,1] op_sel_hi:[1,1]
    v_pk_mul_f32 v[164:165], v[164:165], v[44:45] op_sel:[0,1] op_sel_hi:[1,1]
    v_pk_mul_f32 v[166:167], v[166:167], v[44:45] op_sel:[0,1] op_sel_hi:[1,1]
    v_cvt_pk_bf16_f32 v160, v160, v161
    v_cvt_pk_bf16_f32 v161, v162, v163
    v_cvt_pk_bf16_f32 v162, v164, v165
    v_cvt_pk_bf16_f32 v163, v166, v167
    v_lshlrev_b32 v168, 4, v26
    v_and_b32 v168, 0xf00, v168
    v_bfe_u32 v169, v26, 8, 2
    s_lshl_b32 s68, s61, 6
    v_lshl_add_u32 v168, v169, 4, v168
    s_add_u32 s68, s68, s65
    buffer_store_dwordx4 v[160:163], v168, s[36:39], s68 offen nt
    v_max3_u32 v54, v54, v43, v47
    v_min3_u32 v55, v55, v43, v47
    v_pk_mul_f32 v[96:97], v[96:97], v[32:33] op_sel:[0,1] op_sel_hi:[1,1]
    v_pk_mul_f32 v[98:99], v[98:99], v[32:33] op_sel:[0,1] op_sel_hi:[1,1]
    v_pk_mul_f32 v[100:101], v[100:101], v[32:33] op_sel:[0,1] op_sel_hi:[1,1]
    v_pk_mul_f32 v[102:103], v[102:103], v[32:33] op_sel:[0,1] op_sel_hi:[1,1]
    v_cvt_pk_bf16_f32 v96, v96, v97
    v_cvt_pk_bf16_f32 v97, v98, v99
    v_cvt_pk_bf16_f32 v98, v100, v101
    v_cvt_pk_bf16_f32 v99, v102, v103
    ds_write_b128 v50, v[96:99] offset:4096
    v_pk_mul_f32 v[104:105], v[104:105], v[32:33] op_sel:[0,1] op_sel_hi:[1,1]
    v_pk_mul_f32 v[106:107], v[106:107], v[32:33] op_sel:[0,1] op_sel_hi:[1,1]
    v_pk_mul_f32 v[108:109], v[108:109], v[32:33] op_sel:[0,1] op_sel_hi:[1,1]
    v_pk_mul_f32 v[110:111], v[110:111], v[32:33] op_sel:[0,1] op_sel_hi:[1,1]
    v_cvt_pk_bf16_f32 v104, v104, v105
    v_cvt_pk_bf16_f32 v105, v106, v107
    v_cvt_pk_bf16_f32 v106, v108, v109
    v_cvt_pk_bf16_f32 v107, v110, v111
    ds_write_b128 v50, v[104:107] offset:4608
    v_pk_mul_f32 v[112:113], v[112:113], v[32:33] op_sel:[0,1] op_sel_hi:[1,1]
    v_pk_mul_f32 v[114:115], v[114:115], v[32:33] op_sel:[0,1] op_sel_hi:[1,1]
    v_pk_mul_f32 v[116:117], v[116:117], v[32:33] op_sel:[0,1] op_sel_hi:[1,1]
    v_pk_mul_f32 v[118:119], v[118:119], v[32:33] op_sel:[0,1] op_sel_hi:[1,1]
    v_cvt_pk_bf16_f32 v112, v112, v113
    v_cvt_pk_bf16_f32 v113, v114, v115
    v_cvt_pk_bf16_f32 v114, v116, v117
    v_cvt_pk_bf16_f32 v115, v118, v119
    ds_write_b128 v50, v[112:115] offset:5120
    v_pk_mul_f32 v[120:121], v[120:121], v[32:33] op_sel:[0,1] op_sel_hi:[1,1]
    v_pk_mul_f32 v[122:123], v[122:123], v[32:33] op_sel:[0,1] op_sel_hi:[1,1]
    v_pk_mul_f32 v[124:125], v[124:125], v[32:33] op_sel:[0,1] op_sel_hi:[1,1]
    v_pk_mul_f32 v[126:127], v[126:127], v[32:33] op_sel:[0,1] op_sel_hi:[1,1]
    v_cvt_pk_bf16_f32 v120, v120, v121
    v_cvt_pk_bf16_f32 v121, v122, v123
    v_cvt_pk_bf16_f32 v122, v124, v125
    v_cvt_pk_bf16_f32 v123, v126, v127
    ds_write_b128 v50, v[120:123] offset:5632
    v_pk_mul_f32 v[128:129], v[128:129], v[36:37] op_sel:[0,0] op_sel_hi:[1,0]
    v_pk_mul_f32 v[130:131], v[130:131], v[36:37] op_sel:[0,0] op_sel_hi:[1,0]
    v_pk_mul_f32 v[132:133], v[132:133], v[36:37] op_sel:[0,0] op_sel_hi:[1,0]
    v_pk_mul_f32 v[134:135], v[134:135], v[36:37] op_sel:[0,0] op_sel_hi:[1,0]
    v_cvt_pk_bf16_f32 v128, v128, v129
    v_cvt_pk_bf16_f32 v129, v130, v131
    v_cvt_pk_bf16_f32 v130, v132, v133
    v_cvt_pk_bf16_f32 v131, v134, v135
    ds_write_b128 v50, v[128:131] offset:8192
    v_pk_mul_f32 v[136:137], v[136:137], v[36:37] op_sel:[0,0] op_sel_hi:[1,0]
    v_pk_mul_f32 v[138:139], v[138:139], v[36:37] op_sel:[0,0] op_sel_hi:[1,0]
    v_pk_mul_f32 v[140:141], v[140:141], v[36:37] op_sel:[0,0] op_sel_hi:[1,0]
    v_pk_mul_f32 v[142:143], v[142:143], v[36:37] op_sel:[0,0] op_sel_hi:[1,0]
    v_cvt_pk_bf16_f32 v136, v136, v137
    v_cvt_pk_bf16_f32 v137, v138, v139
    v_cvt_pk_bf16_f32 v138, v140, v141
    v_cvt_pk_bf16_f32 v139, v142, v143
    ds_write_b128 v50, v[136:139] offset:8704
    v_pk_mul_f32 v[144:145], v[144:145], v[36:37] op_sel:[0,0] op_sel_hi:[1,0]
    v_pk_mul_f32 v[146:147], v[146:147], v[36:37] op_sel:[0,0] op_sel_hi:[1,0]
    v_pk_mul_f32 v[148:149], v[148:149], v[36:37] op_sel:[0,0] op_sel_hi:[1,0]
    v_pk_mul_f32 v[150:151], v[150:151], v[36:37] op_sel:[0,0] op_sel_hi:[1,0]
    v_cvt_pk_bf16_f32 v144, v144, v145
    v_cvt_pk_bf16_f32 v145, v146, v147
    v_cvt_pk_bf16_f32 v146, v148, v149
    v_cvt_pk_bf16_f32 v147, v150, v151
    ds_write_b128 v50, v[144:147] offset:9216
    v_pk_mul_f32 v[152:153], v[152:153], v[36:37] op_sel:[0,0] op_sel_hi:[1,0]
    v_pk_mul_f32 v[154:155], v[154:155], v[36:37] op_sel:[0,0] op_sel_hi:[1,0]
    v_pk_mul_f32 v[156:157], v[156:157], v[36:37] op_sel:[0,0] op_sel_hi:[1,0]
    v_pk_mul_f32 v[158:159], v[158:159], v[36:37] op_sel:[0,0] op_sel_hi:[1,0]
    v_cvt_pk_bf16_f32 v152, v152, v153
    v_cvt_pk_bf16_f32 v153, v154, v155
    v_cvt_pk_bf16_f32 v154, v156, v157
    v_cvt_pk_bf16_f32 v155, v158, v159
    ds_write_b128 v50, v[152:155] offset:9728
    s_mov_b32 s48, s63
    s_waitcnt vmcnt(5)
    ds_read_b128 a[96:99], v50 offset:0
    ds_read_b128 a[100:103], v50 offset:512
    ds_read_b128 a[104:107], v50 offset:1024
    ds_read_b128 a[108:111], v50 offset:1536
    v_pk_mul_f32 v[64:65], v[64:65], v[32:33] op_sel:[0,0] op_sel_hi:[1,0]
    v_pk_mul_f32 v[66:67], v[66:67], v[32:33] op_sel:[0,0] op_sel_hi:[1,0]
    v_pk_mul_f32 v[68:69], v[68:69], v[32:33] op_sel:[0,0] op_sel_hi:[1,0]
    v_pk_mul_f32 v[70:71], v[70:71], v[32:33] op_sel:[0,0] op_sel_hi:[1,0]
    v_cvt_pk_bf16_f32 v64, v64, v65
    v_cvt_pk_bf16_f32 v65, v66, v67
    v_cvt_pk_bf16_f32 v66, v68, v69
    v_cvt_pk_bf16_f32 v67, v70, v71
    ds_write_b128 v50, v[64:67] offset:0
    v_pk_mul_f32 v[72:73], v[72:73], v[32:33] op_sel:[0,0] op_sel_hi:[1,0]
    v_pk_mul_f32 v[74:75], v[74:75], v[32:33] op_sel:[0,0] op_sel_hi:[1,0]
    v_pk_mul_f32 v[76:77], v[76:77], v[32:33] op_sel:[0,0] op_sel_hi:[1,0]
    v_pk_mul_f32 v[78:79], v[78:79], v[32:33] op_sel:[0,0] op_sel_hi:[1,0]
    v_cvt_pk_bf16_f32 v72, v72, v73
    v_cvt_pk_bf16_f32 v73, v74, v75
    v_cvt_pk_bf16_f32 v74, v76, v77
    v_cvt_pk_bf16_f32 v75, v78, v79
    ds_write_b128 v50, v[72:75] offset:512
    v_pk_mul_f32 v[80:81], v[80:81], v[32:33] op_sel:[0,0] op_sel_hi:[1,0]
    v_pk_mul_f32 v[82:83], v[82:83], v[32:33] op_sel:[0,0] op_sel_hi:[1,0]
    v_pk_mul_f32 v[84:85], v[84:85], v[32:33] op_sel:[0,0] op_sel_hi:[1,0]
    v_pk_mul_f32 v[86:87], v[86:87], v[32:33] op_sel:[0,0] op_sel_hi:[1,0]
    v_cvt_pk_bf16_f32 v80, v80, v81
    v_cvt_pk_bf16_f32 v81, v82, v83
    v_cvt_pk_bf16_f32 v82, v84, v85
    v_cvt_pk_bf16_f32 v83, v86, v87
    ds_write_b128 v50, v[80:83] offset:1024
    v_pk_mul_f32 v[88:89], v[88:89], v[32:33] op_sel:[0,0] op_sel_hi:[1,0]
    v_pk_mul_f32 v[90:91], v[90:91], v[32:33] op_sel:[0,0] op_sel_hi:[1,0]
    v_pk_mul_f32 v[92:93], v[92:93], v[32:33] op_sel:[0,0] op_sel_hi:[1,0]
    v_pk_mul_f32 v[94:95], v[94:95], v[32:33] op_sel:[0,0] op_sel_hi:[1,0]
    v_cvt_pk_bf16_f32 v88, v88, v89
    v_cvt_pk_bf16_f32 v89, v90, v91
    v_cvt_pk_bf16_f32 v90, v92, v93
    v_cvt_pk_bf16_f32 v91, v94, v95
    ds_write_b128 v50, v[88:91] offset:1536
    v_pk_mul_f32 v[224:225], v[224:225], v[40:41] op_sel:[0,1] op_sel_hi:[1,1]
    v_pk_mul_f32 v[226:227], v[226:227], v[40:41] op_sel:[0,1] op_sel_hi:[1,1]
    v_pk_mul_f32 v[228:229], v[228:229], v[40:41] op_sel:[0,1] op_sel_hi:[1,1]
    v_pk_mul_f32 v[230:231], v[230:231], v[40:41] op_sel:[0,1] op_sel_hi:[1,1]
    v_cvt_pk_bf16_f32 v224, v224, v225
    v_cvt_pk_bf16_f32 v225, v226, v227
    v_cvt_pk_bf16_f32 v226, v228, v229
    v_cvt_pk_bf16_f32 v227, v230, v231
    ds_write_b128 v50, v[224:227] offset:20480
    v_pk_mul_f32 v[232:233], v[232:233], v[40:41] op_sel:[0,1] op_sel_hi:[1,1]
    v_pk_mul_f32 v[234:235], v[234:235], v[40:41] op_sel:[0,1] op_sel_hi:[1,1]
    v_pk_mul_f32 v[236:237], v[236:237], v[40:41] op_sel:[0,1] op_sel_hi:[1,1]
    v_pk_mul_f32 v[238:239], v[238:239], v[40:41] op_sel:[0,1] op_sel_hi:[1,1]
    v_cvt_pk_bf16_f32 v232, v232, v233
    v_cvt_pk_bf16_f32 v233, v234, v235
    v_cvt_pk_bf16_f32 v234, v236, v237
    v_cvt_pk_bf16_f32 v235, v238, v239
    ds_write_b128 v50, v[232:235] offset:20992
    v_pk_mul_f32 v[240:241], v[240:241], v[40:41] op_sel:[0,1] op_sel_hi:[1,1]
    v_pk_mul_f32 v[242:243], v[242:243], v[40:41] op_sel:[0,1] op_sel_hi:[1,1]
    v_pk_mul_f32 v[244:245], v[244:245], v[40:41] op_sel:[0,1] op_sel_hi:[1,1]
    v_pk_mul_f32 v[246:247], v[246:247], v[40:41] op_sel:[0,1] op_sel_hi:[1,1]
    v_cvt_pk_bf16_f32 v240, v240, v241
    v_cvt_pk_bf16_f32 v241, v242, v243
    v_cvt_pk_bf16_f32 v242, v244, v245
    v_cvt_pk_bf16_f32 v243, v246, v247
    ds_write_b128 v50, v[240:243] offset:21504
    v_pk_mul_f32 v[248:249], v[248:249], v[40:41] op_sel:[0,1] op_sel_hi:[1,1]
    v_pk_mul_f32 v[250:251], v[250:251], v[40:41] op_sel:[0,1] op_sel_hi:[1,1]
    v_pk_mul_f32 v[252:253], v[252:253], v[40:41] op_sel:[0,1] op_sel_hi:[1,1]
    v_pk_mul_f32 v[254:255], v[254:255], v[40:41] op_sel:[0,1] op_sel_hi:[1,1]
    v_cvt_pk_bf16_f32 v248, v248, v249
    v_cvt_pk_bf16_f32 v249, v250, v251
    v_cvt_pk_bf16_f32 v250, v252, v253
    v_cvt_pk_bf16_f32 v251, v254, v255
    ds_write_b128 v50, v[248:251] offset:22016
    v_cmp_lt_u32 vcc, s59, v54
    v_cmp_gt_u32 s[70:71], s58, v55
    v_mov_b64 v[32:33], 0
    v_mov_b64 v[34:35], 0
    v_mov_b64 v[36:37], 0
    v_mov_b64 v[38:39], 0
    v_mov_b64 v[40:41], 0
    v_mov_b64 v[42:43], 0
    v_mov_b64 v[44:45], 0
    v_mov_b64 v[46:47], 0
    s_lshl_b32 s68, 1, s56
    s_or_b64 vcc, vcc, s[70:71]
    s_cselect_b32 s68, s68, 0
    s_or_b32 s60, s60, s68
    s_add_u32 s63, s63, 434176
    s_add_u32 s65, s65, 434176
    s_add_u32 s56, s56, 1
    s_mov_b32 s49, s54
    s_mov_b32 s55, 2
    s_cmp_lt_u32 s56, 3
    s_cselect_b32 s46, s63, 0x80000000
    s_cselect_b32 s47, s65, 0x80000000
    s_cselect_b32 s29, 0, s30
    v_add_co_u32 v52, vcc, s29, v52
    s_nop 1
    v_addc_co_u32 v53, vcc, 0, v53, vcc
    s_waitcnt lgkmcnt(8)
L_A_rest:
    v_mfma_f32_16x16x32_bf16 v[0:3], a[144:147], a[32:35], 0
    ds_read_b128 a[240:243], v51 offset:0
    ds_read_b128 a[244:247], v51 offset:1024
    ds_read_b128 a[248:251], v51 offset:2048
    v_mfma_f32_16x16x32_bf16 v[0:3], a[148:151], a[36:39], v[0:3]
    ds_read_b128 a[252:255], v51 offset:3072
    v_mul_f32 v9, s57, v9
    v_mfma_f32_16x16x32_bf16 v[0:3], a[152:155], a[40:43], v[0:3]
    v_exp_f32 v8, v8
    v_mfma_f32_16x16x32_bf16 v[0:3], a[156:159], a[44:47], v[0:3]
    v_exp_f32 v9, v9
    v_mul_f32 v10, s57, v10
    v_mfma_f32_16x16x32_bf16 v[4:7], a[172:175], a[44:47], 0
    v_exp_f32 v10, v10
    v_mfma_f32_16x16x32_bf16 v[4:7], a[168:171], a[40:43], v[4:7]
    v_cvt_pk_bf16_f32 v20, v8, v9
    v_mul_f32 v11, s57, v11
    v_mfma_f32_16x16x32_bf16 v[4:7], a[164:167], a[36:39], v[4:7]
    v_exp_f32 v11, v11
    v_mfma_f32_16x16x32_bf16 v[4:7], a[160:163], a[32:35], v[4:7]
    v_mul_f32 v12, s57, v12
    v_cvt_pk_bf16_f32 v21, v10, v11
    v_mfma_f32_16x16x32_bf16 v[64:67], a[176:179], v[16:19], 0
    v_exp_f32 v12, v12
    v_mfma_f32_16x16x32_bf16 v[68:71], a[180:183], v[16:19], 0
    ds_read_b64_tr_b16 a[208:209], v62 offset:2048
    v_mul_f32 v13, s57, v13
    v_mfma_f32_16x16x32_bf16 v[72:75], a[184:187], v[16:19], 0
    s_waitcnt lgkmcnt(1)
    buffer_store_dwordx4 a[240:243], v49, s[36:39], s48 offen offset:0 nt
    v_mfma_f32_16x16x32_bf16 v[76:79], a[188:191], v[16:19], 0
    v_exp_f32 v13, v13
    v_mul_f32 v14, s57, v14
    v_mfma_f32_16x16x32_bf16 v[80:83], a[192:195], v[16:19], 0
    v_cvt_pk_bf16_f32 v22, v12, v13
    v_exp_f32 v14, v14
    v_mfma_f32_16x16x32_bf16 v[84:87], a[196:199], v[16:19], 0
    ds_read_b64_tr_b16 a[210:211], v63 offset:2048
    ds_read_b64_tr_b16 a[212:213], v62 offset:2056
    v_mul_f32 v15, s57, v15
    v_mfma_f32_16x16x32_bf16 v[88:91], a[200:203], v[16:19], 0
    v_exp_f32 v15, v15
    v_mfma_f32_16x16x32_bf16 v[92:95], a[204:207], v[16:19], 0
    v_mul_f32 v0, s57, v0
    v_cvt_pk_bf16_f32 v23, v14, v15
    v_mfma_f32_16x16x32_bf16 v[8:11], a[144:147], a[48:51], 0
    v_exp_f32 v0, v0
    v_mfma_f32_16x16x32_bf16 v[8:11], a[148:151], a[52:55], v[8:11]
    ds_read_b64_tr_b16 a[214:215], v63 offset:2056
    v_mul_f32 v1, s57, v1
    v_mfma_f32_16x16x32_bf16 v[8:11], a[152:155], a[56:59], v[8:11]
    v_exp_f32 v1, v1
    v_mfma_f32_16x16x32_bf16 v[8:11], a[156:159], a[60:63], v[8:11]
    v_mul_f32 v2, s57, v2
    v_mul_f32 v3, s57, v3
    v_smfmac_f32_16x16x64_bf16 v[32:35], v[28:31], v[16:23], v48
    v_cvt_pk_bf16_f32 v16, v0, v1
    v_exp_f32 v2, v2
    v_mfma_f32_16x16x32_bf16 v[12:15], a[172:175], a[60:63], 0
    buffer_store_dwordx4 a[244:247], v49, s[36:39], s48 offen offset:128 nt
    v_mfma_f32_16x16x32_bf16 v[12:15], a[168:171], a[56:59], v[12:15]
    v_exp_f32 v3, v3
    v_mfma_f32_16x16x32_bf16 v[12:15], a[164:167], a[52:55], v[12:15]
    v_mul_f32 v4, s57, v4
    v_cvt_pk_bf16_f32 v17, v2, v3
    v_mfma_f32_16x16x32_bf16 v[12:15], a[160:163], a[48:51], v[12:15]
    v_exp_f32 v4, v4
    v_mfma_f32_16x16x32_bf16 v[96:99], a[176:179], v[20:23], 0
    ds_read_b64_tr_b16 a[216:217], v62 offset:2560
    ds_read_b64_tr_b16 a[218:219], v63 offset:2560
    v_mul_f32 v5, s57, v5
    v_mfma_f32_16x16x32_bf16 v[100:103], a[180:183], v[20:23], 0
    v_exp_f32 v5, v5
    v_mfma_f32_16x16x32_bf16 v[104:107], a[184:187], v[20:23], 0
    v_mul_f32 v6, s57, v6
    v_cvt_pk_bf16_f32 v18, v4, v5
    v_mfma_f32_16x16x32_bf16 v[108:111], a[188:191], v[20:23], 0
    v_exp_f32 v6, v6
    v_mfma_f32_16x16x32_bf16 v[112:115], a[192:195], v[20:23], 0
    ds_read_b64_tr_b16 a[220:221], v62 offset:2568
    v_mul_f32 v7, s57, v7
    v_mfma_f32_16x16x32_bf16 v[116:119], a[196:199], v[20:23], 0
    v_exp_f32 v7, v7
    v_mfma_f32_16x16x32_bf16 v[120:123], a[200:203], v[20:23], 0
    v_cvt_pk_bf16_f32 v19, v6, v7
    v_mul_f32 v8, s57, v8
    v_mfma_f32_16x16x32_bf16 v[124:127], a[204:207], v[20:23], 0
    buffer_store_dwordx4 a[248:251], v49, s[36:39], s48 offen offset:2048 nt
    v_mfma_f32_16x16x32_bf16 v[0:3], a[144:147], a[64:67], 0
    v_exp_f32 v8, v8
    v_mfma_f32_16x16x32_bf16 v[0:3], a[148:151], a[68:71], v[0:3]
    ds_read_b64_tr_b16 a[222:223], v63 offset:2568
    v_mul_f32 v9, s57, v9
    v_mfma_f32_16x16x32_bf16 v[0:3], a[152:155], a[72:75], v[0:3]
    v_exp_f32 v9, v9
    v_mfma_f32_16x16x32_bf16 v[0:3], a[156:159], a[76:79], v[0:3]
    ds_read_b64_tr_b16 a[224:225], v62 offset:3072
    v_mul_f32 v10, s57, v10
    v_cvt_pk_bf16_f32 v20, v8, v9
    v_mfma_f32_16x16x32_bf16 v[4:7], a[172:175], a[76:79], 0
    v_exp_f32 v10, v10
    v_mfma_f32_16x16x32_bf16 v[4:7], a[168:171], a[72:75], v[4:7]
    ds_read_b128 a[240:243], v51 offset:4096
    v_mul_f32 v11, s57, v11
    v_mfma_f32_16x16x32_bf16 v[4:7], a[164:167], a[68:71], v[4:7]
    v_exp_f32 v11, v11
    v_mfma_f32_16x16x32_bf16 v[4:7], a[160:163], a[64:67], v[4:7]
    ds_read_b64_tr_b16 a[226:227], v63 offset:3072
    v_mul_f32 v12, s57, v12
    v_mfma_f32_16x16x32_bf16 v[128:131], a[176:179], v[16:19], 0
    v_cvt_pk_bf16_f32 v21, v10, v11
    v_exp_f32 v12, v12
    v_mfma_f32_16x16x32_bf16 v[132:135], a[180:183], v[16:19], 0
    ds_read_b128 a[244:247], v51 offset:5120
    v_mul_f32 v13, s57, v13
    v_mfma_f32_16x16x32_bf16 v[136:139], a[184:187], v[16:19], 0
    v_exp_f32 v13, v13
    v_mul_f32 v14, s57, v14
    v_mfma_f32_16x16x32_bf16 v[140:143], a[188:191], v[16:19], 0
    buffer_store_dwordx4 a[252:255], v49, s[36:39], s48 offen offset:2176 nt
    v_mfma_f32_16x16x32_bf16 v[144:147], a[192:195], v[16:19], 0
    s_add_u32 s48, s48, 4096
    v_exp_f32 v14, v14
    v_mfma_f32_16x16x32_bf16 v[148:151], a[196:199], v[16:19], 0
    v_cvt_pk_bf16_f32 v22, v12, v13
    v_mul_f32 v15, s57, v15
    v_mfma_f32_16x16x32_bf16 v[152:155], a[200:203], v[16:19], 0
    ds_read_b64_tr_b16 a[230:231], v63 offset:3080
    v_exp_f32 v15, v15
    v_mfma_f32_16x16x32_bf16 v[156:159], a[204:207], v[16:19], 0
    ds_read_b64_tr_b16 a[228:229], v62 offset:3080
    v_mul_f32 v0, s57, v0
    v_cvt_pk_bf16_f32 v23, v14, v15
    v_mfma_f32_16x16x32_bf16 v[8:11], a[144:147], a[80:83], 0
    v_exp_f32 v0, v0
    v_mfma_f32_16x16x32_bf16 v[8:11], a[148:151], a[84:87], v[8:11]
    ds_read_b64_tr_b16 a[232:233], v62 offset:3584
    v_mul_f32 v1, s57, v1
    v_mfma_f32_16x16x32_bf16 v[8:11], a[152:155], a[88:91], v[8:11]
    v_exp_f32 v1, v1
    v_mfma_f32_16x16x32_bf16 v[8:11], a[156:159], a[92:95], v[8:11]
    ds_read_b64_tr_b16 a[234:235], v63 offset:3584
    v_mul_f32 v2, s57, v2
    v_smfmac_f32_16x16x64_bf16 v[36:39], v[28:31], v[16:23], v48
    v_cvt_pk_bf16_f32 v16, v0, v1
    v_exp_f32 v2, v2
    v_mfma_f32_16x16x32_bf16 v[12:15], a[172:175], a[92:95], 0
    s_waitcnt lgkmcnt(4)
    v_mul_f32 v3, s57, v3
    v_mfma_f32_16x16x32_bf16 v[12:15], a[168:171], a[88:91], v[12:15]
    v_exp_f32 v3, v3
    v_mul_f32 v4, s57, v4
    v_mfma_f32_16x16x32_bf16 v[12:15], a[164:167], a[84:87], v[12:15]
    buffer_store_dwordx4 a[240:243], v49, s[36:39], s48 offen offset:0 nt
    v_mfma_f32_16x16x32_bf16 v[12:15], a[160:163], a[80:83], v[12:15]
    v_cvt_pk_bf16_f32 v17, v2, v3
    v_exp_f32 v4, v4
    v_mfma_f32_16x16x32_bf16 v[160:163], a[176:179], v[20:23], 0
    ds_read_b64_tr_b16 a[236:237], v62 offset:3592
    v_mul_f32 v5, s57, v5
    v_mfma_f32_16x16x32_bf16 v[164:167], a[180:183], v[20:23], 0
    v_exp_f32 v5, v5
    v_mfma_f32_16x16x32_bf16 v[168:171], a[184:187], v[20:23], 0
    v_mul_f32 v6, s57, v6
    v_cvt_pk_bf16_f32 v18, v4, v5
    v_mfma_f32_16x16x32_bf16 v[172:175], a[188:191], v[20:23], 0
    v_exp_f32 v6, v6
    v_mfma_f32_16x16x32_bf16 v[176:179], a[192:195], v[20:23], 0
    ds_read_b64_tr_b16 a[238:239], v63 offset:3592
    v_mul_f32 v7, s57, v7
    v_mfma_f32_16x16x32_bf16 v[180:183], a[196:199], v[20:23], 0
    v_exp_f32 v7, v7
    v_mfma_f32_16x16x32_bf16 v[184:187], a[200:203], v[20:23], 0
    v_cvt_pk_bf16_f32 v19, v6, v7
    v_mul_f32 v8, s57, v8
    v_mfma_f32_16x16x32_bf16 v[188:191], a[204:207], v[20:23], 0
    v_exp_f32 v8, v8
    v_mfma_f32_16x16x32_bf16 v[0:3], a[144:147], a[96:99], 0
    ds_read_b128 a[144:147], v58 offset:0
    v_mul_f32 v9, s57, v9
    v_mfma_f32_16x16x32_bf16 v[0:3], a[148:151], a[100:103], v[0:3]
    v_exp_f32 v9, v9
    v_mfma_f32_16x16x32_bf16 v[0:3], a[152:155], a[104:107], v[0:3]
    buffer_store_dwordx4 a[244:247], v49, s[36:39], s48 offen offset:128 nt
    v_mfma_f32_16x16x32_bf16 v[0:3], a[156:159], a[108:111], v[0:3]
    s_add_u32 s48, s48, 2048
    v_mul_f32 v10, s57, v10
    v_cvt_pk_bf16_f32 v20, v8, v9
    v_mfma_f32_16x16x32_bf16 v[4:7], a[172:175], a[108:111], 0
    ds_read_b128 a[148:151], v58 offset:512
    ds_read_b128 a[152:155], v58 offset:1024
    v_mfma_f32_16x16x32_bf16 v[4:7], a[168:171], a[104:107], v[4:7]
    ds_read_b128 a[156:159], v58 offset:1536
    ds_read_b128 a[172:175], v59 offset:1536
    v_mul_f32 v11, s57, v11
    v_mfma_f32_16x16x32_bf16 v[4:7], a[164:167], a[100:103], v[4:7]
    v_exp_f32 v11, v11
    v_mfma_f32_16x16x32_bf16 v[4:7], a[160:163], a[96:99], v[4:7]
    ds_read_b128 a[164:167], v59 offset:512
    v_mul_f32 v12, s57, v12
    v_mfma_f32_16x16x32_bf16 v[192:195], a[176:179], v[16:19], 0
    v_exp_f32 v10, v10
    v_mfma_f32_16x16x32_bf16 v[196:199], a[180:183], v[16:19], 0
    ds_read_b128 a[168:171], v59 offset:1024
    v_mul_f32 v13, s57, v13
    v_mfma_f32_16x16x32_bf16 v[200:203], a[184:187], v[16:19], 0
    v_exp_f32 v12, v12
    v_mfma_f32_16x16x32_bf16 v[204:207], a[188:191], v[16:19], 0
    ds_read_b128 a[160:163], v59 offset:0
    v_mul_f32 v14, s57, v14
    v_mfma_f32_16x16x32_bf16 v[208:211], a[192:195], v[16:19], 0
    v_cvt_pk_bf16_f32 v21, v10, v11
    v_mul_f32 v15, s57, v15
    v_mfma_f32_16x16x32_bf16 v[212:215], a[196:199], v[16:19], 0
    v_exp_f32 v14, v14
    v_mfma_f32_16x16x32_bf16 v[216:219], a[200:203], v[16:19], 0
    s_waitcnt lgkmcnt(4)
    v_mul_f32 v0, s57, v0
    v_mfma_f32_16x16x32_bf16 v[220:223], a[204:207], v[16:19], 0
    v_exp_f32 v15, v15
    v_mfma_f32_16x16x32_bf16 v[8:11], a[144:147], a[0:3], 0
    v_exp_f32 v13, v13
    v_mfma_f32_16x16x32_bf16 v[8:11], a[148:151], a[4:7], v[8:11]
    v_cvt_pk_bf16_f32 v22, v12, v13
    v_cvt_pk_bf16_f32 v23, v14, v15
    v_mfma_f32_16x16x32_bf16 v[8:11], a[152:155], a[8:11], v[8:11]
    v_mul_f32 v1, s57, v1
    v_mul_f32 v4, s57, v4
    v_mfma_f32_16x16x32_bf16 v[8:11], a[156:159], a[12:15], v[8:11]
    v_mul_f32 v2, s57, v2
    v_mul_f32 v3, s57, v3
    v_smfmac_f32_16x16x64_bf16 v[40:43], v[28:31], v[16:23], v48
    s_waitcnt lgkmcnt(0)
    v_mfma_f32_16x16x32_bf16 v[12:15], a[172:175], a[12:15], 0
    v_exp_f32 v2, v2
    v_mfma_f32_16x16x32_bf16 v[12:15], a[168:171], a[8:11], v[12:15]
    v_exp_f32 v0, v0
    v_mfma_f32_16x16x32_bf16 v[12:15], a[164:167], a[4:7], v[12:15]
    v_exp_f32 v3, v3
    v_mfma_f32_16x16x32_bf16 v[12:15], a[160:163], a[0:3], v[12:15]
    v_exp_f32 v1, v1
    v_mfma_f32_16x16x32_bf16 v[224:227], a[176:179], v[20:23], 0
    v_cvt_pk_bf16_f32 v25, v2, v3
    v_mul_f32 v5, s57, v5
    v_mfma_f32_16x16x32_bf16 v[228:231], a[180:183], v[20:23], 0
    v_exp_f32 v4, v4
    v_mfma_f32_16x16x32_bf16 v[232:235], a[184:187], v[20:23], 0
    v_mul_f32 v6, s57, v6
    v_mul_f32 v7, s57, v7
    v_mfma_f32_16x16x32_bf16 v[236:239], a[188:191], v[20:23], 0
    v_exp_f32 v5, v5
    v_mfma_f32_16x16x32_bf16 v[240:243], a[192:195], v[20:23], 0
    v_exp_f32 v7, v7
    v_mfma_f32_16x16x32_bf16 v[244:247], a[196:199], v[20:23], 0
    v_exp_f32 v6, v6
    v_mfma_f32_16x16x32_bf16 v[248:251], a[200:203], v[20:23], 0
    v_cvt_pk_bf16_f32 v24, v0, v1
    v_cvt_pk_bf16_f32 v26, v4, v5
    v_mfma_f32_16x16x32_bf16 v[252:255], a[204:207], v[20:23], 0
    v_cvt_pk_bf16_f32 v27, v6, v7
    v_mul_f32 v8, s57, v8
    v_mfma_f32_16x16x32_bf16 v[0:3], a[144:147], a[16:19], 0
    s_waitcnt vmcnt(7)
    s_barrier
    v_mfma_f32_16x16x32_bf16 v[0:3], a[148:151], a[20:23], v[0:3]
    s_mov_b32 m0, s50
    v_exp_f32 v8, v8
    v_mfma_f32_16x16x32_bf16 v[0:3], a[152:155], a[24:27], v[0:3]
    buffer_load_dwordx4 v49, s[4:7], s44 offen offset:0 lds
    v_mfma_f32_16x16x32_bf16 v[0:3], a[156:159], a[28:31], v[0:3]
    v_mul_f32 v9, s57, v9
    v_mul_f32 v10, s57, v10
    v_smfmac_f32_16x16x64_bf16 v[44:47], v[28:31], v[20:27], v48
    v_exp_f32 v9, v9
    v_mfma_f32_16x16x32_bf16 v[4:7], a[172:175], a[28:31], 0
    v_cvt_pk_bf16_f32 v16, v8, v9
    v_mul_f32 v11, s57, v11
    v_mfma_f32_16x16x32_bf16 v[4:7], a[168:171], a[24:27], v[4:7]
    v_exp_f32 v11, v11
    v_mfma_f32_16x16x32_bf16 v[4:7], a[164:167], a[20:23], v[4:7]
    v_exp_f32 v10, v10
    v_mul_f32 v12, s57, v12
    v_mfma_f32_16x16x32_bf16 v[4:7], a[160:163], a[16:19], v[4:7]
    buffer_load_dwordx4 v49, s[8:11], s44 offen offset:1024 lds
    v_mfma_f32_16x16x32_bf16 a[112:115], a[176:179], v[24:27], 0
    v_exp_f32 v12, v12
    v_mfma_f32_16x16x32_bf16 a[116:119], a[180:183], v[24:27], 0
    v_cvt_pk_bf16_f32 v17, v10, v11
    v_mul_f32 v13, s57, v13
    v_mfma_f32_16x16x32_bf16 a[120:123], a[184:187], v[24:27], 0
    v_exp_f32 v13, v13
    v_mfma_f32_16x16x32_bf16 a[124:127], a[188:191], v[24:27], 0
    v_mul_f32 v14, s57, v14
    v_cvt_pk_bf16_f32 v18, v12, v13
    v_mfma_f32_16x16x32_bf16 a[128:131], a[192:195], v[24:27], 0
    v_exp_f32 v14, v14
    v_mul_f32 v15, s57, v15
    v_mfma_f32_16x16x32_bf16 a[132:135], a[196:199], v[24:27], 0
    buffer_load_dwordx4 v49, s[12:15], s44 offen offset:2048 lds
    v_mfma_f32_16x16x32_bf16 a[136:139], a[200:203], v[24:27], 0
    v_exp_f32 v15, v15
    v_mul_f32 v0, s57, v0
    v_mfma_f32_16x16x32_bf16 a[140:143], a[204:207], v[24:27], 0
    ds_read_b64_tr_b16 a[176:177], v60 offset:34816
    v_cvt_pk_bf16_f32 v19, v14, v15
    v_mfma_f32_16x16x32_bf16 v[8:11], a[144:147], a[32:35], 0
    v_exp_f32 v0, v0
    v_mfma_f32_16x16x32_bf16 v[8:11], a[148:151], a[36:39], v[8:11]
    v_mul_f32 v1, s57, v1
    v_mul_f32 v2, s57, v2
    v_mfma_f32_16x16x32_bf16 v[8:11], a[152:155], a[40:43], v[8:11]
    v_exp_f32 v1, v1
    v_mfma_f32_16x16x32_bf16 v[8:11], a[156:159], a[44:47], v[8:11]
    buffer_load_dwordx4 v49, s[16:19], s44 offen offset:3072 lds
    v_cvt_pk_bf16_f32 v20, v0, v1
    v_mfma_f32_16x16x32_bf16 v[12:15], a[172:175], a[44:47], 0
    s_add_u32 s44, s44, 8192
    v_exp_f32 v2, v2
    v_mfma_f32_16x16x32_bf16 v[12:15], a[168:171], a[40:43], v[12:15]
    s_mov_b32 m0, s51
    v_mul_f32 v3, s57, v3
    v_mfma_f32_16x16x32_bf16 v[12:15], a[164:167], a[36:39], v[12:15]
    v_exp_f32 v3, v3
    v_mfma_f32_16x16x32_bf16 v[12:15], a[160:163], a[32:35], v[12:15]
    ds_read_b64_tr_b16 a[180:181], v60 offset:34824
    v_mul_f32 v4, s57, v4
    v_cvt_pk_bf16_f32 v21, v2, v3
    v_mfma_f32_16x16x32_bf16 v[64:67], a[208:211], v[16:19], v[64:67]
    v_exp_f32 v4, v4
    v_mul_f32 v5, s57, v5
    v_mfma_f32_16x16x32_bf16 v[68:71], a[212:215], v[16:19], v[68:71]
    buffer_load_dwordx4 v49, s[4:7], s44 offen offset:0 lds
    v_mfma_f32_16x16x32_bf16 v[72:75], a[216:219], v[16:19], v[72:75]
    v_exp_f32 v5, v5
    v_mfma_f32_16x16x32_bf16 v[76:79], a[220:223], v[16:19], v[76:79]
    v_mul_f32 v6, s57, v6
    v_cvt_pk_bf16_f32 v22, v4, v5
    v_mfma_f32_16x16x32_bf16 v[80:83], a[224:227], v[16:19], v[80:83]
    v_exp_f32 v6, v6
    v_mfma_f32_16x16x32_bf16 v[84:87], a[228:231], v[16:19], v[84:87]
    v_mul_f32 v7, s57, v7
    v_mul_f32 v8, s57, v8
    v_mfma_f32_16x16x32_bf16 v[88:91], a[232:235], v[16:19], v[88:91]
    v_exp_f32 v7, v7
    v_mfma_f32_16x16x32_bf16 v[92:95], a[236:239], v[16:19], v[92:95]
    buffer_load_dwordx4 v49, s[8:11], s44 offen offset:1024 lds
    v_cvt_pk_bf16_f32 v23, v6, v7
    v_mfma_f32_16x16x32_bf16 v[0:3], a[144:147], a[48:51], 0
    v_exp_f32 v8, v8
    v_mfma_f32_16x16x32_bf16 v[0:3], a[148:151], a[52:55], v[0:3]
    ds_read_b64_tr_b16 a[184:185], v60 offset:35328
    v_mul_f32 v9, s57, v9
    v_mfma_f32_16x16x32_bf16 v[0:3], a[152:155], a[56:59], v[0:3]
    v_exp_f32 v9, v9
    v_mul_f32 v10, s57, v10
    v_mfma_f32_16x16x32_bf16 v[0:3], a[156:159], a[60:63], v[0:3]
    v_exp_f32 v10, v10
    v_smfmac_f32_16x16x64_bf16 v[32:35], v[28:31], v[16:23], v48
    v_cvt_pk_bf16_f32 v16, v8, v9
    v_mfma_f32_16x16x32_bf16 v[4:7], a[172:175], a[60:63], 0
    buffer_load_dwordx4 v49, s[12:15], s44 offen offset:2048 lds
    v_mul_f32 v11, s57, v11
    v_mfma_f32_16x16x32_bf16 v[4:7], a[168:171], a[56:59], v[4:7]
    v_exp_f32 v11, v11
    v_mfma_f32_16x16x32_bf16 v[4:7], a[164:167], a[52:55], v[4:7]
    v_mul_f32 v12, s57, v12
    v_cvt_pk_bf16_f32 v17, v10, v11
    v_mfma_f32_16x16x32_bf16 v[4:7], a[160:163], a[48:51], v[4:7]
    ds_read_b64_tr_b16 a[186:187], v61 offset:35328
    v_mul_f32 v13, s57, v13
    v_mfma_f32_16x16x32_bf16 v[96:99], a[208:211], v[20:23], v[96:99]
    v_exp_f32 v12, v12
    v_mfma_f32_16x16x32_bf16 v[100:103], a[212:215], v[20:23], v[100:103]
    v_exp_f32 v13, v13
    v_mfma_f32_16x16x32_bf16 v[104:107], a[216:219], v[20:23], v[104:107]
    buffer_load_dwordx4 v49, s[16:19], s44 offen offset:3072 lds
    v_mul_f32 v14, s57, v14
    v_mfma_f32_16x16x32_bf16 v[108:111], a[220:223], v[20:23], v[108:111]
    s_add_u32 s44, s44, 8192
    v_cvt_pk_bf16_f32 v18, v12, v13
    v_mfma_f32_16x16x32_bf16 v[112:115], a[224:227], v[20:23], v[112:115]
    v_exp_f32 v14, v14
    v_mul_f32 v15, s57, v15
    v_mfma_f32_16x16x32_bf16 v[116:119], a[228:231], v[20:23], v[116:119]
    v_exp_f32 v15, v15
    v_mfma_f32_16x16x32_bf16 v[120:123], a[232:235], v[20:23], v[120:123]
    v_cvt_pk_bf16_f32 v19, v14, v15
    v_mul_f32 v0, s57, v0
    v_mfma_f32_16x16x32_bf16 v[124:127], a[236:239], v[20:23], v[124:127]
    v_exp_f32 v0, v0
    v_mfma_f32_16x16x32_bf16 v[8:11], a[144:147], a[64:67], 0
    ds_read_b64_tr_b16 a[190:191], v61 offset:35336
    ds_read_b64_tr_b16 a[192:193], v60 offset:35840
    v_mfma_f32_16x16x32_bf16 v[8:11], a[148:151], a[68:71], v[8:11]
    ds_read_b64_tr_b16 a[178:179], v61 offset:34816
    v_mul_f32 v1, s57, v1
    v_mfma_f32_16x16x32_bf16 v[8:11], a[152:155], a[72:75], v[8:11]
    v_exp_f32 v1, v1
    v_mul_f32 v2, s57, v2
    v_mfma_f32_16x16x32_bf16 v[8:11], a[156:159], a[76:79], v[8:11]
    v_exp_f32 v2, v2
    v_mfma_f32_16x16x32_bf16 v[12:15], a[172:175], a[76:79], 0
    ds_read_b64_tr_b16 a[188:189], v60 offset:35336
    v_cvt_pk_bf16_f32 v20, v0, v1
    v_mfma_f32_16x16x32_bf16 v[12:15], a[168:171], a[72:75], v[12:15]
    ds_read_b64_tr_b16 a[196:197], v60 offset:35848
    v_mul_f32 v3, s57, v3
    v_mfma_f32_16x16x32_bf16 v[12:15], a[164:167], a[68:71], v[12:15]
    v_exp_f32 v3, v3
    v_mfma_f32_16x16x32_bf16 v[12:15], a[160:163], a[64:67], v[12:15]
    v_mul_f32 v4, s57, v4
    v_cvt_pk_bf16_f32 v21, v2, v3
    v_mfma_f32_16x16x32_bf16 v[128:131], a[208:211], v[16:19], v[128:131]
    ds_read_b64_tr_b16 a[198:199], v61 offset:35848
    v_mul_f32 v5, s57, v5
    v_mfma_f32_16x16x32_bf16 v[132:135], a[212:215], v[16:19], v[132:135]
    v_exp_f32 v4, v4
    v_mfma_f32_16x16x32_bf16 v[136:139], a[216:219], v[16:19], v[136:139]
    ds_read_b64_tr_b16 a[194:195], v61 offset:35840
    v_mul_f32 v6, s57, v6
    v_mfma_f32_16x16x32_bf16 v[140:143], a[220:223], v[16:19], v[140:143]
    v_exp_f32 v5, v5
    v_mfma_f32_16x16x32_bf16 v[144:147], a[224:227], v[16:19], v[144:147]
    v_exp_f32 v6, v6
    v_mfma_f32_16x16x32_bf16 v[148:151], a[228:231], v[16:19], v[148:151]
    v_cvt_pk_bf16_f32 v22, v4, v5
    v_mul_f32 v7, s57, v7
    v_mfma_f32_16x16x32_bf16 v[152:155], a[232:235], v[16:19], v[152:155]
    v_exp_f32 v7, v7
    v_mfma_f32_16x16x32_bf16 v[156:159], a[236:239], v[16:19], v[156:159]
    v_mul_f32 v8, s57, v8
    v_cvt_pk_bf16_f32 v23, v6, v7
    v_mfma_f32_16x16x32_bf16 v[0:3], a[144:147], a[80:83], 0
    v_mul_f32 v9, s57, v9
    v_mul_f32 v11, s57, v11
    v_mfma_f32_16x16x32_bf16 v[0:3], a[148:151], a[84:87], v[0:3]
    ds_read_b64_tr_b16 a[202:203], v61 offset:36352
    v_mul_f32 v10, s57, v10
    v_mfma_f32_16x16x32_bf16 v[0:3], a[152:155], a[88:91], v[0:3]
    v_exp_f32 v8, v8
    v_mfma_f32_16x16x32_bf16 v[0:3], a[156:159], a[92:95], v[0:3]
    v_exp_f32 v9, v9
    v_smfmac_f32_16x16x64_bf16 v[36:39], v[28:31], v[16:23], v48
    v_cvt_pk_bf16_f32 v16, v8, v9
    v_mfma_f32_16x16x32_bf16 v[4:7], a[172:175], a[92:95], 0
    v_exp_f32 v10, v10
    v_mfma_f32_16x16x32_bf16 v[4:7], a[168:171], a[88:91], v[4:7]
    v_exp_f32 v11, v11
    v_mfma_f32_16x16x32_bf16 v[4:7], a[164:167], a[84:87], v[4:7]
    v_mul_f32 v12, s57, v12
    v_cvt_pk_bf16_f32 v17, v10, v11
    v_mfma_f32_16x16x32_bf16 v[4:7], a[160:163], a[80:83], v[4:7]
    ds_read_b64_tr_b16 a[182:183], v61 offset:34824
    v_mul_f32 v13, s57, v13
    v_mfma_f32_16x16x32_bf16 v[160:163], a[208:211], v[20:23], v[160:163]
    v_exp_f32 v12, v12
    v_mfma_f32_16x16x32_bf16 v[164:167], a[212:215], v[20:23], v[164:167]
    v_exp_f32 v13, v13
    v_mfma_f32_16x16x32_bf16 v[168:171], a[216:219], v[20:23], v[168:171]
    v_mul_f32 v14, s57, v14
    v_cvt_pk_bf16_f32 v18, v12, v13
    v_mfma_f32_16x16x32_bf16 v[172:175], a[220:223], v[20:23], v[172:175]
    v_exp_f32 v14, v14
    v_mfma_f32_16x16x32_bf16 v[176:179], a[224:227], v[20:23], v[176:179]
    ds_read_b64_tr_b16 a[200:201], v60 offset:36352
    v_mul_f32 v15, s57, v15
    v_mfma_f32_16x16x32_bf16 v[180:183], a[228:231], v[20:23], v[180:183]
    ds_read_b64_tr_b16 a[204:205], v60 offset:36360
    ds_read_b64_tr_b16 a[206:207], v61 offset:36360
    v_mfma_f32_16x16x32_bf16 v[184:187], a[232:235], v[20:23], v[184:187]
    v_exp_f32 v15, v15
    v_mfma_f32_16x16x32_bf16 v[188:191], a[236:239], v[20:23], v[188:191]
    v_cvt_pk_bf16_f32 v19, v14, v15
    v_mul_f32 v0, s57, v0
    v_mfma_f32_16x16x32_bf16 v[8:11], a[144:147], a[96:99], 0
    v_exp_f32 v0, v0
    v_mul_f32 v1, s57, v1
    v_mfma_f32_16x16x32_bf16 v[8:11], a[148:151], a[100:103], v[8:11]
    v_exp_f32 v1, v1
    v_mfma_f32_16x16x32_bf16 v[8:11], a[152:155], a[104:107], v[8:11]
    ds_read_b128 a[144:147], v56 offset:32768
    ds_read_b128 a[148:151], v56 offset:33280
    v_mfma_f32_16x16x32_bf16 v[8:11], a[156:159], a[108:111], v[8:11]
    ds_read_b128 a[152:155], v56 offset:33792
    v_mul_f32 v2, s57, v2
    v_mfma_f32_16x16x32_bf16 v[12:15], a[172:175], a[108:111], 0
    ds_read_b128 a[156:159], v56 offset:34304
    ds_read_b128 a[172:175], v57 offset:34304
    v_mfma_f32_16x16x32_bf16 v[12:15], a[168:171], a[104:107], v[12:15]
    v_exp_f32 v2, v2
    v_mfma_f32_16x16x32_bf16 v[12:15], a[164:167], a[100:103], v[12:15]
    ds_read_b128 a[168:171], v57 offset:33792
    v_mul_f32 v3, s57, v3
    v_mfma_f32_16x16x32_bf16 v[12:15], a[160:163], a[96:99], v[12:15]
    v_exp_f32 v3, v3
    v_mfma_f32_16x16x32_bf16 v[192:195], a[208:211], v[16:19], v[192:195]
    ds_read_b128 a[164:167], v57 offset:33280
    ds_read_b128 a[160:163], v57 offset:32768
    v_mfma_f32_16x16x32_bf16 v[196:199], a[212:215], v[16:19], v[196:199]
    v_mul_f32 v6, s57, v6
    v_mul_f32 v7, s57, v7
    v_mfma_f32_16x16x32_bf16 v[200:203], a[216:219], v[16:19], v[200:203]
    v_exp_f32 v7, v7
    v_mfma_f32_16x16x32_bf16 v[204:207], a[220:223], v[16:19], v[204:207]
    v_exp_f32 v6, v6
    v_mfma_f32_16x16x32_bf16 v[208:211], a[224:227], v[16:19], v[208:211]
    v_mul_f32 v4, s57, v4
    v_cvt_pk_bf16_f32 v21, v2, v3
    v_mfma_f32_16x16x32_bf16 v[212:215], a[228:231], v[16:19], v[212:215]
    v_cvt_pk_bf16_f32 v20, v0, v1
    v_mul_f32 v5, s57, v5
    v_mfma_f32_16x16x32_bf16 v[216:219], a[232:235], v[16:19], v[216:219]
    v_exp_f32 v4, v4
    v_mfma_f32_16x16x32_bf16 v[220:223], a[236:239], v[16:19], v[220:223]
    s_waitcnt lgkmcnt(4)
    v_mul_f32 v8, s57, v8
    v_mfma_f32_16x16x32_bf16 v[0:3], a[144:147], a[0:3], 0
    v_exp_f32 v5, v5
    v_mfma_f32_16x16x32_bf16 v[0:3], a[148:151], a[4:7], v[0:3]
    v_cvt_pk_bf16_f32 v22, v4, v5
    v_cvt_pk_bf16_f32 v23, v6, v7
    v_mfma_f32_16x16x32_bf16 v[0:3], a[152:155], a[8:11], v[0:3]
    v_mul_f32 v9, s57, v9
    v_mul_f32 v11, s57, v11
    v_mfma_f32_16x16x32_bf16 v[0:3], a[156:159], a[12:15], v[0:3]
    v_mul_f32 v10, s57, v10
    v_mul_f32 v12, s57, v12
    v_smfmac_f32_16x16x64_bf16 v[40:43], v[28:31], v[16:23], v48
    s_waitcnt lgkmcnt(0)
    v_mfma_f32_16x16x32_bf16 v[4:7], a[172:175], a[12:15], 0
    v_exp_f32 v8, v8
    v_mfma_f32_16x16x32_bf16 v[4:7], a[168:171], a[8:11], v[4:7]
    v_exp_f32 v11, v11
    v_mfma_f32_16x16x32_bf16 v[4:7], a[164:167], a[4:7], v[4:7]
    v_exp_f32 v10, v10
    v_mfma_f32_16x16x32_bf16 v[4:7], a[160:163], a[0:3], v[4:7]
    v_exp_f32 v9, v9
    v_mfma_f32_16x16x32_bf16 v[224:227], a[208:211], v[20:23], v[224:227]
    v_cvt_pk_bf16_f32 v24, v8, v9
    v_mul_f32 v13, s57, v13
    v_mfma_f32_16x16x32_bf16 v[228:231], a[212:215], v[20:23], v[228:231]
    v_cvt_pk_bf16_f32 v25, v10, v11
    v_mul_f32 v14, s57, v14
    v_mfma_f32_16x16x32_bf16 v[232:235], a[216:219], v[20:23], v[232:235]
    v_exp_f32 v13, v13
    v_mfma_f32_16x16x32_bf16 v[236:239], a[220:223], v[20:23], v[236:239]
    v_exp_f32 v12, v12
    v_mfma_f32_16x16x32_bf16 v[240:243], a[224:227], v[20:23], v[240:243]
    v_cvt_pk_bf16_f32 v26, v12, v13
    v_mul_f32 v15, s57, v15
    v_mfma_f32_16x16x32_bf16 v[244:247], a[228:231], v[20:23], v[244:247]
    v_exp_f32 v14, v14
    v_mfma_f32_16x16x32_bf16 v[248:251], a[232:235], v[20:23], v[248:251]
    v_exp_f32 v15, v15
    v_mfma_f32_16x16x32_bf16 v[252:255], a[236:239], v[20:23], v[252:255]
    v_cvt_pk_bf16_f32 v27, v14, v15
    v_mul_f32 v0, s57, v0
L_A_loop:
    v_mfma_f32_16x16x32_bf16 v[8:11], a[144:147], a[16:19], 0
    s_mov_b32 m0, s49
    v_mul_f32 v1, s57, v1
    v_mfma_f32_16x16x32_bf16 v[8:11], a[148:151], a[20:23], v[8:11]
    buffer_load_dwordx4 v49, s[20:23], s46 offen offset:0 nt lds
    v_mfma_f32_16x16x32_bf16 v[8:11], a[152:155], a[24:27], v[8:11]
    v_exp_f32 v1, v1
    v_mfma_f32_16x16x32_bf16 v[8:11], a[156:159], a[28:31], v[8:11]
    v_exp_f32 v0, v0
    v_mul_f32 v2, s57, v2
    v_smfmac_f32_16x16x64_bf16 v[44:47], v[28:31], v[20:27], v48
    v_cvt_pk_bf16_f32 v16, v0, v1
    v_mfma_f32_16x16x32_bf16 v[12:15], a[172:175], a[28:31], 0
    v_exp_f32 v2, v2
    v_mul_f32 v3, s57, v3
    v_mfma_f32_16x16x32_bf16 v[12:15], a[168:171], a[24:27], v[12:15]
    buffer_load_dwordx4 v49, s[24:27], s46 offen offset:1024 nt lds
    v_mfma_f32_16x16x32_bf16 v[12:15], a[164:167], a[20:23], v[12:15]
    v_mul_f32 v4, s57, v4
    v_mul_f32 v5, s57, v5
    v_mfma_f32_16x16x32_bf16 v[12:15], a[160:163], a[16:19], v[12:15]
    v_exp_f32 v3, v3
    v_mfma_f32_16x16x32_bf16 a[112:115], a[208:211], v[24:27], a[112:115]
    v_cvt_pk_bf16_f32 v17, v2, v3
    v_exp_f32 v4, v4
    v_mfma_f32_16x16x32_bf16 a[116:119], a[212:215], v[24:27], a[116:119]
    v_exp_f32 v5, v5
    v_mfma_f32_16x16x32_bf16 a[120:123], a[216:219], v[24:27], a[120:123]
    v_mul_f32 v6, s57, v6
    v_cvt_pk_bf16_f32 v18, v4, v5
    v_mfma_f32_16x16x32_bf16 a[124:127], a[220:223], v[24:27], a[124:127]
    buffer_load_dwordx4 v49, s[20:23], s46 offen offset:2048 nt lds
    v_mfma_f32_16x16x32_bf16 a[128:131], a[224:227], v[24:27], a[128:131]
    v_exp_f32 v6, v6
    v_mul_f32 v7, s57, v7
    v_mfma_f32_16x16x32_bf16 a[132:135], a[228:231], v[24:27], a[132:135]
    v_exp_f32 v7, v7
    v_mfma_f32_16x16x32_bf16 a[136:139], a[232:235], v[24:27], a[136:139]
    v_cvt_pk_bf16_f32 v19, v6, v7
    v_mul_f32 v8, s57, v8
    v_mfma_f32_16x16x32_bf16 a[140:143], a[236:239], v[24:27], a[140:143]
    ds_read_b64_tr_b16 a[208:209], v62 offset:34816
    v_mul_f32 v9, s57, v9
    v_mfma_f32_16x16x32_bf16 v[0:3], a[144:147], a[32:35], 0
    v_exp_f32 v8, v8
    v_mfma_f32_16x16x32_bf16 v[0:3], a[148:151], a[36:39], v[0:3]
    buffer_load_dwordx4 v49, s[24:27], s46 offen offset:3072 nt lds
    s_add_u32 m0, s49, 4096
    v_mfma_f32_16x16x32_bf16 v[0:3], a[152:155], a[40:43], v[0:3]
    s_add_u32 s46, s46, 4096
    v_exp_f32 v9, v9
    v_mfma_f32_16x16x32_bf16 v[0:3], a[156:159], a[44:47], v[0:3]
    v_mul_f32 v10, s57, v10
    v_cvt_pk_bf16_f32 v20, v8, v9
    v_mfma_f32_16x16x32_bf16 v[4:7], a[172:175], a[44:47], 0
    v_exp_f32 v10, v10
    v_mfma_f32_16x16x32_bf16 v[4:7], a[168:171], a[40:43], v[4:7]
    v_mul_f32 v11, s57, v11
    v_mul_f32 v12, s57, v12
    v_mfma_f32_16x16x32_bf16 v[4:7], a[164:167], a[36:39], v[4:7]
    v_exp_f32 v11, v11
    v_mfma_f32_16x16x32_bf16 v[4:7], a[160:163], a[32:35], v[4:7]
    buffer_load_dwordx4 v49, s[20:23], s46 offen offset:0 nt lds
    v_cvt_pk_bf16_f32 v21, v10, v11
    v_mfma_f32_16x16x32_bf16 v[64:67], a[176:179], v[16:19], v[64:67]
    v_exp_f32 v12, v12
    v_mfma_f32_16x16x32_bf16 v[68:71], a[180:183], v[16:19], v[68:71]
    v_mul_f32 v13, s57, v13
    v_mul_f32 v14, s57, v14
    v_mfma_f32_16x16x32_bf16 v[72:75], a[184:187], v[16:19], v[72:75]
    v_exp_f32 v13, v13
    v_mfma_f32_16x16x32_bf16 v[76:79], a[188:191], v[16:19], v[76:79]
    ds_read_b64_tr_b16 a[214:215], v63 offset:34824
    v_cvt_pk_bf16_f32 v22, v12, v13
    v_mfma_f32_16x16x32_bf16 v[80:83], a[192:195], v[16:19], v[80:83]
    v_exp_f32 v14, v14
    v_mfma_f32_16x16x32_bf16 v[84:87], a[196:199], v[16:19], v[84:87]
    buffer_load_dwordx4 v49, s[24:27], s46 offen offset:1024 nt lds
    v_mul_f32 v15, s57, v15
    v_mfma_f32_16x16x32_bf16 v[88:91], a[200:203], v[16:19], v[88:91]
    s_add_u32 s46, s46, 2048
    v_mul_f32 v0, s57, v0
    v_mfma_f32_16x16x32_bf16 v[92:95], a[204:207], v[16:19], v[92:95]
    v_exp_f32 v15, v15
    v_mfma_f32_16x16x32_bf16 v[8:11], a[144:147], a[48:51], 0
    ds_read_b64_tr_b16 a[216:217], v62 offset:35328
    s_add_u32 s49, s49, 6144
    v_cvt_pk_bf16_f32 v23, v14, v15
    v_mfma_f32_16x16x32_bf16 v[8:11], a[148:151], a[52:55], v[8:11]
    v_exp_f32 v0, v0
    v_mul_f32 v1, s57, v1
    v_mfma_f32_16x16x32_bf16 v[8:11], a[152:155], a[56:59], v[8:11]
    v_exp_f32 v1, v1
    v_mfma_f32_16x16x32_bf16 v[8:11], a[156:159], a[60:63], v[8:11]
    ds_read_b128 a[244:247], v51 offset:7168
    v_mul_f32 v2, s57, v2
    v_smfmac_f32_16x16x64_bf16 v[32:35], v[28:31], v[16:23], v48
    v_exp_f32 v2, v2
    v_mfma_f32_16x16x32_bf16 v[12:15], a[172:175], a[60:63], 0
    v_cvt_pk_bf16_f32 v16, v0, v1
    v_mul_f32 v3, s57, v3
    v_mfma_f32_16x16x32_bf16 v[12:15], a[168:171], a[56:59], v[12:15]
    v_exp_f32 v3, v3
    v_mfma_f32_16x16x32_bf16 v[12:15], a[164:167], a[52:55], v[12:15]
    v_mul_f32 v4, s57, v4
    v_cvt_pk_bf16_f32 v17, v2, v3
    v_mfma_f32_16x16x32_bf16 v[12:15], a[160:163], a[48:51], v[12:15]
    v_exp_f32 v4, v4
    v_mfma_f32_16x16x32_bf16 v[96:99], a[176:179], v[20:23], v[96:99]
    ds_read_b64_tr_b16 a[210:211], v63 offset:34816
    v_mul_f32 v5, s57, v5
    v_mfma_f32_16x16x32_bf16 v[100:103], a[180:183], v[20:23], v[100:103]
    v_exp_f32 v5, v5
    v_mfma_f32_16x16x32_bf16 v[104:107], a[184:187], v[20:23], v[104:107]
    ds_read_b64_tr_b16 a[222:223], v63 offset:35336
    v_cvt_pk_bf16_f32 v18, v4, v5
    v_mfma_f32_16x16x32_bf16 v[108:111], a[188:191], v[20:23], v[108:111]
    ds_read_b64_tr_b16 a[218:219], v63 offset:35328
    v_mul_f32 v6, s57, v6
    v_mfma_f32_16x16x32_bf16 v[112:115], a[192:195], v[20:23], v[112:115]
    ds_read_b128 a[240:243], v51 offset:6144
    v_mul_f32 v7, s57, v7
    v_mfma_f32_16x16x32_bf16 v[116:119], a[196:199], v[20:23], v[116:119]
    v_exp_f32 v6, v6
    v_mfma_f32_16x16x32_bf16 v[120:123], a[200:203], v[20:23], v[120:123]
    ds_read_b64_tr_b16 a[224:225], v62 offset:35840
    v_mul_f32 v8, s57, v8
    v_mfma_f32_16x16x32_bf16 v[124:127], a[204:207], v[20:23], v[124:127]
    v_exp_f32 v7, v7
    v_mfma_f32_16x16x32_bf16 v[0:3], a[144:147], a[64:67], 0
    v_cvt_pk_bf16_f32 v19, v6, v7
    v_mul_f32 v9, s57, v9
    v_mfma_f32_16x16x32_bf16 v[0:3], a[148:151], a[68:71], v[0:3]
    v_exp_f32 v8, v8
    v_mfma_f32_16x16x32_bf16 v[0:3], a[152:155], a[72:75], v[0:3]
    v_exp_f32 v9, v9
    v_mfma_f32_16x16x32_bf16 v[0:3], a[156:159], a[76:79], v[0:3]
    v_mul_f32 v10, s57, v10
    v_cvt_pk_bf16_f32 v20, v8, v9
    v_mfma_f32_16x16x32_bf16 v[4:7], a[172:175], a[76:79], 0
    v_exp_f32 v10, v10
    v_mfma_f32_16x16x32_bf16 v[4:7], a[168:171], a[72:75], v[4:7]
    ds_read_b64_tr_b16 a[220:221], v62 offset:35336
    v_mul_f32 v11, s57, v11
    v_mfma_f32_16x16x32_bf16 v[4:7], a[164:167], a[68:71], v[4:7]
    v_exp_f32 v11, v11
    v_mfma_f32_16x16x32_bf16 v[4:7], a[160:163], a[64:67], v[4:7]
    v_mul_f32 v12, s57, v12
    v_cvt_pk_bf16_f32 v21, v10, v11
    v_mfma_f32_16x16x32_bf16 v[128:131], a[176:179], v[16:19], v[128:131]
    ds_read_b64_tr_b16 a[226:227], v63 offset:35840
    v_mul_f32 v13, s57, v13
    v_mfma_f32_16x16x32_bf16 v[132:135], a[180:183], v[16:19], v[132:135]
    v_exp_f32 v12, v12
    v_mfma_f32_16x16x32_bf16 v[136:139], a[184:187], v[16:19], v[136:139]
    v_exp_f32 v13, v13
    v_mfma_f32_16x16x32_bf16 v[140:143], a[188:191], v[16:19], v[140:143]
    v_mul_f32 v14, s57, v14
    v_cvt_pk_bf16_f32 v22, v12, v13
    v_mfma_f32_16x16x32_bf16 v[144:147], a[192:195], v[16:19], v[144:147]
    v_exp_f32 v14, v14
    v_mfma_f32_16x16x32_bf16 v[148:151], a[196:199], v[16:19], v[148:151]
    ds_read_b64_tr_b16 a[230:231], v63 offset:35848
    v_mul_f32 v15, s57, v15
    v_mfma_f32_16x16x32_bf16 v[152:155], a[200:203], v[16:19], v[152:155]
    v_exp_f32 v15, v15
    v_mfma_f32_16x16x32_bf16 v[156:159], a[204:207], v[16:19], v[156:159]
    v_mul_f32 v0, s57, v0
    v_cvt_pk_bf16_f32 v23, v14, v15
    v_mfma_f32_16x16x32_bf16 v[8:11], a[144:147], a[80:83], 0
    v_exp_f32 v0, v0
    v_mfma_f32_16x16x32_bf16 v[8:11], a[148:151], a[84:87], v[8:11]
    ds_read_b64_tr_b16 a[228:229], v62 offset:35848
    v_mul_f32 v1, s57, v1
    v_mfma_f32_16x16x32_bf16 v[8:11], a[152:155], a[88:91], v[8:11]
    ds_read_b64_tr_b16 a[212:213], v62 offset:34824
    v_mul_f32 v2, s57, v2
    v_mfma_f32_16x16x32_bf16 v[8:11], a[156:159], a[92:95], v[8:11]
    v_exp_f32 v1, v1
    v_smfmac_f32_16x16x64_bf16 v[36:39], v[28:31], v[16:23], v48
    v_exp_f32 v2, v2
    v_mfma_f32_16x16x32_bf16 v[12:15], a[172:175], a[92:95], 0
    v_cvt_pk_bf16_f32 v16, v0, v1
    v_mul_f32 v3, s57, v3
    v_mfma_f32_16x16x32_bf16 v[12:15], a[168:171], a[88:91], v[12:15]
    v_exp_f32 v3, v3
    v_mfma_f32_16x16x32_bf16 v[12:15], a[164:167], a[84:87], v[12:15]
    v_mul_f32 v4, s57, v4
    v_cvt_pk_bf16_f32 v17, v2, v3
    v_mfma_f32_16x16x32_bf16 v[12:15], a[160:163], a[80:83], v[12:15]
    ds_read_b64_tr_b16 a[232:233], v62 offset:36352
    ds_read_b64_tr_b16 a[234:235], v63 offset:36352
    v_mfma_f32_16x16x32_bf16 v[160:163], a[176:179], v[20:23], v[160:163]
    ds_read_b64_tr_b16 a[236:237], v62 offset:36360
    v_mul_f32 v5, s57, v5
    v_mfma_f32_16x16x32_bf16 v[164:167], a[180:183], v[20:23], v[164:167]
    v_exp_f32 v5, v5
    v_mfma_f32_16x16x32_bf16 v[168:171], a[184:187], v[20:23], v[168:171]
    ds_read_b64_tr_b16 a[238:239], v63 offset:36360
    v_mul_f32 v6, s57, v6
    v_mfma_f32_16x16x32_bf16 v[172:175], a[188:191], v[20:23], v[172:175]
    v_exp_f32 v6, v6
    v_mfma_f32_16x16x32_bf16 v[176:179], a[192:195], v[20:23], v[176:179]
    v_exp_f32 v4, v4
    v_mfma_f32_16x16x32_bf16 v[180:183], a[196:199], v[20:23], v[180:183]
    v_cvt_pk_bf16_f32 v18, v4, v5
    v_mul_f32 v7, s57, v7
    v_mfma_f32_16x16x32_bf16 v[184:187], a[200:203], v[20:23], v[184:187]
    v_exp_f32 v7, v7
    v_mfma_f32_16x16x32_bf16 v[188:191], a[204:207], v[20:23], v[188:191]
    v_cvt_pk_bf16_f32 v19, v6, v7
    v_mul_f32 v8, s57, v8
    v_mfma_f32_16x16x32_bf16 v[0:3], a[144:147], a[96:99], 0
    v_exp_f32 v8, v8
    v_mfma_f32_16x16x32_bf16 v[0:3], a[148:151], a[100:103], v[0:3]
    ds_read_b128 a[144:147], v58 offset:32768
    v_mul_f32 v9, s57, v9
    v_mfma_f32_16x16x32_bf16 v[0:3], a[152:155], a[104:107], v[0:3]
    v_exp_f32 v9, v9
    v_mfma_f32_16x16x32_bf16 v[0:3], a[156:159], a[108:111], v[0:3]
    ds_read_b128 a[148:151], v58 offset:33280
    v_mul_f32 v10, s57, v10
    v_cvt_pk_bf16_f32 v20, v8, v9
    v_mfma_f32_16x16x32_bf16 v[4:7], a[172:175], a[108:111], 0
    ds_read_b128 a[152:155], v58 offset:33792
    ds_read_b128 a[156:159], v58 offset:34304
    v_mfma_f32_16x16x32_bf16 v[4:7], a[168:171], a[104:107], v[4:7]
    ds_read_b128 a[172:175], v59 offset:34304
    v_mul_f32 v11, s57, v11
    v_mfma_f32_16x16x32_bf16 v[4:7], a[164:167], a[100:103], v[4:7]
    v_exp_f32 v11, v11
    v_mfma_f32_16x16x32_bf16 v[4:7], a[160:163], a[96:99], v[4:7]
    ds_read_b128 a[164:167], v59 offset:33280
    v_mul_f32 v12, s57, v12
    v_mfma_f32_16x16x32_bf16 v[192:195], a[176:179], v[16:19], v[192:195]
    v_exp_f32 v10, v10
    v_mfma_f32_16x16x32_bf16 v[196:199], a[180:183], v[16:19], v[196:199]
    v_cvt_pk_bf16_f32 v21, v10, v11
    v_mul_f32 v13, s57, v13
    v_mfma_f32_16x16x32_bf16 v[200:203], a[184:187], v[16:19], v[200:203]
    ds_read_b128 a[168:171], v59 offset:33792
    ds_read_b128 a[160:163], v59 offset:32768
    v_mfma_f32_16x16x32_bf16 v[204:207], a[188:191], v[16:19], v[204:207]
    v_mul_f32 v14, s57, v14
    v_mul_f32 v15, s57, v15
    v_mfma_f32_16x16x32_bf16 v[208:211], a[192:195], v[16:19], v[208:211]
    v_exp_f32 v13, v13
    v_mfma_f32_16x16x32_bf16 v[212:215], a[196:199], v[16:19], v[212:215]
    v_exp_f32 v14, v14
    v_mfma_f32_16x16x32_bf16 v[216:219], a[200:203], v[16:19], v[216:219]
    s_waitcnt lgkmcnt(4)
    v_mul_f32 v0, s57, v0
    v_mfma_f32_16x16x32_bf16 v[220:223], a[204:207], v[16:19], v[220:223]
    v_exp_f32 v15, v15
    v_mfma_f32_16x16x32_bf16 v[8:11], a[144:147], a[0:3], 0
    v_exp_f32 v12, v12
    v_mfma_f32_16x16x32_bf16 v[8:11], a[148:151], a[4:7], v[8:11]
    v_cvt_pk_bf16_f32 v22, v12, v13
    v_cvt_pk_bf16_f32 v23, v14, v15
    v_mfma_f32_16x16x32_bf16 v[8:11], a[152:155], a[8:11], v[8:11]
    v_mul_f32 v1, s57, v1
    v_mul_f32 v2, s57, v2
    v_mfma_f32_16x16x32_bf16 v[8:11], a[156:159], a[12:15], v[8:11]
    v_mul_f32 v3, s57, v3
    v_mul_f32 v4, s57, v4
    v_smfmac_f32_16x16x64_bf16 v[40:43], v[28:31], v[16:23], v48
    s_waitcnt lgkmcnt(0)
    v_mfma_f32_16x16x32_bf16 v[12:15], a[172:175], a[12:15], 0
    v_exp_f32 v2, v2
    v_mfma_f32_16x16x32_bf16 v[12:15], a[168:171], a[8:11], v[12:15]
    v_exp_f32 v0, v0
    v_mfma_f32_16x16x32_bf16 v[12:15], a[164:167], a[4:7], v[12:15]
    v_exp_f32 v1, v1
    v_mfma_f32_16x16x32_bf16 v[12:15], a[160:163], a[0:3], v[12:15]
    v_exp_f32 v4, v4
    v_mfma_f32_16x16x32_bf16 v[224:227], a[176:179], v[20:23], v[224:227]
    v_exp_f32 v3, v3
    v_mfma_f32_16x16x32_bf16 v[228:231], a[180:183], v[20:23], v[228:231]
    v_cvt_pk_bf16_f32 v25, v2, v3
    v_mul_f32 v5, s57, v5
    v_mfma_f32_16x16x32_bf16 v[232:235], a[184:187], v[20:23], v[232:235]
    v_mul_f32 v6, s57, v6
    v_mul_f32 v7, s57, v7
    v_mfma_f32_16x16x32_bf16 v[236:239], a[188:191], v[20:23], v[236:239]
    v_exp_f32 v6, v6
    v_mfma_f32_16x16x32_bf16 v[240:243], a[192:195], v[20:23], v[240:243]
    v_exp_f32 v5, v5
    v_mfma_f32_16x16x32_bf16 v[244:247], a[196:199], v[20:23], v[244:247]
    v_exp_f32 v7, v7
    v_mfma_f32_16x16x32_bf16 v[248:251], a[200:203], v[20:23], v[248:251]
    v_cvt_pk_bf16_f32 v24, v0, v1
    v_cvt_pk_bf16_f32 v26, v4, v5
    v_mfma_f32_16x16x32_bf16 v[252:255], a[204:207], v[20:23], v[252:255]
    v_cvt_pk_bf16_f32 v27, v6, v7
    v_mul_f32 v8, s57, v8
    v_mfma_f32_16x16x32_bf16 v[0:3], a[144:147], a[16:19], 0
    s_waitcnt vmcnt(6)
    v_exp_f32 v8, v8
    v_mfma_f32_16x16x32_bf16 v[0:3], a[148:151], a[20:23], v[0:3]
    s_barrier
    s_mov_b32 m0, s52
    v_mfma_f32_16x16x32_bf16 v[0:3], a[152:155], a[24:27], v[0:3]
    buffer_load_dwordx4 v49, s[4:7], s44 offen offset:0 lds
    v_mfma_f32_16x16x32_bf16 v[0:3], a[156:159], a[28:31], v[0:3]
    v_mul_f32 v9, s57, v9
    v_mul_f32 v10, s57, v10
    v_smfmac_f32_16x16x64_bf16 v[44:47], v[28:31], v[20:27], v48
    v_exp_f32 v9, v9
    v_mfma_f32_16x16x32_bf16 v[4:7], a[172:175], a[28:31], 0
    v_exp_f32 v10, v10
    v_mul_f32 v11, s57, v11
    v_mfma_f32_16x16x32_bf16 v[4:7], a[168:171], a[24:27], v[4:7]
    v_cvt_pk_bf16_f32 v16, v8, v9
    v_exp_f32 v11, v11
    v_mfma_f32_16x16x32_bf16 v[4:7], a[164:167], a[20:23], v[4:7]
    v_mul_f32 v12, s57, v12
    v_cvt_pk_bf16_f32 v17, v10, v11
    v_mfma_f32_16x16x32_bf16 v[4:7], a[160:163], a[16:19], v[4:7]
    buffer_load_dwordx4 v49, s[8:11], s44 offen offset:1024 lds
    v_mfma_f32_16x16x32_bf16 a[112:115], a[176:179], v[24:27], a[112:115]
    v_exp_f32 v12, v12
    v_mul_f32 v13, s57, v13
    v_mfma_f32_16x16x32_bf16 a[116:119], a[180:183], v[24:27], a[116:119]
    v_exp_f32 v13, v13
    v_mfma_f32_16x16x32_bf16 a[120:123], a[184:187], v[24:27], a[120:123]
    v_mul_f32 v14, s57, v14
    v_cvt_pk_bf16_f32 v18, v12, v13
    v_mfma_f32_16x16x32_bf16 a[124:127], a[188:191], v[24:27], a[124:127]
    v_exp_f32 v14, v14
    v_mul_f32 v15, s57, v15
    v_mfma_f32_16x16x32_bf16 a[128:131], a[192:195], v[24:27], a[128:131]
    v_exp_f32 v15, v15
    v_mfma_f32_16x16x32_bf16 a[132:135], a[196:199], v[24:27], a[132:135]
    buffer_load_dwordx4 v49, s[12:15], s44 offen offset:2048 lds
    v_mfma_f32_16x16x32_bf16 a[136:139], a[200:203], v[24:27], a[136:139]
    v_cvt_pk_bf16_f32 v19, v14, v15
    v_mul_f32 v0, s57, v0
    v_mfma_f32_16x16x32_bf16 a[140:143], a[204:207], v[24:27], a[140:143]
    ds_read_b64_tr_b16 a[176:177], v60 offset:2048
    v_mul_f32 v1, s57, v1
    v_mfma_f32_16x16x32_bf16 v[8:11], a[144:147], a[32:35], 0
    v_exp_f32 v0, v0
    v_mfma_f32_16x16x32_bf16 v[8:11], a[148:151], a[36:39], v[8:11]
    v_exp_f32 v1, v1
    v_mfma_f32_16x16x32_bf16 v[8:11], a[152:155], a[40:43], v[8:11]
    v_mul_f32 v2, s57, v2
    v_cvt_pk_bf16_f32 v20, v0, v1
    v_mfma_f32_16x16x32_bf16 v[8:11], a[156:159], a[44:47], v[8:11]
    buffer_load_dwordx4 v49, s[16:19], s44 offen offset:3072 lds
    v_mfma_f32_16x16x32_bf16 v[12:15], a[172:175], a[44:47], 0
    ds_read_b64_tr_b16 a[178:179], v61 offset:2048
    v_exp_f32 v2, v2
    v_mfma_f32_16x16x32_bf16 v[12:15], a[168:171], a[40:43], v[12:15]
    s_add_u32 s44, s44, 8192
    v_mul_f32 v3, s57, v3
    v_mfma_f32_16x16x32_bf16 v[12:15], a[164:167], a[36:39], v[12:15]
    ds_read_b64_tr_b16 a[180:181], v60 offset:2056
    v_exp_f32 v3, v3
    v_mfma_f32_16x16x32_bf16 v[12:15], a[160:163], a[32:35], v[12:15]
    v_mul_f32 v4, s57, v4
    v_cvt_pk_bf16_f32 v21, v2, v3
    v_mfma_f32_16x16x32_bf16 v[64:67], a[208:211], v[16:19], v[64:67]
    v_exp_f32 v4, v4
    v_mul_f32 v5, s57, v5
    v_mfma_f32_16x16x32_bf16 v[68:71], a[212:215], v[16:19], v[68:71]
    buffer_store_dwordx4 a[240:243], v49, s[36:39], s48 offen offset:0 nt
    v_mfma_f32_16x16x32_bf16 v[72:75], a[216:219], v[16:19], v[72:75]
    v_exp_f32 v5, v5
    v_mfma_f32_16x16x32_bf16 v[76:79], a[220:223], v[16:19], v[76:79]
    v_mul_f32 v6, s57, v6
    v_cvt_pk_bf16_f32 v22, v4, v5
    v_mfma_f32_16x16x32_bf16 v[80:83], a[224:227], v[16:19], v[80:83]
    v_exp_f32 v6, v6
    v_mfma_f32_16x16x32_bf16 v[84:87], a[228:231], v[16:19], v[84:87]
    v_mul_f32 v7, s57, v7
    v_mul_f32 v8, s57, v8
    v_mfma_f32_16x16x32_bf16 v[88:91], a[232:235], v[16:19], v[88:91]
    v_exp_f32 v7, v7
    v_mfma_f32_16x16x32_bf16 v[92:95], a[236:239], v[16:19], v[92:95]
    ds_read_b64_tr_b16 a[188:189], v60 offset:2568
    v_cvt_pk_bf16_f32 v23, v6, v7
    v_mfma_f32_16x16x32_bf16 v[0:3], a[144:147], a[48:51], 0
    v_exp_f32 v8, v8
    v_mfma_f32_16x16x32_bf16 v[0:3], a[148:151], a[52:55], v[0:3]
    ds_read_b64_tr_b16 a[184:185], v60 offset:2560
    v_mul_f32 v9, s57, v9
    v_mfma_f32_16x16x32_bf16 v[0:3], a[152:155], a[56:59], v[0:3]
    ds_read_b64_tr_b16 a[182:183], v61 offset:2056
    v_exp_f32 v9, v9
    v_mfma_f32_16x16x32_bf16 v[0:3], a[156:159], a[60:63], v[0:3]
    v_mul_f32 v10, s57, v10
    v_mul_f32 v11, s57, v11
    v_smfmac_f32_16x16x64_bf16 v[32:35], v[28:31], v[16:23], v48
    v_cvt_pk_bf16_f32 v16, v8, v9
    v_exp_f32 v10, v10
    v_mfma_f32_16x16x32_bf16 v[4:7], a[172:175], a[60:63], 0
    buffer_store_dwordx4 a[244:247], v49, s[36:39], s48 offen offset:128 nt
    v_mfma_f32_16x16x32_bf16 v[4:7], a[168:171], a[56:59], v[4:7]
    s_mov_b32 m0, s53
    v_exp_f32 v11, v11
    v_mfma_f32_16x16x32_bf16 v[4:7], a[164:167], a[52:55], v[4:7]
    s_add_u32 s48, s48, 2048
    v_mul_f32 v12, s57, v12
    v_mfma_f32_16x16x32_bf16 v[4:7], a[160:163], a[48:51], v[4:7]
    v_cvt_pk_bf16_f32 v17, v10, v11
    v_exp_f32 v12, v12
    v_mfma_f32_16x16x32_bf16 v[96:99], a[208:211], v[20:23], v[96:99]
    ds_read_b64_tr_b16 a[190:191], v61 offset:2568
    v_mul_f32 v13, s57, v13
    v_mfma_f32_16x16x32_bf16 v[100:103], a[212:215], v[20:23], v[100:103]
    ds_read_b64_tr_b16 a[194:195], v61 offset:3072
    v_exp_f32 v13, v13
    v_mfma_f32_16x16x32_bf16 v[104:107], a[216:219], v[20:23], v[104:107]
    v_mul_f32 v14, s57, v14
    v_cvt_pk_bf16_f32 v18, v12, v13
    v_mfma_f32_16x16x32_bf16 v[108:111], a[220:223], v[20:23], v[108:111]
    v_exp_f32 v14, v14
    v_mfma_f32_16x16x32_bf16 v[112:115], a[224:227], v[20:23], v[112:115]
    ds_read_b128 a[248:251], v51 offset:8192
    ds_read_b128 a[240:243], v51 offset:10240
    v_mul_f32 v15, s57, v15
    v_mfma_f32_16x16x32_bf16 v[116:119], a[228:231], v[20:23], v[116:119]
    v_exp_f32 v15, v15
    v_mfma_f32_16x16x32_bf16 v[120:123], a[232:235], v[20:23], v[120:123]
    v_cvt_pk_bf16_f32 v19, v14, v15
    v_mul_f32 v0, s57, v0
    v_mfma_f32_16x16x32_bf16 v[124:127], a[236:239], v[20:23], v[124:127]
    ds_read_b128 a[252:255], v51 offset:9216
    ds_read_b128 a[244:247], v51 offset:11264
    v_mfma_f32_16x16x32_bf16 v[8:11], a[144:147], a[64:67], 0
    buffer_load_dwordx4 v49, s[4:7], s44 offen offset:0 lds
    v_mfma_f32_16x16x32_bf16 v[8:11], a[148:151], a[68:71], v[8:11]
    v_exp_f32 v0, v0
    v_mul_f32 v1, s57, v1
    v_mfma_f32_16x16x32_bf16 v[8:11], a[152:155], a[72:75], v[8:11]
    v_exp_f32 v1, v1
    v_mfma_f32_16x16x32_bf16 v[8:11], a[156:159], a[76:79], v[8:11]
    v_mul_f32 v2, s57, v2
    v_cvt_pk_bf16_f32 v20, v0, v1
    v_mfma_f32_16x16x32_bf16 v[12:15], a[172:175], a[76:79], 0
    v_exp_f32 v2, v2
    v_mfma_f32_16x16x32_bf16 v[12:15], a[168:171], a[72:75], v[12:15]
    ds_read_b64_tr_b16 a[192:193], v60 offset:3072
    v_mul_f32 v3, s57, v3
    v_mfma_f32_16x16x32_bf16 v[12:15], a[164:167], a[68:71], v[12:15]
    buffer_load_dwordx4 v49, s[8:11], s44 offen offset:1024 lds
    v_mfma_f32_16x16x32_bf16 v[12:15], a[160:163], a[64:67], v[12:15]
    v_exp_f32 v3, v3
    v_mul_f32 v4, s57, v4
    v_mfma_f32_16x16x32_bf16 v[128:131], a[208:211], v[16:19], v[128:131]
    v_exp_f32 v4, v4
    v_mfma_f32_16x16x32_bf16 v[132:135], a[212:215], v[16:19], v[132:135]
    v_cvt_pk_bf16_f32 v21, v2, v3
    v_mul_f32 v5, s57, v5
    v_mfma_f32_16x16x32_bf16 v[136:139], a[216:219], v[16:19], v[136:139]
    ds_read_b64_tr_b16 a[196:197], v60 offset:3080
    v_exp_f32 v5, v5
    v_mfma_f32_16x16x32_bf16 v[140:143], a[220:223], v[16:19], v[140:143]
    v_mul_f32 v6, s57, v6
    v_cvt_pk_bf16_f32 v22, v4, v5
    v_mfma_f32_16x16x32_bf16 v[144:147], a[224:227], v[16:19], v[144:147]
    buffer_load_dwordx4 v49, s[12:15], s44 offen offset:2048 lds
    v_mul_f32 v7, s57, v7
    v_mfma_f32_16x16x32_bf16 v[148:151], a[228:231], v[16:19], v[148:151]
    ds_read_b64_tr_b16 a[198:199], v61 offset:3080
    v_exp_f32 v6, v6
    v_mfma_f32_16x16x32_bf16 v[152:155], a[232:235], v[16:19], v[152:155]
    v_exp_f32 v7, v7
    v_mfma_f32_16x16x32_bf16 v[156:159], a[236:239], v[16:19], v[156:159]
    v_mul_f32 v8, s57, v8
    v_cvt_pk_bf16_f32 v23, v6, v7
    v_mfma_f32_16x16x32_bf16 v[0:3], a[144:147], a[80:83], 0
    v_exp_f32 v8, v8
    v_mfma_f32_16x16x32_bf16 v[0:3], a[148:151], a[84:87], v[0:3]
    ds_read_b64_tr_b16 a[204:205], v60 offset:3592
    v_mul_f32 v9, s57, v9
    v_mfma_f32_16x16x32_bf16 v[0:3], a[152:155], a[88:91], v[0:3]
    buffer_load_dwordx4 v49, s[16:19], s44 offen offset:3072 lds
    v_mfma_f32_16x16x32_bf16 v[0:3], a[156:159], a[92:95], v[0:3]
    s_add_u32 s44, s44, 8192
    v_exp_f32 v9, v9
    v_smfmac_f32_16x16x64_bf16 v[36:39], v[28:31], v[16:23], v48
    v_mul_f32 v10, s57, v10
    v_cvt_pk_bf16_f32 v16, v8, v9
    v_mfma_f32_16x16x32_bf16 v[4:7], a[172:175], a[92:95], 0
    ds_read_b64_tr_b16 a[206:207], v61 offset:3592
    v_mul_f32 v11, s57, v11
    v_mfma_f32_16x16x32_bf16 v[4:7], a[168:171], a[88:91], v[4:7]
    v_mul_f32 v12, s57, v12
    v_mul_f32 v13, s57, v13
    v_mfma_f32_16x16x32_bf16 v[4:7], a[164:167], a[84:87], v[4:7]
    v_exp_f32 v11, v11
    v_mfma_f32_16x16x32_bf16 v[4:7], a[160:163], a[80:83], v[4:7]
    v_exp_f32 v10, v10
    v_mfma_f32_16x16x32_bf16 v[160:163], a[208:211], v[20:23], v[160:163]
    v_cvt_pk_bf16_f32 v17, v10, v11
    v_exp_f32 v12, v12
    v_mfma_f32_16x16x32_bf16 v[164:167], a[212:215], v[20:23], v[164:167]
    v_exp_f32 v13, v13
    v_mfma_f32_16x16x32_bf16 v[168:171], a[216:219], v[20:23], v[168:171]
    v_mul_f32 v14, s57, v14
    v_cvt_pk_bf16_f32 v18, v12, v13
    v_mfma_f32_16x16x32_bf16 v[172:175], a[220:223], v[20:23], v[172:175]
    v_exp_f32 v14, v14
    v_mfma_f32_16x16x32_bf16 v[176:179], a[224:227], v[20:23], v[176:179]
    ds_read_b64_tr_b16 a[200:201], v60 offset:3584
    v_mul_f32 v15, s57, v15
    v_mfma_f32_16x16x32_bf16 v[180:183], a[228:231], v[20:23], v[180:183]
    v_exp_f32 v15, v15
    v_mfma_f32_16x16x32_bf16 v[184:187], a[232:235], v[20:23], v[184:187]
    v_cvt_pk_bf16_f32 v19, v14, v15
    v_mul_f32 v0, s57, v0
    v_mfma_f32_16x16x32_bf16 v[188:191], a[236:239], v[20:23], v[188:191]
    ds_read_b64_tr_b16 a[186:187], v61 offset:2560
    ds_read_b64_tr_b16 a[202:203], v61 offset:3584
    v_mfma_f32_16x16x32_bf16 v[8:11], a[144:147], a[96:99], 0
    v_exp_f32 v0, v0
    v_mfma_f32_16x16x32_bf16 v[8:11], a[148:151], a[100:103], v[8:11]
    ds_read_b128 a[144:147], v56 offset:0
    v_mul_f32 v1, s57, v1
    v_mfma_f32_16x16x32_bf16 v[8:11], a[152:155], a[104:107], v[8:11]
    ds_read_b128 a[148:151], v56 offset:512
    v_exp_f32 v1, v1
    v_mfma_f32_16x16x32_bf16 v[8:11], a[156:159], a[108:111], v[8:11]
    v_mul_f32 v2, s57, v2
    v_cvt_pk_bf16_f32 v20, v0, v1
    v_mfma_f32_16x16x32_bf16 v[12:15], a[172:175], a[108:111], 0
    ds_read_b128 a[152:155], v56 offset:1024
    ds_read_b128 a[156:159], v56 offset:1536
    v_mfma_f32_16x16x32_bf16 v[12:15], a[168:171], a[104:107], v[12:15]
    ds_read_b128 a[172:175], v57 offset:1536
    v_mul_f32 v3, s57, v3
    v_mfma_f32_16x16x32_bf16 v[12:15], a[164:167], a[100:103], v[12:15]
    v_exp_f32 v2, v2
    v_mfma_f32_16x16x32_bf16 v[12:15], a[160:163], a[96:99], v[12:15]
    v_exp_f32 v3, v3
    v_mfma_f32_16x16x32_bf16 v[192:195], a[208:211], v[16:19], v[192:195]
    v_mul_f32 v4, s57, v4
    v_cvt_pk_bf16_f32 v21, v2, v3
    v_mfma_f32_16x16x32_bf16 v[196:199], a[212:215], v[16:19], v[196:199]
    ds_read_b128 a[160:163], v57 offset:0
    v_mul_f32 v5, s57, v5
    v_mfma_f32_16x16x32_bf16 v[200:203], a[216:219], v[16:19], v[200:203]
    ds_read_b128 a[168:171], v57 offset:1024
    ds_read_b128 a[164:167], v57 offset:512
    v_mfma_f32_16x16x32_bf16 v[204:207], a[220:223], v[16:19], v[204:207]
    v_exp_f32 v4, v4
    v_mfma_f32_16x16x32_bf16 v[208:211], a[224:227], v[16:19], v[208:211]
    v_mul_f32 v6, s57, v6
    v_mul_f32 v7, s57, v7
    v_mfma_f32_16x16x32_bf16 v[212:215], a[228:231], v[16:19], v[212:215]
    v_exp_f32 v5, v5
    v_mfma_f32_16x16x32_bf16 v[216:219], a[232:235], v[16:19], v[216:219]
    v_exp_f32 v7, v7
    v_mfma_f32_16x16x32_bf16 v[220:223], a[236:239], v[16:19], v[220:223]
    s_waitcnt lgkmcnt(4)
    v_mul_f32 v8, s57, v8
    v_mfma_f32_16x16x32_bf16 v[0:3], a[144:147], a[0:3], 0
    v_exp_f32 v6, v6
    v_mfma_f32_16x16x32_bf16 v[0:3], a[148:151], a[4:7], v[0:3]
    v_cvt_pk_bf16_f32 v22, v4, v5
    v_cvt_pk_bf16_f32 v23, v6, v7
    v_mfma_f32_16x16x32_bf16 v[0:3], a[152:155], a[8:11], v[0:3]
    v_exp_f32 v8, v8
    v_mfma_f32_16x16x32_bf16 v[0:3], a[156:159], a[12:15], v[0:3]
    v_mul_f32 v9, s57, v9
    v_mul_f32 v10, s57, v10
    v_smfmac_f32_16x16x64_bf16 v[40:43], v[28:31], v[16:23], v48
    s_waitcnt lgkmcnt(0)
    v_mfma_f32_16x16x32_bf16 v[4:7], a[172:175], a[12:15], 0
    v_mul_f32 v11, s57, v11
    v_mul_f32 v12, s57, v12
    v_mfma_f32_16x16x32_bf16 v[4:7], a[168:171], a[8:11], v[4:7]
    v_exp_f32 v9, v9
    v_mfma_f32_16x16x32_bf16 v[4:7], a[164:167], a[4:7], v[4:7]
    v_exp_f32 v10, v10
    v_mfma_f32_16x16x32_bf16 v[4:7], a[160:163], a[0:3], v[4:7]
    v_exp_f32 v11, v11
    v_mfma_f32_16x16x32_bf16 v[224:227], a[208:211], v[20:23], v[224:227]
    v_cvt_pk_bf16_f32 v24, v8, v9
    v_mul_f32 v13, s57, v13
    v_mfma_f32_16x16x32_bf16 v[228:231], a[212:215], v[20:23], v[228:231]
    v_cvt_pk_bf16_f32 v25, v10, v11
    v_mul_f32 v14, s57, v14
    v_mfma_f32_16x16x32_bf16 v[232:235], a[216:219], v[20:23], v[232:235]
    v_exp_f32 v13, v13
    v_mfma_f32_16x16x32_bf16 v[236:239], a[220:223], v[20:23], v[236:239]
    v_exp_f32 v14, v14
    v_mfma_f32_16x16x32_bf16 v[240:243], a[224:227], v[20:23], v[240:243]
    v_exp_f32 v12, v12
    v_mfma_f32_16x16x32_bf16 v[244:247], a[228:231], v[20:23], v[244:247]
    v_cvt_pk_bf16_f32 v26, v12, v13
    v_mul_f32 v15, s57, v15
    v_mfma_f32_16x16x32_bf16 v[248:251], a[232:235], v[20:23], v[248:251]
    v_exp_f32 v15, v15
    v_mfma_f32_16x16x32_bf16 v[252:255], a[236:239], v[20:23], v[252:255]
    v_cvt_pk_bf16_f32 v27, v14, v15
    v_mul_f32_e64 v0, s57, v0
L_A_T4:
    v_mfma_f32_16x16x32_bf16 v[8:11], a[144:147], a[16:19], 0
    buffer_store_dwordx4 a[248:251], v49, s[36:39], s48 offen offset:0 nt
    v_mfma_f32_16x16x32_bf16 v[8:11], a[148:151], a[20:23], v[8:11]
    v_exp_f32 v0, v0
    v_mul_f32 v1, s57, v1
    v_mfma_f32_16x16x32_bf16 v[8:11], a[152:155], a[24:27], v[8:11]
    v_exp_f32 v1, v1
    v_mfma_f32_16x16x32_bf16 v[8:11], a[156:159], a[28:31], v[8:11]
    v_mul_f32 v2, s57, v2
    v_cvt_pk_bf16_f32 v16, v0, v1
    v_smfmac_f32_16x16x64_bf16 v[44:47], v[28:31], v[20:27], v48
    v_exp_f32 v2, v2
    v_mfma_f32_16x16x32_bf16 v[12:15], a[172:175], a[28:31], 0
    v_mul_f32 v3, s57, v3
    v_mul_f32 v4, s57, v4
    v_mfma_f32_16x16x32_bf16 v[12:15], a[168:171], a[24:27], v[12:15]
    v_exp_f32 v3, v3
    v_mfma_f32_16x16x32_bf16 v[12:15], a[164:167], a[20:23], v[12:15]
    v_exp_f32 v4, v4
    v_mfma_f32_16x16x32_bf16 v[12:15], a[160:163], a[16:19], v[12:15]
    v_cvt_pk_bf16_f32 v17, v2, v3
    v_mul_f32 v5, s57, v5
    v_mfma_f32_16x16x32_bf16 a[112:115], a[208:211], v[24:27], a[112:115]
    v_exp_f32 v5, v5
    v_mfma_f32_16x16x32_bf16 a[116:119], a[212:215], v[24:27], a[116:119]
    v_mul_f32 v6, s57, v6
    v_mul_f32 v7, s57, v7
    v_mfma_f32_16x16x32_bf16 a[120:123], a[216:219], v[24:27], a[120:123]
    v_exp_f32 v6, v6
    v_mfma_f32_16x16x32_bf16 a[124:127], a[220:223], v[24:27], a[124:127]
    buffer_store_dwordx4 a[252:255], v49, s[36:39], s48 offen offset:128 nt
    v_mfma_f32_16x16x32_bf16 a[128:131], a[224:227], v[24:27], a[128:131]
    v_exp_f32 v7, v7
    v_mfma_f32_16x16x32_bf16 a[132:135], a[228:231], v[24:27], a[132:135]
    v_cvt_pk_bf16_f32 v18, v4, v5
    v_mul_f32 v8, s57, v8
    v_mfma_f32_16x16x32_bf16 a[136:139], a[232:235], v[24:27], a[136:139]
    v_cvt_pk_bf16_f32 v19, v6, v7
    v_mul_f32 v10, s57, v10
    v_mfma_f32_16x16x32_bf16 a[140:143], a[236:239], v[24:27], a[140:143]
    v_exp_f32 v8, v8
    v_mfma_f32_16x16x32_bf16 v[0:3], a[144:147], a[32:35], 0
    ds_read_b64_tr_b16 a[208:209], v62 offset:2048
    v_mul_f32 v9, s57, v9
    v_mfma_f32_16x16x32_bf16 v[0:3], a[148:151], a[36:39], v[0:3]
    v_mul_f32 v11, s57, v11
    v_mul_f32 v12, s57, v12
    v_mfma_f32_16x16x32_bf16 v[0:3], a[152:155], a[40:43], v[0:3]
    v_exp_f32 v10, v10
    v_mfma_f32_16x16x32_bf16 v[0:3], a[156:159], a[44:47], v[0:3]
    v_exp_f32 v11, v11
    v_mfma_f32_16x16x32_bf16 v[4:7], a[172:175], a[44:47], 0
    v_cvt_pk_bf16_f32 v21, v10, v11
    v_mul_f32 v13, s57, v13
    v_mfma_f32_16x16x32_bf16 v[4:7], a[168:171], a[40:43], v[4:7]
    v_exp_f32 v9, v9
    v_mfma_f32_16x16x32_bf16 v[4:7], a[164:167], a[36:39], v[4:7]
    v_exp_f32 v13, v13
    v_mfma_f32_16x16x32_bf16 v[4:7], a[160:163], a[32:35], v[4:7]
    buffer_store_dwordx4 a[240:243], v49, s[36:39], s48 offen offset:2048 nt
    v_mfma_f32_16x16x32_bf16 v[64:67], a[176:179], v[16:19], v[64:67]
    v_exp_f32 v12, v12
    v_mfma_f32_16x16x32_bf16 v[68:71], a[180:183], v[16:19], v[68:71]
    v_cvt_pk_bf16_f32 v20, v8, v9
    v_mul_f32 v14, s57, v14
    v_mfma_f32_16x16x32_bf16 v[72:75], a[184:187], v[16:19], v[72:75]
    v_exp_f32 v14, v14
    v_mfma_f32_16x16x32_bf16 v[76:79], a[188:191], v[16:19], v[76:79]
    ds_read_b64_tr_b16 a[212:213], v62 offset:2056
    ds_read_b64_tr_b16 a[216:217], v62 offset:2560
    v_mfma_f32_16x16x32_bf16 v[80:83], a[192:195], v[16:19], v[80:83]
    ds_read_b64_tr_b16 a[214:215], v63 offset:2056
    v_cvt_pk_bf16_f32 v22, v12, v13
    v_mfma_f32_16x16x32_bf16 v[84:87], a[196:199], v[16:19], v[84:87]
    ds_read_b64_tr_b16 a[218:219], v63 offset:2560
    v_mul_f32 v15, s57, v15
    v_mfma_f32_16x16x32_bf16 v[88:91], a[200:203], v[16:19], v[88:91]
    v_mul_f32 v0, s57, v0
    v_mul_f32 v1, s57, v1
    v_mfma_f32_16x16x32_bf16 v[92:95], a[204:207], v[16:19], v[92:95]
    v_exp_f32 v15, v15
    v_mfma_f32_16x16x32_bf16 v[8:11], a[144:147], a[48:51], 0
    v_exp_f32 v0, v0
    v_mfma_f32_16x16x32_bf16 v[8:11], a[148:151], a[52:55], v[8:11]
    v_cvt_pk_bf16_f32 v23, v14, v15
    v_mul_f32 v4, s57, v4
    v_mfma_f32_16x16x32_bf16 v[8:11], a[152:155], a[56:59], v[8:11]
    v_exp_f32 v1, v1
    v_mul_f32 v2, s57, v2
    v_mfma_f32_16x16x32_bf16 v[8:11], a[156:159], a[60:63], v[8:11]
    buffer_store_dwordx4 a[244:247], v49, s[36:39], s48 offen offset:2176 nt
    v_smfmac_f32_16x16x64_bf16 v[32:35], v[28:31], v[16:23], v48
    s_add_u32 s48, s48, 4096
    v_cvt_pk_bf16_f32 v16, v0, v1
    v_mfma_f32_16x16x32_bf16 v[12:15], a[172:175], a[60:63], 0
    v_exp_f32 v2, v2
    v_mfma_f32_16x16x32_bf16 v[12:15], a[168:171], a[56:59], v[12:15]
    v_exp_f32 v4, v4
    v_mfma_f32_16x16x32_bf16 v[12:15], a[164:167], a[52:55], v[12:15]
    ds_read_b64_tr_b16 a[210:211], v63 offset:2048
    v_mul_f32 v3, s57, v3
    v_mfma_f32_16x16x32_bf16 v[12:15], a[160:163], a[48:51], v[12:15]
    v_exp_f32 v3, v3
    v_mfma_f32_16x16x32_bf16 v[96:99], a[176:179], v[20:23], v[96:99]
    v_cvt_pk_bf16_f32 v17, v2, v3
    v_mul_f32 v5, s57, v5
    v_mfma_f32_16x16x32_bf16 v[100:103], a[180:183], v[20:23], v[100:103]
    v_exp_f32 v5, v5
    v_mfma_f32_16x16x32_bf16 v[104:107], a[184:187], v[20:23], v[104:107]
    v_mul_f32 v6, s57, v6
    v_cvt_pk_bf16_f32 v18, v4, v5
    v_mfma_f32_16x16x32_bf16 v[108:111], a[188:191], v[20:23], v[108:111]
    ds_read_b64_tr_b16 a[222:223], v63 offset:2568
    v_mul_f32 v7, s57, v7
    v_mfma_f32_16x16x32_bf16 v[112:115], a[192:195], v[20:23], v[112:115]
    v_exp_f32 v6, v6
    v_mfma_f32_16x16x32_bf16 v[116:119], a[196:199], v[20:23], v[116:119]
    v_exp_f32 v7, v7
    v_mfma_f32_16x16x32_bf16 v[120:123], a[200:203], v[20:23], v[120:123]
    global_load_dword v55, v[52:53], off
    v_mfma_f32_16x16x32_bf16 v[124:127], a[204:207], v[20:23], v[124:127]
    v_cvt_pk_bf16_f32 v19, v6, v7
    v_mul_f32 v8, s57, v8
    v_mfma_f32_16x16x32_bf16 v[0:3], a[144:147], a[64:67], 0
    v_exp_f32 v8, v8
    v_mfma_f32_16x16x32_bf16 v[0:3], a[148:151], a[68:71], v[0:3]
    ds_read_b64_tr_b16 a[224:225], v62 offset:3072
    v_mul_f32 v9, s57, v9
    v_mfma_f32_16x16x32_bf16 v[0:3], a[152:155], a[72:75], v[0:3]
    v_exp_f32 v9, v9
    v_mfma_f32_16x16x32_bf16 v[0:3], a[156:159], a[76:79], v[0:3]
    v_mul_f32 v10, s57, v10
    v_cvt_pk_bf16_f32 v20, v8, v9
    v_mfma_f32_16x16x32_bf16 v[4:7], a[172:175], a[76:79], 0
    v_exp_f32 v10, v10
    v_mfma_f32_16x16x32_bf16 v[4:7], a[168:171], a[72:75], v[4:7]
    ds_read_b64_tr_b16 a[226:227], v63 offset:3072
    v_mul_f32 v11, s57, v11
    v_mfma_f32_16x16x32_bf16 v[4:7], a[164:167], a[68:71], v[4:7]
    v_exp_f32 v11, v11
    v_mfma_f32_16x16x32_bf16 v[4:7], a[160:163], a[64:67], v[4:7]
    v_mul_f32 v12, s57, v12
    v_cvt_pk_bf16_f32 v21, v10, v11
    v_mfma_f32_16x16x32_bf16 v[128:131], a[176:179], v[16:19], v[128:131]
    ds_read_b64_tr_b16 a[220:221], v62 offset:2568
    v_exp_f32 v12, v12
    v_mfma_f32_16x16x32_bf16 v[132:135], a[180:183], v[16:19], v[132:135]
    ds_read_b64_tr_b16 a[228:229], v62 offset:3080
    v_mul_f32 v13, s57, v13
    v_add_u32 v51, 0x1800, v51
    v_mfma_f32_16x16x32_bf16 v[136:139], a[184:187], v[16:19], v[136:139]
    v_exp_f32 v13, v13
    v_mfma_f32_16x16x32_bf16 v[140:143], a[188:191], v[16:19], v[140:143]
    v_mul_f32 v14, s57, v14
    v_cvt_pk_bf16_f32 v22, v12, v13
    v_mfma_f32_16x16x32_bf16 v[144:147], a[192:195], v[16:19], v[144:147]
    v_exp_f32 v14, v14
    v_mfma_f32_16x16x32_bf16 v[148:151], a[196:199], v[16:19], v[148:151]
    ds_read_b64_tr_b16 a[230:231], v63 offset:3080
    v_mul_f32 v15, s57, v15
    v_mfma_f32_16x16x32_bf16 v[152:155], a[200:203], v[16:19], v[152:155]
    v_exp_f32 v15, v15
    v_mfma_f32_16x16x32_bf16 v[156:159], a[204:207], v[16:19], v[156:159]
    v_mul_f32 v0, s57, v0
    v_cvt_pk_bf16_f32 v23, v14, v15
    v_mfma_f32_16x16x32_bf16 v[8:11], a[144:147], a[80:83], 0
    v_exp_f32 v0, v0
    v_mfma_f32_16x16x32_bf16 v[8:11], a[148:151], a[84:87], v[8:11]
    ds_read_b64_tr_b16 a[232:233], v62 offset:3584
    v_mul_f32 v1, s57, v1
    v_mfma_f32_16x16x32_bf16 v[8:11], a[152:155], a[88:91], v[8:11]
    v_exp_f32 v1, v1
    v_mfma_f32_16x16x32_bf16 v[8:11], a[156:159], a[92:95], v[8:11]
    ds_read_b64_tr_b16 a[234:235], v63 offset:3584
    v_mul_f32 v2, s57, v2
    v_smfmac_f32_16x16x64_bf16 v[36:39], v[28:31], v[16:23], v48
    v_cvt_pk_bf16_f32 v16, v0, v1
    v_mfma_f32_16x16x32_bf16 v[12:15], a[172:175], a[92:95], 0
    v_exp_f32 v2, v2
    v_mfma_f32_16x16x32_bf16 v[12:15], a[168:171], a[88:91], v[12:15]
    v_mul_f32 v3, s57, v3
    v_mul_f32 v4, s57, v4
    v_mfma_f32_16x16x32_bf16 v[12:15], a[164:167], a[84:87], v[12:15]
    v_exp_f32 v3, v3
    v_mfma_f32_16x16x32_bf16 v[12:15], a[160:163], a[80:83], v[12:15]
    v_exp_f32 v4, v4
    v_mfma_f32_16x16x32_bf16 v[160:163], a[176:179], v[20:23], v[160:163]
    v_cvt_pk_bf16_f32 v17, v2, v3
    v_mul_f32 v5, s57, v5
    v_mfma_f32_16x16x32_bf16 v[164:167], a[180:183], v[20:23], v[164:167]
    v_exp_f32 v5, v5
    v_mfma_f32_16x16x32_bf16 v[168:171], a[184:187], v[20:23], v[168:171]
    v_mul_f32 v6, s57, v6
    v_cvt_pk_bf16_f32 v18, v4, v5
    v_mfma_f32_16x16x32_bf16 v[172:175], a[188:191], v[20:23], v[172:175]
    v_exp_f32 v6, v6
    v_mfma_f32_16x16x32_bf16 v[176:179], a[192:195], v[20:23], v[176:179]
    ds_read_b64_tr_b16 a[238:239], v63 offset:3592
    v_mul_f32 v7, s57, v7
    v_mfma_f32_16x16x32_bf16 v[180:183], a[196:199], v[20:23], v[180:183]
    v_exp_f32 v7, v7
    v_mfma_f32_16x16x32_bf16 v[184:187], a[200:203], v[20:23], v[184:187]
    ds_read_b64_tr_b16 a[236:237], v62 offset:3592
    v_mul_f32 v8, s57, v8
    v_mfma_f32_16x16x32_bf16 v[188:191], a[204:207], v[20:23], v[188:191]
    v_cvt_pk_bf16_f32 v19, v6, v7
    v_mul_f32 v9, s57, v9
    v_mfma_f32_16x16x32_bf16 v[0:3], a[144:147], a[96:99], 0
    v_exp_f32 v8, v8
    v_mfma_f32_16x16x32_bf16 v[0:3], a[148:151], a[100:103], v[0:3]
    ds_read_b128 a[144:147], v58 offset:0
    ds_read_b128 a[148:151], v58 offset:512
    v_mfma_f32_16x16x32_bf16 v[0:3], a[152:155], a[104:107], v[0:3]
    v_exp_f32 v9, v9
    v_mfma_f32_16x16x32_bf16 v[0:3], a[156:159], a[108:111], v[0:3]
    v_mul_f32 v10, s57, v10
    v_cvt_pk_bf16_f32 v20, v8, v9
    v_mfma_f32_16x16x32_bf16 v[4:7], a[172:175], a[108:111], 0
    ds_read_b128 a[152:155], v58 offset:1024
    v_exp_f32 v10, v10
    v_mfma_f32_16x16x32_bf16 v[4:7], a[168:171], a[104:107], v[4:7]
    ds_read_b128 a[156:159], v58 offset:1536
    v_mul_f32 v11, s57, v11
    v_mfma_f32_16x16x32_bf16 v[4:7], a[164:167], a[100:103], v[4:7]
    v_exp_f32 v11, v11
    v_mfma_f32_16x16x32_bf16 v[4:7], a[160:163], a[96:99], v[4:7]
    v_mul_f32 v12, s57, v12
    v_cvt_pk_bf16_f32 v21, v10, v11
    v_mfma_f32_16x16x32_bf16 v[192:195], a[176:179], v[16:19], v[192:195]
    ds_read_b128 a[168:171], v59 offset:1024
    ds_read_b128 a[164:167], v59 offset:512
    v_mfma_f32_16x16x32_bf16 v[196:199], a[180:183], v[16:19], v[196:199]
    ds_read_b128 a[172:175], v59 offset:1536
    v_mul_f32 v13, s57, v13
    v_mfma_f32_16x16x32_bf16 v[200:203], a[184:187], v[16:19], v[200:203]
    ds_read_b128 a[160:163], v59 offset:0
    v_mul_f32 v14, s57, v14
    v_mfma_f32_16x16x32_bf16 v[204:207], a[188:191], v[16:19], v[204:207]
    v_exp_f32 v12, v12
    v_mfma_f32_16x16x32_bf16 v[208:211], a[192:195], v[16:19], v[208:211]
    v_exp_f32 v13, v13
    v_mfma_f32_16x16x32_bf16 v[212:215], a[196:199], v[16:19], v[212:215]
    v_cvt_pk_bf16_f32 v22, v12, v13
    v_mul_f32 v15, s57, v15
    v_mfma_f32_16x16x32_bf16 v[216:219], a[200:203], v[16:19], v[216:219]
    v_exp_f32 v14, v14
    v_mfma_f32_16x16x32_bf16 v[220:223], a[204:207], v[16:19], v[220:223]
    s_waitcnt lgkmcnt(4)
    v_mul_f32 v0, s57, v0
    v_mfma_f32_16x16x32_bf16 v[8:11], a[144:147], a[0:3], 0
    v_exp_f32 v15, v15
    v_mfma_f32_16x16x32_bf16 v[8:11], a[148:151], a[4:7], v[8:11]
    v_cvt_pk_bf16_f32 v23, v14, v15
    v_mul_f32 v1, s57, v1
    v_mfma_f32_16x16x32_bf16 v[8:11], a[152:155], a[8:11], v[8:11]
    v_exp_f32 v0, v0
    v_mfma_f32_16x16x32_bf16 v[8:11], a[156:159], a[12:15], v[8:11]
    v_mul_f32 v2, s57, v2
    v_mul_f32 v4, s57, v4
    v_smfmac_f32_16x16x64_bf16 v[40:43], v[28:31], v[16:23], v48
    s_waitcnt lgkmcnt(0)
    v_mfma_f32_16x16x32_bf16 v[12:15], a[172:175], a[12:15], 0
    v_mul_f32 v3, s57, v3
    v_mul_f32 v5, s57, v5
    v_mfma_f32_16x16x32_bf16 v[12:15], a[168:171], a[8:11], v[12:15]
    v_exp_f32 v1, v1
    v_mfma_f32_16x16x32_bf16 v[12:15], a[164:167], a[4:7], v[12:15]
    v_exp_f32 v3, v3
    v_mfma_f32_16x16x32_bf16 v[12:15], a[160:163], a[0:3], v[12:15]
    v_exp_f32 v2, v2
    v_mfma_f32_16x16x32_bf16 v[224:227], a[176:179], v[20:23], v[224:227]
    v_cvt_pk_bf16_f32 v24, v0, v1
    v_cvt_pk_bf16_f32 v25, v2, v3
    v_mfma_f32_16x16x32_bf16 v[228:231], a[180:183], v[20:23], v[228:231]
    v_exp_f32 v5, v5
    v_mfma_f32_16x16x32_bf16 v[232:235], a[184:187], v[20:23], v[232:235]
    v_mul_f32 v6, s57, v6
    v_mul_f32 v7, s57, v7
    v_mfma_f32_16x16x32_bf16 v[236:239], a[188:191], v[20:23], v[236:239]
    v_exp_f32 v4, v4
    v_mfma_f32_16x16x32_bf16 v[240:243], a[192:195], v[20:23], v[240:243]
    v_exp_f32 v6, v6
    v_mfma_f32_16x16x32_bf16 v[244:247], a[196:199], v[20:23], v[244:247]
    v_exp_f32 v7, v7
    v_mfma_f32_16x16x32_bf16 v[248:251], a[200:203], v[20:23], v[248:251]
    v_cvt_pk_bf16_f32 v26, v4, v5
    v_mul_f32 v8, s57, v8
    v_mfma_f32_16x16x32_bf16 v[252:255], a[204:207], v[20:23], v[252:255]
    v_cvt_pk_bf16_f32 v27, v6, v7
    v_mfma_f32_16x16x32_bf16 v[0:3], a[144:147], a[16:19], 0
    s_waitcnt vmcnt(5)
    v_exp_f32 v8, v8
    v_mfma_f32_16x16x32_bf16 v[0:3], a[148:151], a[20:23], v[0:3]
    s_barrier
    s_mov_b32 m0, s50
    v_mul_f32 v9, s57, v9
    v_mfma_f32_16x16x32_bf16 v[0:3], a[152:155], a[24:27], v[0:3]
    buffer_load_dwordx4 v49, s[4:7], s44 offen offset:0 lds
    v_mfma_f32_16x16x32_bf16 v[0:3], a[156:159], a[28:31], v[0:3]
    v_exp_f32 v9, v9
    v_mul_f32 v10, s57, v10
    v_smfmac_f32_16x16x64_bf16 v[44:47], v[28:31], v[20:27], v48
    v_cvt_pk_bf16_f32 v16, v8, v9
    v_mfma_f32_16x16x32_bf16 v[4:7], a[172:175], a[28:31], 0
    v_exp_f32 v10, v10
    v_mul_f32 v11, s57, v11
    v_mfma_f32_16x16x32_bf16 v[4:7], a[168:171], a[24:27], v[4:7]
    v_exp_f32 v11, v11
    v_mfma_f32_16x16x32_bf16 v[4:7], a[164:167], a[20:23], v[4:7]
    v_mul_f32 v12, s57, v12
    v_cvt_pk_bf16_f32 v17, v10, v11
    v_mfma_f32_16x16x32_bf16 v[4:7], a[160:163], a[16:19], v[4:7]
    buffer_load_dwordx4 v49, s[8:11], s44 offen offset:1024 lds
    v_mfma_f32_16x16x32_bf16 a[112:115], a[176:179], v[24:27], a[112:115]
    v_exp_f32 v12, v12
    v_mul_f32 v13, s57, v13
    v_mfma_f32_16x16x32_bf16 a[116:119], a[180:183], v[24:27], a[116:119]
    v_exp_f32 v13, v13
    v_mfma_f32_16x16x32_bf16 a[120:123], a[184:187], v[24:27], a[120:123]
    v_mul_f32 v14, s57, v14
    v_cvt_pk_bf16_f32 v18, v12, v13
    v_mfma_f32_16x16x32_bf16 a[124:127], a[188:191], v[24:27], a[124:127]
    v_exp_f32 v14, v14
    v_mul_f32 v15, s57, v15
    v_mfma_f32_16x16x32_bf16 a[128:131], a[192:195], v[24:27], a[128:131]
    v_exp_f32 v15, v15
    v_mfma_f32_16x16x32_bf16 a[132:135], a[196:199], v[24:27], a[132:135]
    buffer_load_dwordx4 v49, s[12:15], s44 offen offset:2048 lds
    v_mfma_f32_16x16x32_bf16 a[136:139], a[200:203], v[24:27], a[136:139]
    v_cvt_pk_bf16_f32 v19, v14, v15
    v_mul_f32 v0, s57, v0
    v_mfma_f32_16x16x32_bf16 a[140:143], a[204:207], v[24:27], a[140:143]
    ds_read_b64_tr_b16 a[178:179], v61 offset:34816
    v_mul_f32 v1, s57, v1
    v_mfma_f32_16x16x32_bf16 v[8:11], a[144:147], a[32:35], 0
    v_exp_f32 v0, v0
    v_mfma_f32_16x16x32_bf16 v[8:11], a[148:151], a[36:39], v[8:11]
    v_exp_f32 v1, v1
    v_mul_f32 v2, s57, v2
    v_mfma_f32_16x16x32_bf16 v[8:11], a[152:155], a[40:43], v[8:11]
    v_exp_f32 v2, v2
    v_mfma_f32_16x16x32_bf16 v[8:11], a[156:159], a[44:47], v[8:11]
    buffer_load_dwordx4 v49, s[16:19], s44 offen offset:3072 lds
    v_cvt_pk_bf16_f32 v20, v0, v1
    v_mfma_f32_16x16x32_bf16 v[12:15], a[172:175], a[44:47], 0
    s_add_u32 s44, s44, 8192
    s_mov_b32 m0, s51
    v_mfma_f32_16x16x32_bf16 v[12:15], a[168:171], a[40:43], v[12:15]
    ds_read_b64_tr_b16 a[180:181], v60 offset:34824
    v_mul_f32 v3, s57, v3
    v_mfma_f32_16x16x32_bf16 v[12:15], a[164:167], a[36:39], v[12:15]
    v_exp_f32 v3, v3
    v_mfma_f32_16x16x32_bf16 v[12:15], a[160:163], a[32:35], v[12:15]
    v_mul_f32 v4, s57, v4
    v_cvt_pk_bf16_f32 v21, v2, v3
    v_mfma_f32_16x16x32_bf16 v[64:67], a[208:211], v[16:19], v[64:67]
    v_exp_f32 v4, v4
    v_mfma_f32_16x16x32_bf16 v[68:71], a[212:215], v[16:19], v[68:71]
    buffer_load_dwordx4 v49, s[4:7], s44 offen offset:0 lds
    v_mul_f32 v5, s57, v5
    v_mfma_f32_16x16x32_bf16 v[72:75], a[216:219], v[16:19], v[72:75]
    v_exp_f32 v5, v5
    v_mfma_f32_16x16x32_bf16 v[76:79], a[220:223], v[16:19], v[76:79]
    v_mul_f32 v6, s57, v6
    v_cvt_pk_bf16_f32 v22, v4, v5
    v_mfma_f32_16x16x32_bf16 v[80:83], a[224:227], v[16:19], v[80:83]
    v_exp_f32 v6, v6
    v_mfma_f32_16x16x32_bf16 v[84:87], a[228:231], v[16:19], v[84:87]
    v_mul_f32 v7, s57, v7
    v_mul_f32 v8, s57, v8
    v_mfma_f32_16x16x32_bf16 v[88:91], a[232:235], v[16:19], v[88:91]
    v_exp_f32 v7, v7
    v_mfma_f32_16x16x32_bf16 v[92:95], a[236:239], v[16:19], v[92:95]
    buffer_load_dwordx4 v49, s[8:11], s44 offen offset:1024 lds
    v_cvt_pk_bf16_f32 v23, v6, v7
    v_mfma_f32_16x16x32_bf16 v[0:3], a[144:147], a[48:51], 0
    v_exp_f32 v8, v8
    v_mfma_f32_16x16x32_bf16 v[0:3], a[148:151], a[52:55], v[0:3]
    v_mul_f32 v9, s57, v9
    v_mul_f32 v10, s57, v10
    v_mfma_f32_16x16x32_bf16 v[0:3], a[152:155], a[56:59], v[0:3]
    v_exp_f32 v9, v9
    v_mfma_f32_16x16x32_bf16 v[0:3], a[156:159], a[60:63], v[0:3]
    v_exp_f32 v10, v10
    v_smfmac_f32_16x16x64_bf16 v[32:35], v[28:31], v[16:23], v48
    ds_read_b64_tr_b16 a[186:187], v61 offset:35328
    v_cvt_pk_bf16_f32 v16, v8, v9
    v_mfma_f32_16x16x32_bf16 v[4:7], a[172:175], a[60:63], 0
    buffer_load_dwordx4 v49, s[12:15], s44 offen offset:2048 lds
    v_mul_f32 v11, s57, v11
    v_mfma_f32_16x16x32_bf16 v[4:7], a[168:171], a[56:59], v[4:7]
    v_exp_f32 v11, v11
    v_mfma_f32_16x16x32_bf16 v[4:7], a[164:167], a[52:55], v[4:7]
    v_mul_f32 v12, s57, v12
    v_cvt_pk_bf16_f32 v17, v10, v11
    v_mfma_f32_16x16x32_bf16 v[4:7], a[160:163], a[48:51], v[4:7]
    v_exp_f32 v12, v12
    v_mfma_f32_16x16x32_bf16 v[96:99], a[208:211], v[20:23], v[96:99]
    ds_read_b64_tr_b16 a[182:183], v61 offset:34824
    v_mul_f32 v13, s57, v13
    v_mfma_f32_16x16x32_bf16 v[100:103], a[212:215], v[20:23], v[100:103]
    v_exp_f32 v13, v13
    v_mul_f32 v14, s57, v14
    v_mfma_f32_16x16x32_bf16 v[104:107], a[216:219], v[20:23], v[104:107]
    buffer_load_dwordx4 v49, s[16:19], s44 offen offset:3072 lds
    v_cvt_pk_bf16_f32 v18, v12, v13
    v_mfma_f32_16x16x32_bf16 v[108:111], a[220:223], v[20:23], v[108:111]
    ds_read_b64_tr_b16 a[190:191], v61 offset:35336
    s_add_u32 s44, s44, 8192
    v_mfma_f32_16x16x32_bf16 v[112:115], a[224:227], v[20:23], v[112:115]
    ds_read_b64_tr_b16 a[184:185], v60 offset:35328
    v_mul_f32 v15, s57, v15
    v_mfma_f32_16x16x32_bf16 v[116:119], a[228:231], v[20:23], v[116:119]
    v_exp_f32 v14, v14
    v_mfma_f32_16x16x32_bf16 v[120:123], a[232:235], v[20:23], v[120:123]
    v_exp_f32 v15, v15
    v_mul_f32 v0, s57, v0
    v_mfma_f32_16x16x32_bf16 v[124:127], a[236:239], v[20:23], v[124:127]
    ds_read_b64_tr_b16 a[188:189], v60 offset:35336
    v_cvt_pk_bf16_f32 v19, v14, v15
    v_mfma_f32_16x16x32_bf16 v[8:11], a[144:147], a[64:67], 0
    v_exp_f32 v0, v0
    v_mfma_f32_16x16x32_bf16 v[8:11], a[148:151], a[68:71], v[8:11]
    ds_read_b64_tr_b16 a[192:193], v60 offset:35840
    v_mul_f32 v1, s57, v1
    v_mfma_f32_16x16x32_bf16 v[8:11], a[152:155], a[72:75], v[8:11]
    v_exp_f32 v1, v1
    v_mfma_f32_16x16x32_bf16 v[8:11], a[156:159], a[76:79], v[8:11]
    v_mul_f32 v2, s57, v2
    v_cvt_pk_bf16_f32 v20, v0, v1
    v_mfma_f32_16x16x32_bf16 v[12:15], a[172:175], a[76:79], 0
    v_exp_f32 v2, v2
    v_mfma_f32_16x16x32_bf16 v[12:15], a[168:171], a[72:75], v[12:15]
    ds_read_b64_tr_b16 a[194:195], v61 offset:35840
    v_mul_f32 v3, s57, v3
    v_mfma_f32_16x16x32_bf16 v[12:15], a[164:167], a[68:71], v[12:15]
    v_exp_f32 v3, v3
    v_mfma_f32_16x16x32_bf16 v[12:15], a[160:163], a[64:67], v[12:15]
    v_mul_f32 v4, s57, v4
    v_cvt_pk_bf16_f32 v21, v2, v3
    v_mfma_f32_16x16x32_bf16 v[128:131], a[208:211], v[16:19], v[128:131]
    v_exp_f32 v4, v4
    v_mfma_f32_16x16x32_bf16 v[132:135], a[212:215], v[16:19], v[132:135]
    ds_read_b64_tr_b16 a[196:197], v60 offset:35848
    v_mul_f32 v5, s57, v5
    v_mfma_f32_16x16x32_bf16 v[136:139], a[216:219], v[16:19], v[136:139]
    v_exp_f32 v5, v5
    v_mul_f32 v6, s57, v6
    v_mfma_f32_16x16x32_bf16 v[140:143], a[220:223], v[16:19], v[140:143]
    v_cvt_pk_bf16_f32 v22, v4, v5
    v_mul_f32 v7, s57, v7
    v_mfma_f32_16x16x32_bf16 v[144:147], a[224:227], v[16:19], v[144:147]
    v_exp_f32 v6, v6
    v_mfma_f32_16x16x32_bf16 v[148:151], a[228:231], v[16:19], v[148:151]
    v_exp_f32 v7, v7
    v_mfma_f32_16x16x32_bf16 v[152:155], a[232:235], v[16:19], v[152:155]
    ds_read_b64_tr_b16 a[198:199], v61 offset:35848
    v_mul_f32 v8, s57, v8
    v_mfma_f32_16x16x32_bf16 v[156:159], a[236:239], v[16:19], v[156:159]
    v_cvt_pk_bf16_f32 v23, v6, v7
    v_mul_f32 v9, s57, v9
    v_mfma_f32_16x16x32_bf16 v[0:3], a[144:147], a[80:83], 0
    v_exp_f32 v8, v8
    v_mfma_f32_16x16x32_bf16 v[0:3], a[148:151], a[84:87], v[0:3]
    v_exp_f32 v9, v9
    v_mfma_f32_16x16x32_bf16 v[0:3], a[152:155], a[88:91], v[0:3]
    ds_read_b64_tr_b16 a[200:201], v60 offset:36352
    v_mul_f32 v10, s57, v10
    v_mfma_f32_16x16x32_bf16 v[0:3], a[156:159], a[92:95], v[0:3]
    v_exp_f32 v10, v10
    v_smfmac_f32_16x16x64_bf16 v[36:39], v[28:31], v[16:23], v48
    v_cvt_pk_bf16_f32 v16, v8, v9
    v_mfma_f32_16x16x32_bf16 v[4:7], a[172:175], a[92:95], 0
    ds_read_b64_tr_b16 a[202:203], v61 offset:36352
    v_mul_f32 v11, s57, v11
    v_mfma_f32_16x16x32_bf16 v[4:7], a[168:171], a[88:91], v[4:7]
    v_exp_f32 v11, v11
    v_mfma_f32_16x16x32_bf16 v[4:7], a[164:167], a[84:87], v[4:7]
    v_mul_f32 v12, s57, v12
    v_cvt_pk_bf16_f32 v17, v10, v11
    v_mfma_f32_16x16x32_bf16 v[4:7], a[160:163], a[80:83], v[4:7]
    v_exp_f32 v12, v12
    v_mfma_f32_16x16x32_bf16 v[160:163], a[208:211], v[20:23], v[160:163]
    ds_read_b64_tr_b16 a[176:177], v60 offset:34816
    v_mul_f32 v13, s57, v13
    v_mfma_f32_16x16x32_bf16 v[164:167], a[212:215], v[20:23], v[164:167]
    v_exp_f32 v13, v13
    v_mfma_f32_16x16x32_bf16 v[168:171], a[216:219], v[20:23], v[168:171]
    v_mul_f32 v14, s57, v14
    v_cvt_pk_bf16_f32 v18, v12, v13
    v_mfma_f32_16x16x32_bf16 v[172:175], a[220:223], v[20:23], v[172:175]
    ds_read_b64_tr_b16 a[204:205], v60 offset:36360
    v_mul_f32 v15, s57, v15
    v_mfma_f32_16x16x32_bf16 v[176:179], a[224:227], v[20:23], v[176:179]
    v_exp_f32 v14, v14
    v_mfma_f32_16x16x32_bf16 v[180:183], a[228:231], v[20:23], v[180:183]
    v_exp_f32 v15, v15
    v_mfma_f32_16x16x32_bf16 v[184:187], a[232:235], v[20:23], v[184:187]
    v_cvt_pk_bf16_f32 v19, v14, v15
    v_mul_f32 v0, s57, v0
    v_mfma_f32_16x16x32_bf16 v[188:191], a[236:239], v[20:23], v[188:191]
    v_exp_f32 v0, v0
    v_mfma_f32_16x16x32_bf16 v[8:11], a[144:147], a[96:99], 0
    ds_read_b64_tr_b16 a[206:207], v61 offset:36360
    v_mul_f32 v1, s57, v1
    v_mfma_f32_16x16x32_bf16 v[8:11], a[148:151], a[100:103], v[8:11]
    v_exp_f32 v1, v1
    v_mfma_f32_16x16x32_bf16 v[8:11], a[152:155], a[104:107], v[8:11]
    ds_read_b128 a[148:151], v56 offset:33280
    v_mul_f32 v2, s57, v2
    v_mfma_f32_16x16x32_bf16 v[8:11], a[156:159], a[108:111], v[8:11]
    ds_read_b128 a[144:147], v56 offset:32768
    ds_read_b128 a[156:159], v56 offset:34304
    v_cvt_pk_bf16_f32 v20, v0, v1
    v_mfma_f32_16x16x32_bf16 v[12:15], a[172:175], a[108:111], 0
    v_exp_f32 v2, v2
    v_mfma_f32_16x16x32_bf16 v[12:15], a[168:171], a[104:107], v[12:15]
    ds_read_b128 a[172:175], v57 offset:34304
    v_mul_f32 v3, s57, v3
    v_mfma_f32_16x16x32_bf16 v[12:15], a[164:167], a[100:103], v[12:15]
    ds_read_b128 a[152:155], v56 offset:33792
    ds_read_b128 a[168:171], v57 offset:33792
    ds_read_b128 a[164:167], v57 offset:33280
    v_mfma_f32_16x16x32_bf16 v[12:15], a[160:163], a[96:99], v[12:15]
    v_exp_f32 v3, v3
    v_mfma_f32_16x16x32_bf16 v[192:195], a[208:211], v[16:19], v[192:195]
    v_mul_f32 v4, s57, v4
    v_cvt_pk_bf16_f32 v21, v2, v3
    v_mfma_f32_16x16x32_bf16 v[196:199], a[212:215], v[16:19], v[196:199]
    ds_read_b128 a[160:163], v57 offset:32768
    v_mul_f32 v5, s57, v5
    v_mfma_f32_16x16x32_bf16 v[200:203], a[216:219], v[16:19], v[200:203]
    v_exp_f32 v4, v4
    v_mfma_f32_16x16x32_bf16 v[204:207], a[220:223], v[16:19], v[204:207]
    v_mul_f32 v6, s57, v6
    v_mul_f32 v7, s57, v7
    v_mfma_f32_16x16x32_bf16 v[208:211], a[224:227], v[16:19], v[208:211]
    v_exp_f32 v5, v5
    v_mfma_f32_16x16x32_bf16 v[212:215], a[228:231], v[16:19], v[212:215]
    v_exp_f32 v6, v6
    v_mfma_f32_16x16x32_bf16 v[216:219], a[232:235], v[16:19], v[216:219]
    v_cvt_pk_bf16_f32 v22, v4, v5
    v_mul_f32 v8, s57, v8
    v_mfma_f32_16x16x32_bf16 v[220:223], a[236:239], v[16:19], v[220:223]
    s_waitcnt lgkmcnt(3)
    v_mul_f32 v10, s57, v10
    v_mfma_f32_16x16x32_bf16 v[0:3], a[144:147], a[0:3], 0
    v_exp_f32 v7, v7
    v_mfma_f32_16x16x32_bf16 v[0:3], a[148:151], a[4:7], v[0:3]
    v_cvt_pk_bf16_f32 v23, v6, v7
    v_mul_f32 v9, s57, v9
    v_mfma_f32_16x16x32_bf16 v[0:3], a[152:155], a[8:11], v[0:3]
    v_mul_f32 v11, s57, v11
    v_mul_f32 v13, s57, v13
    v_mfma_f32_16x16x32_bf16 v[0:3], a[156:159], a[12:15], v[0:3]
    v_exp_f32 v8, v8
    v_smfmac_f32_16x16x64_bf16 v[40:43], v[28:31], v[16:23], v48
    s_waitcnt lgkmcnt(0)
    v_mfma_f32_16x16x32_bf16 v[4:7], a[172:175], a[12:15], 0
    v_mul_f32 v12, s57, v12
    v_mul_f32 v15, s57, v15
    v_mfma_f32_16x16x32_bf16 v[4:7], a[168:171], a[8:11], v[4:7]
    v_exp_f32 v11, v11
    v_mfma_f32_16x16x32_bf16 v[4:7], a[164:167], a[4:7], v[4:7]
    v_exp_f32 v9, v9
    v_mfma_f32_16x16x32_bf16 v[4:7], a[160:163], a[0:3], v[4:7]
    v_exp_f32 v10, v10
    v_mfma_f32_16x16x32_bf16 v[224:227], a[208:211], v[20:23], v[224:227]
    v_cvt_pk_bf16_f32 v25, v10, v11
    v_mul_f32 v14, s57, v14
    v_mfma_f32_16x16x32_bf16 v[228:231], a[212:215], v[20:23], v[228:231]
    v_exp_f32 v13, v13
    v_mfma_f32_16x16x32_bf16 v[232:235], a[216:219], v[20:23], v[232:235]
    v_exp_f32 v12, v12
    v_mfma_f32_16x16x32_bf16 v[236:239], a[220:223], v[20:23], v[236:239]
    v_exp_f32 v14, v14
    v_mfma_f32_16x16x32_bf16 v[240:243], a[224:227], v[20:23], v[240:243]
    v_exp_f32_e64 v15, v15
    v_mfma_f32_16x16x32_bf16 v[244:247], a[228:231], v[20:23], v[244:247]
    v_cvt_pk_bf16_f32 v24, v8, v9
    v_cvt_pk_bf16_f32 v26, v12, v13
    v_mfma_f32_16x16x32_bf16 v[248:251], a[232:235], v[20:23], v[248:251]
    v_cvt_pk_bf16_f32 v27, v14, v15
    v_mul_f32_e64 v0, s57, v0
    v_mfma_f32_16x16x32_bf16 v[252:255], a[236:239], v[20:23], v[252:255]
    s_sub_u32 s55, s55, 1
    s_cbranch_scc0 L_A_loop
    s_cmp_eq_u32 s56, 3
    s_cbranch_scc1 L_tail_A
L_A_T14:
    v_mfma_f32_16x16x32_bf16 v[8:11], a[144:147], a[16:19], 0
    s_mov_b32 m0, s49
    v_exp_f32 v0, v0
    v_mfma_f32_16x16x32_bf16 v[8:11], a[148:151], a[20:23], v[8:11]
    buffer_load_dwordx4 v49, s[20:23], s46 offen offset:0 nt lds
    v_mfma_f32_16x16x32_bf16 v[8:11], a[152:155], a[24:27], v[8:11]
    v_mul_f32 v1, s57, v1
    v_mul_f32 v2, s57, v2
    v_mfma_f32_16x16x32_bf16 v[8:11], a[156:159], a[28:31], v[8:11]
    v_exp_f32 v1, v1
    v_smfmac_f32_16x16x64_bf16 v[44:47], v[28:31], v[20:27], v48
    v_cvt_pk_bf16_f32 v16, v0, v1
    v_mfma_f32_16x16x32_bf16 v[12:15], a[172:175], a[28:31], 0
    v_exp_f32 v2, v2
    v_mul_f32 v3, s57, v3
    v_mfma_f32_16x16x32_bf16 v[12:15], a[168:171], a[24:27], v[12:15]
    buffer_load_dwordx4 v49, s[24:27], s46 offen offset:1024 nt lds
    v_mfma_f32_16x16x32_bf16 v[12:15], a[164:167], a[20:23], v[12:15]
    v_exp_f32 v3, v3
    v_mul_f32 v4, s57, v4
    v_mfma_f32_16x16x32_bf16 v[12:15], a[160:163], a[16:19], v[12:15]
    v_cvt_pk_bf16_f32 v17, v2, v3
    v_mul_f32 v5, s57, v5
    v_mfma_f32_16x16x32_bf16 a[112:115], a[208:211], v[24:27], a[112:115]
    v_exp_f32 v4, v4
    v_mfma_f32_16x16x32_bf16 a[116:119], a[212:215], v[24:27], a[116:119]
    v_exp_f32 v5, v5
    v_mfma_f32_16x16x32_bf16 a[120:123], a[216:219], v[24:27], a[120:123]
    v_mul_f32 v6, s57, v6
    v_cvt_pk_bf16_f32 v18, v4, v5
    v_mfma_f32_16x16x32_bf16 a[124:127], a[220:223], v[24:27], a[124:127]
    buffer_load_dwordx4 v49, s[20:23], s46 offen offset:2048 nt lds
    v_mul_f32 v7, s57, v7
    v_mfma_f32_16x16x32_bf16 a[128:131], a[224:227], v[24:27], a[128:131]
    v_exp_f32 v6, v6
    v_mfma_f32_16x16x32_bf16 a[132:135], a[228:231], v[24:27], a[132:135]
    v_exp_f32 v7, v7
    v_mfma_f32_16x16x32_bf16 a[136:139], a[232:235], v[24:27], a[136:139]
    v_cvt_pk_bf16_f32 v19, v6, v7
    v_mul_f32 v8, s57, v8
    v_mfma_f32_16x16x32_bf16 a[140:143], a[236:239], v[24:27], a[140:143]
    v_exp_f32 v8, v8
    v_mfma_f32_16x16x32_bf16 v[0:3], a[144:147], a[32:35], 0
    ds_read_b64_tr_b16 a[208:209], v62 offset:34816
    v_mul_f32 v9, s57, v9
    v_mfma_f32_16x16x32_bf16 v[0:3], a[148:151], a[36:39], v[0:3]
    buffer_load_dwordx4 v49, s[24:27], s46 offen offset:3072 nt lds
    s_add_u32 m0, s49, 4096
    v_mfma_f32_16x16x32_bf16 v[0:3], a[152:155], a[40:43], v[0:3]
    s_add_u32 s46, s46, 4096
    v_exp_f32 v9, v9
    v_mfma_f32_16x16x32_bf16 v[0:3], a[156:159], a[44:47], v[0:3]
    v_mul_f32 v10, s57, v10
    v_cvt_pk_bf16_f32 v20, v8, v9
    v_mfma_f32_16x16x32_bf16 v[4:7], a[172:175], a[44:47], 0
    v_exp_f32 v10, v10
    v_mfma_f32_16x16x32_bf16 v[4:7], a[168:171], a[40:43], v[4:7]
    v_mul_f32 v11, s57, v11
    v_mul_f32 v13, s57, v13
    v_mfma_f32_16x16x32_bf16 v[4:7], a[164:167], a[36:39], v[4:7]
    v_exp_f32 v11, v11
    v_mul_f32 v12, s57, v12
    v_mfma_f32_16x16x32_bf16 v[4:7], a[160:163], a[32:35], v[4:7]
    buffer_load_dwordx4 v49, s[20:23], s46 offen offset:0 nt lds
    v_cvt_pk_bf16_f32 v21, v10, v11
    v_mfma_f32_16x16x32_bf16 v[64:67], a[176:179], v[16:19], v[64:67]
    v_exp_f32 v12, v12
    v_mfma_f32_16x16x32_bf16 v[68:71], a[180:183], v[16:19], v[68:71]
    v_exp_f32 v13, v13
    v_mfma_f32_16x16x32_bf16 v[72:75], a[184:187], v[16:19], v[72:75]
    v_mul_f32 v14, s57, v14
    v_cvt_pk_bf16_f32 v22, v12, v13
    v_mfma_f32_16x16x32_bf16 v[76:79], a[188:191], v[16:19], v[76:79]
    ds_read_b64_tr_b16 a[216:217], v62 offset:35328
    v_mul_f32 v15, s57, v15
    v_mfma_f32_16x16x32_bf16 v[80:83], a[192:195], v[16:19], v[80:83]
    v_exp_f32 v14, v14
    v_mfma_f32_16x16x32_bf16 v[84:87], a[196:199], v[16:19], v[84:87]
    buffer_load_dwordx4 v49, s[24:27], s46 offen offset:1024 nt lds
    v_mfma_f32_16x16x32_bf16 v[88:91], a[200:203], v[16:19], v[88:91]
    s_add_u32 s46, s46, 2048
    v_exp_f32 v15, v15
    v_mfma_f32_16x16x32_bf16 v[92:95], a[204:207], v[16:19], v[92:95]
    v_mul_f32 v0, s57, v0
    v_cvt_pk_bf16_f32 v23, v14, v15
    v_mfma_f32_16x16x32_bf16 v[8:11], a[144:147], a[48:51], 0
    v_exp_f32 v0, v0
    v_mfma_f32_16x16x32_bf16 v[8:11], a[148:151], a[52:55], v[8:11]
    s_add_u32 s49, s49, 6144
    v_mul_f32 v1, s57, v1
    v_mfma_f32_16x16x32_bf16 v[8:11], a[152:155], a[56:59], v[8:11]
    ds_read_b64_tr_b16 a[214:215], v63 offset:34824
    v_exp_f32 v1, v1
    v_mfma_f32_16x16x32_bf16 v[8:11], a[156:159], a[60:63], v[8:11]
    ds_read_b64_tr_b16 a[212:213], v62 offset:34824
    v_mul_f32 v2, s57, v2
    v_smfmac_f32_16x16x64_bf16 v[32:35], v[28:31], v[16:23], v48
    v_cvt_pk_bf16_f32 v16, v0, v1
    v_mfma_f32_16x16x32_bf16 v[12:15], a[172:175], a[60:63], 0
    v_exp_f32 v2, v2
    v_mul_f32 v3, s57, v3
    v_mfma_f32_16x16x32_bf16 v[12:15], a[168:171], a[56:59], v[12:15]
    v_exp_f32 v3, v3
    v_mfma_f32_16x16x32_bf16 v[12:15], a[164:167], a[52:55], v[12:15]
    v_mul_f32 v4, s57, v4
    v_cvt_pk_bf16_f32 v17, v2, v3
    v_mfma_f32_16x16x32_bf16 v[12:15], a[160:163], a[48:51], v[12:15]
    v_exp_f32 v4, v4
    v_mfma_f32_16x16x32_bf16 v[96:99], a[176:179], v[20:23], v[96:99]
    ds_read_b64_tr_b16 a[218:219], v63 offset:35328
    v_mul_f32 v5, s57, v5
    v_mfma_f32_16x16x32_bf16 v[100:103], a[180:183], v[20:23], v[100:103]
    v_exp_f32 v5, v5
    v_mfma_f32_16x16x32_bf16 v[104:107], a[184:187], v[20:23], v[104:107]
    v_mul_f32 v6, s57, v6
    v_cvt_pk_bf16_f32 v18, v4, v5
    v_mfma_f32_16x16x32_bf16 v[108:111], a[188:191], v[20:23], v[108:111]
    v_exp_f32 v6, v6
    v_mfma_f32_16x16x32_bf16 v[112:115], a[192:195], v[20:23], v[112:115]
    ds_read_b64_tr_b16 a[220:221], v62 offset:35336
    v_mul_f32 v7, s57, v7
    v_mfma_f32_16x16x32_bf16 v[116:119], a[196:199], v[20:23], v[116:119]
    v_exp_f32 v7, v7
    v_mfma_f32_16x16x32_bf16 v[120:123], a[200:203], v[20:23], v[120:123]
    ds_read_b64_tr_b16 a[224:225], v62 offset:35840
    v_cvt_pk_bf16_f32 v19, v6, v7
    v_mfma_f32_16x16x32_bf16 v[124:127], a[204:207], v[20:23], v[124:127]
    ds_read_b64_tr_b16 a[210:211], v63 offset:34816
    v_mul_f32 v8, s57, v8
    v_mfma_f32_16x16x32_bf16 v[0:3], a[144:147], a[64:67], 0
    v_exp_f32 v8, v8
    v_mfma_f32_16x16x32_bf16 v[0:3], a[148:151], a[68:71], v[0:3]
    ds_read_b64_tr_b16 a[222:223], v63 offset:35336
    v_mul_f32 v9, s57, v9
    v_mfma_f32_16x16x32_bf16 v[0:3], a[152:155], a[72:75], v[0:3]
    ds_read_b64_tr_b16 a[226:227], v63 offset:35840
    v_mul_f32 v10, s57, v10
    v_mfma_f32_16x16x32_bf16 v[0:3], a[156:159], a[76:79], v[0:3]
    v_exp_f32 v9, v9
    v_mfma_f32_16x16x32_bf16 v[4:7], a[172:175], a[76:79], 0
    v_cvt_pk_bf16_f32 v20, v8, v9
    v_exp_f32 v10, v10
    v_mfma_f32_16x16x32_bf16 v[4:7], a[168:171], a[72:75], v[4:7]
    ds_read_b64_tr_b16 a[228:229], v62 offset:35848
    v_mul_f32 v11, s57, v11
    v_mfma_f32_16x16x32_bf16 v[4:7], a[164:167], a[68:71], v[4:7]
    v_exp_f32 v11, v11
    v_mfma_f32_16x16x32_bf16 v[4:7], a[160:163], a[64:67], v[4:7]
    v_mul_f32 v12, s57, v12
    v_cvt_pk_bf16_f32 v21, v10, v11
    v_mfma_f32_16x16x32_bf16 v[128:131], a[176:179], v[16:19], v[128:131]
    v_exp_f32 v12, v12
    v_mfma_f32_16x16x32_bf16 v[132:135], a[180:183], v[16:19], v[132:135]
    ds_read_b64_tr_b16 a[230:231], v63 offset:35848
    v_mul_f32 v13, s57, v13
    v_mfma_f32_16x16x32_bf16 v[136:139], a[184:187], v[16:19], v[136:139]
    v_exp_f32 v13, v13
    v_mfma_f32_16x16x32_bf16 v[140:143], a[188:191], v[16:19], v[140:143]
    v_mul_f32 v14, s57, v14
    v_cvt_pk_bf16_f32 v22, v12, v13
    v_mfma_f32_16x16x32_bf16 v[144:147], a[192:195], v[16:19], v[144:147]
    v_exp_f32 v14, v14
    v_mfma_f32_16x16x32_bf16 v[148:151], a[196:199], v[16:19], v[148:151]
    v_mul_f32 v15, s57, v15
    v_mul_f32 v0, s57, v0
    v_mfma_f32_16x16x32_bf16 v[152:155], a[200:203], v[16:19], v[152:155]
    v_exp_f32 v15, v15
    v_mfma_f32_16x16x32_bf16 v[156:159], a[204:207], v[16:19], v[156:159]
    ds_read_b64_tr_b16 a[232:233], v62 offset:36352
    v_cvt_pk_bf16_f32 v23, v14, v15
    v_mfma_f32_16x16x32_bf16 v[8:11], a[144:147], a[80:83], 0
    v_exp_f32 v0, v0
    v_mfma_f32_16x16x32_bf16 v[8:11], a[148:151], a[84:87], v[8:11]
    ds_read_b64_tr_b16 a[238:239], v63 offset:36360
    v_mul_f32 v1, s57, v1
    v_mfma_f32_16x16x32_bf16 v[8:11], a[152:155], a[88:91], v[8:11]
    v_mul_f32 v2, s57, v2
    v_mul_f32 v3, s57, v3
    v_mfma_f32_16x16x32_bf16 v[8:11], a[156:159], a[92:95], v[8:11]
    v_exp_f32 v1, v1
    v_smfmac_f32_16x16x64_bf16 v[36:39], v[28:31], v[16:23], v48
    v_cvt_pk_bf16_f32 v16, v0, v1
    v_mfma_f32_16x16x32_bf16 v[12:15], a[172:175], a[92:95], 0
    v_exp_f32 v2, v2
    v_mfma_f32_16x16x32_bf16 v[12:15], a[168:171], a[88:91], v[12:15]
    v_exp_f32 v3, v3
    v_mfma_f32_16x16x32_bf16 v[12:15], a[164:167], a[84:87], v[12:15]
    v_mul_f32 v4, s57, v4
    v_cvt_pk_bf16_f32 v17, v2, v3
    v_mfma_f32_16x16x32_bf16 v[12:15], a[160:163], a[80:83], v[12:15]
    v_exp_f32 v4, v4
    v_mfma_f32_16x16x32_bf16 v[160:163], a[176:179], v[20:23], v[160:163]
    ds_read_b64_tr_b16 a[234:235], v63 offset:36352
    v_mul_f32 v5, s57, v5
    v_mfma_f32_16x16x32_bf16 v[164:167], a[180:183], v[20:23], v[164:167]
    v_mul_f32 v6, s57, v6
    v_mul_f32 v7, s57, v7
    v_mfma_f32_16x16x32_bf16 v[168:171], a[184:187], v[20:23], v[168:171]
    v_exp_f32 v5, v5
    v_mfma_f32_16x16x32_bf16 v[172:175], a[188:191], v[20:23], v[172:175]
    v_exp_f32 v6, v6
    v_mfma_f32_16x16x32_bf16 v[176:179], a[192:195], v[20:23], v[176:179]
    v_exp_f32 v7, v7
    v_mfma_f32_16x16x32_bf16 v[180:183], a[196:199], v[20:23], v[180:183]
    ds_read_b64_tr_b16 a[236:237], v62 offset:36360
    v_cvt_pk_bf16_f32 v18, v4, v5
    v_mfma_f32_16x16x32_bf16 v[184:187], a[200:203], v[20:23], v[184:187]
    v_cvt_pk_bf16_f32 v19, v6, v7
    v_mul_f32 v8, s57, v8
    v_mfma_f32_16x16x32_bf16 v[188:191], a[204:207], v[20:23], v[188:191]
    v_exp_f32 v8, v8
    v_mfma_f32_16x16x32_bf16 v[0:3], a[144:147], a[96:99], 0
    ds_read_b128 a[144:147], v58 offset:32768
    v_mul_f32 v9, s57, v9
    v_mfma_f32_16x16x32_bf16 v[0:3], a[148:151], a[100:103], v[0:3]
    ds_read_b128 a[148:151], v58 offset:33280
    v_mul_f32 v13, s57, v13
    v_mfma_f32_16x16x32_bf16 v[0:3], a[152:155], a[104:107], v[0:3]
    ds_read_b128 a[152:155], v58 offset:33792
    v_mul_f32 v11, s57, v11
    v_mfma_f32_16x16x32_bf16 v[0:3], a[156:159], a[108:111], v[0:3]
    ds_read_b128 a[156:159], v58 offset:34304
    v_mul_f32 v10, s57, v10
    v_mfma_f32_16x16x32_bf16 v[4:7], a[172:175], a[108:111], 0
    ds_read_b128 a[172:175], v59 offset:34304
    v_mul_f32 v12, s57, v12
    v_mfma_f32_16x16x32_bf16 v[4:7], a[168:171], a[104:107], v[4:7]
    v_exp_f32 v10, v10
    v_mfma_f32_16x16x32_bf16 v[4:7], a[164:167], a[100:103], v[4:7]
    v_exp_f32 v11, v11
    v_mfma_f32_16x16x32_bf16 v[4:7], a[160:163], a[96:99], v[4:7]
    ds_read_b128 a[164:167], v59 offset:33280
    v_cvt_pk_bf16_f32 v21, v10, v11
    v_mfma_f32_16x16x32_bf16 v[192:195], a[176:179], v[16:19], v[192:195]
    v_exp_f32 v9, v9
    v_mfma_f32_16x16x32_bf16 v[196:199], a[180:183], v[16:19], v[196:199]
    ds_read_b128 a[160:163], v59 offset:32768
    v_cvt_pk_bf16_f32 v20, v8, v9
    v_mfma_f32_16x16x32_bf16 v[200:203], a[184:187], v[16:19], v[200:203]
    ds_read_b128 a[168:171], v59 offset:33792
    v_mul_f32 v14, s57, v14
    v_mfma_f32_16x16x32_bf16 v[204:207], a[188:191], v[16:19], v[204:207]
    v_exp_f32 v12, v12
    v_mfma_f32_16x16x32_bf16 v[208:211], a[192:195], v[16:19], v[208:211]
    v_exp_f32 v13, v13
    v_mfma_f32_16x16x32_bf16 v[212:215], a[196:199], v[16:19], v[212:215]
    v_cvt_pk_bf16_f32 v22, v12, v13
    v_mul_f32 v15, s57, v15
    v_mfma_f32_16x16x32_bf16 v[216:219], a[200:203], v[16:19], v[216:219]
    s_waitcnt lgkmcnt(4)
    v_mul_f32 v0, s57, v0
    v_mfma_f32_16x16x32_bf16 v[220:223], a[204:207], v[16:19], v[220:223]
    v_exp_f32 v14, v14
    v_mfma_f32_16x16x32_bf16 v[8:11], a[144:147], a[0:3], 0
    v_exp_f32 v15, v15
    v_mfma_f32_16x16x32_bf16 v[8:11], a[148:151], a[4:7], v[8:11]
    v_cvt_pk_bf16_f32 v23, v14, v15
    v_mul_f32 v1, s57, v1
    v_mfma_f32_16x16x32_bf16 v[8:11], a[152:155], a[8:11], v[8:11]
    v_mul_f32 v4, s57, v4
    v_mul_f32 v7, s57, v7
    v_mfma_f32_16x16x32_bf16 v[8:11], a[156:159], a[12:15], v[8:11]
    v_mul_f32 v2, s57, v2
    v_mul_f32 v3, s57, v3
    v_smfmac_f32_16x16x64_bf16 v[40:43], v[28:31], v[16:23], v48
    s_waitcnt lgkmcnt(0)
    v_mfma_f32_16x16x32_bf16 v[12:15], a[172:175], a[12:15], 0
    v_mul_f32 v5, s57, v5
    v_mul_f32 v6, s57, v6
    v_mfma_f32_16x16x32_bf16 v[12:15], a[168:171], a[8:11], v[12:15]
    v_exp_f32 v0, v0
    v_mfma_f32_16x16x32_bf16 v[12:15], a[164:167], a[4:7], v[12:15]
    v_exp_f32 v2, v2
    v_mfma_f32_16x16x32_bf16 v[12:15], a[160:163], a[0:3], v[12:15]
    v_exp_f32 v4, v4
    v_mfma_f32_16x16x32_bf16 v[224:227], a[176:179], v[20:23], v[224:227]
    v_exp_f32 v3, v3
    v_mfma_f32_16x16x32_bf16 v[228:231], a[180:183], v[20:23], v[228:231]
    v_exp_f32 v1, v1
    v_mfma_f32_16x16x32_bf16 v[232:235], a[184:187], v[20:23], v[232:235]
    v_exp_f32 v5, v5
    v_mfma_f32_16x16x32_bf16 v[236:239], a[188:191], v[20:23], v[236:239]
    v_exp_f32 v6, v6
    v_mfma_f32_16x16x32_bf16 v[240:243], a[192:195], v[20:23], v[240:243]
    v_cvt_pk_bf16_f32 v24, v0, v1
    v_cvt_pk_bf16_f32 v26, v4, v5
    v_mfma_f32_16x16x32_bf16 v[244:247], a[196:199], v[20:23], v[244:247]
    v_exp_f32 v7, v7
    v_mfma_f32_16x16x32_bf16 v[248:251], a[200:203], v[20:23], v[248:251]
    v_cvt_pk_bf16_f32 v27, v6, v7
    v_mul_f32 v8, s57, v8
    v_mfma_f32_16x16x32_bf16 v[252:255], a[204:207], v[20:23], v[252:255]
    v_add_u32 v51, 0xffffb800, v51
    v_cvt_pk_bf16_f32 v25, v2, v3
    v_mfma_f32_16x16x32_bf16 v[0:3], a[144:147], a[16:19], 0
    ds_read_b128 a[0:3], v50 offset:0
    s_waitcnt vmcnt(6)
    s_barrier
    v_mfma_f32_16x16x32_bf16 v[0:3], a[148:151], a[20:23], v[0:3]
    s_mov_b32 m0, s52
    v_exp_f32 v8, v8
    v_mfma_f32_16x16x32_bf16 v[0:3], a[152:155], a[24:27], v[0:3]
    buffer_load_dwordx4 v49, s[4:7], s44 offen offset:0 lds
    v_mul_f32 v9, s57, v9
    v_mfma_f32_16x16x32_bf16 v[0:3], a[156:159], a[28:31], v[0:3]
    ds_read_b128 a[4:7], v50 offset:512
    v_exp_f32 v9, v9
    v_smfmac_f32_16x16x64_bf16 v[44:47], v[28:31], v[20:27], v48
    ds_read_b128 a[8:11], v50 offset:1024
    ds_read_b128 a[12:15], v50 offset:1536
    v_cvt_pk_bf16_f32 v16, v8, v9
    v_mfma_f32_16x16x32_bf16 v[4:7], a[172:175], a[28:31], 0
    v_mul_f32 v10, s57, v10
    v_mul_f32 v11, s57, v11
    v_mfma_f32_16x16x32_bf16 v[4:7], a[168:171], a[24:27], v[4:7]
    v_exp_f32 v11, v11
    v_mfma_f32_16x16x32_bf16 v[4:7], a[164:167], a[20:23], v[4:7]
    v_exp_f32 v10, v10
    v_mul_f32 v12, s57, v12
    v_mfma_f32_16x16x32_bf16 v[4:7], a[160:163], a[16:19], v[4:7]
    buffer_load_dwordx4 v49, s[8:11], s44 offen offset:1024 lds
    v_cvt_pk_bf16_f32 v17, v10, v11
    v_mfma_f32_16x16x32_bf16 a[112:115], a[176:179], v[24:27], a[112:115]
    v_exp_f32 v12, v12
    v_mul_f32 v13, s57, v13
    v_mfma_f32_16x16x32_bf16 a[116:119], a[180:183], v[24:27], a[116:119]
    v_exp_f32 v13, v13
    v_mfma_f32_16x16x32_bf16 a[120:123], a[184:187], v[24:27], a[120:123]
    ds_read_b128 a[16:19], v50 offset:4096
    v_mul_f32 v14, s57, v14
    v_cvt_pk_bf16_f32 v18, v12, v13
    v_mfma_f32_16x16x32_bf16 a[124:127], a[188:191], v[24:27], a[124:127]
    ds_read_b128 a[28:31], v50 offset:5632
    v_exp_f32 v14, v14
    v_mfma_f32_16x16x32_bf16 a[128:131], a[192:195], v[24:27], a[128:131]
    ds_read_b128 a[24:27], v50 offset:5120
    s_waitcnt lgkmcnt(3)
    v_mul_f32 v15, s57, v15
    v_mfma_f32_16x16x32_bf16 a[132:135], a[196:199], v[24:27], a[132:135]
    buffer_load_dwordx4 v49, s[12:15], s44 offen offset:2048 lds
    v_mfma_f32_16x16x32_bf16 a[136:139], a[200:203], v[24:27], a[136:139]
    v_exp_f32 v15, v15
    v_mul_f32 v0, s57, v0
    v_mfma_f32_16x16x32_bf16 a[140:143], a[204:207], v[24:27], a[140:143]
    ds_read_b64_tr_b16 a[176:177], v60 offset:2048
    v_cvt_pk_bf16_f32 v19, v14, v15
    v_mfma_f32_16x16x32_bf16 v[8:11], a[144:147], a[32:35], 0
    v_exp_f32 v0, v0
    v_mfma_f32_16x16x32_bf16 v[8:11], a[148:151], a[36:39], v[8:11]
    ds_read_b64_tr_b16 a[178:179], v61 offset:2048
    v_mul_f32 v1, s57, v1
    v_mfma_f32_16x16x32_bf16 v[8:11], a[152:155], a[40:43], v[8:11]
    v_exp_f32 v1, v1
    v_mul_f32 v2, s57, v2
    v_mfma_f32_16x16x32_bf16 v[8:11], a[156:159], a[44:47], v[8:11]
    buffer_load_dwordx4 v49, s[16:19], s44 offen offset:3072 lds
    v_cvt_pk_bf16_f32 v20, v0, v1
    v_mfma_f32_16x16x32_bf16 v[12:15], a[172:175], a[44:47], 0
    s_add_u32 s44, s44, 8192
    v_exp_f32 v2, v2
    v_mfma_f32_16x16x32_bf16 v[12:15], a[168:171], a[40:43], v[12:15]
    s_mov_b32 m0, s54
    v_mul_f32 v3, s57, v3
    v_mfma_f32_16x16x32_bf16 v[12:15], a[164:167], a[36:39], v[12:15]
    ds_read_b64_tr_b16 a[180:181], v60 offset:2056
    v_exp_f32 v3, v3
    v_mfma_f32_16x16x32_bf16 v[12:15], a[160:163], a[32:35], v[12:15]
    ds_read_b128 a[36:39], v50 offset:8704
    v_mul_f32 v4, s57, v4
    v_cvt_pk_bf16_f32 v21, v2, v3
    v_mfma_f32_16x16x32_bf16 v[64:67], a[208:211], v[16:19], v[64:67]
    ds_read_b128 a[32:35], v50 offset:8192
    v_exp_f32 v4, v4
    v_mfma_f32_16x16x32_bf16 v[68:71], a[212:215], v[16:19], v[68:71]
    buffer_load_dwordx4 v49, s[20:23], s47 offen offset:0 nt lds
    v_mul_f32 v5, s57, v5
    v_mfma_f32_16x16x32_bf16 v[72:75], a[216:219], v[16:19], v[72:75]
    ds_read_b128 a[40:43], v50 offset:9216
    v_exp_f32 v5, v5
    v_mfma_f32_16x16x32_bf16 v[76:79], a[220:223], v[16:19], v[76:79]
    v_mul_f32 v6, s57, v6
    v_cvt_pk_bf16_f32 v22, v4, v5
    v_mfma_f32_16x16x32_bf16 v[80:83], a[224:227], v[16:19], v[80:83]
    v_exp_f32 v6, v6
    v_mfma_f32_16x16x32_bf16 v[84:87], a[228:231], v[16:19], v[84:87]
    ds_read_b128 a[44:47], v50 offset:9728
    ds_read_b64_tr_b16 a[182:183], v61 offset:2056
    v_mul_f32 v7, s57, v7
    v_mfma_f32_16x16x32_bf16 v[88:91], a[232:235], v[16:19], v[88:91]
    v_exp_f32 v7, v7
    v_mul_f32 v8, s57, v8
    v_mfma_f32_16x16x32_bf16 v[92:95], a[236:239], v[16:19], v[92:95]
    buffer_load_dwordx4 v49, s[24:27], s47 offen offset:1024 nt lds
    v_cvt_pk_bf16_f32 v23, v6, v7
    v_mfma_f32_16x16x32_bf16 v[0:3], a[144:147], a[48:51], 0
    v_exp_f32 v8, v8
    v_mfma_f32_16x16x32_bf16 v[0:3], a[148:151], a[52:55], v[0:3]
    ds_read_b64_tr_b16 a[184:185], v60 offset:2560
    v_mul_f32 v9, s57, v9
    v_mfma_f32_16x16x32_bf16 v[0:3], a[152:155], a[56:59], v[0:3]
    v_exp_f32 v9, v9
    v_mfma_f32_16x16x32_bf16 v[0:3], a[156:159], a[60:63], v[0:3]
    ds_read_b128 a[20:23], v50 offset:4608
    ds_read_b64_tr_b16 a[186:187], v61 offset:2560
    v_mul_f32 v10, s57, v10
    v_smfmac_f32_16x16x64_bf16 v[32:35], v[28:31], v[16:23], v48
    v_cvt_pk_bf16_f32 v16, v8, v9
    v_exp_f32 v10, v10
    v_mfma_f32_16x16x32_bf16 v[4:7], a[172:175], a[60:63], 0
    buffer_load_dwordx4 v49, s[20:23], s47 offen offset:2048 nt lds
    v_mul_f32 v11, s57, v11
    v_mfma_f32_16x16x32_bf16 v[4:7], a[168:171], a[56:59], v[4:7]
    v_exp_f32 v11, v11
    v_mfma_f32_16x16x32_bf16 v[4:7], a[164:167], a[52:55], v[4:7]
    ds_read_b64_tr_b16 a[188:189], v60 offset:2568
    v_mul_f32 v12, s57, v12
    v_cvt_pk_bf16_f32 v17, v10, v11
    v_mfma_f32_16x16x32_bf16 v[4:7], a[160:163], a[48:51], v[4:7]
    ds_read_b128 a[48:51], v50 offset:12288
    v_exp_f32 v12, v12
    v_mfma_f32_16x16x32_bf16 v[96:99], a[208:211], v[20:23], v[96:99]
    ds_read_b128 a[56:59], v50 offset:13312
    ds_read_b128 a[60:63], v50 offset:13824
    v_mul_f32 v13, s57, v13
    v_mfma_f32_16x16x32_bf16 v[100:103], a[212:215], v[20:23], v[100:103]
    v_exp_f32 v13, v13
    v_mul_f32 v14, s57, v14
    v_mfma_f32_16x16x32_bf16 v[104:107], a[216:219], v[20:23], v[104:107]
    buffer_load_dwordx4 v49, s[24:27], s47 offen offset:3072 nt lds
    v_cvt_pk_bf16_f32 v18, v12, v13
    v_mfma_f32_16x16x32_bf16 v[108:111], a[220:223], v[20:23], v[108:111]
    s_mov_b32 m0, s53
    v_exp_f32 v14, v14
    v_mfma_f32_16x16x32_bf16 v[112:115], a[224:227], v[20:23], v[112:115]
    ds_read_b64_tr_b16 a[190:191], v61 offset:2568
    v_mul_f32 v15, s57, v15
    v_mfma_f32_16x16x32_bf16 v[116:119], a[228:231], v[20:23], v[116:119]
    v_exp_f32 v15, v15
    v_mfma_f32_16x16x32_bf16 v[120:123], a[232:235], v[20:23], v[120:123]
    v_cvt_pk_bf16_f32 v19, v14, v15
    v_mul_f32 v0, s57, v0
    v_mfma_f32_16x16x32_bf16 v[124:127], a[236:239], v[20:23], v[124:127]
    ds_read_b128 a[52:55], v50 offset:12800
    ds_read_b64_tr_b16 a[192:193], v60 offset:3072
    v_mfma_f32_16x16x32_bf16 v[8:11], a[144:147], a[64:67], 0
    buffer_load_dwordx4 v49, s[4:7], s44 offen offset:0 lds
    v_mfma_f32_16x16x32_bf16 v[8:11], a[148:151], a[68:71], v[8:11]
    v_exp_f32 v0, v0
    v_mul_f32 v1, s57, v1
    v_mfma_f32_16x16x32_bf16 v[8:11], a[152:155], a[72:75], v[8:11]
    v_exp_f32 v1, v1
    v_mfma_f32_16x16x32_bf16 v[8:11], a[156:159], a[76:79], v[8:11]
    ds_read_b64_tr_b16 a[194:195], v61 offset:3072
    v_mul_f32 v2, s57, v2
    v_cvt_pk_bf16_f32 v20, v0, v1
    v_mfma_f32_16x16x32_bf16 v[12:15], a[172:175], a[76:79], 0
    v_exp_f32 v2, v2
    v_mul_f32 v3, s57, v3
    v_mfma_f32_16x16x32_bf16 v[12:15], a[168:171], a[72:75], v[12:15]
    v_exp_f32 v3, v3
    v_mfma_f32_16x16x32_bf16 v[12:15], a[164:167], a[68:71], v[12:15]
    buffer_load_dwordx4 v49, s[8:11], s44 offen offset:1024 lds
    s_waitcnt vmcnt(10)
    v_mfma_f32_16x16x32_bf16 v[12:15], a[160:163], a[64:67], v[12:15]
    ds_read_b64_tr_b16 a[196:197], v60 offset:3080
    v_mul_f32 v4, s57, v4
    v_cvt_pk_bf16_f32 v21, v2, v3
    v_mfma_f32_16x16x32_bf16 v[128:131], a[208:211], v[16:19], v[128:131]
    v_exp_f32 v4, v4
    v_mfma_f32_16x16x32_bf16 v[132:135], a[212:215], v[16:19], v[132:135]
    ds_read_b128 a[64:67], v50 offset:16384
    ds_read_b128 a[68:71], v50 offset:16896
    v_mul_f32 v5, s57, v5
    v_mfma_f32_16x16x32_bf16 v[136:139], a[216:219], v[16:19], v[136:139]
    ds_read_b128 a[72:75], v50 offset:17408
    v_exp_f32 v5, v5
    v_mfma_f32_16x16x32_bf16 v[140:143], a[220:223], v[16:19], v[140:143]
    ds_read_b128 a[76:79], v50 offset:17920
    v_mul_f32 v6, s57, v6
    v_cvt_pk_bf16_f32 v22, v4, v5
    v_mfma_f32_16x16x32_bf16 v[144:147], a[224:227], v[16:19], v[144:147]
    buffer_load_dwordx4 v49, s[12:15], s44 offen offset:2048 lds
    v_mfma_f32_16x16x32_bf16 v[148:151], a[228:231], v[16:19], v[148:151]
    v_exp_f32 v6, v6
    v_mul_f32 v7, s57, v7
    v_mfma_f32_16x16x32_bf16 v[152:155], a[232:235], v[16:19], v[152:155]
    v_exp_f32 v7, v7
    v_mul_f32 v8, s57, v8
    v_mfma_f32_16x16x32_bf16 v[156:159], a[236:239], v[16:19], v[156:159]
    v_cvt_pk_bf16_f32 v23, v6, v7
    v_exp_f32 v8, v8
    v_mfma_f32_16x16x32_bf16 v[0:3], a[144:147], a[80:83], 0
    ds_read_b64_tr_b16 a[198:199], v61 offset:3080
    ds_read_b64_tr_b16 a[200:201], v60 offset:3584
    v_mul_f32 v9, s57, v9
    v_mfma_f32_16x16x32_bf16 v[0:3], a[148:151], a[84:87], v[0:3]
    v_exp_f32 v9, v9
    v_mfma_f32_16x16x32_bf16 v[0:3], a[152:155], a[88:91], v[0:3]
    buffer_load_dwordx4 v49, s[16:19], s44 offen offset:3072 lds
    v_mfma_f32_16x16x32_bf16 v[0:3], a[156:159], a[92:95], v[0:3]
    s_add_u32 s44, s44, 8192
    v_mul_f32 v10, s57, v10
    v_smfmac_f32_16x16x64_bf16 v[36:39], v[28:31], v[16:23], v48
    ds_read_b64_tr_b16 a[202:203], v61 offset:3584
    v_exp_f32 v10, v10
    v_mfma_f32_16x16x32_bf16 v[4:7], a[172:175], a[92:95], 0
    v_cvt_pk_bf16_f32 v16, v8, v9
    v_mul_f32 v11, s57, v11
    v_mfma_f32_16x16x32_bf16 v[4:7], a[168:171], a[88:91], v[4:7]
    v_exp_f32 v11, v11
    v_mul_f32 v12, s57, v12
    v_mfma_f32_16x16x32_bf16 v[4:7], a[164:167], a[84:87], v[4:7]
    ds_read_b64_tr_b16 a[204:205], v60 offset:3592
    v_cvt_pk_bf16_f32 v17, v10, v11
    v_mfma_f32_16x16x32_bf16 v[4:7], a[160:163], a[80:83], v[4:7]
    v_exp_f32 v12, v12
    v_mfma_f32_16x16x32_bf16 v[160:163], a[208:211], v[20:23], v[160:163]
    ds_read_b128 a[84:87], v50 offset:20992
    v_mul_f32 v13, s57, v13
    v_mfma_f32_16x16x32_bf16 v[164:167], a[212:215], v[20:23], v[164:167]
    ds_read_b128 a[80:83], v50 offset:20480
    v_exp_f32 v13, v13
    v_mfma_f32_16x16x32_bf16 v[168:171], a[216:219], v[20:23], v[168:171]
    v_mul_f32 v14, s57, v14
    v_cvt_pk_bf16_f32 v18, v12, v13
    v_mfma_f32_16x16x32_bf16 v[172:175], a[220:223], v[20:23], v[172:175]
    v_exp_f32 v14, v14
    v_mfma_f32_16x16x32_bf16 v[176:179], a[224:227], v[20:23], v[176:179]
    ds_read_b128 a[92:95], v50 offset:22016
    v_mul_f32 v15, s57, v15
    v_mfma_f32_16x16x32_bf16 v[180:183], a[228:231], v[20:23], v[180:183]
    v_exp_f32 v15, v15
    v_mfma_f32_16x16x32_bf16 v[184:187], a[232:235], v[20:23], v[184:187]
    v_cvt_pk_bf16_f32 v19, v14, v15
    v_mul_f32 v0, s57, v0
    v_mfma_f32_16x16x32_bf16 v[188:191], a[236:239], v[20:23], v[188:191]
    ds_read_b128 a[88:91], v50 offset:21504
    ds_read_b64_tr_b16 a[206:207], v61 offset:3592
    v_mfma_f32_16x16x32_bf16 v[8:11], a[144:147], a[96:99], 0
    v_exp_f32 v0, v0
    v_mfma_f32_16x16x32_bf16 v[8:11], a[148:151], a[100:103], v[8:11]
    ds_read_b128 a[144:147], v56 offset:0
    v_mul_f32 v1, s57, v1
    v_mfma_f32_16x16x32_bf16 v[8:11], a[152:155], a[104:107], v[8:11]
    ds_read_b128 a[148:151], v56 offset:512
    v_exp_f32 v1, v1
    v_mfma_f32_16x16x32_bf16 v[8:11], a[156:159], a[108:111], v[8:11]
    v_mul_f32 v2, s57, v2
    v_cvt_pk_bf16_f32 v20, v0, v1
    v_mfma_f32_16x16x32_bf16 v[12:15], a[172:175], a[108:111], 0
    ds_read_b128 a[152:155], v56 offset:1024
    v_mul_f32 v3, s57, v3
    v_mfma_f32_16x16x32_bf16 v[12:15], a[168:171], a[104:107], v[12:15]
    v_exp_f32 v2, v2
    v_mfma_f32_16x16x32_bf16 v[12:15], a[164:167], a[100:103], v[12:15]
    ds_read_b128 a[156:159], v56 offset:1536
    v_mul_f32 v4, s57, v4
    v_mfma_f32_16x16x32_bf16 v[12:15], a[160:163], a[96:99], v[12:15]
    v_exp_f32 v3, v3
    v_mfma_f32_16x16x32_bf16 v[192:195], a[208:211], v[16:19], v[192:195]
    ds_read_b128 a[160:163], v57 offset:0
    v_cvt_pk_bf16_f32 v21, v2, v3
    v_mfma_f32_16x16x32_bf16 v[196:199], a[212:215], v[16:19], v[196:199]
    ds_read_b128 a[168:171], v57 offset:1024
    v_mul_f32 v5, s57, v5
    v_mfma_f32_16x16x32_bf16 v[200:203], a[216:219], v[16:19], v[200:203]
    v_exp_f32 v4, v4
    v_mfma_f32_16x16x32_bf16 v[204:207], a[220:223], v[16:19], v[204:207]
    ds_read_b128 a[172:175], v57 offset:1536
    ds_read_b128 a[164:167], v57 offset:512
    v_mfma_f32_16x16x32_bf16 v[208:211], a[224:227], v[16:19], v[208:211]
    v_mul_f32 v6, s57, v6
    v_mul_f32 v7, s57, v7
    v_mfma_f32_16x16x32_bf16 v[212:215], a[228:231], v[16:19], v[212:215]
    v_exp_f32 v5, v5
    v_mfma_f32_16x16x32_bf16 v[216:219], a[232:235], v[16:19], v[216:219]
    v_exp_f32 v6, v6
    v_mfma_f32_16x16x32_bf16 v[220:223], a[236:239], v[16:19], v[220:223]
    s_waitcnt lgkmcnt(4)
    v_mul_f32 v8, s57, v8
    v_mfma_f32_16x16x32_bf16 v[0:3], a[144:147], a[0:3], 0
    v_exp_f32 v7, v7
    v_mfma_f32_16x16x32_bf16 v[0:3], a[148:151], a[4:7], v[0:3]
    v_cvt_pk_bf16_f32 v22, v4, v5
    v_cvt_pk_bf16_f32 v23, v6, v7
    v_mfma_f32_16x16x32_bf16 v[0:3], a[152:155], a[8:11], v[0:3]
    v_mul_f32 v9, s57, v9
    v_mul_f32 v10, s57, v10
    v_mfma_f32_16x16x32_bf16 v[0:3], a[156:159], a[12:15], v[0:3]
    v_mul_f32 v11, s57, v11
    v_mul_f32 v12, s57, v12
    v_smfmac_f32_16x16x64_bf16 v[40:43], v[28:31], v[16:23], v48
    s_waitcnt lgkmcnt(0)
    v_mfma_f32_16x16x32_bf16 v[4:7], a[172:175], a[12:15], 0
    v_exp_f32 v8, v8
    v_mfma_f32_16x16x32_bf16 v[4:7], a[168:171], a[8:11], v[4:7]
    v_exp_f32 v9, v9
    v_mfma_f32_16x16x32_bf16 v[4:7], a[164:167], a[4:7], v[4:7]
    v_exp_f32 v10, v10
    v_mfma_f32_16x16x32_bf16 v[4:7], a[160:163], a[0:3], v[4:7]
    v_cvt_pk_bf16_f32 v24, v8, v9
    v_mul_f32 v13, s57, v13
    v_mfma_f32_16x16x32_bf16 v[224:227], a[208:211], v[20:23], v[224:227]
    v_exp_f32 v12, v12
    v_mfma_f32_16x16x32_bf16 v[228:231], a[212:215], v[20:23], v[228:231]
    v_exp_f32 v13, v13
    v_mfma_f32_16x16x32_bf16 v[232:235], a[216:219], v[20:23], v[232:235]
    v_exp_f32 v11, v11
    v_mfma_f32_16x16x32_bf16 v[236:239], a[220:223], v[20:23], v[236:239]
    v_cvt_pk_bf16_f32 v25, v10, v11
    v_cvt_pk_bf16_f32 v26, v12, v13
    v_mfma_f32_16x16x32_bf16 v[240:243], a[224:227], v[20:23], v[240:243]
    v_mul_f32 v14, s57, v14
    v_mul_f32 v15, s57, v15
    v_mfma_f32_16x16x32_bf16 v[244:247], a[228:231], v[20:23], v[244:247]
    v_exp_f32 v14, v14
    v_mfma_f32_16x16x32_bf16 v[248:251], a[232:235], v[20:23], v[248:251]
    v_exp_f32_e64 v15, v15
    v_mfma_f32_16x16x32_bf16 v[252:255], a[236:239], v[20:23], v[252:255]
    v_cvt_pk_bf16_f32 v27, v14, v15
    v_mul_f32_e64 v0, s57, v0
L_B_S0:
    v_mfma_f32_16x16x32_bf16 v[8:11], a[144:147], a[16:19], 0
    v_exp_f32 v0, v0
    v_mfma_f32_16x16x32_bf16 v[8:11], a[148:151], a[20:23], v[8:11]
    v_mul_f32 v1, s57, v1
    v_mfma_f32_16x16x32_bf16 v[8:11], a[152:155], a[24:27], v[8:11]
    v_exp_f32 v1, v1
    v_mfma_f32_16x16x32_bf16 v[8:11], a[156:159], a[28:31], v[8:11]
    v_mul_f32 v2, s57, v2
    v_cvt_pk_bf16_f32 v16, v0, v1
    v_smfmac_f32_16x16x64_bf16 v[44:47], v[28:31], v[20:27], v48
    v_mul_f32 v3, s57, v3
    v_mfma_f32_16x16x32_bf16 v[12:15], a[172:175], a[28:31], 0
    v_exp_f32 v2, v2
    v_mfma_f32_16x16x32_bf16 v[12:15], a[168:171], a[24:27], v[12:15]
    v_exp_f32 v3, v3
    v_mfma_f32_16x16x32_bf16 v[12:15], a[164:167], a[20:23], v[12:15]
    v_mul_f32 v4, s57, v4
    v_cvt_pk_bf16_f32 v17, v2, v3
    v_mfma_f32_16x16x32_bf16 v[12:15], a[160:163], a[16:19], v[12:15]
    v_exp_f32 v4, v4
    v_mfma_f32_16x16x32_bf16 a[112:115], a[208:211], v[24:27], a[112:115]
    v_mul_f32 v5, s57, v5
    v_mfma_f32_16x16x32_bf16 a[116:119], a[212:215], v[24:27], a[116:119]
    v_exp_f32 v5, v5
    v_mfma_f32_16x16x32_bf16 a[120:123], a[216:219], v[24:27], a[120:123]
    v_mul_f32 v6, s57, v6
    v_cvt_pk_bf16_f32 v18, v4, v5
    v_mfma_f32_16x16x32_bf16 a[124:127], a[220:223], v[24:27], a[124:127]
    v_exp_f32 v6, v6
    v_mfma_f32_16x16x32_bf16 a[128:131], a[224:227], v[24:27], a[128:131]
    v_mul_f32 v7, s57, v7
    v_mfma_f32_16x16x32_bf16 a[132:135], a[228:231], v[24:27], a[132:135]
    v_exp_f32 v7, v7
    v_mfma_f32_16x16x32_bf16 a[136:139], a[232:235], v[24:27], a[136:139]
    v_cvt_pk_bf16_f32 v19, v6, v7
    v_mul_f32 v8, s57, v8
    v_mfma_f32_16x16x32_bf16 a[140:143], a[236:239], v[24:27], a[140:143]
    v_pk_add_f32 v[34:35], v[32:33], v[34:35]
    v_pk_add_f32 v[38:39], v[36:37], v[38:39]
    v_pk_add_f32 v[42:43], v[40:41], v[42:43]
    v_pk_add_f32 v[46:47], v[44:45], v[46:47]
    v_rcp_f32 v32, v34
    v_rcp_f32 v33, v35
    v_rcp_f32 v36, v38
    v_rcp_f32 v37, v39
    v_rcp_f32 v40, v42
    v_rcp_f32 v41, v43
    v_rcp_f32 v45, v47
    v_max3_u32 v54, v34, v35, v38
    v_max3_u32 v54, v54, v39, v42
    v_min3_u32 v55, v34, v35, v38
    v_min3_u32 v55, v55, v39, v42
    v_max3_u32 v54, v54, v43, v47
    v_min3_u32 v55, v55, v43, v47
    s_add_u32 s48, s62, 4096
    v_pk_mul_f32 v[64:65], v[64:65], v[32:33] op_sel:[0,0] op_sel_hi:[1,0]
    v_pk_mul_f32 v[66:67], v[66:67], v[32:33] op_sel:[0,0] op_sel_hi:[1,0]
    v_pk_mul_f32 v[68:69], v[68:69], v[32:33] op_sel:[0,0] op_sel_hi:[1,0]
    v_pk_mul_f32 v[70:71], v[70:71], v[32:33] op_sel:[0,0] op_sel_hi:[1,0]
    v_cvt_pk_bf16_f32 v64, v64, v65
    v_cvt_pk_bf16_f32 v65, v66, v67
    v_cvt_pk_bf16_f32 v66, v68, v69
    v_cvt_pk_bf16_f32 v67, v70, v71
    ds_write_b128 v50, v[64:67] offset:20480
    v_pk_mul_f32 v[72:73], v[72:73], v[32:33] op_sel:[0,0] op_sel_hi:[1,0]
    v_pk_mul_f32 v[74:75], v[74:75], v[32:33] op_sel:[0,0] op_sel_hi:[1,0]
    v_pk_mul_f32 v[76:77], v[76:77], v[32:33] op_sel:[0,0] op_sel_hi:[1,0]
    v_pk_mul_f32 v[78:79], v[78:79], v[32:33] op_sel:[0,0] op_sel_hi:[1,0]
    v_cvt_pk_bf16_f32 v72, v72, v73
    v_cvt_pk_bf16_f32 v73, v74, v75
    v_cvt_pk_bf16_f32 v74, v76, v77
    v_cvt_pk_bf16_f32 v75, v78, v79
    ds_write_b128 v50, v[72:75] offset:20992
    v_pk_mul_f32 v[80:81], v[80:81], v[32:33] op_sel:[0,0] op_sel_hi:[1,0]
    v_pk_mul_f32 v[82:83], v[82:83], v[32:33] op_sel:[0,0] op_sel_hi:[1,0]
    v_pk_mul_f32 v[84:85], v[84:85], v[32:33] op_sel:[0,0] op_sel_hi:[1,0]
    v_pk_mul_f32 v[86:87], v[86:87], v[32:33] op_sel:[0,0] op_sel_hi:[1,0]
    v_cvt_pk_bf16_f32 v80, v80, v81
    v_cvt_pk_bf16_f32 v81, v82, v83
    v_cvt_pk_bf16_f32 v82, v84, v85
    v_cvt_pk_bf16_f32 v83, v86, v87
    ds_write_b128 v50, v[80:83] offset:21504
    v_pk_mul_f32 v[88:89], v[88:89], v[32:33] op_sel:[0,0] op_sel_hi:[1,0]
    v_pk_mul_f32 v[90:91], v[90:91], v[32:33] op_sel:[0,0] op_sel_hi:[1,0]
    v_pk_mul_f32 v[92:93], v[92:93], v[32:33] op_sel:[0,0] op_sel_hi:[1,0]
    v_pk_mul_f32 v[94:95], v[94:95], v[32:33] op_sel:[0,0] op_sel_hi:[1,0]
    v_cvt_pk_bf16_f32 v88, v88, v89
    v_cvt_pk_bf16_f32 v89, v90, v91
    v_cvt_pk_bf16_f32 v90, v92, v93
    v_cvt_pk_bf16_f32 v91, v94, v95
    ds_write_b128 v50, v[88:91] offset:22016
    ds_read_b128 a[240:243], v51 offset:20480
    ds_read_b128 a[244:247], v51 offset:21504
    ds_read_b128 a[248:251], v51 offset:22528
    ds_read_b128 a[252:255], v51 offset:23552
    v_pk_mul_f32 v[128:129], v[128:129], v[36:37] op_sel:[0,0] op_sel_hi:[1,0]
    v_pk_mul_f32 v[130:131], v[130:131], v[36:37] op_sel:[0,0] op_sel_hi:[1,0]
    v_pk_mul_f32 v[132:133], v[132:133], v[36:37] op_sel:[0,0] op_sel_hi:[1,0]
    v_pk_mul_f32 v[134:135], v[134:135], v[36:37] op_sel:[0,0] op_sel_hi:[1,0]
    v_cvt_pk_bf16_f32 v128, v128, v129
    v_cvt_pk_bf16_f32 v129, v130, v131
    v_cvt_pk_bf16_f32 v130, v132, v133
    v_cvt_pk_bf16_f32 v131, v134, v135
    ds_write_b128 v50, v[128:131] offset:4096
    v_pk_mul_f32 v[136:137], v[136:137], v[36:37] op_sel:[0,0] op_sel_hi:[1,0]
    v_pk_mul_f32 v[138:139], v[138:139], v[36:37] op_sel:[0,0] op_sel_hi:[1,0]
    v_pk_mul_f32 v[140:141], v[140:141], v[36:37] op_sel:[0,0] op_sel_hi:[1,0]
    v_pk_mul_f32 v[142:143], v[142:143], v[36:37] op_sel:[0,0] op_sel_hi:[1,0]
    v_cvt_pk_bf16_f32 v136, v136, v137
    v_cvt_pk_bf16_f32 v137, v138, v139
    v_cvt_pk_bf16_f32 v138, v140, v141
    v_cvt_pk_bf16_f32 v139, v142, v143
    ds_write_b128 v50, v[136:139] offset:4608
    v_pk_mul_f32 v[144:145], v[144:145], v[36:37] op_sel:[0,0] op_sel_hi:[1,0]
    v_pk_mul_f32 v[146:147], v[146:147], v[36:37] op_sel:[0,0] op_sel_hi:[1,0]
    v_pk_mul_f32 v[148:149], v[148:149], v[36:37] op_sel:[0,0] op_sel_hi:[1,0]
    v_pk_mul_f32 v[150:151], v[150:151], v[36:37] op_sel:[0,0] op_sel_hi:[1,0]
    v_cvt_pk_bf16_f32 v144, v144, v145
    v_cvt_pk_bf16_f32 v145, v146, v147
    v_cvt_pk_bf16_f32 v146, v148, v149
    v_cvt_pk_bf16_f32 v147, v150, v151
    ds_write_b128 v50, v[144:147] offset:5120
    v_pk_mul_f32 v[152:153], v[152:153], v[36:37] op_sel:[0,0] op_sel_hi:[1,0]
    v_pk_mul_f32 v[154:155], v[154:155], v[36:37] op_sel:[0,0] op_sel_hi:[1,0]
    v_pk_mul_f32 v[156:157], v[156:157], v[36:37] op_sel:[0,0] op_sel_hi:[1,0]
    v_pk_mul_f32 v[158:159], v[158:159], v[36:37] op_sel:[0,0] op_sel_hi:[1,0]
    v_cvt_pk_bf16_f32 v152, v152, v153
    v_cvt_pk_bf16_f32 v153, v154, v155
    v_cvt_pk_bf16_f32 v154, v156, v157
    v_cvt_pk_bf16_f32 v155, v158, v159
    ds_write_b128 v50, v[152:155] offset:5632
    v_pk_mul_f32 v[160:161], v[160:161], v[36:37] op_sel:[0,1] op_sel_hi:[1,1]
    v_pk_mul_f32 v[162:163], v[162:163], v[36:37] op_sel:[0,1] op_sel_hi:[1,1]
    v_pk_mul_f32 v[164:165], v[164:165], v[36:37] op_sel:[0,1] op_sel_hi:[1,1]
    v_pk_mul_f32 v[166:167], v[166:167], v[36:37] op_sel:[0,1] op_sel_hi:[1,1]
    v_cvt_pk_bf16_f32 v160, v160, v161
    v_cvt_pk_bf16_f32 v161, v162, v163
    v_cvt_pk_bf16_f32 v162, v164, v165
    v_cvt_pk_bf16_f32 v163, v166, v167
    ds_write_b128 v50, v[160:163] offset:8192
    s_waitcnt lgkmcnt(5)
    buffer_store_dwordx4 a[240:243], v49, s[36:39], s62 offen offset:0 nt
    v_pk_mul_f32 v[168:169], v[168:169], v[36:37] op_sel:[0,1] op_sel_hi:[1,1]
    v_pk_mul_f32 v[170:171], v[170:171], v[36:37] op_sel:[0,1] op_sel_hi:[1,1]
    v_pk_mul_f32 v[172:173], v[172:173], v[36:37] op_sel:[0,1] op_sel_hi:[1,1]
    v_pk_mul_f32 v[174:175], v[174:175], v[36:37] op_sel:[0,1] op_sel_hi:[1,1]
    v_cvt_pk_bf16_f32 v168, v168, v169
    v_cvt_pk_bf16_f32 v169, v170, v171
    v_cvt_pk_bf16_f32 v170, v172, v173
    v_cvt_pk_bf16_f32 v171, v174, v175
    ds_write_b128 v50, v[168:171] offset:8704
    v_pk_mul_f32 v[176:177], v[176:177], v[36:37] op_sel:[0,1] op_sel_hi:[1,1]
    v_pk_mul_f32 v[178:179], v[178:179], v[36:37] op_sel:[0,1] op_sel_hi:[1,1]
    v_pk_mul_f32 v[180:181], v[180:181], v[36:37] op_sel:[0,1] op_sel_hi:[1,1]
    v_pk_mul_f32 v[182:183], v[182:183], v[36:37] op_sel:[0,1] op_sel_hi:[1,1]
    v_cvt_pk_bf16_f32 v176, v176, v177
    v_cvt_pk_bf16_f32 v177, v178, v179
    v_cvt_pk_bf16_f32 v178, v180, v181
    v_cvt_pk_bf16_f32 v179, v182, v183
    ds_write_b128 v50, v[176:179] offset:9216
    v_pk_mul_f32 v[184:185], v[184:185], v[36:37] op_sel:[0,1] op_sel_hi:[1,1]
    v_pk_mul_f32 v[186:187], v[186:187], v[36:37] op_sel:[0,1] op_sel_hi:[1,1]
    v_pk_mul_f32 v[188:189], v[188:189], v[36:37] op_sel:[0,1] op_sel_hi:[1,1]
    v_pk_mul_f32 v[190:191], v[190:191], v[36:37] op_sel:[0,1] op_sel_hi:[1,1]
    v_cvt_pk_bf16_f32 v184, v184, v185
    v_cvt_pk_bf16_f32 v185, v186, v187
    v_cvt_pk_bf16_f32 v186, v188, v189
    v_cvt_pk_bf16_f32 v187, v190, v191
    ds_write_b128 v50, v[184:187] offset:9728
    v_pk_mul_f32 v[192:193], v[192:193], v[40:41] op_sel:[0,0] op_sel_hi:[1,0]
    v_pk_mul_f32 v[194:195], v[194:195], v[40:41] op_sel:[0,0] op_sel_hi:[1,0]
    v_pk_mul_f32 v[196:197], v[196:197], v[40:41] op_sel:[0,0] op_sel_hi:[1,0]
    v_pk_mul_f32 v[198:199], v[198:199], v[40:41] op_sel:[0,0] op_sel_hi:[1,0]
    v_cvt_pk_bf16_f32 v192, v192, v193
    v_cvt_pk_bf16_f32 v193, v194, v195
    v_cvt_pk_bf16_f32 v194, v196, v197
    v_cvt_pk_bf16_f32 v195, v198, v199
    ds_write_b128 v50, v[192:195] offset:12288
    buffer_store_dwordx4 a[244:247], v49, s[36:39], s62 offen offset:128 nt
    v_pk_mul_f32 v[200:201], v[200:201], v[40:41] op_sel:[0,0] op_sel_hi:[1,0]
    v_pk_mul_f32 v[202:203], v[202:203], v[40:41] op_sel:[0,0] op_sel_hi:[1,0]
    v_pk_mul_f32 v[204:205], v[204:205], v[40:41] op_sel:[0,0] op_sel_hi:[1,0]
    v_pk_mul_f32 v[206:207], v[206:207], v[40:41] op_sel:[0,0] op_sel_hi:[1,0]
    v_cvt_pk_bf16_f32 v200, v200, v201
    v_cvt_pk_bf16_f32 v201, v202, v203
    v_cvt_pk_bf16_f32 v202, v204, v205
    v_cvt_pk_bf16_f32 v203, v206, v207
    ds_write_b128 v50, v[200:203] offset:12800
    v_pk_mul_f32 v[208:209], v[208:209], v[40:41] op_sel:[0,0] op_sel_hi:[1,0]
    v_pk_mul_f32 v[210:211], v[210:211], v[40:41] op_sel:[0,0] op_sel_hi:[1,0]
    v_pk_mul_f32 v[212:213], v[212:213], v[40:41] op_sel:[0,0] op_sel_hi:[1,0]
    v_pk_mul_f32 v[214:215], v[214:215], v[40:41] op_sel:[0,0] op_sel_hi:[1,0]
    v_cvt_pk_bf16_f32 v208, v208, v209
    v_cvt_pk_bf16_f32 v209, v210, v211
    v_cvt_pk_bf16_f32 v210, v212, v213
    v_cvt_pk_bf16_f32 v211, v214, v215
    ds_write_b128 v50, v[208:211] offset:13312
    v_pk_mul_f32 v[216:217], v[216:217], v[40:41] op_sel:[0,0] op_sel_hi:[1,0]
    v_pk_mul_f32 v[218:219], v[218:219], v[40:41] op_sel:[0,0] op_sel_hi:[1,0]
    v_pk_mul_f32 v[220:221], v[220:221], v[40:41] op_sel:[0,0] op_sel_hi:[1,0]
    v_pk_mul_f32 v[222:223], v[222:223], v[40:41] op_sel:[0,0] op_sel_hi:[1,0]
    v_cvt_pk_bf16_f32 v216, v216, v217
    v_cvt_pk_bf16_f32 v217, v218, v219
    v_cvt_pk_bf16_f32 v218, v220, v221
    v_cvt_pk_bf16_f32 v219, v222, v223
    ds_write_b128 v50, v[216:219] offset:13824
    v_pk_mul_f32 v[224:225], v[224:225], v[40:41] op_sel:[0,1] op_sel_hi:[1,1]
    v_pk_mul_f32 v[226:227], v[226:227], v[40:41] op_sel:[0,1] op_sel_hi:[1,1]
    v_pk_mul_f32 v[228:229], v[228:229], v[40:41] op_sel:[0,1] op_sel_hi:[1,1]
    v_pk_mul_f32 v[230:231], v[230:231], v[40:41] op_sel:[0,1] op_sel_hi:[1,1]
    v_cvt_pk_bf16_f32 v224, v224, v225
    v_cvt_pk_bf16_f32 v225, v226, v227
    v_cvt_pk_bf16_f32 v226, v228, v229
    v_cvt_pk_bf16_f32 v227, v230, v231
    ds_write_b128 v50, v[224:227] offset:16384
    buffer_store_dwordx4 a[248:251], v49, s[36:39], s62 offen offset:2048 nt
    v_pk_mul_f32 v[232:233], v[232:233], v[40:41] op_sel:[0,1] op_sel_hi:[1,1]
    v_pk_mul_f32 v[234:235], v[234:235], v[40:41] op_sel:[0,1] op_sel_hi:[1,1]
    v_pk_mul_f32 v[236:237], v[236:237], v[40:41] op_sel:[0,1] op_sel_hi:[1,1]
    v_pk_mul_f32 v[238:239], v[238:239], v[40:41] op_sel:[0,1] op_sel_hi:[1,1]
    v_cvt_pk_bf16_f32 v232, v232, v233
    v_cvt_pk_bf16_f32 v233, v234, v235
    v_cvt_pk_bf16_f32 v234, v236, v237
    v_cvt_pk_bf16_f32 v235, v238, v239
    ds_write_b128 v50, v[232:235] offset:16896
    v_pk_mul_f32 v[240:241], v[240:241], v[40:41] op_sel:[0,1] op_sel_hi:[1,1]
    v_pk_mul_f32 v[242:243], v[242:243], v[40:41] op_sel:[0,1] op_sel_hi:[1,1]
    v_pk_mul_f32 v[244:245], v[244:245], v[40:41] op_sel:[0,1] op_sel_hi:[1,1]
    v_pk_mul_f32 v[246:247], v[246:247], v[40:41] op_sel:[0,1] op_sel_hi:[1,1]
    v_cvt_pk_bf16_f32 v240, v240, v241
    v_cvt_pk_bf16_f32 v241, v242, v243
    v_cvt_pk_bf16_f32 v242, v244, v245
    v_cvt_pk_bf16_f32 v243, v246, v247
    ds_write_b128 v50, v[240:243] offset:17408
    v_pk_mul_f32 v[248:249], v[248:249], v[40:41] op_sel:[0,1] op_sel_hi:[1,1]
    v_pk_mul_f32 v[250:251], v[250:251], v[40:41] op_sel:[0,1] op_sel_hi:[1,1]
    v_pk_mul_f32 v[252:253], v[252:253], v[40:41] op_sel:[0,1] op_sel_hi:[1,1]
    v_pk_mul_f32 v[254:255], v[254:255], v[40:41] op_sel:[0,1] op_sel_hi:[1,1]
    v_cvt_pk_bf16_f32 v248, v248, v249
    v_cvt_pk_bf16_f32 v249, v250, v251
    v_cvt_pk_bf16_f32 v250, v252, v253
    v_cvt_pk_bf16_f32 v251, v254, v255
    ds_write_b128 v50, v[248:251] offset:17920
    s_waitcnt vmcnt(7)
    ds_read_b128 a[96:99], v50 offset:0
    ds_read_b128 a[100:103], v50 offset:512
    ds_read_b128 a[104:107], v50 offset:1024
    ds_read_b128 a[108:111], v50 offset:1536
    v_pk_mul_f32 v[96:97], v[96:97], v[32:33] op_sel:[0,1] op_sel_hi:[1,1]
    v_pk_mul_f32 v[98:99], v[98:99], v[32:33] op_sel:[0,1] op_sel_hi:[1,1]
    v_pk_mul_f32 v[100:101], v[100:101], v[32:33] op_sel:[0,1] op_sel_hi:[1,1]
    v_pk_mul_f32 v[102:103], v[102:103], v[32:33] op_sel:[0,1] op_sel_hi:[1,1]
    v_cvt_pk_bf16_f32 v96, v96, v97
    v_cvt_pk_bf16_f32 v97, v98, v99
    v_cvt_pk_bf16_f32 v98, v100, v101
    v_cvt_pk_bf16_f32 v99, v102, v103
    ds_write_b128 v50, v[96:99] offset:0
    v_pk_mul_f32 v[104:105], v[104:105], v[32:33] op_sel:[0,1] op_sel_hi:[1,1]
    v_pk_mul_f32 v[106:107], v[106:107], v[32:33] op_sel:[0,1] op_sel_hi:[1,1]
    v_pk_mul_f32 v[108:109], v[108:109], v[32:33] op_sel:[0,1] op_sel_hi:[1,1]
    v_pk_mul_f32 v[110:111], v[110:111], v[32:33] op_sel:[0,1] op_sel_hi:[1,1]
    v_cvt_pk_bf16_f32 v104, v104, v105
    v_cvt_pk_bf16_f32 v105, v106, v107
    v_cvt_pk_bf16_f32 v106, v108, v109
    v_cvt_pk_bf16_f32 v107, v110, v111
    ds_write_b128 v50, v[104:107] offset:512
    v_pk_mul_f32 v[112:113], v[112:113], v[32:33] op_sel:[0,1] op_sel_hi:[1,1]
    v_pk_mul_f32 v[114:115], v[114:115], v[32:33] op_sel:[0,1] op_sel_hi:[1,1]
    v_pk_mul_f32 v[116:117], v[116:117], v[32:33] op_sel:[0,1] op_sel_hi:[1,1]
    v_pk_mul_f32 v[118:119], v[118:119], v[32:33] op_sel:[0,1] op_sel_hi:[1,1]
    v_cvt_pk_bf16_f32 v112, v112, v113
    v_cvt_pk_bf16_f32 v113, v114, v115
    v_cvt_pk_bf16_f32 v114, v116, v117
    v_cvt_pk_bf16_f32 v115, v118, v119
    ds_write_b128 v50, v[112:115] offset:1024
    v_pk_mul_f32 v[120:121], v[120:121], v[32:33] op_sel:[0,1] op_sel_hi:[1,1]
    v_pk_mul_f32 v[122:123], v[122:123], v[32:33] op_sel:[0,1] op_sel_hi:[1,1]
    v_pk_mul_f32 v[124:125], v[124:125], v[32:33] op_sel:[0,1] op_sel_hi:[1,1]
    v_pk_mul_f32 v[126:127], v[126:127], v[32:33] op_sel:[0,1] op_sel_hi:[1,1]
    v_cvt_pk_bf16_f32 v120, v120, v121
    v_cvt_pk_bf16_f32 v121, v122, v123
    v_cvt_pk_bf16_f32 v122, v124, v125
    v_cvt_pk_bf16_f32 v123, v126, v127
    ds_write_b128 v50, v[120:123] offset:1536
    v_accvgpr_read_b32 v64, a112
    v_accvgpr_read_b32 v65, a113
    v_accvgpr_read_b32 v66, a114
    v_accvgpr_read_b32 v67, a115
    v_accvgpr_read_b32 v68, a116
    v_accvgpr_read_b32 v69, a117
    v_accvgpr_read_b32 v70, a118
    v_accvgpr_read_b32 v71, a119
    v_accvgpr_read_b32 v72, a120
    v_accvgpr_read_b32 v73, a121
    v_accvgpr_read_b32 v74, a122
    v_accvgpr_read_b32 v75, a123
    v_accvgpr_read_b32 v76, a124
    v_accvgpr_read_b32 v77, a125
    v_accvgpr_read_b32 v78, a126
    v_accvgpr_read_b32 v79, a127
    v_accvgpr_read_b32 v80, a128
    v_accvgpr_read_b32 v81, a129
    v_accvgpr_read_b32 v82, a130
    v_accvgpr_read_b32 v83, a131
    v_accvgpr_read_b32 v84, a132
    v_accvgpr_read_b32 v85, a133
    v_accvgpr_read_b32 v86, a134
    v_accvgpr_read_b32 v87, a135
    v_accvgpr_read_b32 v88, a136
    v_accvgpr_read_b32 v89, a137
    v_accvgpr_read_b32 v90, a138
    v_accvgpr_read_b32 v91, a139
    v_accvgpr_read_b32 v92, a140
    v_accvgpr_read_b32 v93, a141
    v_accvgpr_read_b32 v94, a142
    v_accvgpr_read_b32 v95, a143
    v_pk_mul_f32 v[64:65], v[64:65], v[44:45] op_sel:[0,1] op_sel_hi:[1,1]
    v_pk_mul_f32 v[66:67], v[66:67], v[44:45] op_sel:[0,1] op_sel_hi:[1,1]
    v_pk_mul_f32 v[68:69], v[68:69], v[44:45] op_sel:[0,1] op_sel_hi:[1,1]
    v_pk_mul_f32 v[70:71], v[70:71], v[44:45] op_sel:[0,1] op_sel_hi:[1,1]
    v_cvt_pk_bf16_f32 v64, v64, v65
    v_cvt_pk_bf16_f32 v65, v66, v67
    v_cvt_pk_bf16_f32 v66, v68, v69
    v_cvt_pk_bf16_f32 v67, v70, v71
    ds_write_b128 v50, v[64:67] offset:20480
    buffer_store_dwordx4 a[252:255], v49, s[36:39], s62 offen offset:2176 nt
    v_pk_mul_f32 v[72:73], v[72:73], v[44:45] op_sel:[0,1] op_sel_hi:[1,1]
    v_pk_mul_f32 v[74:75], v[74:75], v[44:45] op_sel:[0,1] op_sel_hi:[1,1]
    v_pk_mul_f32 v[76:77], v[76:77], v[44:45] op_sel:[0,1] op_sel_hi:[1,1]
    v_pk_mul_f32 v[78:79], v[78:79], v[44:45] op_sel:[0,1] op_sel_hi:[1,1]
    v_cvt_pk_bf16_f32 v72, v72, v73
    v_cvt_pk_bf16_f32 v73, v74, v75
    v_cvt_pk_bf16_f32 v74, v76, v77
    v_cvt_pk_bf16_f32 v75, v78, v79
    ds_write_b128 v50, v[72:75] offset:20992
    v_pk_mul_f32 v[80:81], v[80:81], v[44:45] op_sel:[0,1] op_sel_hi:[1,1]
    v_pk_mul_f32 v[82:83], v[82:83], v[44:45] op_sel:[0,1] op_sel_hi:[1,1]
    v_pk_mul_f32 v[84:85], v[84:85], v[44:45] op_sel:[0,1] op_sel_hi:[1,1]
    v_pk_mul_f32 v[86:87], v[86:87], v[44:45] op_sel:[0,1] op_sel_hi:[1,1]
    v_cvt_pk_bf16_f32 v80, v80, v81
    v_cvt_pk_bf16_f32 v81, v82, v83
    v_cvt_pk_bf16_f32 v82, v84, v85
    v_cvt_pk_bf16_f32 v83, v86, v87
    ds_write_b128 v50, v[80:83] offset:21504
    v_pk_mul_f32 v[88:89], v[88:89], v[44:45] op_sel:[0,1] op_sel_hi:[1,1]
    v_pk_mul_f32 v[90:91], v[90:91], v[44:45] op_sel:[0,1] op_sel_hi:[1,1]
    v_pk_mul_f32 v[92:93], v[92:93], v[44:45] op_sel:[0,1] op_sel_hi:[1,1]
    v_pk_mul_f32 v[94:95], v[94:95], v[44:45] op_sel:[0,1] op_sel_hi:[1,1]
    v_cvt_pk_bf16_f32 v88, v88, v89
    v_cvt_pk_bf16_f32 v89, v90, v91
    v_cvt_pk_bf16_f32 v90, v92, v93
    v_cvt_pk_bf16_f32 v91, v94, v95
    ds_write_b128 v50, v[88:91] offset:22016
    v_mov_b64 v[26:27], 0
    v_cmp_lt_u32 vcc, s59, v54
    v_cmp_gt_u32 s[70:71], s58, v55
    v_mov_b64 v[32:33], 0
    v_mov_b64 v[34:35], 0
    v_mov_b64 v[36:37], 0
    v_mov_b64 v[38:39], 0
    v_mov_b64 v[40:41], 0
    v_mov_b64 v[42:43], 0
    v_mov_b64 v[44:45], 0
    v_mov_b64 v[46:47], 0
    s_lshl_b32 s68, 1, s56
    s_or_b64 vcc, vcc, s[70:71]
    s_cselect_b32 s68, s68, 0
    s_or_b32 s60, s60, s68
    s_add_u32 s62, s62, 434176
    s_add_u32 s64, s64, 434176
    s_add_u32 s56, s56, 1
    s_mov_b32 s49, s54
    s_mov_b32 s55, 2
    s_cmp_lt_u32 s56, 3
    s_cselect_b32 s46, s62, 0x80000000
    s_cselect_b32 s47, s64, 0x80000000
    s_cselect_b32 s29, 0, s30
    v_add_co_u32 v52, vcc, s29, v52
    s_nop 1
    v_addc_co_u32 v53, vcc, 0, v53, vcc
    s_waitcnt lgkmcnt(8)
L_B_rest:
    v_mfma_f32_16x16x32_bf16 v[0:3], a[144:147], a[96:99], 0
    ds_read_b128 a[240:243], v51 offset:0
    v_exp_f32 v8, v8
    v_mfma_f32_16x16x32_bf16 v[0:3], a[148:151], a[100:103], v[0:3]
    ds_read_b128 a[244:247], v51 offset:1024
    ds_read_b128 a[248:251], v51 offset:2048
    ds_read_b128 a[252:255], v51 offset:3072
    v_mfma_f32_16x16x32_bf16 v[0:3], a[152:155], a[104:107], v[0:3]
    v_mul_f32 v9, s57, v9
    v_mul_f32 v10, s57, v10
    v_mfma_f32_16x16x32_bf16 v[0:3], a[156:159], a[108:111], v[0:3]
    v_exp_f32 v9, v9
    v_mul_f32 v11, s57, v11
    v_mfma_f32_16x16x32_bf16 v[64:67], a[176:179], v[16:19], 0
    v_cvt_pk_bf16_f32 v20, v8, v9
    v_exp_f32 v11, v11
    v_mfma_f32_16x16x32_bf16 v[68:71], a[180:183], v[16:19], 0
    v_exp_f32 v10, v10
    v_mfma_f32_16x16x32_bf16 v[72:75], a[184:187], v[16:19], 0
    v_mul_f32 v12, s57, v12
    v_cvt_pk_bf16_f32 v21, v10, v11
    v_mul_f32 v13, s57, v13
    v_mfma_f32_16x16x32_bf16 v[76:79], a[188:191], v[16:19], 0
    v_exp_f32 v13, v13
    v_mfma_f32_16x16x32_bf16 v[80:83], a[192:195], v[16:19], 0
    v_exp_f32 v12, v12
    v_mul_f32 v14, s57, v14
    v_mfma_f32_16x16x32_bf16 v[84:87], a[196:199], v[16:19], 0
    v_exp_f32 v14, v14
    v_mfma_f32_16x16x32_bf16 v[88:91], a[200:203], v[16:19], 0
    s_waitcnt lgkmcnt(0)
    buffer_store_dwordx4 a[240:243], v49, s[36:39], s48 offen offset:0 nt
    v_mfma_f32_16x16x32_bf16 v[92:95], a[204:207], v[16:19], 0
    v_mul_f32 v15, s57, v15
    v_mul_f32 v0, s57, v0
    v_mfma_f32_16x16x32_bf16 v[8:11], a[144:147], a[32:35], 0
    v_exp_f32 v15, v15
    v_mfma_f32_16x16x32_bf16 v[8:11], a[148:151], a[36:39], v[8:11]
    v_cvt_pk_bf16_f32 v22, v12, v13
    v_cvt_pk_bf16_f32 v23, v14, v15
    v_mfma_f32_16x16x32_bf16 v[8:11], a[152:155], a[40:43], v[8:11]
    ds_read_b64_tr_b16 a[208:209], v62 offset:2048
    ds_read_b64_tr_b16 a[210:211], v63 offset:2048
    v_mfma_f32_16x16x32_bf16 v[8:11], a[156:159], a[44:47], v[8:11]
    ds_read_b64_tr_b16 a[214:215], v63 offset:2056
    v_mul_f32 v1, s57, v1
    v_smfmac_f32_16x16x64_bf16 v[32:35], v[28:31], v[16:23], v48
    ds_read_b64_tr_b16 a[216:217], v62 offset:2560
    v_mfma_f32_16x16x32_bf16 v[12:15], a[172:175], a[44:47], 0
    v_exp_f32 v1, v1
    v_mfma_f32_16x16x32_bf16 v[12:15], a[168:171], a[40:43], v[12:15]
    ds_read_b64_tr_b16 a[220:221], v62 offset:2568
    v_mul_f32 v2, s57, v2
    v_mfma_f32_16x16x32_bf16 v[12:15], a[164:167], a[36:39], v[12:15]
    v_exp_f32 v0, v0
    v_mfma_f32_16x16x32_bf16 v[12:15], a[160:163], a[32:35], v[12:15]
    v_exp_f32 v2, v2
    v_mfma_f32_16x16x32_bf16 v[96:99], a[176:179], v[20:23], 0
    buffer_store_dwordx4 a[244:247], v49, s[36:39], s48 offen offset:128 nt
    v_mfma_f32_16x16x32_bf16 v[100:103], a[180:183], v[20:23], 0
    ds_read_b64_tr_b16 a[226:227], v63 offset:3072
    v_cvt_pk_bf16_f32 v24, v0, v1
    v_mfma_f32_16x16x32_bf16 v[104:107], a[184:187], v[20:23], 0
    v_mul_f32 v3, s57, v3
    v_mul_f32 v8, s57, v8
    v_mfma_f32_16x16x32_bf16 v[108:111], a[188:191], v[20:23], 0
    v_exp_f32 v3, v3
    v_mfma_f32_16x16x32_bf16 v[112:115], a[192:195], v[20:23], 0
    v_cvt_pk_bf16_f32 v25, v2, v3
    v_mul_f32 v9, s57, v9
    v_mfma_f32_16x16x32_bf16 v[116:119], a[196:199], v[20:23], 0
    v_mul_f32 v10, s57, v10
    v_mul_f32 v11, s57, v11
    v_mfma_f32_16x16x32_bf16 v[120:123], a[200:203], v[20:23], 0
    v_exp_f32 v10, v10
    v_mfma_f32_16x16x32_bf16 v[124:127], a[204:207], v[20:23], 0
    v_exp_f32 v9, v9
    v_mfma_f32_16x16x32_bf16 v[0:3], a[144:147], a[48:51], 0
    v_exp_f32 v11, v11
    v_mfma_f32_16x16x32_bf16 v[0:3], a[148:151], a[52:55], v[0:3]
    ds_read_b64_tr_b16 a[212:213], v62 offset:2056
    ds_read_b64_tr_b16 a[218:219], v63 offset:2560
    v_mfma_f32_16x16x32_bf16 v[0:3], a[152:155], a[56:59], v[0:3]
    ds_read_b64_tr_b16 a[224:225], v62 offset:3072
    ds_read_b128 a[240:243], v51 offset:4096
    v_mfma_f32_16x16x32_bf16 v[0:3], a[156:159], a[60:63], v[0:3]
    ds_read_b64_tr_b16 a[222:223], v63 offset:2568
    ds_read_b64_tr_b16 a[232:233], v62 offset:3584
    v_smfmac_f32_16x16x64_bf16 v[44:47], v[28:31], v[20:27], v48
    ds_read_b64_tr_b16 a[230:231], v63 offset:3080
    v_mfma_f32_16x16x32_bf16 v[4:7], a[172:175], a[60:63], 0
    ds_read_b64_tr_b16 a[234:235], v63 offset:3584
    v_mul_f32 v12, s57, v12
    v_mfma_f32_16x16x32_bf16 v[4:7], a[168:171], a[56:59], v[4:7]
    buffer_store_dwordx4 a[248:251], v49, s[36:39], s48 offen offset:2048 nt
    v_mfma_f32_16x16x32_bf16 v[4:7], a[164:167], a[52:55], v[4:7]
    v_exp_f32 v8, v8
    v_mfma_f32_16x16x32_bf16 v[4:7], a[160:163], a[48:51], v[4:7]
    v_cvt_pk_bf16_f32 v16, v8, v9
    v_cvt_pk_bf16_f32 v17, v10, v11
    v_mfma_f32_16x16x16_bf16 a[112:115], a[176:177], v[24:25], 0
    v_exp_f32 v12, v12
    v_mul_f32 v13, s57, v13
    v_mfma_f32_16x16x16_bf16 a[116:119], a[180:181], v[24:25], 0
    v_exp_f32 v13, v13
    v_mul_f32 v14, s57, v14
    v_mfma_f32_16x16x16_bf16 a[120:123], a[184:185], v[24:25], 0
    v_cvt_pk_bf16_f32 v18, v12, v13
    v_exp_f32 v14, v14
    v_mfma_f32_16x16x16_bf16 a[124:127], a[188:189], v[24:25], 0
    ds_read_b64_tr_b16 a[228:229], v62 offset:3080
    ds_read_b128 a[244:247], v51 offset:5120
    v_mul_f32 v15, s57, v15
    v_mfma_f32_16x16x16_bf16 a[128:131], a[192:193], v[24:25], 0
    v_exp_f32 v15, v15
    v_mul_f32 v0, s57, v0
    v_mfma_f32_16x16x16_bf16 a[132:135], a[196:197], v[24:25], 0
    v_exp_f32 v0, v0
    v_mul_f32 v2, s57, v2
    v_mfma_f32_16x16x16_bf16 a[136:139], a[200:201], v[24:25], 0
    v_cvt_pk_bf16_f32 v19, v14, v15
    v_exp_f32 v2, v2
    v_mfma_f32_16x16x16_bf16 a[140:143], a[204:205], v[24:25], 0
    ds_read_b64_tr_b16 a[236:237], v62 offset:3592
    v_mul_f32 v1, s57, v1
    v_mul_f32 v6, s57, v6
    v_mfma_f32_16x16x32_bf16 v[8:11], a[144:147], a[64:67], 0
    buffer_store_dwordx4 a[252:255], v49, s[36:39], s48 offen offset:2176 nt
    v_mfma_f32_16x16x32_bf16 v[8:11], a[148:151], a[68:71], v[8:11]
    v_exp_f32 v1, v1
    v_mfma_f32_16x16x32_bf16 v[8:11], a[152:155], a[72:75], v[8:11]
    s_add_u32 s48, s48, 4096
    v_cvt_pk_bf16_f32 v20, v0, v1
    v_mfma_f32_16x16x32_bf16 v[8:11], a[156:159], a[76:79], v[8:11]
    v_exp_f32 v6, v6
    v_mfma_f32_16x16x32_bf16 v[12:15], a[172:175], a[76:79], 0
    v_mul_f32 v3, s57, v3
    v_mul_f32 v7, s57, v7
    v_mfma_f32_16x16x32_bf16 v[12:15], a[168:171], a[72:75], v[12:15]
    v_exp_f32 v7, v7
    v_mfma_f32_16x16x32_bf16 v[12:15], a[164:167], a[68:71], v[12:15]
    v_exp_f32 v3, v3
    v_mfma_f32_16x16x32_bf16 v[12:15], a[160:163], a[64:67], v[12:15]
    v_mul_f32 v4, s57, v4
    v_cvt_pk_bf16_f32 v21, v2, v3
    v_mfma_f32_16x16x32_bf16 v[128:131], a[176:179], v[16:19], 0
    ds_read_b64_tr_b16 a[238:239], v63 offset:3592
    s_waitcnt lgkmcnt(2)
    v_mfma_f32_16x16x32_bf16 v[132:135], a[180:183], v[16:19], 0
    v_mul_f32 v5, s57, v5
    v_mul_f32 v11, s57, v11
    v_mfma_f32_16x16x32_bf16 v[136:139], a[184:187], v[16:19], 0
    v_mul_f32 v8, s57, v8
    v_cvt_pk_bf16_f32 v23, v6, v7
    v_mfma_f32_16x16x32_bf16 v[140:143], a[188:191], v[16:19], 0
    buffer_store_dwordx4 a[240:243], v49, s[36:39], s48 offen offset:0 nt
    v_mfma_f32_16x16x32_bf16 v[144:147], a[192:195], v[16:19], 0
    v_mul_f32 v9, s57, v9
    v_mul_f32 v14, s57, v14
    v_mfma_f32_16x16x32_bf16 v[148:151], a[196:199], v[16:19], 0
    v_exp_f32 v5, v5
    v_mfma_f32_16x16x32_bf16 v[152:155], a[200:203], v[16:19], 0
    v_mul_f32 v10, s57, v10
    v_mul_f32 v13, s57, v13
    v_mfma_f32_16x16x32_bf16 v[156:159], a[204:207], v[16:19], 0
    v_exp_f32 v4, v4
    v_mfma_f32_16x16x32_bf16 v[0:3], a[144:147], a[80:83], 0
    ds_read_b128 a[144:147], v58 offset:0
    v_cvt_pk_bf16_f32 v22, v4, v5
    v_mfma_f32_16x16x32_bf16 v[0:3], a[148:151], a[84:87], v[0:3]
    v_exp_f32 v8, v8
    v_mfma_f32_16x16x32_bf16 v[0:3], a[152:155], a[88:91], v[0:3]
    v_exp_f32 v9, v9
    v_mfma_f32_16x16x32_bf16 v[0:3], a[156:159], a[92:95], v[0:3]
    ds_read_b128 a[148:151], v58 offset:512
    ds_read_b128 a[152:155], v58 offset:1024
    v_smfmac_f32_16x16x64_bf16 v[36:39], v[28:31], v[16:23], v48
    v_cvt_pk_bf16_f32 v16, v8, v9
    v_mfma_f32_16x16x32_bf16 v[4:7], a[172:175], a[92:95], 0
    v_exp_f32 v10, v10
    v_mfma_f32_16x16x32_bf16 v[4:7], a[168:171], a[88:91], v[4:7]
    buffer_store_dwordx4 a[244:247], v49, s[36:39], s48 offen offset:128 nt
    v_mfma_f32_16x16x32_bf16 v[4:7], a[164:167], a[84:87], v[4:7]
    ds_read_b128 a[156:159], v58 offset:1536
    s_add_u32 s48, s48, 2048
    v_mfma_f32_16x16x32_bf16 v[4:7], a[160:163], a[80:83], v[4:7]
    ds_read_b128 a[164:167], v59 offset:512
    v_mul_f32 v12, s57, v12
    v_mfma_f32_16x16x32_bf16 v[160:163], a[176:179], v[20:23], 0
    ds_read_b128 a[172:175], v59 offset:1536
    ds_read_b128 a[160:163], v59 offset:0
    v_mfma_f32_16x16x32_bf16 v[164:167], a[180:183], v[20:23], 0
    ds_read_b128 a[168:171], v59 offset:1024
    v_mul_f32 v15, s57, v15
    v_mfma_f32_16x16x32_bf16 v[168:171], a[184:187], v[20:23], 0
    v_exp_f32 v11, v11
    v_mfma_f32_16x16x32_bf16 v[172:175], a[188:191], v[20:23], 0
    v_exp_f32 v13, v13
    v_mfma_f32_16x16x32_bf16 v[176:179], a[192:195], v[20:23], 0
    v_exp_f32 v14, v14
    v_mfma_f32_16x16x32_bf16 v[180:183], a[196:199], v[20:23], 0
    v_exp_f32 v15, v15
    v_mfma_f32_16x16x32_bf16 v[184:187], a[200:203], v[20:23], 0
    v_cvt_pk_bf16_f32 v19, v14, v15
    v_mul_f32 v0, s57, v0
    v_mfma_f32_16x16x32_bf16 v[188:191], a[204:207], v[20:23], 0
    s_waitcnt lgkmcnt(4)
    v_cvt_pk_bf16_f32 v17, v10, v11
    v_mfma_f32_16x16x32_bf16 v[8:11], a[144:147], a[0:3], 0
    v_mul_f32 v1, s57, v1
    v_mul_f32 v2, s57, v2
    v_mfma_f32_16x16x32_bf16 v[8:11], a[148:151], a[4:7], v[8:11]
    v_exp_f32 v12, v12
    v_mfma_f32_16x16x32_bf16 v[8:11], a[152:155], a[8:11], v[8:11]
    v_cvt_pk_bf16_f32 v18, v12, v13
    v_mul_f32 v6, s57, v6
    v_mfma_f32_16x16x32_bf16 v[8:11], a[156:159], a[12:15], v[8:11]
    s_waitcnt lgkmcnt(0)
    v_mul_f32 v3, s57, v3
    v_mfma_f32_16x16x32_bf16 v[12:15], a[172:175], a[12:15], 0
    v_exp_f32 v2, v2
    v_mfma_f32_16x16x32_bf16 v[12:15], a[168:171], a[8:11], v[12:15]
    v_mul_f32 v4, s57, v4
    v_mul_f32 v5, s57, v5
    v_mfma_f32_16x16x32_bf16 v[12:15], a[164:167], a[4:7], v[12:15]
    v_exp_f32 v0, v0
    v_mfma_f32_16x16x32_bf16 v[12:15], a[160:163], a[0:3], v[12:15]
    v_exp_f32 v1, v1
    v_mfma_f32_16x16x32_bf16 v[192:195], a[176:179], v[16:19], 0
    v_exp_f32 v3, v3
    v_mfma_f32_16x16x32_bf16 v[196:199], a[180:183], v[16:19], 0
    v_cvt_pk_bf16_f32 v20, v0, v1
    v_cvt_pk_bf16_f32 v21, v2, v3
    v_mfma_f32_16x16x32_bf16 v[200:203], a[184:187], v[16:19], 0
    v_exp_f32 v5, v5
    v_mfma_f32_16x16x32_bf16 v[204:207], a[188:191], v[16:19], 0
    v_exp_f32 v4, v4
    v_mfma_f32_16x16x32_bf16 v[208:211], a[192:195], v[16:19], 0
    v_cvt_pk_bf16_f32 v22, v4, v5
    v_mul_f32 v7, s57, v7
    v_mfma_f32_16x16x32_bf16 v[212:215], a[196:199], v[16:19], 0
    v_exp_f32 v6, v6
    v_mfma_f32_16x16x32_bf16 v[216:219], a[200:203], v[16:19], 0
    v_exp_f32 v7, v7
    v_mfma_f32_16x16x32_bf16 v[220:223], a[204:207], v[16:19], 0
    v_mul_f32 v8, s57, v8
    v_cvt_pk_bf16_f32 v23, v6, v7
    v_mfma_f32_16x16x32_bf16 v[0:3], a[144:147], a[16:19], 0
    s_waitcnt vmcnt(10)
    s_barrier
    v_mfma_f32_16x16x32_bf16 v[0:3], a[148:151], a[20:23], v[0:3]
    s_mov_b32 m0, s50
    v_exp_f32 v8, v8
    v_mfma_f32_16x16x32_bf16 v[0:3], a[152:155], a[24:27], v[0:3]
    buffer_load_dwordx4 v49, s[4:7], s44 offen offset:0 lds
    v_mfma_f32_16x16x32_bf16 v[0:3], a[156:159], a[28:31], v[0:3]
    v_mul_f32 v9, s57, v9
    v_mul_f32 v10, s57, v10
    v_smfmac_f32_16x16x64_bf16 v[40:43], v[28:31], v[16:23], v48
    v_exp_f32 v9, v9
    v_mfma_f32_16x16x32_bf16 v[4:7], a[172:175], a[28:31], 0
    v_cvt_pk_bf16_f32 v16, v8, v9
    v_mul_f32 v11, s57, v11
    v_mfma_f32_16x16x32_bf16 v[4:7], a[168:171], a[24:27], v[4:7]
    v_exp_f32 v10, v10
    v_mfma_f32_16x16x32_bf16 v[4:7], a[164:167], a[20:23], v[4:7]
    v_exp_f32 v11, v11
    v_mul_f32 v12, s57, v12
    v_mfma_f32_16x16x32_bf16 v[4:7], a[160:163], a[16:19], v[4:7]
    buffer_load_dwordx4 v49, s[8:11], s44 offen offset:1024 lds
    v_cvt_pk_bf16_f32 v17, v10, v11
    v_mfma_f32_16x16x32_bf16 v[224:227], a[176:179], v[20:23], 0
    v_exp_f32 v12, v12
    v_mfma_f32_16x16x32_bf16 v[228:231], a[180:183], v[20:23], 0
    v_mul_f32 v13, s57, v13
    v_mul_f32 v14, s57, v14
    v_mfma_f32_16x16x32_bf16 v[232:235], a[184:187], v[20:23], 0
    v_exp_f32 v13, v13
    v_mfma_f32_16x16x32_bf16 v[236:239], a[188:191], v[20:23], 0
    v_exp_f32 v14, v14
    v_mfma_f32_16x16x32_bf16 v[240:243], a[192:195], v[20:23], 0
    v_cvt_pk_bf16_f32 v18, v12, v13
    v_mul_f32 v15, s57, v15
    v_mfma_f32_16x16x32_bf16 v[244:247], a[196:199], v[20:23], 0
    buffer_load_dwordx4 v49, s[12:15], s44 offen offset:2048 lds
    v_mfma_f32_16x16x32_bf16 v[248:251], a[200:203], v[20:23], 0
    v_exp_f32 v15, v15
    v_mul_f32 v0, s57, v0
    v_mfma_f32_16x16x32_bf16 v[252:255], a[204:207], v[20:23], 0
    v_cvt_pk_bf16_f32 v19, v14, v15
    v_mul_f32 v1, s57, v1
    v_mfma_f32_16x16x32_bf16 v[8:11], a[144:147], a[32:35], 0
    ds_read_b64_tr_b16 a[176:177], v60 offset:34816
    v_exp_f32 v0, v0
    v_mfma_f32_16x16x32_bf16 v[8:11], a[148:151], a[36:39], v[8:11]
    v_exp_f32 v1, v1
    v_mfma_f32_16x16x32_bf16 v[8:11], a[152:155], a[40:43], v[8:11]
    ds_read_b64_tr_b16 a[178:179], v61 offset:34816
    v_cvt_pk_bf16_f32 v20, v0, v1
    v_mfma_f32_16x16x32_bf16 v[8:11], a[156:159], a[44:47], v[8:11]
    buffer_load_dwordx4 v49, s[16:19], s44 offen offset:3072 lds
    v_mul_f32 v2, s57, v2
    v_mfma_f32_16x16x32_bf16 v[12:15], a[172:175], a[44:47], 0
    s_add_u32 s44, s44, 8192
    s_mov_b32 m0, s51
    v_mfma_f32_16x16x32_bf16 v[12:15], a[168:171], a[40:43], v[12:15]
    v_exp_f32 v2, v2
    v_mul_f32 v3, s57, v3
    v_mfma_f32_16x16x32_bf16 v[12:15], a[164:167], a[36:39], v[12:15]
    v_exp_f32 v3, v3
    v_mfma_f32_16x16x32_bf16 v[12:15], a[160:163], a[32:35], v[12:15]
    v_mul_f32 v4, s57, v4
    v_cvt_pk_bf16_f32 v21, v2, v3
    v_mfma_f32_16x16x32_bf16 v[64:67], a[208:211], v[16:19], v[64:67]
    v_exp_f32 v4, v4
    v_mfma_f32_16x16x32_bf16 v[68:71], a[212:215], v[16:19], v[68:71]
    buffer_load_dwordx4 v49, s[4:7], s44 offen offset:0 lds
    v_mul_f32 v5, s57, v5
    v_mfma_f32_16x16x32_bf16 v[72:75], a[216:219], v[16:19], v[72:75]
    v_exp_f32 v5, v5
    v_mfma_f32_16x16x32_bf16 v[76:79], a[220:223], v[16:19], v[76:79]
    ds_read_b64_tr_b16 a[182:183], v61 offset:34824
    v_mul_f32 v6, s57, v6
    v_cvt_pk_bf16_f32 v22, v4, v5
    v_mfma_f32_16x16x32_bf16 v[80:83], a[224:227], v[16:19], v[80:83]
    ds_read_b64_tr_b16 a[180:181], v60 offset:34824
    ds_read_b64_tr_b16 a[184:185], v60 offset:35328
    v_mfma_f32_16x16x32_bf16 v[84:87], a[228:231], v[16:19], v[84:87]
    v_exp_f32 v6, v6
    v_mul_f32 v7, s57, v7
    v_mfma_f32_16x16x32_bf16 v[88:91], a[232:235], v[16:19], v[88:91]
    v_exp_f32 v7, v7
    v_mul_f32 v8, s57, v8
    v_mfma_f32_16x16x32_bf16 v[92:95], a[236:239], v[16:19], v[92:95]
    buffer_load_dwordx4 v49, s[8:11], s44 offen offset:1024 lds
    v_cvt_pk_bf16_f32 v23, v6, v7
    v_mfma_f32_16x16x32_bf16 v[0:3], a[144:147], a[48:51], 0
    v_exp_f32 v8, v8
    v_mfma_f32_16x16x32_bf16 v[0:3], a[148:151], a[52:55], v[0:3]
    ds_read_b64_tr_b16 a[186:187], v61 offset:35328
    v_mul_f32 v9, s57, v9
    v_mfma_f32_16x16x32_bf16 v[0:3], a[152:155], a[56:59], v[0:3]
    v_exp_f32 v9, v9
    v_mul_f32 v10, s57, v10
    v_mfma_f32_16x16x32_bf16 v[0:3], a[156:159], a[60:63], v[0:3]
    ds_read_b64_tr_b16 a[188:189], v60 offset:35336
    v_mul_f32 v11, s57, v11
    v_smfmac_f32_16x16x64_bf16 v[32:35], v[28:31], v[16:23], v48
    v_cvt_pk_bf16_f32 v16, v8, v9
    v_exp_f32 v10, v10
    v_mfma_f32_16x16x32_bf16 v[4:7], a[172:175], a[60:63], 0
    buffer_load_dwordx4 v49, s[12:15], s44 offen offset:2048 lds
    v_mfma_f32_16x16x32_bf16 v[4:7], a[168:171], a[56:59], v[4:7]
    v_exp_f32 v11, v11
    v_mfma_f32_16x16x32_bf16 v[4:7], a[164:167], a[52:55], v[4:7]
    v_mul_f32 v12, s57, v12
    v_cvt_pk_bf16_f32 v17, v10, v11
    v_mfma_f32_16x16x32_bf16 v[4:7], a[160:163], a[48:51], v[4:7]
    ds_read_b64_tr_b16 a[192:193], v60 offset:35840
    v_exp_f32 v12, v12
    v_mfma_f32_16x16x32_bf16 v[96:99], a[208:211], v[20:23], v[96:99]
    v_mul_f32 v13, s57, v13
    v_mul_f32 v14, s57, v14
    v_mfma_f32_16x16x32_bf16 v[100:103], a[212:215], v[20:23], v[100:103]
    v_exp_f32 v13, v13
    v_mfma_f32_16x16x32_bf16 v[104:107], a[216:219], v[20:23], v[104:107]
    buffer_load_dwordx4 v49, s[16:19], s44 offen offset:3072 lds
    v_cvt_pk_bf16_f32 v18, v12, v13
    v_mfma_f32_16x16x32_bf16 v[108:111], a[220:223], v[20:23], v[108:111]
    v_exp_f32 v14, v14
    v_mfma_f32_16x16x32_bf16 v[112:115], a[224:227], v[20:23], v[112:115]
    s_add_u32 s44, s44, 8192
    v_mul_f32 v15, s57, v15
    v_mfma_f32_16x16x32_bf16 v[116:119], a[228:231], v[20:23], v[116:119]
    v_exp_f32 v15, v15
    v_mfma_f32_16x16x32_bf16 v[120:123], a[232:235], v[20:23], v[120:123]
    v_cvt_pk_bf16_f32 v19, v14, v15
    v_mul_f32 v0, s57, v0
    v_mfma_f32_16x16x32_bf16 v[124:127], a[236:239], v[20:23], v[124:127]
    ds_read_b64_tr_b16 a[190:191], v61 offset:35336
    ds_read_b64_tr_b16 a[196:197], v60 offset:35848
    v_mfma_f32_16x16x32_bf16 v[8:11], a[144:147], a[64:67], 0
    v_exp_f32 v0, v0
    v_mfma_f32_16x16x32_bf16 v[8:11], a[148:151], a[68:71], v[8:11]
    ds_read_b64_tr_b16 a[194:195], v61 offset:35840
    v_mul_f32 v1, s57, v1
    v_mfma_f32_16x16x32_bf16 v[8:11], a[152:155], a[72:75], v[8:11]
    v_exp_f32 v1, v1
    v_mfma_f32_16x16x32_bf16 v[8:11], a[156:159], a[76:79], v[8:11]
    ds_read_b64_tr_b16 a[198:199], v61 offset:35848
    v_mul_f32 v2, s57, v2
    v_mfma_f32_16x16x32_bf16 v[12:15], a[172:175], a[76:79], 0
    v_cvt_pk_bf16_f32 v20, v0, v1
    v_exp_f32 v2, v2
    v_mfma_f32_16x16x32_bf16 v[12:15], a[168:171], a[72:75], v[12:15]
    ds_read_b64_tr_b16 a[200:201], v60 offset:36352
    v_mul_f32 v3, s57, v3
    v_mfma_f32_16x16x32_bf16 v[12:15], a[164:167], a[68:71], v[12:15]
    v_exp_f32 v3, v3
    v_mfma_f32_16x16x32_bf16 v[12:15], a[160:163], a[64:67], v[12:15]
    v_mul_f32 v4, s57, v4
    v_cvt_pk_bf16_f32 v21, v2, v3
    v_mfma_f32_16x16x32_bf16 v[128:131], a[208:211], v[16:19], v[128:131]
    v_exp_f32 v4, v4
    v_mfma_f32_16x16x32_bf16 v[132:135], a[212:215], v[16:19], v[132:135]
    ds_read_b64_tr_b16 a[202:203], v61 offset:36352
    v_mul_f32 v5, s57, v5
    v_mfma_f32_16x16x32_bf16 v[136:139], a[216:219], v[16:19], v[136:139]
    v_exp_f32 v5, v5
    v_mfma_f32_16x16x32_bf16 v[140:143], a[220:223], v[16:19], v[140:143]
    v_mul_f32 v6, s57, v6
    v_cvt_pk_bf16_f32 v22, v4, v5
    v_mfma_f32_16x16x32_bf16 v[144:147], a[224:227], v[16:19], v[144:147]
    v_exp_f32 v6, v6
    v_mul_f32 v7, s57, v7
    v_mfma_f32_16x16x32_bf16 v[148:151], a[228:231], v[16:19], v[148:151]
    v_exp_f32 v7, v7
    v_mfma_f32_16x16x32_bf16 v[152:155], a[232:235], v[16:19], v[152:155]
    ds_read_b64_tr_b16 a[206:207], v61 offset:36360
    v_mul_f32 v8, s57, v8
    v_mfma_f32_16x16x32_bf16 v[156:159], a[236:239], v[16:19], v[156:159]
    v_exp_f32 v8, v8
    v_mfma_f32_16x16x32_bf16 v[0:3], a[144:147], a[80:83], 0
    ds_read_b128 a[144:147], v56 offset:32768
    v_cvt_pk_bf16_f32 v23, v6, v7
    v_mfma_f32_16x16x32_bf16 v[0:3], a[148:151], a[84:87], v[0:3]
    ds_read_b64_tr_b16 a[204:205], v60 offset:36360
    v_mul_f32 v9, s57, v9
    v_mfma_f32_16x16x32_bf16 v[0:3], a[152:155], a[88:91], v[0:3]
    ds_read_b128 a[148:151], v56 offset:33280
    v_exp_f32 v9, v9
    v_mfma_f32_16x16x32_bf16 v[0:3], a[156:159], a[92:95], v[0:3]
    ds_read_b128 a[156:159], v56 offset:34304
    v_mul_f32 v10, s57, v10
    v_smfmac_f32_16x16x64_bf16 v[36:39], v[28:31], v[16:23], v48
    v_cvt_pk_bf16_f32 v16, v8, v9
    v_mfma_f32_16x16x32_bf16 v[4:7], a[172:175], a[92:95], 0
    v_exp_f32 v10, v10
    v_mfma_f32_16x16x32_bf16 v[4:7], a[168:171], a[88:91], v[4:7]
    ds_read_b128 a[152:155], v56 offset:33792
    v_mul_f32 v11, s57, v11
    v_mfma_f32_16x16x32_bf16 v[4:7], a[164:167], a[84:87], v[4:7]
    v_exp_f32 v11, v11
    v_mfma_f32_16x16x32_bf16 v[4:7], a[160:163], a[80:83], v[4:7]
    ds_read_b128 a[164:167], v57 offset:33280
    v_mul_f32 v12, s57, v12
    v_mfma_f32_16x16x32_bf16 v[160:163], a[208:211], v[20:23], v[160:163]
    v_cvt_pk_bf16_f32 v17, v10, v11
    v_mul_f32 v13, s57, v13
    v_mfma_f32_16x16x32_bf16 v[164:167], a[212:215], v[20:23], v[164:167]
    ds_read_b128 a[172:175], v57 offset:34304
    ds_read_b128 a[160:163], v57 offset:32768
    v_mfma_f32_16x16x32_bf16 v[168:171], a[216:219], v[20:23], v[168:171]
    ds_read_b128 a[168:171], v57 offset:33792
    v_mul_f32 v14, s57, v14
    v_mfma_f32_16x16x32_bf16 v[172:175], a[220:223], v[20:23], v[172:175]
    v_exp_f32 v13, v13
    v_mfma_f32_16x16x32_bf16 v[176:179], a[224:227], v[20:23], v[176:179]
    v_exp_f32 v12, v12
    v_mfma_f32_16x16x32_bf16 v[180:183], a[228:231], v[20:23], v[180:183]
    v_cvt_pk_bf16_f32 v18, v12, v13
    v_mul_f32 v15, s57, v15
    v_mfma_f32_16x16x32_bf16 v[184:187], a[232:235], v[20:23], v[184:187]
    v_mul_f32 v0, s57, v0
    v_mul_f32 v1, s57, v1
    v_mfma_f32_16x16x32_bf16 v[188:191], a[236:239], v[20:23], v[188:191]
    s_waitcnt lgkmcnt(4)
    v_mul_f32 v2, s57, v2
    v_mfma_f32_16x16x32_bf16 v[8:11], a[144:147], a[0:3], 0
    v_exp_f32 v15, v15
    v_mfma_f32_16x16x32_bf16 v[8:11], a[148:151], a[4:7], v[8:11]
    v_exp_f32 v0, v0
    v_mfma_f32_16x16x32_bf16 v[8:11], a[152:155], a[8:11], v[8:11]
    v_exp_f32 v14, v14
    v_mfma_f32_16x16x32_bf16 v[8:11], a[156:159], a[12:15], v[8:11]
    s_waitcnt lgkmcnt(0)
    v_cvt_pk_bf16_f32 v19, v14, v15
    v_mfma_f32_16x16x32_bf16 v[12:15], a[172:175], a[12:15], 0
    v_exp_f32 v1, v1
    v_mfma_f32_16x16x32_bf16 v[12:15], a[168:171], a[8:11], v[12:15]
    v_cvt_pk_bf16_f32 v20, v0, v1
    v_mul_f32 v3, s57, v3
    v_mfma_f32_16x16x32_bf16 v[12:15], a[164:167], a[4:7], v[12:15]
    v_exp_f32 v3, v3
    v_mfma_f32_16x16x32_bf16 v[12:15], a[160:163], a[0:3], v[12:15]
    v_mul_f32 v4, s57, v4
    v_mul_f32 v6, s57, v6
    v_mfma_f32_16x16x32_bf16 v[192:195], a[208:211], v[16:19], v[192:195]
    v_exp_f32 v2, v2
    v_mfma_f32_16x16x32_bf16 v[196:199], a[212:215], v[16:19], v[196:199]
    v_cvt_pk_bf16_f32 v21, v2, v3
    v_mul_f32 v5, s57, v5
    v_mfma_f32_16x16x32_bf16 v[200:203], a[216:219], v[16:19], v[200:203]
    v_exp_f32 v5, v5
    v_mfma_f32_16x16x32_bf16 v[204:207], a[220:223], v[16:19], v[204:207]
    v_mul_f32 v7, s57, v7
    v_mul_f32 v8, s57, v8
    v_mfma_f32_16x16x32_bf16 v[208:211], a[224:227], v[16:19], v[208:211]
    v_exp_f32 v6, v6
    v_mfma_f32_16x16x32_bf16 v[212:215], a[228:231], v[16:19], v[212:215]
    v_exp_f32 v4, v4
    v_mfma_f32_16x16x32_bf16 v[216:219], a[232:235], v[16:19], v[216:219]
    v_exp_f32 v7, v7
    v_mfma_f32_16x16x32_bf16 v[220:223], a[236:239], v[16:19], v[220:223]
    v_cvt_pk_bf16_f32 v22, v4, v5
    v_cvt_pk_bf16_f32 v23, v6, v7
L_B_loop:
    v_mfma_f32_16x16x32_bf16 v[0:3], a[144:147], a[16:19], 0
    s_mov_b32 m0, s49
    v_exp_f32 v8, v8
    v_mfma_f32_16x16x32_bf16 v[0:3], a[148:151], a[20:23], v[0:3]
    buffer_load_dwordx4 v49, s[20:23], s46 offen offset:0 nt lds
    v_mfma_f32_16x16x32_bf16 v[0:3], a[152:155], a[24:27], v[0:3]
    v_mul_f32 v9, s57, v9
    v_mul_f32 v10, s57, v10
    v_mfma_f32_16x16x32_bf16 v[0:3], a[156:159], a[28:31], v[0:3]
    v_exp_f32 v9, v9
    v_smfmac_f32_16x16x64_bf16 v[40:43], v[28:31], v[16:23], v48
    v_cvt_pk_bf16_f32 v16, v8, v9
    v_mfma_f32_16x16x32_bf16 v[4:7], a[172:175], a[28:31], 0
    v_exp_f32 v10, v10
    v_mul_f32 v11, s57, v11
    v_mfma_f32_16x16x32_bf16 v[4:7], a[168:171], a[24:27], v[4:7]
    buffer_load_dwordx4 v49, s[24:27], s46 offen offset:1024 nt lds
    v_mul_f32 v12, s57, v12
    v_mfma_f32_16x16x32_bf16 v[4:7], a[164:167], a[20:23], v[4:7]
    v_exp_f32 v11, v11
    v_mfma_f32_16x16x32_bf16 v[4:7], a[160:163], a[16:19], v[4:7]
    v_cvt_pk_bf16_f32 v17, v10, v11
    v_mul_f32 v13, s57, v13
    v_mfma_f32_16x16x32_bf16 v[224:227], a[208:211], v[20:23], v[224:227]
    v_exp_f32 v12, v12
    v_mfma_f32_16x16x32_bf16 v[228:231], a[212:215], v[20:23], v[228:231]
    v_exp_f32 v13, v13
    v_mul_f32 v14, s57, v14
    v_mfma_f32_16x16x32_bf16 v[232:235], a[216:219], v[20:23], v[232:235]
    v_exp_f32 v14, v14
    v_mfma_f32_16x16x32_bf16 v[236:239], a[220:223], v[20:23], v[236:239]
    buffer_load_dwordx4 v49, s[20:23], s46 offen offset:2048 nt lds
    v_mfma_f32_16x16x32_bf16 v[240:243], a[224:227], v[20:23], v[240:243]
    v_cvt_pk_bf16_f32 v18, v12, v13
    v_mul_f32 v15, s57, v15
    v_mfma_f32_16x16x32_bf16 v[244:247], a[228:231], v[20:23], v[244:247]
    v_exp_f32 v15, v15
    v_mfma_f32_16x16x32_bf16 v[248:251], a[232:235], v[20:23], v[248:251]
    v_cvt_pk_bf16_f32 v19, v14, v15
    v_mul_f32 v0, s57, v0
    v_mfma_f32_16x16x32_bf16 v[252:255], a[236:239], v[20:23], v[252:255]
    v_exp_f32 v0, v0
    v_mul_f32 v1, s57, v1
    v_mfma_f32_16x16x32_bf16 v[8:11], a[144:147], a[96:99], 0
    v_exp_f32 v1, v1
    v_mfma_f32_16x16x32_bf16 v[8:11], a[148:151], a[100:103], v[8:11]
    buffer_load_dwordx4 v49, s[24:27], s46 offen offset:3072 nt lds
    v_mfma_f32_16x16x32_bf16 v[8:11], a[152:155], a[104:107], v[8:11]
    s_add_u32 s46, s46, 4096
    s_add_u32 m0, s49, 4096
    v_mul_f32 v2, s57, v2
    v_mfma_f32_16x16x32_bf16 v[8:11], a[156:159], a[108:111], v[8:11]
    v_cvt_pk_bf16_f32 v20, v0, v1
    v_mul_f32 v3, s57, v3
    v_mfma_f32_16x16x32_bf16 v[64:67], a[176:179], v[16:19], v[64:67]
    v_exp_f32 v2, v2
    v_mfma_f32_16x16x32_bf16 v[68:71], a[180:183], v[16:19], v[68:71]
    v_exp_f32 v3, v3
    v_mul_f32 v4, s57, v4
    v_mfma_f32_16x16x32_bf16 v[72:75], a[184:187], v[16:19], v[72:75]
    v_cvt_pk_bf16_f32 v21, v2, v3
    v_mul_f32 v5, s57, v5
    v_mfma_f32_16x16x32_bf16 v[76:79], a[188:191], v[16:19], v[76:79]
    buffer_load_dwordx4 v49, s[20:23], s46 offen offset:0 nt lds
    v_mfma_f32_16x16x32_bf16 v[80:83], a[192:195], v[16:19], v[80:83]
    v_exp_f32 v5, v5
    v_mul_f32 v6, s57, v6
    v_mfma_f32_16x16x32_bf16 v[84:87], a[196:199], v[16:19], v[84:87]
    v_mul_f32 v7, s57, v7
    v_mul_f32 v8, s57, v8
    v_mfma_f32_16x16x32_bf16 v[88:91], a[200:203], v[16:19], v[88:91]
    v_exp_f32 v6, v6
    v_mfma_f32_16x16x32_bf16 v[92:95], a[204:207], v[16:19], v[92:95]
    v_exp_f32 v4, v4
    v_mfma_f32_16x16x32_bf16 v[0:3], a[144:147], a[32:35], 0
    v_exp_f32 v7, v7
    v_mfma_f32_16x16x32_bf16 v[0:3], a[148:151], a[36:39], v[0:3]
    v_cvt_pk_bf16_f32 v22, v4, v5
    v_cvt_pk_bf16_f32 v23, v6, v7
    v_mfma_f32_16x16x32_bf16 v[0:3], a[152:155], a[40:43], v[0:3]
    ds_read_b64_tr_b16 a[210:211], v63 offset:34816
    v_mul_f32 v9, s57, v9
    v_mfma_f32_16x16x32_bf16 v[0:3], a[156:159], a[44:47], v[0:3]
    buffer_load_dwordx4 v49, s[24:27], s46 offen offset:1024 nt lds
    v_smfmac_f32_16x16x64_bf16 v[32:35], v[28:31], v[16:23], v48
    s_add_u32 s46, s46, 2048
    v_mfma_f32_16x16x32_bf16 v[4:7], a[172:175], a[44:47], 0
    v_exp_f32 v8, v8
    v_mfma_f32_16x16x32_bf16 v[4:7], a[168:171], a[40:43], v[4:7]
    ds_read_b64_tr_b16 a[208:209], v62 offset:34816
    s_add_u32 s49, s49, 6144
    v_mfma_f32_16x16x32_bf16 v[4:7], a[164:167], a[36:39], v[4:7]
    v_exp_f32 v9, v9
    v_mfma_f32_16x16x32_bf16 v[4:7], a[160:163], a[32:35], v[4:7]
    v_cvt_pk_bf16_f32 v24, v8, v9
    v_mul_f32 v10, s57, v10
    v_mfma_f32_16x16x32_bf16 v[96:99], a[176:179], v[20:23], v[96:99]
    ds_read_b64_tr_b16 a[216:217], v62 offset:35328
    ds_read_b128 a[244:247], v51 offset:7168
    v_mfma_f32_16x16x32_bf16 v[100:103], a[180:183], v[20:23], v[100:103]
    ds_read_b64_tr_b16 a[214:215], v63 offset:34824
    ds_read_b128 a[240:243], v51 offset:6144
    v_mfma_f32_16x16x32_bf16 v[104:107], a[184:187], v[20:23], v[104:107]
    ds_read_b64_tr_b16 a[220:221], v62 offset:35336
    v_mul_f32 v11, s57, v11
    v_mfma_f32_16x16x32_bf16 v[108:111], a[188:191], v[20:23], v[108:111]
    v_exp_f32 v11, v11
    v_mfma_f32_16x16x32_bf16 v[112:115], a[192:195], v[20:23], v[112:115]
    v_exp_f32 v10, v10
    v_mfma_f32_16x16x32_bf16 v[116:119], a[196:199], v[20:23], v[116:119]
    ds_read_b64_tr_b16 a[218:219], v63 offset:35328
    v_cvt_pk_bf16_f32 v25, v10, v11
    v_mfma_f32_16x16x32_bf16 v[120:123], a[200:203], v[20:23], v[120:123]
    ds_read_b64_tr_b16 a[222:223], v63 offset:35336
    v_mul_f32 v0, s57, v0
    v_mfma_f32_16x16x32_bf16 v[124:127], a[204:207], v[20:23], v[124:127]
    ds_read_b64_tr_b16 a[212:213], v62 offset:34824
    ds_read_b64_tr_b16 a[236:237], v62 offset:36360
    v_mfma_f32_16x16x32_bf16 v[8:11], a[144:147], a[48:51], 0
    v_exp_f32 v0, v0
    v_mfma_f32_16x16x32_bf16 v[8:11], a[148:151], a[52:55], v[8:11]
    v_mul_f32 v1, s57, v1
    v_mfma_f32_16x16x32_bf16 v[8:11], a[152:155], a[56:59], v[8:11]
    v_exp_f32 v1, v1
    v_mfma_f32_16x16x32_bf16 v[8:11], a[156:159], a[60:63], v[8:11]
    v_mul_f32 v2, s57, v2
    v_cvt_pk_bf16_f32 v16, v0, v1
    v_smfmac_f32_16x16x64_bf16 v[44:47], v[28:31], v[20:27], v48
    v_mul_f32 v3, s57, v3
    v_mfma_f32_16x16x32_bf16 v[12:15], a[172:175], a[60:63], 0
    v_exp_f32 v2, v2
    v_mfma_f32_16x16x32_bf16 v[12:15], a[168:171], a[56:59], v[12:15]
    v_exp_f32 v3, v3
    v_mfma_f32_16x16x32_bf16 v[12:15], a[164:167], a[52:55], v[12:15]
    v_mul_f32 v4, s57, v4
    v_cvt_pk_bf16_f32 v17, v2, v3
    v_mfma_f32_16x16x32_bf16 v[12:15], a[160:163], a[48:51], v[12:15]
    v_exp_f32 v4, v4
    v_mfma_f32_16x16x16_bf16 a[112:115], a[176:177], v[24:25], a[112:115]
    ds_read_b64_tr_b16 a[224:225], v62 offset:35840
    ds_read_b64_tr_b16 a[228:229], v62 offset:35848
    v_mul_f32 v5, s57, v5
    v_mfma_f32_16x16x16_bf16 a[116:119], a[180:181], v[24:25], a[116:119]
    v_exp_f32 v5, v5
    v_mfma_f32_16x16x16_bf16 a[120:123], a[184:185], v[24:25], a[120:123]
    v_mul_f32 v6, s57, v6
    v_cvt_pk_bf16_f32 v18, v4, v5
    v_mfma_f32_16x16x16_bf16 a[124:127], a[188:189], v[24:25], a[124:127]
    ds_read_b64_tr_b16 a[230:231], v63 offset:35848
    v_exp_f32 v6, v6
    v_mfma_f32_16x16x16_bf16 a[128:131], a[192:193], v[24:25], a[128:131]
    ds_read_b64_tr_b16 a[226:227], v63 offset:35840
    v_mul_f32 v7, s57, v7
    v_mfma_f32_16x16x16_bf16 a[132:135], a[196:197], v[24:25], a[132:135]
    v_exp_f32 v7, v7
    v_mfma_f32_16x16x16_bf16 a[136:139], a[200:201], v[24:25], a[136:139]
    ds_read_b64_tr_b16 a[232:233], v62 offset:36352
    v_cvt_pk_bf16_f32 v19, v6, v7
    v_mul_f32 v8, s57, v8
    v_mfma_f32_16x16x16_bf16 a[140:143], a[204:205], v[24:25], a[140:143]
    v_exp_f32 v8, v8
    v_mfma_f32_16x16x32_bf16 v[0:3], a[144:147], a[64:67], 0
    ds_read_b64_tr_b16 a[234:235], v63 offset:36352
    v_mul_f32 v9, s57, v9
    v_mfma_f32_16x16x32_bf16 v[0:3], a[148:151], a[68:71], v[0:3]
    v_exp_f32 v9, v9
    v_mfma_f32_16x16x32_bf16 v[0:3], a[152:155], a[72:75], v[0:3]
    v_mul_f32 v10, s57, v10
    v_mul_f32 v11, s57, v11
    v_mfma_f32_16x16x32_bf16 v[0:3], a[156:159], a[76:79], v[0:3]
    v_cvt_pk_bf16_f32 v20, v8, v9
    v_mul_f32 v12, s57, v12
    v_mfma_f32_16x16x32_bf16 v[4:7], a[172:175], a[76:79], 0
    v_exp_f32 v10, v10
    v_mfma_f32_16x16x32_bf16 v[4:7], a[168:171], a[72:75], v[4:7]
    ds_read_b64_tr_b16 a[238:239], v63 offset:36360
    v_mul_f32 v14, s57, v14
    v_mfma_f32_16x16x32_bf16 v[4:7], a[164:167], a[68:71], v[4:7]
    v_exp_f32 v11, v11
    v_mfma_f32_16x16x32_bf16 v[4:7], a[160:163], a[64:67], v[4:7]
    v_cvt_pk_bf16_f32 v21, v10, v11
    v_mul_f32 v13, s57, v13
    v_mfma_f32_16x16x32_bf16 v[128:131], a[176:179], v[16:19], v[128:131]
    v_exp_f32 v12, v12
    v_mfma_f32_16x16x32_bf16 v[132:135], a[180:183], v[16:19], v[132:135]
    v_exp_f32 v13, v13
    v_mfma_f32_16x16x32_bf16 v[136:139], a[184:187], v[16:19], v[136:139]
    v_cvt_pk_bf16_f32 v22, v12, v13
    v_mul_f32 v15, s57, v15
    v_mfma_f32_16x16x32_bf16 v[140:143], a[188:191], v[16:19], v[140:143]
    v_exp_f32 v14, v14
    v_mfma_f32_16x16x32_bf16 v[144:147], a[192:195], v[16:19], v[144:147]
    v_exp_f32 v15, v15
    v_mfma_f32_16x16x32_bf16 v[148:151], a[196:199], v[16:19], v[148:151]
    v_mul_f32 v0, s57, v0
    v_cvt_pk_bf16_f32 v23, v14, v15
    v_mfma_f32_16x16x32_bf16 v[152:155], a[200:203], v[16:19], v[152:155]
    v_exp_f32 v0, v0
    v_mfma_f32_16x16x32_bf16 v[156:159], a[204:207], v[16:19], v[156:159]
    v_mul_f32 v1, s57, v1
    v_mul_f32 v2, s57, v2
    v_mfma_f32_16x16x32_bf16 v[8:11], a[144:147], a[80:83], 0
    v_exp_f32 v2, v2
    v_mfma_f32_16x16x32_bf16 v[8:11], a[148:151], a[84:87], v[8:11]
    v_exp_f32 v1, v1
    v_mfma_f32_16x16x32_bf16 v[8:11], a[152:155], a[88:91], v[8:11]
    ds_read_b128 a[148:151], v58 offset:33280
    v_mul_f32 v3, s57, v3
    v_mfma_f32_16x16x32_bf16 v[8:11], a[156:159], a[92:95], v[8:11]
    v_exp_f32 v3, v3
    v_smfmac_f32_16x16x64_bf16 v[36:39], v[28:31], v[16:23], v48
    v_cvt_pk_bf16_f32 v16, v0, v1
    v_mfma_f32_16x16x32_bf16 v[12:15], a[172:175], a[92:95], 0
    ds_read_b128 a[144:147], v58 offset:32768
    ds_read_b128 a[152:155], v58 offset:33792
    v_mfma_f32_16x16x32_bf16 v[12:15], a[168:171], a[88:91], v[12:15]
    ds_read_b128 a[156:159], v58 offset:34304
    ds_read_b128 a[172:175], v59 offset:34304
    v_mfma_f32_16x16x32_bf16 v[12:15], a[164:167], a[84:87], v[12:15]
    v_mul_f32 v4, s57, v4
    v_cvt_pk_bf16_f32 v17, v2, v3
    v_mfma_f32_16x16x32_bf16 v[12:15], a[160:163], a[80:83], v[12:15]
    v_exp_f32 v4, v4
    v_mfma_f32_16x16x32_bf16 v[160:163], a[176:179], v[20:23], v[160:163]
    ds_read_b128 a[168:171], v59 offset:33792
    v_mul_f32 v5, s57, v5
    v_mfma_f32_16x16x32_bf16 v[164:167], a[180:183], v[20:23], v[164:167]
    ds_read_b128 a[164:167], v59 offset:33280
    ds_read_b128 a[160:163], v59 offset:32768
    v_mfma_f32_16x16x32_bf16 v[168:171], a[184:187], v[20:23], v[168:171]
    v_mul_f32 v6, s57, v6
    v_mul_f32 v7, s57, v7
    v_mfma_f32_16x16x32_bf16 v[172:175], a[188:191], v[20:23], v[172:175]
    v_exp_f32 v5, v5
    v_mfma_f32_16x16x32_bf16 v[176:179], a[192:195], v[20:23], v[176:179]
    v_exp_f32 v6, v6
    v_mfma_f32_16x16x32_bf16 v[180:183], a[196:199], v[20:23], v[180:183]
    v_exp_f32 v7, v7
    v_mfma_f32_16x16x32_bf16 v[184:187], a[200:203], v[20:23], v[184:187]
    v_cvt_pk_bf16_f32 v19, v6, v7
    v_mul_f32 v8, s57, v8
    v_mfma_f32_16x16x32_bf16 v[188:191], a[204:207], v[20:23], v[188:191]
    s_waitcnt lgkmcnt(4)
    v_cvt_pk_bf16_f32 v18, v4, v5
    v_mfma_f32_16x16x32_bf16 v[0:3], a[144:147], a[0:3], 0
    v_exp_f32 v8, v8
    v_mfma_f32_16x16x32_bf16 v[0:3], a[148:151], a[4:7], v[0:3]
    v_mul_f32 v9, s57, v9
    v_mul_f32 v10, s57, v10
    v_mfma_f32_16x16x32_bf16 v[0:3], a[152:155], a[8:11], v[0:3]
    v_exp_f32 v9, v9
    v_mfma_f32_16x16x32_bf16 v[0:3], a[156:159], a[12:15], v[0:3]
    s_waitcnt lgkmcnt(0)
    v_cvt_pk_bf16_f32 v20, v8, v9
    v_mfma_f32_16x16x32_bf16 v[4:7], a[172:175], a[12:15], 0
    v_exp_f32 v10, v10
    v_mfma_f32_16x16x32_bf16 v[4:7], a[168:171], a[8:11], v[4:7]
    v_mul_f32 v11, s57, v11
    v_mfma_f32_16x16x32_bf16 v[4:7], a[164:167], a[4:7], v[4:7]
    v_exp_f32 v11, v11
    v_mfma_f32_16x16x32_bf16 v[4:7], a[160:163], a[0:3], v[4:7]
    v_mul_f32 v12, s57, v12
    v_cvt_pk_bf16_f32 v21, v10, v11
    v_mfma_f32_16x16x32_bf16 v[192:195], a[176:179], v[16:19], v[192:195]
    v_exp_f32 v12, v12
    v_mfma_f32_16x16x32_bf16 v[196:199], a[180:183], v[16:19], v[196:199]
    v_mul_f32 v13, s57, v13
    v_mfma_f32_16x16x32_bf16 v[200:203], a[184:187], v[16:19], v[200:203]
    v_exp_f32 v13, v13
    v_mfma_f32_16x16x32_bf16 v[204:207], a[188:191], v[16:19], v[204:207]
    v_mul_f32 v14, s57, v14
    v_cvt_pk_bf16_f32 v22, v12, v13
    v_mfma_f32_16x16x32_bf16 v[208:211], a[192:195], v[16:19], v[208:211]
    v_exp_f32 v14, v14
    v_mfma_f32_16x16x32_bf16 v[212:215], a[196:199], v[16:19], v[212:215]
    v_mul_f32 v15, s57, v15
    v_mul_f32 v0, s57, v0
    v_mfma_f32_16x16x32_bf16 v[216:219], a[200:203], v[16:19], v[216:219]
    v_exp_f32 v15, v15
    v_mfma_f32_16x16x32_bf16 v[220:223], a[204:207], v[16:19], v[220:223]
    v_cvt_pk_bf16_f32 v23, v14, v15
    v_mfma_f32_16x16x32_bf16 v[8:11], a[144:147], a[16:19], 0
    s_waitcnt vmcnt(6)
    v_exp_f32 v0, v0
    v_mfma_f32_16x16x32_bf16 v[8:11], a[148:151], a[20:23], v[8:11]
    s_barrier
    s_mov_b32 m0, s52
    v_mul_f32 v1, s57, v1
    v_mfma_f32_16x16x32_bf16 v[8:11], a[152:155], a[24:27], v[8:11]
    buffer_load_dwordx4 v49, s[4:7], s44 offen offset:0 lds
    v_mfma_f32_16x16x32_bf16 v[8:11], a[156:159], a[28:31], v[8:11]
    v_exp_f32 v1, v1
    v_mul_f32 v2, s57, v2
    v_smfmac_f32_16x16x64_bf16 v[40:43], v[28:31], v[16:23], v48
    v_exp_f32 v2, v2
    v_mfma_f32_16x16x32_bf16 v[12:15], a[172:175], a[28:31], 0
    v_cvt_pk_bf16_f32 v16, v0, v1
    v_mul_f32 v3, s57, v3
    v_mfma_f32_16x16x32_bf16 v[12:15], a[168:171], a[24:27], v[12:15]
    v_exp_f32 v3, v3
    v_mfma_f32_16x16x32_bf16 v[12:15], a[164:167], a[20:23], v[12:15]
    v_mul_f32 v4, s57, v4
    v_cvt_pk_bf16_f32 v17, v2, v3
    v_mfma_f32_16x16x32_bf16 v[12:15], a[160:163], a[16:19], v[12:15]
    buffer_load_dwordx4 v49, s[8:11], s44 offen offset:1024 lds
    v_mfma_f32_16x16x32_bf16 v[224:227], a[176:179], v[20:23], v[224:227]
    v_exp_f32 v4, v4
    v_mul_f32 v5, s57, v5
    v_mfma_f32_16x16x32_bf16 v[228:231], a[180:183], v[20:23], v[228:231]
    v_exp_f32 v5, v5
    v_mul_f32 v7, s57, v7
    v_mfma_f32_16x16x32_bf16 v[232:235], a[184:187], v[20:23], v[232:235]
    v_mul_f32 v6, s57, v6
    v_cvt_pk_bf16_f32 v18, v4, v5
    v_mfma_f32_16x16x32_bf16 v[236:239], a[188:191], v[20:23], v[236:239]
    v_exp_f32 v6, v6
    v_mfma_f32_16x16x32_bf16 v[240:243], a[192:195], v[20:23], v[240:243]
    v_exp_f32 v7, v7
    v_mfma_f32_16x16x32_bf16 v[244:247], a[196:199], v[20:23], v[244:247]
    buffer_load_dwordx4 v49, s[12:15], s44 offen offset:2048 lds
    v_mfma_f32_16x16x32_bf16 v[248:251], a[200:203], v[20:23], v[248:251]
    v_cvt_pk_bf16_f32 v19, v6, v7
    v_mul_f32 v8, s57, v8
    v_mfma_f32_16x16x32_bf16 v[252:255], a[204:207], v[20:23], v[252:255]
    ds_read_b64_tr_b16 a[176:177], v60 offset:2048
    v_mul_f32 v9, s57, v9
    v_mfma_f32_16x16x32_bf16 v[0:3], a[144:147], a[32:35], 0
    v_exp_f32 v8, v8
    v_mfma_f32_16x16x32_bf16 v[0:3], a[148:151], a[36:39], v[0:3]
    v_exp_f32 v9, v9
    v_mfma_f32_16x16x32_bf16 v[0:3], a[152:155], a[40:43], v[0:3]
    ds_read_b64_tr_b16 a[178:179], v61 offset:2048
    v_mul_f32 v10, s57, v10
    v_mfma_f32_16x16x32_bf16 v[0:3], a[156:159], a[44:47], v[0:3]
    buffer_load_dwordx4 v49, s[16:19], s44 offen offset:3072 lds
    v_cvt_pk_bf16_f32 v20, v8, v9
    v_mfma_f32_16x16x32_bf16 v[4:7], a[172:175], a[44:47], 0
    s_add_u32 s44, s44, 8192
    v_exp_f32 v10, v10
    v_mfma_f32_16x16x32_bf16 v[4:7], a[168:171], a[40:43], v[4:7]
    ds_read_b64_tr_b16 a[180:181], v60 offset:2056
    v_mul_f32 v11, s57, v11
    v_mfma_f32_16x16x32_bf16 v[4:7], a[164:167], a[36:39], v[4:7]
    v_exp_f32 v11, v11
    v_mfma_f32_16x16x32_bf16 v[4:7], a[160:163], a[32:35], v[4:7]
    v_mul_f32 v12, s57, v12
    v_cvt_pk_bf16_f32 v21, v10, v11
    v_mul_f32 v13, s57, v13
    v_mfma_f32_16x16x32_bf16 v[64:67], a[208:211], v[16:19], v[64:67]
    ds_read_b64_tr_b16 a[182:183], v61 offset:2056
    v_exp_f32 v12, v12
    v_mfma_f32_16x16x32_bf16 v[68:71], a[212:215], v[16:19], v[68:71]
    buffer_store_dwordx4 a[240:243], v49, s[36:39], s48 offen offset:0 nt
    v_mfma_f32_16x16x32_bf16 v[72:75], a[216:219], v[16:19], v[72:75]
    v_exp_f32 v13, v13
    v_mfma_f32_16x16x32_bf16 v[76:79], a[220:223], v[16:19], v[76:79]
    ds_read_b64_tr_b16 a[184:185], v60 offset:2560
    v_mul_f32 v14, s57, v14
    v_cvt_pk_bf16_f32 v22, v12, v13
    v_mfma_f32_16x16x32_bf16 v[80:83], a[224:227], v[16:19], v[80:83]
    v_exp_f32 v14, v14
    v_mfma_f32_16x16x32_bf16 v[84:87], a[228:231], v[16:19], v[84:87]
    v_mul_f32 v15, s57, v15
    v_mul_f32 v0, s57, v0
    v_mfma_f32_16x16x32_bf16 v[88:91], a[232:235], v[16:19], v[88:91]
    v_exp_f32 v15, v15
    v_mfma_f32_16x16x32_bf16 v[92:95], a[236:239], v[16:19], v[92:95]
    ds_read_b64_tr_b16 a[186:187], v61 offset:2560
    v_cvt_pk_bf16_f32 v23, v14, v15
    v_mfma_f32_16x16x32_bf16 v[8:11], a[144:147], a[48:51], 0
    v_exp_f32 v0, v0
    v_mfma_f32_16x16x32_bf16 v[8:11], a[148:151], a[52:55], v[8:11]
    ds_read_b64_tr_b16 a[188:189], v60 offset:2568
    v_mul_f32 v1, s57, v1
    v_mfma_f32_16x16x32_bf16 v[8:11], a[152:155], a[56:59], v[8:11]
    v_exp_f32 v1, v1
    v_mfma_f32_16x16x32_bf16 v[8:11], a[156:159], a[60:63], v[8:11]
    ds_read_b64_tr_b16 a[192:193], v60 offset:3072
    v_mul_f32 v2, s57, v2
    v_mul_f32 v3, s57, v3
    v_smfmac_f32_16x16x64_bf16 v[32:35], v[28:31], v[16:23], v48
    v_cvt_pk_bf16_f32 v16, v0, v1
    v_exp_f32 v2, v2
    v_mfma_f32_16x16x32_bf16 v[12:15], a[172:175], a[60:63], 0
    buffer_store_dwordx4 a[244:247], v49, s[36:39], s48 offen offset:128 nt
    v_mfma_f32_16x16x32_bf16 v[12:15], a[168:171], a[56:59], v[12:15]
    s_mov_b32 m0, s53
    v_exp_f32 v3, v3
    v_mfma_f32_16x16x32_bf16 v[12:15], a[164:167], a[52:55], v[12:15]
    s_add_u32 s48, s48, 2048
    v_mul_f32 v4, s57, v4
    v_cvt_pk_bf16_f32 v17, v2, v3
    v_mfma_f32_16x16x32_bf16 v[12:15], a[160:163], a[48:51], v[12:15]
    ds_read_b64_tr_b16 a[190:191], v61 offset:2568
    v_exp_f32 v4, v4
    v_mfma_f32_16x16x32_bf16 v[96:99], a[208:211], v[20:23], v[96:99]
    ds_read_b64_tr_b16 a[194:195], v61 offset:3072
    v_mul_f32 v5, s57, v5
    v_mfma_f32_16x16x32_bf16 v[100:103], a[212:215], v[20:23], v[100:103]
    ds_read_b128 a[248:251], v51 offset:8192
    v_exp_f32 v5, v5
    v_mfma_f32_16x16x32_bf16 v[104:107], a[216:219], v[20:23], v[104:107]
    v_mul_f32 v6, s57, v6
    v_cvt_pk_bf16_f32 v18, v4, v5
    v_mfma_f32_16x16x32_bf16 v[108:111], a[220:223], v[20:23], v[108:111]
    v_exp_f32 v6, v6
    v_mfma_f32_16x16x32_bf16 v[112:115], a[224:227], v[20:23], v[112:115]
    ds_read_b128 a[252:255], v51 offset:9216
    ds_read_b128 a[244:247], v51 offset:11264
    v_mul_f32 v7, s57, v7
    v_mfma_f32_16x16x32_bf16 v[116:119], a[228:231], v[20:23], v[116:119]
    ds_read_b64_tr_b16 a[196:197], v60 offset:3080
    v_exp_f32 v7, v7
    v_mfma_f32_16x16x32_bf16 v[120:123], a[232:235], v[20:23], v[120:123]
    v_cvt_pk_bf16_f32 v19, v6, v7
    v_mul_f32 v8, s57, v8
    v_mfma_f32_16x16x32_bf16 v[124:127], a[236:239], v[20:23], v[124:127]
    ds_read_b128 a[240:243], v51 offset:10240
    ds_read_b64_tr_b16 a[200:201], v60 offset:3584
    v_mfma_f32_16x16x32_bf16 v[0:3], a[144:147], a[64:67], 0
    buffer_load_dwordx4 v49, s[4:7], s44 offen offset:0 lds
    v_mfma_f32_16x16x32_bf16 v[0:3], a[148:151], a[68:71], v[0:3]
    v_exp_f32 v8, v8
    v_mul_f32 v9, s57, v9
    v_mfma_f32_16x16x32_bf16 v[0:3], a[152:155], a[72:75], v[0:3]
    v_exp_f32 v9, v9
    v_mfma_f32_16x16x32_bf16 v[0:3], a[156:159], a[76:79], v[0:3]
    v_mul_f32 v10, s57, v10
    v_cvt_pk_bf16_f32 v20, v8, v9
    v_mfma_f32_16x16x32_bf16 v[4:7], a[172:175], a[76:79], 0
    ds_read_b64_tr_b16 a[198:199], v61 offset:3080
    v_exp_f32 v10, v10
    v_mfma_f32_16x16x32_bf16 v[4:7], a[168:171], a[72:75], v[4:7]
    ds_read_b64_tr_b16 a[202:203], v61 offset:3584
    v_mul_f32 v11, s57, v11
    v_mfma_f32_16x16x32_bf16 v[4:7], a[164:167], a[68:71], v[4:7]
    buffer_load_dwordx4 v49, s[8:11], s44 offen offset:1024 lds
    v_mul_f32 v12, s57, v12
    v_mfma_f32_16x16x32_bf16 v[4:7], a[160:163], a[64:67], v[4:7]
    v_exp_f32 v11, v11
    v_mfma_f32_16x16x32_bf16 v[128:131], a[208:211], v[16:19], v[128:131]
    v_cvt_pk_bf16_f32 v21, v10, v11
    v_exp_f32 v12, v12
    v_mfma_f32_16x16x32_bf16 v[132:135], a[212:215], v[16:19], v[132:135]
    ds_read_b64_tr_b16 a[204:205], v60 offset:3592
    v_mul_f32 v13, s57, v13
    v_mfma_f32_16x16x32_bf16 v[136:139], a[216:219], v[16:19], v[136:139]
    v_exp_f32 v13, v13
    v_mfma_f32_16x16x32_bf16 v[140:143], a[220:223], v[16:19], v[140:143]
    v_mul_f32 v14, s57, v14
    v_cvt_pk_bf16_f32 v22, v12, v13
    v_mfma_f32_16x16x32_bf16 v[144:147], a[224:227], v[16:19], v[144:147]
    buffer_load_dwordx4 v49, s[12:15], s44 offen offset:2048 lds
    v_mfma_f32_16x16x32_bf16 v[148:151], a[228:231], v[16:19], v[148:151]
    v_exp_f32 v14, v14
    v_mul_f32 v15, s57, v15
    v_mfma_f32_16x16x32_bf16 v[152:155], a[232:235], v[16:19], v[152:155]
    v_exp_f32 v15, v15
    v_mul_f32 v0, s57, v0
    v_mfma_f32_16x16x32_bf16 v[156:159], a[236:239], v[16:19], v[156:159]
    ds_read_b64_tr_b16 a[206:207], v61 offset:3592
    v_cvt_pk_bf16_f32 v23, v14, v15
    v_mfma_f32_16x16x32_bf16 v[8:11], a[144:147], a[80:83], 0
    ds_read_b128 a[144:147], v56 offset:0
    v_exp_f32 v0, v0
    v_mfma_f32_16x16x32_bf16 v[8:11], a[148:151], a[84:87], v[8:11]
    ds_read_b128 a[148:151], v56 offset:512
    v_mul_f32 v1, s57, v1
    v_mfma_f32_16x16x32_bf16 v[8:11], a[152:155], a[88:91], v[8:11]
    buffer_load_dwordx4 v49, s[16:19], s44 offen offset:3072 lds
    v_mul_f32 v2, s57, v2
    v_mfma_f32_16x16x32_bf16 v[8:11], a[156:159], a[92:95], v[8:11]
    s_add_u32 s44, s44, 8192
    v_exp_f32 v1, v1
    v_smfmac_f32_16x16x64_bf16 v[36:39], v[28:31], v[16:23], v48
    v_exp_f32 v2, v2
    v_mfma_f32_16x16x32_bf16 v[12:15], a[172:175], a[92:95], 0
    v_cvt_pk_bf16_f32 v16, v0, v1
    v_mul_f32 v3, s57, v3
    v_mfma_f32_16x16x32_bf16 v[12:15], a[168:171], a[88:91], v[12:15]
    ds_read_b128 a[156:159], v56 offset:1536
    ds_read_b128 a[172:175], v57 offset:1536
    v_mfma_f32_16x16x32_bf16 v[12:15], a[164:167], a[84:87], v[12:15]
    ds_read_b128 a[152:155], v56 offset:1024
    v_mul_f32 v4, s57, v4
    v_mfma_f32_16x16x32_bf16 v[12:15], a[160:163], a[80:83], v[12:15]
    v_exp_f32 v3, v3
    v_mfma_f32_16x16x32_bf16 v[160:163], a[208:211], v[20:23], v[160:163]
    ds_read_b128 a[164:167], v57 offset:512
    v_mul_f32 v5, s57, v5
    v_mfma_f32_16x16x32_bf16 v[164:167], a[212:215], v[20:23], v[164:167]
    ds_read_b128 a[168:171], v57 offset:1024
    ds_read_b128 a[160:163], v57 offset:0
    v_mfma_f32_16x16x32_bf16 v[168:171], a[216:219], v[20:23], v[168:171]
    v_exp_f32 v5, v5
    v_mfma_f32_16x16x32_bf16 v[172:175], a[220:223], v[20:23], v[172:175]
    v_mul_f32 v6, s57, v6
    v_mul_f32 v7, s57, v7
    v_mfma_f32_16x16x32_bf16 v[176:179], a[224:227], v[20:23], v[176:179]
    v_exp_f32 v6, v6
    v_mfma_f32_16x16x32_bf16 v[180:183], a[228:231], v[20:23], v[180:183]
    v_exp_f32 v7, v7
    v_mfma_f32_16x16x32_bf16 v[184:187], a[232:235], v[20:23], v[184:187]
    v_cvt_pk_bf16_f32 v19, v6, v7
    v_mul_f32 v8, s57, v8
    v_mfma_f32_16x16x32_bf16 v[188:191], a[236:239], v[20:23], v[188:191]
    s_waitcnt lgkmcnt(3)
    v_cvt_pk_bf16_f32 v17, v2, v3
    v_mfma_f32_16x16x32_bf16 v[0:3], a[144:147], a[0:3], 0
    v_mul_f32 v9, s57, v9
    v_mul_f32 v10, s57, v10
    v_mfma_f32_16x16x32_bf16 v[0:3], a[148:151], a[4:7], v[0:3]
    v_exp_f32 v8, v8
    v_mfma_f32_16x16x32_bf16 v[0:3], a[152:155], a[8:11], v[0:3]
    v_exp_f32 v4, v4
    v_mfma_f32_16x16x32_bf16 v[0:3], a[156:159], a[12:15], v[0:3]
    s_waitcnt lgkmcnt(0)
    v_cvt_pk_bf16_f32 v18, v4, v5
    v_mfma_f32_16x16x32_bf16 v[4:7], a[172:175], a[12:15], 0
    v_exp_f32 v9, v9
    v_mfma_f32_16x16x32_bf16 v[4:7], a[168:171], a[8:11], v[4:7]
    v_cvt_pk_bf16_f32 v20, v8, v9
    v_mul_f32 v11, s57, v11
    v_mfma_f32_16x16x32_bf16 v[4:7], a[164:167], a[4:7], v[4:7]
    v_exp_f32 v11, v11
    v_mfma_f32_16x16x32_bf16 v[4:7], a[160:163], a[0:3], v[4:7]
    v_exp_f32 v10, v10
    v_mfma_f32_16x16x32_bf16 v[192:195], a[208:211], v[16:19], v[192:195]
    v_mul_f32 v12, s57, v12
    v_mul_f32 v13, s57, v13
    v_mfma_f32_16x16x32_bf16 v[196:199], a[212:215], v[16:19], v[196:199]
    v_mul_f32 v14, s57, v14
    v_mul_f32 v15, s57, v15
    v_mfma_f32_16x16x32_bf16 v[200:203], a[216:219], v[16:19], v[200:203]
    v_exp_f32 v12, v12
    v_mfma_f32_16x16x32_bf16 v[204:207], a[220:223], v[16:19], v[204:207]
    v_exp_f32 v13, v13
    v_mfma_f32_16x16x32_bf16 v[208:211], a[224:227], v[16:19], v[208:211]
    v_exp_f32 v14, v14
    v_mfma_f32_16x16x32_bf16 v[212:215], a[228:231], v[16:19], v[212:215]
    v_exp_f32 v15, v15
    v_mfma_f32_16x16x32_bf16 v[216:219], a[232:235], v[16:19], v[216:219]
    v_cvt_pk_bf16_f32 v21, v10, v11
    v_mul_f32 v0, s57, v0
    v_mfma_f32_16x16x32_bf16 v[220:223], a[236:239], v[16:19], v[220:223]
    v_cvt_pk_bf16_f32 v22, v12, v13
    v_cvt_pk_bf16_f32 v23, v14, v15
L_B_T4:
    v_mfma_f32_16x16x32_bf16 v[8:11], a[144:147], a[16:19], 0
    buffer_store_dwordx4 a[248:251], v49, s[36:39], s48 offen offset:0 nt
    v_mfma_f32_16x16x32_bf16 v[8:11], a[148:151], a[20:23], v[8:11]
    v_exp_f32 v0, v0
    v_mfma_f32_16x16x32_bf16 v[8:11], a[152:155], a[24:27], v[8:11]
    v_mul_f32 v1, s57, v1
    v_mul_f32 v2, s57, v2
    v_mfma_f32_16x16x32_bf16 v[8:11], a[156:159], a[28:31], v[8:11]
    v_mul_f32 v3, s57, v3
    v_mul_f32 v5, s57, v5
    v_smfmac_f32_16x16x64_bf16 v[40:43], v[28:31], v[16:23], v48
    v_mul_f32 v4, s57, v4
    v_mfma_f32_16x16x32_bf16 v[12:15], a[172:175], a[28:31], 0
    v_exp_f32 v1, v1
    v_mfma_f32_16x16x32_bf16 v[12:15], a[168:171], a[24:27], v[12:15]
    v_exp_f32 v3, v3
    v_mfma_f32_16x16x32_bf16 v[12:15], a[164:167], a[20:23], v[12:15]
    v_exp_f32 v2, v2
    v_mfma_f32_16x16x32_bf16 v[12:15], a[160:163], a[16:19], v[12:15]
    v_exp_f32 v4, v4
    v_mfma_f32_16x16x32_bf16 v[224:227], a[208:211], v[20:23], v[224:227]
    v_cvt_pk_bf16_f32 v16, v0, v1
    v_cvt_pk_bf16_f32 v17, v2, v3
    v_mfma_f32_16x16x32_bf16 v[228:231], a[212:215], v[20:23], v[228:231]
    v_mul_f32 v6, s57, v6
    v_mul_f32 v7, s57, v7
    v_mfma_f32_16x16x32_bf16 v[232:235], a[216:219], v[20:23], v[232:235]
    v_exp_f32 v5, v5
    v_mfma_f32_16x16x32_bf16 v[236:239], a[220:223], v[20:23], v[236:239]
    buffer_store_dwordx4 a[252:255], v49, s[36:39], s48 offen offset:128 nt
    v_mfma_f32_16x16x32_bf16 v[240:243], a[224:227], v[20:23], v[240:243]
    v_exp_f32 v6, v6
    v_mfma_f32_16x16x32_bf16 v[244:247], a[228:231], v[20:23], v[244:247]
    v_exp_f32 v7, v7
    v_mfma_f32_16x16x32_bf16 v[248:251], a[232:235], v[20:23], v[248:251]
    v_cvt_pk_bf16_f32 v18, v4, v5
    v_cvt_pk_bf16_f32 v19, v6, v7
    v_mfma_f32_16x16x32_bf16 v[252:255], a[236:239], v[20:23], v[252:255]
    v_mul_f32 v8, s57, v8
    v_mul_f32 v9, s57, v9
    v_mfma_f32_16x16x32_bf16 v[0:3], a[144:147], a[96:99], 0
    v_exp_f32 v8, v8
    v_mfma_f32_16x16x32_bf16 v[0:3], a[148:151], a[100:103], v[0:3]
    v_exp_f32 v9, v9
    v_mfma_f32_16x16x32_bf16 v[0:3], a[152:155], a[104:107], v[0:3]
    v_mul_f32 v10, s57, v10
    v_cvt_pk_bf16_f32 v20, v8, v9
    v_mfma_f32_16x16x32_bf16 v[0:3], a[156:159], a[108:111], v[0:3]
    v_mul_f32 v11, s57, v11
    v_mul_f32 v12, s57, v12
    v_mfma_f32_16x16x32_bf16 v[64:67], a[176:179], v[16:19], v[64:67]
    v_exp_f32 v11, v11
    v_mfma_f32_16x16x32_bf16 v[68:71], a[180:183], v[16:19], v[68:71]
    v_exp_f32 v10, v10
    v_mul_f32 v13, s57, v13
    v_mfma_f32_16x16x32_bf16 v[72:75], a[184:187], v[16:19], v[72:75]
    v_exp_f32 v12, v12
    v_mfma_f32_16x16x32_bf16 v[76:79], a[188:191], v[16:19], v[76:79]
    buffer_store_dwordx4 a[240:243], v49, s[36:39], s48 offen offset:2048 nt
    v_mfma_f32_16x16x32_bf16 v[80:83], a[192:195], v[16:19], v[80:83]
    v_cvt_pk_bf16_f32 v21, v10, v11
    v_mul_f32 v14, s57, v14
    v_mfma_f32_16x16x32_bf16 v[84:87], a[196:199], v[16:19], v[84:87]
    v_exp_f32 v13, v13
    v_mfma_f32_16x16x32_bf16 v[88:91], a[200:203], v[16:19], v[88:91]
    v_exp_f32 v14, v14
    v_mfma_f32_16x16x32_bf16 v[92:95], a[204:207], v[16:19], v[92:95]
    v_mul_f32 v15, s57, v15
    v_mul_f32 v0, s57, v0
    v_mfma_f32_16x16x32_bf16 v[8:11], a[144:147], a[32:35], 0
    v_exp_f32 v15, v15
    v_mfma_f32_16x16x32_bf16 v[8:11], a[148:151], a[36:39], v[8:11]
    v_cvt_pk_bf16_f32 v22, v12, v13
    v_cvt_pk_bf16_f32 v23, v14, v15
    v_mfma_f32_16x16x32_bf16 v[8:11], a[152:155], a[40:43], v[8:11]
    ds_read_b64_tr_b16 a[208:209], v62 offset:2048
    ds_read_b64_tr_b16 a[212:213], v62 offset:2056
    v_mfma_f32_16x16x32_bf16 v[8:11], a[156:159], a[44:47], v[8:11]
    v_exp_f32 v0, v0
    v_smfmac_f32_16x16x64_bf16 v[32:35], v[28:31], v[16:23], v48
    v_mul_f32 v1, s57, v1
    v_mfma_f32_16x16x32_bf16 v[12:15], a[172:175], a[44:47], 0
    v_exp_f32 v1, v1
    v_mfma_f32_16x16x32_bf16 v[12:15], a[168:171], a[40:43], v[12:15]
    ds_read_b64_tr_b16 a[210:211], v63 offset:2048
    v_cvt_pk_bf16_f32 v24, v0, v1
    v_mfma_f32_16x16x32_bf16 v[12:15], a[164:167], a[36:39], v[12:15]
    buffer_store_dwordx4 a[244:247], v49, s[36:39], s48 offen offset:2176 nt
    v_mfma_f32_16x16x32_bf16 v[12:15], a[160:163], a[32:35], v[12:15]
    s_add_u32 s48, s48, 4096
    v_mul_f32 v2, s57, v2
    v_mfma_f32_16x16x32_bf16 v[96:99], a[176:179], v[20:23], v[96:99]
    v_exp_f32 v2, v2
    v_mfma_f32_16x16x32_bf16 v[100:103], a[180:183], v[20:23], v[100:103]
    ds_read_b64_tr_b16 a[216:217], v62 offset:2560
    ds_read_b64_tr_b16 a[218:219], v63 offset:2560
    v_mfma_f32_16x16x32_bf16 v[104:107], a[184:187], v[20:23], v[104:107]
    ds_read_b64_tr_b16 a[220:221], v62 offset:2568
    v_mul_f32 v3, s57, v3
    v_mfma_f32_16x16x32_bf16 v[108:111], a[188:191], v[20:23], v[108:111]
    v_exp_f32 v3, v3
    v_mfma_f32_16x16x32_bf16 v[112:115], a[192:195], v[20:23], v[112:115]
    v_cvt_pk_bf16_f32 v25, v2, v3
    v_mfma_f32_16x16x32_bf16 v[116:119], a[196:199], v[20:23], v[116:119]
    ds_read_b64_tr_b16 a[222:223], v63 offset:2568
    v_mfma_f32_16x16x32_bf16 v[120:123], a[200:203], v[20:23], v[120:123]
    v_mul_f32 v8, s57, v8
    v_mfma_f32_16x16x32_bf16 v[124:127], a[204:207], v[20:23], v[124:127]
    ds_read_b64_tr_b16 a[224:225], v62 offset:3072
    v_mfma_f32_16x16x32_bf16 v[0:3], a[144:147], a[48:51], 0
    v_exp_f32 v8, v8
    v_mfma_f32_16x16x32_bf16 v[0:3], a[148:151], a[52:55], v[0:3]
    v_mul_f32 v9, s57, v9
    v_mul_f32 v10, s57, v10
    v_mfma_f32_16x16x32_bf16 v[0:3], a[152:155], a[56:59], v[0:3]
    global_load_dword v55, v[52:53], off
    v_mfma_f32_16x16x32_bf16 v[0:3], a[156:159], a[60:63], v[0:3]
    v_exp_f32 v9, v9
    v_smfmac_f32_16x16x64_bf16 v[44:47], v[28:31], v[20:27], v48
    v_cvt_pk_bf16_f32 v16, v8, v9
    v_mfma_f32_16x16x32_bf16 v[4:7], a[172:175], a[60:63], 0
    v_exp_f32 v10, v10
    v_mfma_f32_16x16x32_bf16 v[4:7], a[168:171], a[56:59], v[4:7]
    ds_read_b64_tr_b16 a[226:227], v63 offset:3072
    v_mul_f32 v11, s57, v11
    v_mfma_f32_16x16x32_bf16 v[4:7], a[164:167], a[52:55], v[4:7]
    v_mul_f32 v12, s57, v12
    v_mfma_f32_16x16x32_bf16 v[4:7], a[160:163], a[48:51], v[4:7]
    v_exp_f32 v11, v11
    v_mfma_f32_16x16x16_bf16 a[112:115], a[176:177], v[24:25], a[112:115]
    v_exp_f32 v12, v12
    v_mul_f32 v13, s57, v13
    v_mfma_f32_16x16x16_bf16 a[116:119], a[180:181], v[24:25], a[116:119]
    v_cvt_pk_bf16_f32 v17, v10, v11
    v_exp_f32 v13, v13
    v_mfma_f32_16x16x16_bf16 a[120:123], a[184:185], v[24:25], a[120:123]
    ds_read_b64_tr_b16 a[228:229], v62 offset:3080
    v_mul_f32 v14, s57, v14
    v_cvt_pk_bf16_f32 v18, v12, v13
    v_mfma_f32_16x16x16_bf16 a[124:127], a[188:189], v[24:25], a[124:127]
    v_exp_f32 v14, v14
    v_mfma_f32_16x16x16_bf16 a[128:131], a[192:193], v[24:25], a[128:131]
    ds_read_b64_tr_b16 a[230:231], v63 offset:3080
    ds_read_b64_tr_b16 a[234:235], v63 offset:3584
    v_mul_f32 v15, s57, v15
    v_mfma_f32_16x16x16_bf16 a[132:135], a[196:197], v[24:25], a[132:135]
    v_exp_f32 v15, v15
    v_add_u32 v51, 0x1800, v51
    v_mfma_f32_16x16x16_bf16 a[136:139], a[200:201], v[24:25], a[136:139]
    ds_read_b64_tr_b16 a[238:239], v63 offset:3592
    v_cvt_pk_bf16_f32 v19, v14, v15
    v_mul_f32 v0, s57, v0
    v_mfma_f32_16x16x16_bf16 a[140:143], a[204:205], v[24:25], a[140:143]
    ds_read_b64_tr_b16 a[232:233], v62 offset:3584
    v_exp_f32 v0, v0
    v_mfma_f32_16x16x32_bf16 v[8:11], a[144:147], a[64:67], 0
    ds_read_b64_tr_b16 a[236:237], v62 offset:3592
    v_mul_f32 v1, s57, v1
    v_mfma_f32_16x16x32_bf16 v[8:11], a[148:151], a[68:71], v[8:11]
    v_exp_f32 v1, v1
    v_mfma_f32_16x16x32_bf16 v[8:11], a[152:155], a[72:75], v[8:11]
    v_mul_f32 v2, s57, v2
    v_cvt_pk_bf16_f32 v20, v0, v1
    v_mfma_f32_16x16x32_bf16 v[8:11], a[156:159], a[76:79], v[8:11]
    v_mul_f32 v3, s57, v3
    v_mul_f32 v4, s57, v4
    v_mfma_f32_16x16x32_bf16 v[12:15], a[172:175], a[76:79], 0
    v_exp_f32 v2, v2
    v_mfma_f32_16x16x32_bf16 v[12:15], a[168:171], a[72:75], v[12:15]
    v_exp_f32 v3, v3
    v_mfma_f32_16x16x32_bf16 v[12:15], a[164:167], a[68:71], v[12:15]
    v_exp_f32 v4, v4
    v_mfma_f32_16x16x32_bf16 v[12:15], a[160:163], a[64:67], v[12:15]
    v_cvt_pk_bf16_f32 v21, v2, v3
    v_mul_f32 v5, s57, v5
    v_mfma_f32_16x16x32_bf16 v[128:131], a[176:179], v[16:19], v[128:131]
    v_exp_f32 v5, v5
    v_mfma_f32_16x16x32_bf16 v[132:135], a[180:183], v[16:19], v[132:135]
    ds_read_b64_tr_b16 a[214:215], v63 offset:2056
    v_cvt_pk_bf16_f32 v22, v4, v5
    v_mfma_f32_16x16x32_bf16 v[136:139], a[184:187], v[16:19], v[136:139]
    v_mul_f32 v6, s57, v6
    v_mul_f32 v7, s57, v7
    v_mfma_f32_16x16x32_bf16 v[140:143], a[188:191], v[16:19], v[140:143]
    v_exp_f32 v7, v7
    v_mfma_f32_16x16x32_bf16 v[144:147], a[192:195], v[16:19], v[144:147]
    v_exp_f32 v6, v6
    v_mfma_f32_16x16x32_bf16 v[148:151], a[196:199], v[16:19], v[148:151]
    v_mul_f32 v8, s57, v8
    v_mul_f32 v11, s57, v11
    v_mfma_f32_16x16x32_bf16 v[152:155], a[200:203], v[16:19], v[152:155]
    v_cvt_pk_bf16_f32 v23, v6, v7
    v_mul_f32 v10, s57, v10
    v_mfma_f32_16x16x32_bf16 v[156:159], a[204:207], v[16:19], v[156:159]
    v_exp_f32 v8, v8
    v_mfma_f32_16x16x32_bf16 v[0:3], a[144:147], a[80:83], 0
    ds_read_b128 a[144:147], v58 offset:0
    v_mul_f32 v9, s57, v9
    v_mfma_f32_16x16x32_bf16 v[0:3], a[148:151], a[84:87], v[0:3]
    v_exp_f32 v9, v9
    v_mfma_f32_16x16x32_bf16 v[0:3], a[152:155], a[88:91], v[0:3]
    ds_read_b128 a[148:151], v58 offset:512
    ds_read_b128 a[152:155], v58 offset:1024
    v_mfma_f32_16x16x32_bf16 v[0:3], a[156:159], a[92:95], v[0:3]
    v_exp_f32 v10, v10
    v_smfmac_f32_16x16x64_bf16 v[36:39], v[28:31], v[16:23], v48
    v_cvt_pk_bf16_f32 v16, v8, v9
    v_mfma_f32_16x16x32_bf16 v[4:7], a[172:175], a[92:95], 0
    ds_read_b128 a[156:159], v58 offset:1536
    ds_read_b128 a[172:175], v59 offset:1536
    v_mfma_f32_16x16x32_bf16 v[4:7], a[168:171], a[88:91], v[4:7]
    ds_read_b128 a[168:171], v59 offset:1024
    v_mul_f32 v12, s57, v12
    v_mfma_f32_16x16x32_bf16 v[4:7], a[164:167], a[84:87], v[4:7]
    v_exp_f32 v11, v11
    v_mfma_f32_16x16x32_bf16 v[4:7], a[160:163], a[80:83], v[4:7]
    v_exp_f32 v12, v12
    v_mfma_f32_16x16x32_bf16 v[160:163], a[176:179], v[20:23], v[160:163]
    v_cvt_pk_bf16_f32 v17, v10, v11
    v_mul_f32 v13, s57, v13
    v_mfma_f32_16x16x32_bf16 v[164:167], a[180:183], v[20:23], v[164:167]
    ds_read_b128 a[164:167], v59 offset:512
    ds_read_b128 a[160:163], v59 offset:0
    v_mfma_f32_16x16x32_bf16 v[168:171], a[184:187], v[20:23], v[168:171]
    v_exp_f32 v13, v13
    v_mfma_f32_16x16x32_bf16 v[172:175], a[188:191], v[20:23], v[172:175]
    v_mul_f32 v14, s57, v14
    v_mul_f32 v15, s57, v15
    v_mfma_f32_16x16x32_bf16 v[176:179], a[192:195], v[20:23], v[176:179]
    v_exp_f32 v14, v14
    v_mfma_f32_16x16x32_bf16 v[180:183], a[196:199], v[20:23], v[180:183]
    v_exp_f32 v15, v15
    v_mfma_f32_16x16x32_bf16 v[184:187], a[200:203], v[20:23], v[184:187]
    v_cvt_pk_bf16_f32 v19, v14, v15
    v_mul_f32 v0, s57, v0
    v_mfma_f32_16x16x32_bf16 v[188:191], a[204:207], v[20:23], v[188:191]
    s_waitcnt lgkmcnt(4)
    v_cvt_pk_bf16_f32 v18, v12, v13
    v_mfma_f32_16x16x32_bf16 v[8:11], a[144:147], a[0:3], 0
    v_exp_f32 v0, v0
    v_mfma_f32_16x16x32_bf16 v[8:11], a[148:151], a[4:7], v[8:11]
    v_mul_f32 v1, s57, v1
    v_mul_f32 v2, s57, v2
    v_mfma_f32_16x16x32_bf16 v[8:11], a[152:155], a[8:11], v[8:11]
    v_exp_f32 v1, v1
    v_mfma_f32_16x16x32_bf16 v[8:11], a[156:159], a[12:15], v[8:11]
    s_waitcnt lgkmcnt(0)
    v_cvt_pk_bf16_f32 v20, v0, v1
    v_mfma_f32_16x16x32_bf16 v[12:15], a[172:175], a[12:15], 0
    v_exp_f32 v2, v2
    v_mfma_f32_16x16x32_bf16 v[12:15], a[168:171], a[8:11], v[12:15]
    v_mul_f32 v3, s57, v3
    v_mfma_f32_16x16x32_bf16 v[12:15], a[164:167], a[4:7], v[12:15]
    v_exp_f32 v3, v3
    v_mfma_f32_16x16x32_bf16 v[12:15], a[160:163], a[0:3], v[12:15]
    v_mul_f32 v4, s57, v4
    v_cvt_pk_bf16_f32 v21, v2, v3
    v_mfma_f32_16x16x32_bf16 v[192:195], a[176:179], v[16:19], v[192:195]
    v_exp_f32 v4, v4
    v_mfma_f32_16x16x32_bf16 v[196:199], a[180:183], v[16:19], v[196:199]
    v_mul_f32 v5, s57, v5
    v_mfma_f32_16x16x32_bf16 v[200:203], a[184:187], v[16:19], v[200:203]
    v_exp_f32 v5, v5
    v_mfma_f32_16x16x32_bf16 v[204:207], a[188:191], v[16:19], v[204:207]
    v_mul_f32 v6, s57, v6
    v_cvt_pk_bf16_f32 v22, v4, v5
    v_mfma_f32_16x16x32_bf16 v[208:211], a[192:195], v[16:19], v[208:211]
    v_exp_f32 v6, v6
    v_mfma_f32_16x16x32_bf16 v[212:215], a[196:199], v[16:19], v[212:215]
    v_mul_f32 v7, s57, v7
    v_mul_f32 v8, s57, v8
    v_mfma_f32_16x16x32_bf16 v[216:219], a[200:203], v[16:19], v[216:219]
    v_exp_f32 v7, v7
    v_mfma_f32_16x16x32_bf16 v[220:223], a[204:207], v[16:19], v[220:223]
    v_cvt_pk_bf16_f32 v23, v6, v7
    v_mfma_f32_16x16x32_bf16 v[0:3], a[144:147], a[16:19], 0
    s_waitcnt vmcnt(5)
    v_exp_f32 v8, v8
    v_mfma_f32_16x16x32_bf16 v[0:3], a[148:151], a[20:23], v[0:3]
    s_barrier
    s_mov_b32 m0, s50
    v_mul_f32 v9, s57, v9
    v_mfma_f32_16x16x32_bf16 v[0:3], a[152:155], a[24:27], v[0:3]
    buffer_load_dwordx4 v49, s[4:7], s44 offen offset:0 lds
    v_mfma_f32_16x16x32_bf16 v[0:3], a[156:159], a[28:31], v[0:3]
    v_exp_f32 v9, v9
    v_mul_f32 v10, s57, v10
    v_smfmac_f32_16x16x64_bf16 v[40:43], v[28:31], v[16:23], v48
    v_cvt_pk_bf16_f32 v16, v8, v9
    v_exp_f32 v10, v10
    v_mfma_f32_16x16x32_bf16 v[4:7], a[172:175], a[28:31], 0
    v_mul_f32 v11, s57, v11
    v_mul_f32 v13, s57, v13
    v_mfma_f32_16x16x32_bf16 v[4:7], a[168:171], a[24:27], v[4:7]
    v_exp_f32 v11, v11
    v_mfma_f32_16x16x32_bf16 v[4:7], a[164:167], a[20:23], v[4:7]
    v_mul_f32 v12, s57, v12
    v_cvt_pk_bf16_f32 v17, v10, v11
    v_mfma_f32_16x16x32_bf16 v[4:7], a[160:163], a[16:19], v[4:7]
    buffer_load_dwordx4 v49, s[8:11], s44 offen offset:1024 lds
    v_mfma_f32_16x16x32_bf16 v[224:227], a[176:179], v[20:23], v[224:227]
    v_exp_f32 v12, v12
    v_mfma_f32_16x16x32_bf16 v[228:231], a[180:183], v[20:23], v[228:231]
    v_exp_f32 v13, v13
    v_mfma_f32_16x16x32_bf16 v[232:235], a[184:187], v[20:23], v[232:235]
    v_mul_f32 v14, s57, v14
    v_cvt_pk_bf16_f32 v18, v12, v13
    v_mfma_f32_16x16x32_bf16 v[236:239], a[188:191], v[20:23], v[236:239]
    v_exp_f32 v14, v14
    v_mfma_f32_16x16x32_bf16 v[240:243], a[192:195], v[20:23], v[240:243]
    ds_read_b64_tr_b16 a[176:177], v60 offset:34816
    v_mul_f32 v15, s57, v15
    v_mfma_f32_16x16x32_bf16 v[244:247], a[196:199], v[20:23], v[244:247]
    buffer_load_dwordx4 v49, s[12:15], s44 offen offset:2048 lds
    v_mfma_f32_16x16x32_bf16 v[248:251], a[200:203], v[20:23], v[248:251]
    v_exp_f32 v15, v15
    v_mul_f32 v0, s57, v0
    v_mfma_f32_16x16x32_bf16 v[252:255], a[204:207], v[20:23], v[252:255]
    ds_read_b64_tr_b16 a[178:179], v61 offset:34816
    v_cvt_pk_bf16_f32 v19, v14, v15
    v_mfma_f32_16x16x32_bf16 v[8:11], a[144:147], a[32:35], 0
    v_exp_f32 v0, v0
    v_mul_f32 v1, s57, v1
    v_mfma_f32_16x16x32_bf16 v[8:11], a[148:151], a[36:39], v[8:11]
    v_exp_f32 v1, v1
    v_mfma_f32_16x16x32_bf16 v[8:11], a[152:155], a[40:43], v[8:11]
    v_mul_f32 v2, s57, v2
    v_cvt_pk_bf16_f32 v20, v0, v1
    v_mfma_f32_16x16x32_bf16 v[8:11], a[156:159], a[44:47], v[8:11]
    buffer_load_dwordx4 v49, s[16:19], s44 offen offset:3072 lds
    v_mfma_f32_16x16x32_bf16 v[12:15], a[172:175], a[44:47], 0
    s_add_u32 s44, s44, 8192
    v_exp_f32 v2, v2
    v_mfma_f32_16x16x32_bf16 v[12:15], a[168:171], a[40:43], v[12:15]
    ds_read_b64_tr_b16 a[180:181], v60 offset:34824
    s_mov_b32 m0, s51
    v_mul_f32 v3, s57, v3
    v_mfma_f32_16x16x32_bf16 v[12:15], a[164:167], a[36:39], v[12:15]
    v_exp_f32 v3, v3
    v_mfma_f32_16x16x32_bf16 v[12:15], a[160:163], a[32:35], v[12:15]
    v_mul_f32 v4, s57, v4
    v_cvt_pk_bf16_f32 v21, v2, v3
    v_mfma_f32_16x16x32_bf16 v[64:67], a[208:211], v[16:19], v[64:67]
    v_exp_f32 v4, v4
    v_mfma_f32_16x16x32_bf16 v[68:71], a[212:215], v[16:19], v[68:71]
    buffer_load_dwordx4 v49, s[4:7], s44 offen offset:0 lds
    v_mul_f32 v5, s57, v5
    v_mfma_f32_16x16x32_bf16 v[72:75], a[216:219], v[16:19], v[72:75]
    v_exp_f32 v5, v5
    v_mfma_f32_16x16x32_bf16 v[76:79], a[220:223], v[16:19], v[76:79]
    v_mul_f32 v6, s57, v6
    v_cvt_pk_bf16_f32 v22, v4, v5
    v_mfma_f32_16x16x32_bf16 v[80:83], a[224:227], v[16:19], v[80:83]
    ds_read_b64_tr_b16 a[184:185], v60 offset:35328
    v_exp_f32 v6, v6
    v_mfma_f32_16x16x32_bf16 v[84:87], a[228:231], v[16:19], v[84:87]
    ds_read_b64_tr_b16 a[182:183], v61 offset:34824
    v_mul_f32 v7, s57, v7
    v_mfma_f32_16x16x32_bf16 v[88:91], a[232:235], v[16:19], v[88:91]
    v_exp_f32 v7, v7
    v_mul_f32 v8, s57, v8
    v_mfma_f32_16x16x32_bf16 v[92:95], a[236:239], v[16:19], v[92:95]
    buffer_load_dwordx4 v49, s[8:11], s44 offen offset:1024 lds
    v_cvt_pk_bf16_f32 v23, v6, v7
    v_mfma_f32_16x16x32_bf16 v[0:3], a[144:147], a[48:51], 0
    v_exp_f32 v8, v8
    v_mfma_f32_16x16x32_bf16 v[0:3], a[148:151], a[52:55], v[0:3]
    ds_read_b64_tr_b16 a[186:187], v61 offset:35328
    v_mul_f32 v9, s57, v9
    v_mfma_f32_16x16x32_bf16 v[0:3], a[152:155], a[56:59], v[0:3]
    ds_read_b64_tr_b16 a[188:189], v60 offset:35336
    v_exp_f32 v9, v9
    v_mfma_f32_16x16x32_bf16 v[0:3], a[156:159], a[60:63], v[0:3]
    ds_read_b64_tr_b16 a[190:191], v61 offset:35336
    v_mul_f32 v10, s57, v10
    v_smfmac_f32_16x16x64_bf16 v[32:35], v[28:31], v[16:23], v48
    v_cvt_pk_bf16_f32 v16, v8, v9
    v_exp_f32 v10, v10
    v_mfma_f32_16x16x32_bf16 v[4:7], a[172:175], a[60:63], 0
    buffer_load_dwordx4 v49, s[12:15], s44 offen offset:2048 lds
    v_mul_f32 v11, s57, v11
    v_mfma_f32_16x16x32_bf16 v[4:7], a[168:171], a[56:59], v[4:7]
    v_exp_f32 v11, v11
    v_mfma_f32_16x16x32_bf16 v[4:7], a[164:167], a[52:55], v[4:7]
    v_mul_f32 v12, s57, v12
    v_cvt_pk_bf16_f32 v17, v10, v11
    v_mfma_f32_16x16x32_bf16 v[4:7], a[160:163], a[48:51], v[4:7]
    v_exp_f32 v12, v12
    v_mul_f32 v13, s57, v13
    v_mfma_f32_16x16x32_bf16 v[96:99], a[208:211], v[20:23], v[96:99]
    v_exp_f32 v13, v13
    v_mfma_f32_16x16x32_bf16 v[100:103], a[212:215], v[20:23], v[100:103]
    v_mul_f32 v14, s57, v14
    v_cvt_pk_bf16_f32 v18, v12, v13
    v_mfma_f32_16x16x32_bf16 v[104:107], a[216:219], v[20:23], v[104:107]
    buffer_load_dwordx4 v49, s[16:19], s44 offen offset:3072 lds
    v_mfma_f32_16x16x32_bf16 v[108:111], a[220:223], v[20:23], v[108:111]
    s_add_u32 s44, s44, 8192
    v_exp_f32 v14, v14
    v_mfma_f32_16x16x32_bf16 v[112:115], a[224:227], v[20:23], v[112:115]
    ds_read_b64_tr_b16 a[192:193], v60 offset:35840
    v_mul_f32 v15, s57, v15
    v_mfma_f32_16x16x32_bf16 v[116:119], a[228:231], v[20:23], v[116:119]
    v_exp_f32 v15, v15
    v_mfma_f32_16x16x32_bf16 v[120:123], a[232:235], v[20:23], v[120:123]
    ds_read_b64_tr_b16 a[196:197], v60 offset:35848
    v_mul_f32 v0, s57, v0
    v_mfma_f32_16x16x32_bf16 v[124:127], a[236:239], v[20:23], v[124:127]
    ds_read_b64_tr_b16 a[194:195], v61 offset:35840
    v_cvt_pk_bf16_f32 v19, v14, v15
    v_mfma_f32_16x16x32_bf16 v[8:11], a[144:147], a[64:67], 0
    v_exp_f32 v0, v0
    v_mfma_f32_16x16x32_bf16 v[8:11], a[148:151], a[68:71], v[8:11]
    ds_read_b64_tr_b16 a[198:199], v61 offset:35848
    v_mul_f32 v1, s57, v1
    v_mfma_f32_16x16x32_bf16 v[8:11], a[152:155], a[72:75], v[8:11]
    v_exp_f32 v1, v1
    v_mfma_f32_16x16x32_bf16 v[8:11], a[156:159], a[76:79], v[8:11]
    v_mul_f32 v2, s57, v2
    v_cvt_pk_bf16_f32 v20, v0, v1
    v_mfma_f32_16x16x32_bf16 v[12:15], a[172:175], a[76:79], 0
    ds_read_b64_tr_b16 a[202:203], v61 offset:36352
    v_exp_f32 v2, v2
    v_mfma_f32_16x16x32_bf16 v[12:15], a[168:171], a[72:75], v[12:15]
    ds_read_b64_tr_b16 a[200:201], v60 offset:36352
    v_mul_f32 v3, s57, v3
    v_mfma_f32_16x16x32_bf16 v[12:15], a[164:167], a[68:71], v[12:15]
    v_exp_f32 v3, v3
    v_mfma_f32_16x16x32_bf16 v[12:15], a[160:163], a[64:67], v[12:15]
    v_mul_f32 v4, s57, v4
    v_cvt_pk_bf16_f32 v21, v2, v3
    v_mfma_f32_16x16x32_bf16 v[128:131], a[208:211], v[16:19], v[128:131]
    v_exp_f32 v4, v4
    v_mfma_f32_16x16x32_bf16 v[132:135], a[212:215], v[16:19], v[132:135]
    ds_read_b64_tr_b16 a[204:205], v60 offset:36360
    v_mul_f32 v5, s57, v5
    v_mfma_f32_16x16x32_bf16 v[136:139], a[216:219], v[16:19], v[136:139]
    v_exp_f32 v5, v5
    v_mfma_f32_16x16x32_bf16 v[140:143], a[220:223], v[16:19], v[140:143]
    v_mul_f32 v6, s57, v6
    v_cvt_pk_bf16_f32 v22, v4, v5
    v_mfma_f32_16x16x32_bf16 v[144:147], a[224:227], v[16:19], v[144:147]
    v_exp_f32 v6, v6
    v_mfma_f32_16x16x32_bf16 v[148:151], a[228:231], v[16:19], v[148:151]
    ds_read_b64_tr_b16 a[206:207], v61 offset:36360
    v_mul_f32 v7, s57, v7
    v_mfma_f32_16x16x32_bf16 v[152:155], a[232:235], v[16:19], v[152:155]
    v_exp_f32 v7, v7
    v_mfma_f32_16x16x32_bf16 v[156:159], a[236:239], v[16:19], v[156:159]
    v_mul_f32 v8, s57, v8
    v_cvt_pk_bf16_f32 v23, v6, v7
    v_mfma_f32_16x16x32_bf16 v[0:3], a[144:147], a[80:83], 0
    v_exp_f32 v8, v8
    v_mfma_f32_16x16x32_bf16 v[0:3], a[148:151], a[84:87], v[0:3]
    ds_read_b128 a[144:147], v56 offset:32768
    v_mul_f32 v9, s57, v9
    v_mfma_f32_16x16x32_bf16 v[0:3], a[152:155], a[88:91], v[0:3]
    ds_read_b128 a[152:155], v56 offset:33792
    v_exp_f32 v9, v9
    v_mfma_f32_16x16x32_bf16 v[0:3], a[156:159], a[92:95], v[0:3]
    ds_read_b128 a[148:151], v56 offset:33280
    v_mul_f32 v10, s57, v10
    v_smfmac_f32_16x16x64_bf16 v[36:39], v[28:31], v[16:23], v48
    v_exp_f32 v10, v10
    v_mfma_f32_16x16x32_bf16 v[4:7], a[172:175], a[92:95], 0
    v_cvt_pk_bf16_f32 v16, v8, v9
    v_mul_f32 v11, s57, v11
    v_mfma_f32_16x16x32_bf16 v[4:7], a[168:171], a[88:91], v[4:7]
    v_exp_f32 v11, v11
    v_mfma_f32_16x16x32_bf16 v[4:7], a[164:167], a[84:87], v[4:7]
    ds_read_b128 a[156:159], v56 offset:34304
    v_mul_f32 v12, s57, v12
    v_mfma_f32_16x16x32_bf16 v[4:7], a[160:163], a[80:83], v[4:7]
    ds_read_b128 a[172:175], v57 offset:34304
    ds_read_b128 a[164:167], v57 offset:33280
    v_mfma_f32_16x16x32_bf16 v[160:163], a[208:211], v[20:23], v[160:163]
    v_exp_f32 v12, v12
    v_mfma_f32_16x16x32_bf16 v[164:167], a[212:215], v[20:23], v[164:167]
    ds_read_b128 a[160:163], v57 offset:32768
    v_mul_f32 v13, s57, v13
    v_mfma_f32_16x16x32_bf16 v[168:171], a[216:219], v[20:23], v[168:171]
    ds_read_b128 a[168:171], v57 offset:33792
    v_mul_f32 v14, s57, v14
    v_mfma_f32_16x16x32_bf16 v[172:175], a[220:223], v[20:23], v[172:175]
    v_exp_f32 v13, v13
    v_mfma_f32_16x16x32_bf16 v[176:179], a[224:227], v[20:23], v[176:179]
    v_exp_f32 v14, v14
    v_mfma_f32_16x16x32_bf16 v[180:183], a[228:231], v[20:23], v[180:183]
    v_cvt_pk_bf16_f32 v17, v10, v11
    v_mul_f32 v15, s57, v15
    v_mfma_f32_16x16x32_bf16 v[184:187], a[232:235], v[20:23], v[184:187]
    v_exp_f32 v15, v15
    v_mfma_f32_16x16x32_bf16 v[188:191], a[236:239], v[20:23], v[188:191]
    s_waitcnt lgkmcnt(4)
    v_mul_f32 v0, s57, v0
    v_mfma_f32_16x16x32_bf16 v[8:11], a[144:147], a[0:3], 0
    v_exp_f32 v0, v0
    v_mfma_f32_16x16x32_bf16 v[8:11], a[148:151], a[4:7], v[8:11]
    v_cvt_pk_bf16_f32 v18, v12, v13
    v_mul_f32 v1, s57, v1
    v_mfma_f32_16x16x32_bf16 v[8:11], a[152:155], a[8:11], v[8:11]
    v_cvt_pk_bf16_f32 v19, v14, v15
    v_mul_f32 v2, s57, v2
    v_mfma_f32_16x16x32_bf16 v[8:11], a[156:159], a[12:15], v[8:11]
    s_waitcnt lgkmcnt(0)
    v_mul_f32 v3, s57, v3
    v_mfma_f32_16x16x32_bf16 v[12:15], a[172:175], a[12:15], 0
    v_exp_f32 v1, v1
    v_mfma_f32_16x16x32_bf16 v[12:15], a[168:171], a[8:11], v[12:15]
    v_exp_f32 v2, v2
    v_mfma_f32_16x16x32_bf16 v[12:15], a[164:167], a[4:7], v[12:15]
    v_exp_f32 v3, v3
    v_mfma_f32_16x16x32_bf16 v[12:15], a[160:163], a[0:3], v[12:15]
    v_cvt_pk_bf16_f32 v20, v0, v1
    v_cvt_pk_bf16_f32 v21, v2, v3
    v_mfma_f32_16x16x32_bf16 v[192:195], a[208:211], v[16:19], v[192:195]
    v_mul_f32 v4, s57, v4
    v_mul_f32 v5, s57, v5
    v_mfma_f32_16x16x32_bf16 v[196:199], a[212:215], v[16:19], v[196:199]
    v_exp_f32 v4, v4
    v_mfma_f32_16x16x32_bf16 v[200:203], a[216:219], v[16:19], v[200:203]
    v_exp_f32 v5, v5
    v_mfma_f32_16x16x32_bf16 v[204:207], a[220:223], v[16:19], v[204:207]
    v_mul_f32 v6, s57, v6
    v_cvt_pk_bf16_f32 v22, v4, v5
    v_mfma_f32_16x16x32_bf16 v[208:211], a[224:227], v[16:19], v[208:211]
    v_exp_f32 v6, v6
    v_mul_f32 v7, s57, v7
    v_mfma_f32_16x16x32_bf16 v[212:215], a[228:231], v[16:19], v[212:215]
    v_exp_f32 v7, v7
    v_mfma_f32_16x16x32_bf16 v[216:219], a[232:235], v[16:19], v[216:219]
    v_cvt_pk_bf16_f32 v23, v6, v7
    v_mul_f32 v8, s57, v8
    v_mfma_f32_16x16x32_bf16 v[220:223], a[236:239], v[16:19], v[220:223]
    s_sub_u32 s55, s55, 1
    s_cbranch_scc0 L_B_loop
    s_cmp_eq_u32 s56, 3
    s_cbranch_scc1 L_tail_B
L_B_T14:
    v_mfma_f32_16x16x32_bf16 v[0:3], a[144:147], a[16:19], 0
    s_mov_b32 m0, s49
    v_exp_f32 v8, v8
    v_mfma_f32_16x16x32_bf16 v[0:3], a[148:151], a[20:23], v[0:3]
    buffer_load_dwordx4 v49, s[20:23], s46 offen offset:0 nt lds
    v_mfma_f32_16x16x32_bf16 v[0:3], a[152:155], a[24:27], v[0:3]
    v_mul_f32 v9, s57, v9
    v_mul_f32 v10, s57, v10
    v_mfma_f32_16x16x32_bf16 v[0:3], a[156:159], a[28:31], v[0:3]
    v_exp_f32 v9, v9
    v_smfmac_f32_16x16x64_bf16 v[40:43], v[28:31], v[16:23], v48
    v_cvt_pk_bf16_f32 v16, v8, v9
    v_mfma_f32_16x16x32_bf16 v[4:7], a[172:175], a[28:31], 0
    v_exp_f32 v10, v10
    v_mul_f32 v11, s57, v11
    v_mfma_f32_16x16x32_bf16 v[4:7], a[168:171], a[24:27], v[4:7]
    buffer_load_dwordx4 v49, s[24:27], s46 offen offset:1024 nt lds
    v_mfma_f32_16x16x32_bf16 v[4:7], a[164:167], a[20:23], v[4:7]
    v_exp_f32 v11, v11
    v_mfma_f32_16x16x32_bf16 v[4:7], a[160:163], a[16:19], v[4:7]
    v_mul_f32 v12, s57, v12
    v_cvt_pk_bf16_f32 v17, v10, v11
    v_mfma_f32_16x16x32_bf16 v[224:227], a[208:211], v[20:23], v[224:227]
    v_exp_f32 v12, v12
    v_mul_f32 v13, s57, v13
    v_mfma_f32_16x16x32_bf16 v[228:231], a[212:215], v[20:23], v[228:231]
    v_exp_f32 v13, v13
    v_mfma_f32_16x16x32_bf16 v[232:235], a[216:219], v[20:23], v[232:235]
    v_mul_f32 v14, s57, v14
    v_cvt_pk_bf16_f32 v18, v12, v13
    v_mfma_f32_16x16x32_bf16 v[236:239], a[220:223], v[20:23], v[236:239]
    buffer_load_dwordx4 v49, s[20:23], s46 offen offset:2048 nt lds
    v_mfma_f32_16x16x32_bf16 v[240:243], a[224:227], v[20:23], v[240:243]
    v_exp_f32 v14, v14
    v_mul_f32 v15, s57, v15
    v_mfma_f32_16x16x32_bf16 v[244:247], a[228:231], v[20:23], v[244:247]
    v_exp_f32 v15, v15
    v_mfma_f32_16x16x32_bf16 v[248:251], a[232:235], v[20:23], v[248:251]
    v_cvt_pk_bf16_f32 v19, v14, v15
    v_mul_f32 v0, s57, v0
    v_mfma_f32_16x16x32_bf16 v[252:255], a[236:239], v[20:23], v[252:255]
    v_exp_f32 v0, v0
    v_mul_f32 v1, s57, v1
    v_mfma_f32_16x16x32_bf16 v[8:11], a[144:147], a[96:99], 0
    v_exp_f32 v1, v1
    v_mfma_f32_16x16x32_bf16 v[8:11], a[148:151], a[100:103], v[8:11]
    buffer_load_dwordx4 v49, s[24:27], s46 offen offset:3072 nt lds
    v_mfma_f32_16x16x32_bf16 v[8:11], a[152:155], a[104:107], v[8:11]
    s_add_u32 s46, s46, 4096
    v_cvt_pk_bf16_f32 v20, v0, v1
    v_mfma_f32_16x16x32_bf16 v[8:11], a[156:159], a[108:111], v[8:11]
    s_add_u32 m0, s49, 4096
    v_mul_f32 v2, s57, v2
    v_mul_f32 v3, s57, v3
    v_mfma_f32_16x16x32_bf16 v[64:67], a[176:179], v[16:19], v[64:67]
    v_exp_f32 v2, v2
    v_mfma_f32_16x16x32_bf16 v[68:71], a[180:183], v[16:19], v[68:71]
    v_exp_f32 v3, v3
    v_mfma_f32_16x16x32_bf16 v[72:75], a[184:187], v[16:19], v[72:75]
    v_mul_f32 v4, s57, v4
    v_cvt_pk_bf16_f32 v21, v2, v3
    v_mfma_f32_16x16x32_bf16 v[76:79], a[188:191], v[16:19], v[76:79]
    v_exp_f32 v4, v4
    v_mfma_f32_16x16x32_bf16 v[80:83], a[192:195], v[16:19], v[80:83]
    v_mul_f32 v5, s57, v5
    v_mul_f32 v6, s57, v6
    v_mfma_f32_16x16x32_bf16 v[84:87], a[196:199], v[16:19], v[84:87]
    v_exp_f32 v6, v6
    v_mfma_f32_16x16x32_bf16 v[88:91], a[200:203], v[16:19], v[88:91]
    v_mul_f32 v7, s57, v7
    v_mul_f32 v8, s57, v8
    v_mfma_f32_16x16x32_bf16 v[92:95], a[204:207], v[16:19], v[92:95]
    v_exp_f32 v5, v5
    v_mfma_f32_16x16x32_bf16 v[0:3], a[144:147], a[32:35], 0
    v_exp_f32 v7, v7
    v_mfma_f32_16x16x32_bf16 v[0:3], a[148:151], a[36:39], v[0:3]
    v_cvt_pk_bf16_f32 v22, v4, v5
    v_cvt_pk_bf16_f32 v23, v6, v7
    v_mfma_f32_16x16x32_bf16 v[0:3], a[152:155], a[40:43], v[0:3]
    buffer_load_dwordx4 v49, s[20:23], s46 offen offset:0 nt lds
    v_mfma_f32_16x16x32_bf16 v[0:3], a[156:159], a[44:47], v[0:3]
    ds_read_b64_tr_b16 a[210:211], v63 offset:34816
    v_mul_f32 v9, s57, v9
    v_smfmac_f32_16x16x64_bf16 v[32:35], v[28:31], v[16:23], v48
    s_add_u32 s49, s49, 6144
    v_mfma_f32_16x16x32_bf16 v[4:7], a[172:175], a[44:47], 0
    v_exp_f32 v9, v9
    v_mfma_f32_16x16x32_bf16 v[4:7], a[168:171], a[40:43], v[4:7]
    v_exp_f32 v8, v8
    v_mfma_f32_16x16x32_bf16 v[4:7], a[164:167], a[36:39], v[4:7]
    buffer_load_dwordx4 v49, s[24:27], s46 offen offset:1024 nt lds
    v_mfma_f32_16x16x32_bf16 v[4:7], a[160:163], a[32:35], v[4:7]
    s_add_u32 s46, s46, 2048
    v_cvt_pk_bf16_f32 v24, v8, v9
    v_mfma_f32_16x16x32_bf16 v[96:99], a[176:179], v[20:23], v[96:99]
    ds_read_b64_tr_b16 a[214:215], v63 offset:34824
    v_mul_f32 v10, s57, v10
    v_mfma_f32_16x16x32_bf16 v[100:103], a[180:183], v[20:23], v[100:103]
    v_exp_f32 v10, v10
    v_mfma_f32_16x16x32_bf16 v[104:107], a[184:187], v[20:23], v[104:107]
    ds_read_b64_tr_b16 a[216:217], v62 offset:35328
    v_mul_f32 v11, s57, v11
    v_mfma_f32_16x16x32_bf16 v[108:111], a[188:191], v[20:23], v[108:111]
    v_exp_f32 v11, v11
    v_mfma_f32_16x16x32_bf16 v[112:115], a[192:195], v[20:23], v[112:115]
    ds_read_b64_tr_b16 a[208:209], v62 offset:34816
    v_cvt_pk_bf16_f32 v25, v10, v11
    v_mfma_f32_16x16x32_bf16 v[116:119], a[196:199], v[20:23], v[116:119]
    ds_read_b64_tr_b16 a[212:213], v62 offset:34824
    ds_read_b64_tr_b16 a[218:219], v63 offset:35328
    v_mfma_f32_16x16x32_bf16 v[120:123], a[200:203], v[20:23], v[120:123]
    ds_read_b64_tr_b16 a[222:223], v63 offset:35336
    v_mul_f32 v0, s57, v0
    v_mfma_f32_16x16x32_bf16 v[124:127], a[204:207], v[20:23], v[124:127]
    ds_read_b64_tr_b16 a[220:221], v62 offset:35336
    v_add_u32 v51, 0xffffb800, v51
    v_mfma_f32_16x16x32_bf16 v[8:11], a[144:147], a[48:51], 0
    v_exp_f32 v0, v0
    v_mfma_f32_16x16x32_bf16 v[8:11], a[148:151], a[52:55], v[8:11]
    ds_read_b64_tr_b16 a[224:225], v62 offset:35840
    v_mul_f32 v1, s57, v1
    v_mfma_f32_16x16x32_bf16 v[8:11], a[152:155], a[56:59], v[8:11]
    v_exp_f32 v1, v1
    v_mfma_f32_16x16x32_bf16 v[8:11], a[156:159], a[60:63], v[8:11]
    v_mul_f32 v2, s57, v2
    v_cvt_pk_bf16_f32 v16, v0, v1
    v_smfmac_f32_16x16x64_bf16 v[44:47], v[28:31], v[20:27], v48
    v_mfma_f32_16x16x32_bf16 v[12:15], a[172:175], a[60:63], 0
    ds_read_b64_tr_b16 a[226:227], v63 offset:35840
    v_mul_f32 v3, s57, v3
    v_mfma_f32_16x16x32_bf16 v[12:15], a[168:171], a[56:59], v[12:15]
    v_exp_f32 v3, v3
    v_mfma_f32_16x16x32_bf16 v[12:15], a[164:167], a[52:55], v[12:15]
    v_exp_f32 v2, v2
    v_mfma_f32_16x16x32_bf16 v[12:15], a[160:163], a[48:51], v[12:15]
    v_mul_f32 v4, s57, v4
    v_cvt_pk_bf16_f32 v17, v2, v3
    v_mfma_f32_16x16x16_bf16 a[112:115], a[176:177], v[24:25], a[112:115]
    v_exp_f32 v4, v4
    v_mul_f32 v5, s57, v5
    v_mfma_f32_16x16x16_bf16 a[116:119], a[180:181], v[24:25], a[116:119]
    ds_read_b64_tr_b16 a[228:229], v62 offset:35848
    v_exp_f32 v5, v5
    v_mfma_f32_16x16x16_bf16 a[120:123], a[184:185], v[24:25], a[120:123]
    ds_read_b64_tr_b16 a[238:239], v63 offset:36360
    v_mul_f32 v6, s57, v6
    v_cvt_pk_bf16_f32 v18, v4, v5
    v_mfma_f32_16x16x16_bf16 a[124:127], a[188:189], v[24:25], a[124:127]
    ds_read_b64_tr_b16 a[230:231], v63 offset:35848
    v_exp_f32 v6, v6
    v_mfma_f32_16x16x16_bf16 a[128:131], a[192:193], v[24:25], a[128:131]
    v_mul_f32 v7, s57, v7
    v_mfma_f32_16x16x16_bf16 a[132:135], a[196:197], v[24:25], a[132:135]
    ds_read_b64_tr_b16 a[232:233], v62 offset:36352
    v_exp_f32 v7, v7
    v_mfma_f32_16x16x16_bf16 a[136:139], a[200:201], v[24:25], a[136:139]
    v_cvt_pk_bf16_f32 v19, v6, v7
    v_mul_f32 v8, s57, v8
    v_mfma_f32_16x16x16_bf16 a[140:143], a[204:205], v[24:25], a[140:143]
    v_exp_f32 v8, v8
    v_mul_f32 v11, s57, v11
    v_mfma_f32_16x16x32_bf16 v[0:3], a[144:147], a[64:67], 0
    ds_read_b64_tr_b16 a[234:235], v63 offset:36352
    ds_read_b64_tr_b16 a[236:237], v62 offset:36360
    v_mfma_f32_16x16x32_bf16 v[0:3], a[148:151], a[68:71], v[0:3]
    v_mul_f32 v9, s57, v9
    v_mul_f32 v12, s57, v12
    v_mfma_f32_16x16x32_bf16 v[0:3], a[152:155], a[72:75], v[0:3]
    v_exp_f32 v9, v9
    v_mfma_f32_16x16x32_bf16 v[0:3], a[156:159], a[76:79], v[0:3]
    v_mul_f32 v10, s57, v10
    v_cvt_pk_bf16_f32 v20, v8, v9
    v_mfma_f32_16x16x32_bf16 v[4:7], a[172:175], a[76:79], 0
    v_exp_f32 v10, v10
    v_mfma_f32_16x16x32_bf16 v[4:7], a[168:171], a[72:75], v[4:7]
    v_exp_f32 v12, v12
    v_mfma_f32_16x16x32_bf16 v[4:7], a[164:167], a[68:71], v[4:7]
    v_exp_f32 v11, v11
    v_mfma_f32_16x16x32_bf16 v[4:7], a[160:163], a[64:67], v[4:7]
    v_cvt_pk_bf16_f32 v21, v10, v11
    v_mul_f32 v13, s57, v13
    v_mfma_f32_16x16x32_bf16 v[128:131], a[176:179], v[16:19], v[128:131]
    v_exp_f32 v13, v13
    v_mfma_f32_16x16x32_bf16 v[132:135], a[180:183], v[16:19], v[132:135]
    v_mul_f32 v14, s57, v14
    v_mul_f32 v15, s57, v15
    v_mfma_f32_16x16x32_bf16 v[136:139], a[184:187], v[16:19], v[136:139]
    v_exp_f32 v15, v15
    v_mfma_f32_16x16x32_bf16 v[140:143], a[188:191], v[16:19], v[140:143]
    v_cvt_pk_bf16_f32 v22, v12, v13
    v_mul_f32 v0, s57, v0
    v_mfma_f32_16x16x32_bf16 v[144:147], a[192:195], v[16:19], v[144:147]
    v_exp_f32 v14, v14
    v_mfma_f32_16x16x32_bf16 v[148:151], a[196:199], v[16:19], v[148:151]
    v_exp_f32 v0, v0
    v_mfma_f32_16x16x32_bf16 v[152:155], a[200:203], v[16:19], v[152:155]
    v_mul_f32 v1, s57, v1
    v_mul_f32 v2, s57, v2
    v_mfma_f32_16x16x32_bf16 v[156:159], a[204:207], v[16:19], v[156:159]
    v_cvt_pk_bf16_f32 v23, v14, v15
    v_mul_f32 v3, s57, v3
    v_mfma_f32_16x16x32_bf16 v[8:11], a[144:147], a[80:83], 0
    v_exp_f32 v1, v1
    v_mfma_f32_16x16x32_bf16 v[8:11], a[148:151], a[84:87], v[8:11]
    ds_read_b128 a[144:147], v58 offset:32768
    ds_read_b128 a[148:151], v58 offset:33280
    v_mfma_f32_16x16x32_bf16 v[8:11], a[152:155], a[88:91], v[8:11]
    v_exp_f32 v2, v2
    v_mfma_f32_16x16x32_bf16 v[8:11], a[156:159], a[92:95], v[8:11]
    v_exp_f32 v3, v3
    v_smfmac_f32_16x16x64_bf16 v[36:39], v[28:31], v[16:23], v48
    ds_read_b128 a[152:155], v58 offset:33792
    v_mfma_f32_16x16x32_bf16 v[12:15], a[172:175], a[92:95], 0
    ds_read_b128 a[156:159], v58 offset:34304
    v_cvt_pk_bf16_f32 v16, v0, v1
    v_mfma_f32_16x16x32_bf16 v[12:15], a[168:171], a[88:91], v[12:15]
    ds_read_b128 a[172:175], v59 offset:34304
    ds_read_b128 a[168:171], v59 offset:33792
    v_mfma_f32_16x16x32_bf16 v[12:15], a[164:167], a[84:87], v[12:15]
    v_mul_f32 v4, s57, v4
    v_cvt_pk_bf16_f32 v17, v2, v3
    v_mfma_f32_16x16x32_bf16 v[12:15], a[160:163], a[80:83], v[12:15]
    v_exp_f32 v4, v4
    v_mfma_f32_16x16x32_bf16 v[160:163], a[176:179], v[20:23], v[160:163]
    ds_read_b128 a[160:163], v59 offset:32768
    v_mul_f32 v5, s57, v5
    v_mfma_f32_16x16x32_bf16 v[164:167], a[180:183], v[20:23], v[164:167]
    ds_read_b128 a[164:167], v59 offset:33280
    v_mul_f32 v6, s57, v6
    v_mfma_f32_16x16x32_bf16 v[168:171], a[184:187], v[20:23], v[168:171]
    v_exp_f32 v5, v5
    v_mfma_f32_16x16x32_bf16 v[172:175], a[188:191], v[20:23], v[172:175]
    v_exp_f32 v6, v6
    v_mfma_f32_16x16x32_bf16 v[176:179], a[192:195], v[20:23], v[176:179]
    v_cvt_pk_bf16_f32 v18, v4, v5
    v_mul_f32 v7, s57, v7
    v_mfma_f32_16x16x32_bf16 v[180:183], a[196:199], v[20:23], v[180:183]
    v_exp_f32 v7, v7
    v_mfma_f32_16x16x32_bf16 v[184:187], a[200:203], v[20:23], v[184:187]
    v_cvt_pk_bf16_f32 v19, v6, v7
    v_mul_f32 v8, s57, v8
    v_mfma_f32_16x16x32_bf16 v[188:191], a[204:207], v[20:23], v[188:191]
    s_waitcnt lgkmcnt(4)
    v_mfma_f32_16x16x32_bf16 v[0:3], a[144:147], a[0:3], 0
    v_exp_f32 v8, v8
    v_mfma_f32_16x16x32_bf16 v[0:3], a[148:151], a[4:7], v[0:3]
    v_mul_f32 v9, s57, v9
    v_mul_f32 v10, s57, v10
    v_mfma_f32_16x16x32_bf16 v[0:3], a[152:155], a[8:11], v[0:3]
    v_exp_f32 v9, v9
    v_mfma_f32_16x16x32_bf16 v[0:3], a[156:159], a[12:15], v[0:3]
    s_waitcnt lgkmcnt(0)
    v_cvt_pk_bf16_f32 v20, v8, v9
    v_mfma_f32_16x16x32_bf16 v[4:7], a[172:175], a[12:15], 0
    v_exp_f32 v10, v10
    v_mfma_f32_16x16x32_bf16 v[4:7], a[168:171], a[8:11], v[4:7]
    v_mul_f32 v11, s57, v11
    v_mfma_f32_16x16x32_bf16 v[4:7], a[164:167], a[4:7], v[4:7]
    v_exp_f32 v11, v11
    v_mfma_f32_16x16x32_bf16 v[4:7], a[160:163], a[0:3], v[4:7]
    v_mul_f32 v12, s57, v12
    v_cvt_pk_bf16_f32 v21, v10, v11
    v_mfma_f32_16x16x32_bf16 v[192:195], a[176:179], v[16:19], v[192:195]
    v_exp_f32 v12, v12
    v_mfma_f32_16x16x32_bf16 v[196:199], a[180:183], v[16:19], v[196:199]
    v_mul_f32 v13, s57, v13
    v_mfma_f32_16x16x32_bf16 v[200:203], a[184:187], v[16:19], v[200:203]
    v_exp_f32 v13, v13
    v_mfma_f32_16x16x32_bf16 v[204:207], a[188:191], v[16:19], v[204:207]
    v_mul_f32 v14, s57, v14
    v_cvt_pk_bf16_f32 v22, v12, v13
    v_mfma_f32_16x16x32_bf16 v[208:211], a[192:195], v[16:19], v[208:211]
    v_exp_f32 v14, v14
    v_mfma_f32_16x16x32_bf16 v[212:215], a[196:199], v[16:19], v[212:215]
    v_mul_f32 v15, s57, v15
    v_mfma_f32_16x16x32_bf16 v[216:219], a[200:203], v[16:19], v[216:219]
    v_exp_f32 v15, v15
    v_mfma_f32_16x16x32_bf16 v[220:223], a[204:207], v[16:19], v[220:223]
    v_mul_f32 v0, s57, v0
    v_cvt_pk_bf16_f32 v23, v14, v15
    v_mfma_f32_16x16x32_bf16 v[8:11], a[144:147], a[16:19], 0
    ds_read_b128 a[0:3], v50 offset:0
    s_waitcnt vmcnt(6)
    s_barrier
    v_mfma_f32_16x16x32_bf16 v[8:11], a[148:151], a[20:23], v[8:11]
    ds_read_b128 a[4:7], v50 offset:512
    s_mov_b32 m0, s52
    v_mul_f32 v1, s57, v1
    v_mfma_f32_16x16x32_bf16 v[8:11], a[152:155], a[24:27], v[8:11]
    buffer_load_dwordx4 v49, s[4:7], s44 offen offset:0 lds
    v_mfma_f32_16x16x32_bf16 v[8:11], a[156:159], a[28:31], v[8:11]
    ds_read_b128 a[8:11], v50 offset:1024
    ds_read_b128 a[12:15], v50 offset:1536
    v_mul_f32 v2, s57, v2
    v_smfmac_f32_16x16x64_bf16 v[40:43], v[28:31], v[16:23], v48
    v_exp_f32 v0, v0
    v_mfma_f32_16x16x32_bf16 v[12:15], a[172:175], a[28:31], 0
    v_exp_f32 v1, v1
    v_mul_f32 v3, s57, v3
    v_mfma_f32_16x16x32_bf16 v[12:15], a[168:171], a[24:27], v[12:15]
    v_cvt_pk_bf16_f32 v16, v0, v1
    v_exp_f32 v3, v3
    v_mfma_f32_16x16x32_bf16 v[12:15], a[164:167], a[20:23], v[12:15]
    v_exp_f32 v2, v2
    v_mul_f32 v4, s57, v4
    v_mfma_f32_16x16x32_bf16 v[12:15], a[160:163], a[16:19], v[12:15]
    buffer_load_dwordx4 v49, s[8:11], s44 offen offset:1024 lds
    v_cvt_pk_bf16_f32 v17, v2, v3
    v_mfma_f32_16x16x32_bf16 v[224:227], a[176:179], v[20:23], v[224:227]
    v_exp_f32 v4, v4
    v_mul_f32 v5, s57, v5
    v_mfma_f32_16x16x32_bf16 v[228:231], a[180:183], v[20:23], v[228:231]
    ds_read_b128 a[20:23], v50 offset:4608
    v_exp_f32 v5, v5
    v_mfma_f32_16x16x32_bf16 v[232:235], a[184:187], v[20:23], v[232:235]
    ds_read_b128 a[16:19], v50 offset:4096
    ds_read_b128 a[28:31], v50 offset:5632
    v_mul_f32 v6, s57, v6
    v_mfma_f32_16x16x32_bf16 v[236:239], a[188:191], v[20:23], v[236:239]
    s_waitcnt lgkmcnt(3)
    v_exp_f32 v6, v6
    v_mfma_f32_16x16x32_bf16 v[240:243], a[192:195], v[20:23], v[240:243]
    v_cvt_pk_bf16_f32 v18, v4, v5
    v_mul_f32 v7, s57, v7
    v_mfma_f32_16x16x32_bf16 v[244:247], a[196:199], v[20:23], v[244:247]
    buffer_load_dwordx4 v49, s[12:15], s44 offen offset:2048 lds
    v_mfma_f32_16x16x32_bf16 v[248:251], a[200:203], v[20:23], v[248:251]
    v_exp_f32 v7, v7
    v_mul_f32 v8, s57, v8
    v_mfma_f32_16x16x32_bf16 v[252:255], a[204:207], v[20:23], v[252:255]
    ds_read_b128 a[24:27], v50 offset:5120
    v_cvt_pk_bf16_f32 v19, v6, v7
    v_mfma_f32_16x16x32_bf16 v[0:3], a[144:147], a[32:35], 0
    v_exp_f32 v8, v8
    v_mul_f32 v9, s57, v9
    v_mfma_f32_16x16x32_bf16 v[0:3], a[148:151], a[36:39], v[0:3]
    ds_read_b64_tr_b16 a[178:179], v61 offset:2048
    v_exp_f32 v9, v9
    v_mfma_f32_16x16x32_bf16 v[0:3], a[152:155], a[40:43], v[0:3]
    v_cvt_pk_bf16_f32 v20, v8, v9
    v_add_f32 v47, v45, v47
    v_mul_f32 v13, s57, v13
    v_mfma_f32_16x16x32_bf16 v[0:3], a[156:159], a[44:47], v[0:3]
    buffer_load_dwordx4 v49, s[16:19], s44 offen offset:3072 lds
    v_mul_f32 v10, s57, v10
    v_mfma_f32_16x16x32_bf16 v[4:7], a[172:175], a[44:47], 0
    s_add_u32 s44, s44, 8192
    v_exp_f32 v10, v10
    v_mfma_f32_16x16x32_bf16 v[4:7], a[168:171], a[40:43], v[4:7]
    v_mul_f32 v11, s57, v11
    v_exp_f32 v13, v13
    v_mfma_f32_16x16x32_bf16 v[4:7], a[164:167], a[36:39], v[4:7]
    s_mov_b32 m0, s54
    v_exp_f32 v11, v11
    v_mfma_f32_16x16x32_bf16 v[4:7], a[160:163], a[32:35], v[4:7]
    ds_read_b64_tr_b16 a[180:181], v60 offset:2056
    ds_read_b128 a[32:35], v50 offset:8192
    v_mul_f32 v12, s57, v12
    v_mfma_f32_16x16x32_bf16 v[64:67], a[208:211], v[16:19], v[64:67]
    ds_read_b128 a[36:39], v50 offset:8704
    v_exp_f32 v12, v12
    v_mfma_f32_16x16x32_bf16 v[68:71], a[212:215], v[16:19], v[68:71]
    buffer_load_dwordx4 v49, s[20:23], s47 offen offset:0 nt lds
    v_cvt_pk_bf16_f32 v21, v10, v11
    v_mfma_f32_16x16x32_bf16 v[72:75], a[216:219], v[16:19], v[72:75]
    ds_read_b128 a[40:43], v50 offset:9216
    ds_read_b128 a[44:47], v50 offset:9728
    v_mul_f32 v14, s57, v14
    v_mfma_f32_16x16x32_bf16 v[76:79], a[220:223], v[16:19], v[76:79]
    ds_read_b64_tr_b16 a[182:183], v61 offset:2056
    ds_read_b64_tr_b16 a[190:191], v61 offset:2568
    v_cvt_pk_bf16_f32 v22, v12, v13
    v_mfma_f32_16x16x32_bf16 v[80:83], a[224:227], v[16:19], v[80:83]
    v_exp_f32 v14, v14
    v_mul_f32 v15, s57, v15
    v_mfma_f32_16x16x32_bf16 v[84:87], a[228:231], v[16:19], v[84:87]
    v_exp_f32 v15, v15
    v_mul_f32 v0, s57, v0
    v_mfma_f32_16x16x32_bf16 v[88:91], a[232:235], v[16:19], v[88:91]
    ds_write_b128 v51, a[112:115] offset:4096
    v_mfma_f32_16x16x32_bf16 v[92:95], a[236:239], v[16:19], v[92:95]
    buffer_load_dwordx4 v49, s[24:27], s47 offen offset:1024 nt lds
    v_cvt_pk_bf16_f32 v23, v14, v15
    v_mfma_f32_16x16x32_bf16 v[8:11], a[144:147], a[48:51], 0
    ds_write_b128 v51, a[120:123] offset:6144
    v_mfma_f32_16x16x32_bf16 v[8:11], a[148:151], a[52:55], v[8:11]
    v_exp_f32 v0, v0
    v_mul_f32 v1, s57, v1
    v_mfma_f32_16x16x32_bf16 v[8:11], a[152:155], a[56:59], v[8:11]
    ds_read_b64_tr_b16 a[188:189], v60 offset:2568
    v_exp_f32 v1, v1
    v_mfma_f32_16x16x32_bf16 v[8:11], a[156:159], a[60:63], v[8:11]
    ds_read_b64_tr_b16 a[176:177], v60 offset:2048
    ds_read_b64_tr_b16 a[186:187], v61 offset:2560
    v_mul_f32 v2, s57, v2
    v_smfmac_f32_16x16x64_bf16 v[32:35], v[28:31], v[16:23], v48
    v_cvt_pk_bf16_f32 v16, v0, v1
    v_exp_f32 v2, v2
    v_mfma_f32_16x16x32_bf16 v[12:15], a[172:175], a[60:63], 0
    buffer_load_dwordx4 v49, s[20:23], s47 offen offset:2048 nt lds
    v_mul_f32 v3, s57, v3
    v_mfma_f32_16x16x32_bf16 v[12:15], a[168:171], a[56:59], v[12:15]
    v_exp_f32 v3, v3
    v_mul_f32 v4, s57, v4
    v_mfma_f32_16x16x32_bf16 v[12:15], a[164:167], a[52:55], v[12:15]
    v_cvt_pk_bf16_f32 v17, v2, v3
    v_exp_f32 v4, v4
    v_mfma_f32_16x16x32_bf16 v[12:15], a[160:163], a[48:51], v[12:15]
    ds_write_b128 v51, a[116:119] offset:5120
    v_mfma_f32_16x16x32_bf16 v[96:99], a[208:211], v[20:23], v[96:99]
    ds_read_b64_tr_b16 a[192:193], v60 offset:3072
    ds_read_b128 a[56:59], v50 offset:13312
    v_mul_f32 v5, s57, v5
    v_mfma_f32_16x16x32_bf16 v[100:103], a[212:215], v[20:23], v[100:103]
    ds_read_b128 a[60:63], v50 offset:13824
    v_exp_f32 v5, v5
    v_mfma_f32_16x16x32_bf16 v[104:107], a[216:219], v[20:23], v[104:107]
    buffer_load_dwordx4 v49, s[24:27], s47 offen offset:3072 nt lds
    v_mul_f32 v6, s57, v6
    v_cvt_pk_bf16_f32 v18, v4, v5
    v_mfma_f32_16x16x32_bf16 v[108:111], a[220:223], v[20:23], v[108:111]
    s_mov_b32 m0, s53
    v_exp_f32 v6, v6
    v_mul_f32 v7, s57, v7
    v_mfma_f32_16x16x32_bf16 v[112:115], a[224:227], v[20:23], v[112:115]
    ds_read_b128 a[52:55], v50 offset:12800
    v_exp_f32 v7, v7
    v_mfma_f32_16x16x32_bf16 v[116:119], a[228:231], v[20:23], v[116:119]
    ds_read_b64_tr_b16 a[196:197], v60 offset:3080
    v_cvt_pk_bf16_f32 v19, v6, v7
    v_mul_f32 v8, s57, v8
    v_mfma_f32_16x16x32_bf16 v[120:123], a[232:235], v[20:23], v[120:123]
    ds_write_b128 v51, a[124:127] offset:7168
    v_mfma_f32_16x16x32_bf16 v[124:127], a[236:239], v[20:23], v[124:127]
    ds_write_b128 v51, a[132:135] offset:9216
    v_mfma_f32_16x16x32_bf16 v[0:3], a[144:147], a[64:67], 0
    buffer_load_dwordx4 v49, s[4:7], s44 offen offset:0 lds
    v_mul_f32 v9, s57, v9
    v_mfma_f32_16x16x32_bf16 v[0:3], a[148:151], a[68:71], v[0:3]
    ds_read_b64_tr_b16 a[194:195], v61 offset:3072
    v_exp_f32 v8, v8
    v_mfma_f32_16x16x32_bf16 v[0:3], a[152:155], a[72:75], v[0:3]
    ds_read_b64_tr_b16 a[198:199], v61 offset:3080
    v_exp_f32 v9, v9
    v_mfma_f32_16x16x32_bf16 v[0:3], a[156:159], a[76:79], v[0:3]
    ds_read_b128 a[48:51], v50 offset:12288
    v_mul_f32 v10, s57, v10
    v_cvt_pk_bf16_f32 v20, v8, v9
    v_mfma_f32_16x16x32_bf16 v[4:7], a[172:175], a[76:79], 0
    v_exp_f32 v10, v10
    v_mul_f32 v11, s57, v11
    v_mfma_f32_16x16x32_bf16 v[4:7], a[168:171], a[72:75], v[4:7]
    ds_write_b128 v51, a[128:131] offset:8192
    v_mfma_f32_16x16x32_bf16 v[4:7], a[164:167], a[68:71], v[4:7]
    buffer_load_dwordx4 v49, s[8:11], s44 offen offset:1024 lds
    s_waitcnt vmcnt(10)
    v_mfma_f32_16x16x32_bf16 v[4:7], a[160:163], a[64:67], v[4:7]
    ds_read_b64_tr_b16 a[200:201], v60 offset:3584
    ds_read_b64_tr_b16 a[206:207], v61 offset:3592
    v_mul_f32 v12, s57, v12
    v_mfma_f32_16x16x32_bf16 v[128:131], a[208:211], v[16:19], v[128:131]
    v_exp_f32 v11, v11
    v_mul_f32 v13, s57, v13
    v_mfma_f32_16x16x32_bf16 v[132:135], a[212:215], v[16:19], v[132:135]
    ds_write_b128 v51, a[140:143] offset:11264
    v_mfma_f32_16x16x32_bf16 v[136:139], a[216:219], v[16:19], v[136:139]
    v_cvt_pk_bf16_f32 v21, v10, v11
    v_exp_f32 v13, v13
    v_mfma_f32_16x16x32_bf16 v[140:143], a[220:223], v[16:19], v[140:143]
    v_exp_f32 v12, v12
    v_mul_f32 v14, s57, v14
    v_mfma_f32_16x16x32_bf16 v[144:147], a[224:227], v[16:19], v[144:147]
    buffer_load_dwordx4 v49, s[12:15], s44 offen offset:2048 lds
    v_cvt_pk_bf16_f32 v22, v12, v13
    v_mfma_f32_16x16x32_bf16 v[148:151], a[228:231], v[16:19], v[148:151]
    v_exp_f32 v14, v14
    v_mul_f32 v15, s57, v15
    v_mfma_f32_16x16x32_bf16 v[152:155], a[232:235], v[16:19], v[152:155]
    ds_read_b64_tr_b16 a[184:185], v60 offset:2560
    v_exp_f32 v15, v15
    v_mfma_f32_16x16x32_bf16 v[156:159], a[236:239], v[16:19], v[156:159]
    ds_read_b128 a[68:71], v50 offset:16896
    v_mul_f32 v0, s57, v0
    v_cvt_pk_bf16_f32 v23, v14, v15
    v_mfma_f32_16x16x32_bf16 v[8:11], a[144:147], a[80:83], 0
    ds_read_b128 a[72:75], v50 offset:17408
    v_exp_f32 v0, v0
    v_mfma_f32_16x16x32_bf16 v[8:11], a[148:151], a[84:87], v[8:11]
    ds_read_b128 a[76:79], v50 offset:17920
    ds_read_b128 a[144:147], v56 offset:0
    v_mul_f32 v1, s57, v1
    v_mfma_f32_16x16x32_bf16 v[8:11], a[152:155], a[88:91], v[8:11]
    buffer_load_dwordx4 v49, s[16:19], s44 offen offset:3072 lds
    s_add_u32 s44, s44, 8192
    v_mfma_f32_16x16x32_bf16 v[8:11], a[156:159], a[92:95], v[8:11]
    ds_read_b64_tr_b16 a[202:203], v61 offset:3584
    ds_read_b128 a[148:151], v56 offset:512
    v_mul_f32 v2, s57, v2
    v_smfmac_f32_16x16x64_bf16 v[36:39], v[28:31], v[16:23], v48
    ds_write_b128 v51, a[136:139] offset:10240
    v_mfma_f32_16x16x32_bf16 v[12:15], a[172:175], a[92:95], 0
    ds_read_b64_tr_b16 a[204:205], v60 offset:3592
    ds_read_b128 a[156:159], v56 offset:1536
    v_mul_f32 v3, s57, v3
    v_mfma_f32_16x16x32_bf16 v[12:15], a[168:171], a[88:91], v[12:15]
    ds_read_b128 a[152:155], v56 offset:1024
    v_exp_f32 v2, v2
    v_mfma_f32_16x16x32_bf16 v[12:15], a[164:167], a[84:87], v[12:15]
    v_exp_f32 v1, v1
    v_mul_f32 v4, s57, v4
    v_mfma_f32_16x16x32_bf16 v[12:15], a[160:163], a[80:83], v[12:15]
    ds_read_b128 a[64:67], v50 offset:16384
    ds_read_b128 a[80:83], v50 offset:20480
    v_cvt_pk_bf16_f32 v16, v0, v1
    v_mfma_f32_16x16x32_bf16 v[160:163], a[208:211], v[20:23], v[160:163]
    ds_read_b128 a[168:171], v57 offset:1024
    ds_read_b128 a[88:91], v50 offset:21504
    v_mul_f32 v5, s57, v5
    v_mfma_f32_16x16x32_bf16 v[164:167], a[212:215], v[20:23], v[164:167]
    ds_read_b128 a[172:175], v57 offset:1536
    ds_read_b128 a[164:167], v57 offset:512
    ds_read_b128 a[160:163], v57 offset:0
    v_mfma_f32_16x16x32_bf16 v[168:171], a[216:219], v[20:23], v[168:171]
    ds_read_b128 a[84:87], v50 offset:20992
    ds_read_b128 a[92:95], v50 offset:22016
    ds_write_b32 v51, v47 offset:20480
    v_mfma_f32_16x16x32_bf16 v[172:175], a[220:223], v[20:23], v[172:175]
    v_exp_f32 v3, v3
    v_mul_f32 v6, s57, v6
    v_mfma_f32_16x16x32_bf16 v[176:179], a[224:227], v[20:23], v[176:179]
    v_exp_f32 v5, v5
    v_mul_f32 v7, s57, v7
    v_mfma_f32_16x16x32_bf16 v[180:183], a[228:231], v[20:23], v[180:183]
    v_cvt_pk_bf16_f32 v17, v2, v3
    v_exp_f32 v7, v7
    v_mfma_f32_16x16x32_bf16 v[184:187], a[232:235], v[20:23], v[184:187]
    v_exp_f32 v6, v6
    v_mul_f32 v8, s57, v8
    v_mfma_f32_16x16x32_bf16 v[188:191], a[236:239], v[20:23], v[188:191]
    s_waitcnt lgkmcnt(10)
    v_cvt_pk_bf16_f32 v19, v6, v7
    v_mfma_f32_16x16x32_bf16 v[0:3], a[144:147], a[0:3], 0
    v_exp_f32 v4, v4
    v_mfma_f32_16x16x32_bf16 v[0:3], a[148:151], a[4:7], v[0:3]
    v_cvt_pk_bf16_f32 v18, v4, v5
    v_mul_f32 v9, s57, v9
    v_mfma_f32_16x16x32_bf16 v[0:3], a[152:155], a[8:11], v[0:3]
    v_exp_f32 v9, v9
    v_mfma_f32_16x16x32_bf16 v[0:3], a[156:159], a[12:15], v[0:3]
    s_waitcnt lgkmcnt(0)
    v_mul_f32 v10, s57, v10
    v_mfma_f32_16x16x32_bf16 v[4:7], a[172:175], a[12:15], 0
    v_exp_f32 v10, v10
    v_mfma_f32_16x16x32_bf16 v[4:7], a[168:171], a[8:11], v[4:7]
    v_exp_f32 v8, v8
    v_mul_f32 v11, s57, v11
    v_mfma_f32_16x16x32_bf16 v[4:7], a[164:167], a[4:7], v[4:7]
    v_exp_f32 v11, v11
    v_mfma_f32_16x16x32_bf16 v[4:7], a[160:163], a[0:3], v[4:7]
    v_cvt_pk_bf16_f32 v20, v8, v9
    v_mul_f32 v12, s57, v12
    v_mfma_f32_16x16x32_bf16 v[192:195], a[208:211], v[16:19], v[192:195]
    v_cvt_pk_bf16_f32 v21, v10, v11
    v_mul_f32 v13, s57, v13
    v_mfma_f32_16x16x32_bf16 v[196:199], a[212:215], v[16:19], v[196:199]
    v_exp_f32 v12, v12
    v_mfma_f32_16x16x32_bf16 v[200:203], a[216:219], v[16:19], v[200:203]
    v_exp_f32 v13, v13
    v_mfma_f32_16x16x32_bf16 v[204:207], a[220:223], v[16:19], v[204:207]
    v_mul_f32 v14, s57, v14
    v_cvt_pk_bf16_f32 v22, v12, v13
    v_mfma_f32_16x16x32_bf16 v[208:211], a[224:227], v[16:19], v[208:211]
    v_exp_f32 v14, v14
    v_mul_f32 v15, s57, v15
    v_mfma_f32_16x16x32_bf16 v[212:215], a[228:231], v[16:19], v[212:215]
    v_exp_f32 v15, v15
    v_mfma_f32_16x16x32_bf16 v[216:219], a[232:235], v[16:19], v[216:219]
    v_cvt_pk_bf16_f32 v23, v14, v15
    v_mul_f32 v0, s57, v0
    v_mfma_f32_16x16x32_bf16 v[220:223], a[236:239], v[16:19], v[220:223]
    s_branch L_A_S0
    s_nop 0
    s_nop 0
    s_nop 0
L_tail_A:
    v_mfma_f32_16x16x32_bf16 v[8:11], a[144:147], a[16:19], 0
    v_exp_f32 v0, v0
    v_mfma_f32_16x16x32_bf16 v[8:11], a[148:151], a[20:23], v[8:11]
    ds_read_b128 a[144:147], v58 offset:32768
    ds_read_b128 a[148:151], v58 offset:33280
    v_mul_f32 v1, s57, v1
    v_mfma_f32_16x16x32_bf16 v[8:11], a[152:155], a[24:27], v[8:11]
    v_exp_f32 v1, v1
    v_mfma_f32_16x16x32_bf16 v[8:11], a[156:159], a[28:31], v[8:11]
    v_mul_f32 v2, s57, v2
    v_cvt_pk_bf16_f32 v16, v0, v1
    v_smfmac_f32_16x16x64_bf16 v[44:47], v[28:31], v[20:27], v48
    ds_read_b128 a[152:155], v58 offset:33792
    v_exp_f32 v2, v2
    v_mfma_f32_16x16x32_bf16 v[12:15], a[172:175], a[28:31], 0
    ds_read_b128 a[156:159], v58 offset:34304
    v_mul_f32 v3, s57, v3
    v_mfma_f32_16x16x32_bf16 v[12:15], a[168:171], a[24:27], v[12:15]
    v_exp_f32 v3, v3
    v_mfma_f32_16x16x32_bf16 v[12:15], a[164:167], a[20:23], v[12:15]
    v_mul_f32 v4, s57, v4
    v_cvt_pk_bf16_f32 v17, v2, v3
    v_mfma_f32_16x16x32_bf16 v[12:15], a[160:163], a[16:19], v[12:15]
    ds_read_b128 a[168:171], v59 offset:33792
    v_exp_f32 v4, v4
    v_mfma_f32_16x16x32_bf16 a[112:115], a[208:211], v[24:27], a[112:115]
    ds_read_b128 a[160:163], v59 offset:32768
    ds_read_b64_tr_b16 a[208:209], v62 offset:34816
    v_mul_f32 v5, s57, v5
    v_mfma_f32_16x16x32_bf16 a[116:119], a[212:215], v[24:27], a[116:119]
    ds_read_b128 a[164:167], v59 offset:33280
    v_exp_f32 v5, v5
    v_mfma_f32_16x16x32_bf16 a[120:123], a[216:219], v[24:27], a[120:123]
    ds_read_b128 a[172:175], v59 offset:34304
    v_mul_f32 v6, s57, v6
    v_cvt_pk_bf16_f32 v18, v4, v5
    v_mfma_f32_16x16x32_bf16 a[124:127], a[220:223], v[24:27], a[124:127]
    ds_read_b64_tr_b16 a[210:211], v63 offset:34816
    v_exp_f32 v6, v6
    v_mfma_f32_16x16x32_bf16 a[128:131], a[224:227], v[24:27], a[128:131]
    ds_read_b64_tr_b16 a[212:213], v62 offset:34824
    v_mul_f32 v7, s57, v7
    v_mfma_f32_16x16x32_bf16 a[132:135], a[228:231], v[24:27], a[132:135]
    ds_read_b64_tr_b16 a[214:215], v63 offset:34824
    v_exp_f32 v7, v7
    v_mfma_f32_16x16x32_bf16 a[136:139], a[232:235], v[24:27], a[136:139]
    v_cvt_pk_bf16_f32 v19, v6, v7
    v_mul_f32 v8, s57, v8
    v_mfma_f32_16x16x32_bf16 a[140:143], a[236:239], v[24:27], a[140:143]
    ds_read_b64_tr_b16 a[216:217], v62 offset:35328
    ds_read_b64_tr_b16 a[218:219], v63 offset:35328
    s_waitcnt lgkmcnt(10)
    v_mfma_f32_16x16x32_bf16 v[0:3], a[144:147], a[0:3], 0
    ds_read_b64_tr_b16 a[220:221], v62 offset:35336
    v_exp_f32 v8, v8
    v_mfma_f32_16x16x32_bf16 v[0:3], a[148:151], a[4:7], v[0:3]
    ds_read_b64_tr_b16 a[224:225], v62 offset:35840
    ds_read_b64_tr_b16 a[228:229], v62 offset:35848
    v_mul_f32 v9, s57, v9
    v_mfma_f32_16x16x32_bf16 v[0:3], a[152:155], a[8:11], v[0:3]
    ds_read_b64_tr_b16 a[222:223], v63 offset:35336
    v_exp_f32 v9, v9
    v_mfma_f32_16x16x32_bf16 v[0:3], a[156:159], a[12:15], v[0:3]
    s_waitcnt lgkmcnt(9)
    v_mul_f32 v10, s57, v10
    v_cvt_pk_bf16_f32 v20, v8, v9
    v_mfma_f32_16x16x32_bf16 v[4:7], a[172:175], a[12:15], 0
    ds_read_b64_tr_b16 a[226:227], v63 offset:35840
    v_exp_f32 v10, v10
    v_mfma_f32_16x16x32_bf16 v[4:7], a[168:171], a[8:11], v[4:7]
    ds_read_b64_tr_b16 a[230:231], v63 offset:35848
    v_mul_f32 v11, s57, v11
    v_mfma_f32_16x16x32_bf16 v[4:7], a[164:167], a[4:7], v[4:7]
    ds_read_b64_tr_b16 a[232:233], v62 offset:36352
    v_exp_f32 v11, v11
    v_mfma_f32_16x16x32_bf16 v[4:7], a[160:163], a[0:3], v[4:7]
    v_mul_f32 v12, s57, v12
    v_cvt_pk_bf16_f32 v21, v10, v11
    v_mfma_f32_16x16x32_bf16 v[64:67], a[176:179], v[16:19], v[64:67]
    ds_read_b64_tr_b16 a[234:235], v63 offset:36352
    v_exp_f32 v12, v12
    v_mfma_f32_16x16x32_bf16 v[68:71], a[180:183], v[16:19], v[68:71]
    ds_read_b64_tr_b16 a[238:239], v63 offset:36360
    v_mul_f32 v13, s57, v13
    v_mfma_f32_16x16x32_bf16 v[72:75], a[184:187], v[16:19], v[72:75]
    v_exp_f32 v13, v13
    v_mfma_f32_16x16x32_bf16 v[76:79], a[188:191], v[16:19], v[76:79]
    v_mul_f32 v14, s57, v14
    v_cvt_pk_bf16_f32 v22, v12, v13
    v_mfma_f32_16x16x32_bf16 v[80:83], a[192:195], v[16:19], v[80:83]
    v_exp_f32 v14, v14
    v_mfma_f32_16x16x32_bf16 v[84:87], a[196:199], v[16:19], v[84:87]
    ds_read_b64_tr_b16 a[236:237], v62 offset:36360
    v_mul_f32 v15, s57, v15
    v_mfma_f32_16x16x32_bf16 v[88:91], a[200:203], v[16:19], v[88:91]
    v_exp_f32 v15, v15
    v_mfma_f32_16x16x32_bf16 v[92:95], a[204:207], v[16:19], v[92:95]
    v_mul_f32 v0, s57, v0
    v_cvt_pk_bf16_f32 v23, v14, v15
    v_mfma_f32_16x16x32_bf16 v[8:11], a[144:147], a[16:19], 0
    v_exp_f32 v0, v0
    v_mfma_f32_16x16x32_bf16 v[8:11], a[148:151], a[20:23], v[8:11]
    ds_read_b128 a[144:147], v56 offset:32768
    v_mul_f32 v1, s57, v1
    v_mfma_f32_16x16x32_bf16 v[8:11], a[152:155], a[24:27], v[8:11]
    v_exp_f32 v1, v1
    v_mfma_f32_16x16x32_bf16 v[8:11], a[156:159], a[28:31], v[8:11]
    ds_read_b128 a[148:151], v56 offset:33280
    ds_read_b128 a[156:159], v56 offset:34304
    v_mul_f32 v2, s57, v2
    v_smfmac_f32_16x16x64_bf16 v[32:35], v[28:31], v[16:23], v48
    v_cvt_pk_bf16_f32 v16, v0, v1
    v_exp_f32 v2, v2
    v_mfma_f32_16x16x32_bf16 v[12:15], a[172:175], a[28:31], 0
    ds_read_b128 a[152:155], v56 offset:33792
    v_mul_f32 v3, s57, v3
    v_mfma_f32_16x16x32_bf16 v[12:15], a[168:171], a[24:27], v[12:15]
    v_exp_f32 v3, v3
    v_mfma_f32_16x16x32_bf16 v[12:15], a[164:167], a[20:23], v[12:15]
    ds_read_b128 a[172:175], v57 offset:34304
    v_mul_f32 v4, s57, v4
    v_cvt_pk_bf16_f32 v17, v2, v3
    v_mfma_f32_16x16x32_bf16 v[12:15], a[160:163], a[16:19], v[12:15]
    ds_read_b128 a[168:171], v57 offset:33792
    v_exp_f32 v4, v4
    v_mfma_f32_16x16x32_bf16 v[96:99], a[176:179], v[20:23], v[96:99]
    ds_read_b128 a[164:167], v57 offset:33280
    ds_read_b128 a[160:163], v57 offset:32768
    v_mul_f32 v5, s57, v5
    v_mfma_f32_16x16x32_bf16 v[100:103], a[180:183], v[20:23], v[100:103]
    ds_read_b64_tr_b16 a[176:177], v60 offset:34816
    v_exp_f32 v5, v5
    v_mfma_f32_16x16x32_bf16 v[104:107], a[184:187], v[20:23], v[104:107]
    v_mul_f32 v6, s57, v6
    v_cvt_pk_bf16_f32 v18, v4, v5
    v_mfma_f32_16x16x32_bf16 v[108:111], a[188:191], v[20:23], v[108:111]
    v_exp_f32 v6, v6
    v_mfma_f32_16x16x32_bf16 v[112:115], a[192:195], v[20:23], v[112:115]
    ds_read_b64_tr_b16 a[178:179], v61 offset:34816
    ds_read_b64_tr_b16 a[182:183], v61 offset:34824
    v_mul_f32 v7, s57, v7
    v_mfma_f32_16x16x32_bf16 v[116:119], a[196:199], v[20:23], v[116:119]
    ds_read_b64_tr_b16 a[188:189], v60 offset:35336
    v_exp_f32 v7, v7
    v_mfma_f32_16x16x32_bf16 v[120:123], a[200:203], v[20:23], v[120:123]
    ds_read_b64_tr_b16 a[180:181], v60 offset:34824
    v_cvt_pk_bf16_f32 v19, v6, v7
    v_mul_f32 v8, s57, v8
    v_mfma_f32_16x16x32_bf16 v[124:127], a[204:207], v[20:23], v[124:127]
    ds_read_b64_tr_b16 a[184:185], v60 offset:35328
    ds_read_b64_tr_b16 a[186:187], v61 offset:35328
    s_waitcnt lgkmcnt(11)
    v_mfma_f32_16x16x32_bf16 v[0:3], a[144:147], a[64:67], 0
    ds_read_b64_tr_b16 a[190:191], v61 offset:35336
    v_exp_f32 v8, v8
    v_mfma_f32_16x16x32_bf16 v[0:3], a[148:151], a[68:71], v[0:3]
    ds_read_b64_tr_b16 a[194:195], v61 offset:35840
    v_mul_f32 v9, s57, v9
    v_mfma_f32_16x16x32_bf16 v[0:3], a[152:155], a[72:75], v[0:3]
    v_exp_f32 v9, v9
    v_mfma_f32_16x16x32_bf16 v[0:3], a[156:159], a[76:79], v[0:3]
    s_waitcnt lgkmcnt(9)
    v_mul_f32 v10, s57, v10
    v_cvt_pk_bf16_f32 v20, v8, v9
    v_mfma_f32_16x16x32_bf16 v[4:7], a[172:175], a[76:79], 0
    ds_read_b64_tr_b16 a[196:197], v60 offset:35848
    v_exp_f32 v10, v10
    v_mfma_f32_16x16x32_bf16 v[4:7], a[168:171], a[72:75], v[4:7]
    ds_read_b64_tr_b16 a[198:199], v61 offset:35848
    v_mul_f32 v11, s57, v11
    v_mfma_f32_16x16x32_bf16 v[4:7], a[164:167], a[68:71], v[4:7]
    ds_read_b64_tr_b16 a[192:193], v60 offset:35840
    v_exp_f32 v11, v11
    v_mfma_f32_16x16x32_bf16 v[4:7], a[160:163], a[64:67], v[4:7]
    s_waitcnt lgkmcnt(15)
    v_mul_f32 v12, s57, v12
    v_cvt_pk_bf16_f32 v21, v10, v11
    v_mfma_f32_16x16x32_bf16 v[64:67], a[208:211], v[16:19], v[64:67]
    v_exp_f32 v12, v12
    v_mfma_f32_16x16x32_bf16 v[68:71], a[212:215], v[16:19], v[68:71]
    ds_read_b64_tr_b16 a[204:205], v60 offset:36360
    v_mul_f32 v13, s57, v13
    v_mfma_f32_16x16x32_bf16 v[72:75], a[216:219], v[16:19], v[72:75]
    v_exp_f32 v13, v13
    v_mfma_f32_16x16x32_bf16 v[76:79], a[220:223], v[16:19], v[76:79]
    v_mul_f32 v14, s57, v14
    v_cvt_pk_bf16_f32 v22, v12, v13
    v_mfma_f32_16x16x32_bf16 v[80:83], a[224:227], v[16:19], v[80:83]
    v_exp_f32 v14, v14
    v_mfma_f32_16x16x32_bf16 v[84:87], a[228:231], v[16:19], v[84:87]
    ds_read_b64_tr_b16 a[206:207], v61 offset:36360
    v_mul_f32 v15, s57, v15
    v_mfma_f32_16x16x32_bf16 v[88:91], a[232:235], v[16:19], v[88:91]
    v_exp_f32 v15, v15
    v_mfma_f32_16x16x32_bf16 v[92:95], a[236:239], v[16:19], v[92:95]
    v_mul_f32 v0, s57, v0
    v_cvt_pk_bf16_f32 v23, v14, v15
    v_mfma_f32_16x16x32_bf16 v[8:11], a[144:147], a[80:83], 0
    v_exp_f32 v0, v0
    v_mfma_f32_16x16x32_bf16 v[8:11], a[148:151], a[84:87], v[8:11]
    ds_read_b64_tr_b16 a[200:201], v60 offset:36352
    ds_read_b64_tr_b16 a[202:203], v61 offset:36352
    v_mfma_f32_16x16x32_bf16 v[8:11], a[152:155], a[88:91], v[8:11]
    v_mul_f32 v1, s57, v1
    v_mul_f32 v2, s57, v2
    v_mfma_f32_16x16x32_bf16 v[8:11], a[156:159], a[92:95], v[8:11]
    v_exp_f32 v1, v1
    v_smfmac_f32_16x16x64_bf16 v[32:35], v[28:31], v[16:23], v48
    v_exp_f32 v2, v2
    v_mfma_f32_16x16x32_bf16 v[12:15], a[172:175], a[92:95], 0
    v_cvt_pk_bf16_f32 v16, v0, v1
    v_mul_f32 v3, s57, v3
    v_mfma_f32_16x16x32_bf16 v[12:15], a[168:171], a[88:91], v[12:15]
    v_exp_f32 v3, v3
    v_mfma_f32_16x16x32_bf16 v[12:15], a[164:167], a[84:87], v[12:15]
    v_mul_f32 v4, s57, v4
    v_cvt_pk_bf16_f32 v17, v2, v3
    v_mfma_f32_16x16x32_bf16 v[12:15], a[160:163], a[80:83], v[12:15]
    v_exp_f32 v4, v4
    v_mfma_f32_16x16x32_bf16 v[96:99], a[208:211], v[20:23], v[96:99]
    ds_read_b64_tr_b16 a[210:211], v63 offset:34816
    v_mul_f32 v5, s57, v5
    v_mfma_f32_16x16x32_bf16 v[100:103], a[212:215], v[20:23], v[100:103]
    v_exp_f32 v5, v5
    v_mfma_f32_16x16x32_bf16 v[104:107], a[216:219], v[20:23], v[104:107]
    ds_read_b64_tr_b16 a[208:209], v62 offset:34816
    v_mul_f32 v6, s57, v6
    v_cvt_pk_bf16_f32 v18, v4, v5
    v_mfma_f32_16x16x32_bf16 v[108:111], a[220:223], v[20:23], v[108:111]
    v_exp_f32 v6, v6
    v_mfma_f32_16x16x32_bf16 v[112:115], a[224:227], v[20:23], v[112:115]
    ds_read_b64_tr_b16 a[214:215], v63 offset:34824
    ds_read_b64_tr_b16 a[220:221], v62 offset:35336
    v_mul_f32 v7, s57, v7
    v_mfma_f32_16x16x32_bf16 v[116:119], a[228:231], v[20:23], v[116:119]
    ds_read_b64_tr_b16 a[212:213], v62 offset:34824
    v_exp_f32 v7, v7
    v_mfma_f32_16x16x32_bf16 v[120:123], a[232:235], v[20:23], v[120:123]
    ds_read_b64_tr_b16 a[216:217], v62 offset:35328
    ds_read_b64_tr_b16 a[218:219], v63 offset:35328
    v_mul_f32 v8, s57, v8
    v_mfma_f32_16x16x32_bf16 v[124:127], a[236:239], v[20:23], v[124:127]
    v_cvt_pk_bf16_f32 v19, v6, v7
    v_exp_f32 v8, v8
    s_waitcnt vmcnt(8)
    s_nop 0
    v_pk_add_f32 v[34:35], v[32:33], v[34:35]
    v_rcp_f32 v32, v34
    v_rcp_f32 v33, v35
    v_max_u32 v54, v34, v35
    v_min_u32 v55, v34, v35
    v_add_u32 v51, 0xffffb800, v51
    v_pk_mul_f32 v[64:65], v[64:65], v[32:33] op_sel:[0,0] op_sel_hi:[1,0]
    v_pk_mul_f32 v[66:67], v[66:67], v[32:33] op_sel:[0,0] op_sel_hi:[1,0]
    v_pk_mul_f32 v[68:69], v[68:69], v[32:33] op_sel:[0,0] op_sel_hi:[1,0]
    v_pk_mul_f32 v[70:71], v[70:71], v[32:33] op_sel:[0,0] op_sel_hi:[1,0]
    v_cvt_pk_bf16_f32 v64, v64, v65
    v_cvt_pk_bf16_f32 v65, v66, v67
    v_cvt_pk_bf16_f32 v66, v68, v69
    v_cvt_pk_bf16_f32 v67, v70, v71
    ds_write_b128 v50, v[64:67] offset:0
    v_pk_mul_f32 v[72:73], v[72:73], v[32:33] op_sel:[0,0] op_sel_hi:[1,0]
    v_pk_mul_f32 v[74:75], v[74:75], v[32:33] op_sel:[0,0] op_sel_hi:[1,0]
    v_pk_mul_f32 v[76:77], v[76:77], v[32:33] op_sel:[0,0] op_sel_hi:[1,0]
    v_pk_mul_f32 v[78:79], v[78:79], v[32:33] op_sel:[0,0] op_sel_hi:[1,0]
    v_cvt_pk_bf16_f32 v72, v72, v73
    v_cvt_pk_bf16_f32 v73, v74, v75
    v_cvt_pk_bf16_f32 v74, v76, v77
    v_cvt_pk_bf16_f32 v75, v78, v79
    ds_write_b128 v50, v[72:75] offset:512
    v_pk_mul_f32 v[80:81], v[80:81], v[32:33] op_sel:[0,0] op_sel_hi:[1,0]
    v_pk_mul_f32 v[82:83], v[82:83], v[32:33] op_sel:[0,0] op_sel_hi:[1,0]
    v_pk_mul_f32 v[84:85], v[84:85], v[32:33] op_sel:[0,0] op_sel_hi:[1,0]
    v_pk_mul_f32 v[86:87], v[86:87], v[32:33] op_sel:[0,0] op_sel_hi:[1,0]
    v_cvt_pk_bf16_f32 v80, v80, v81
    v_cvt_pk_bf16_f32 v81, v82, v83
    v_cvt_pk_bf16_f32 v82, v84, v85
    v_cvt_pk_bf16_f32 v83, v86, v87
    ds_write_b128 v50, v[80:83] offset:1024
    v_pk_mul_f32 v[88:89], v[88:89], v[32:33] op_sel:[0,0] op_sel_hi:[1,0]
    v_pk_mul_f32 v[90:91], v[90:91], v[32:33] op_sel:[0,0] op_sel_hi:[1,0]
    v_pk_mul_f32 v[92:93], v[92:93], v[32:33] op_sel:[0,0] op_sel_hi:[1,0]
    v_pk_mul_f32 v[94:95], v[94:95], v[32:33] op_sel:[0,0] op_sel_hi:[1,0]
    v_cvt_pk_bf16_f32 v88, v88, v89
    v_cvt_pk_bf16_f32 v89, v90, v91
    v_cvt_pk_bf16_f32 v90, v92, v93
    v_cvt_pk_bf16_f32 v91, v94, v95
    ds_write_b128 v50, v[88:91] offset:1536
    ds_read_b128 a[0:3], v51 offset:0
    ds_read_b128 a[4:7], v51 offset:1024
    ds_read_b128 a[8:11], v51 offset:2048
    ds_read_b128 a[12:15], v51 offset:3072
    v_pk_mul_f32 v[96:97], v[96:97], v[32:33] op_sel:[0,1] op_sel_hi:[1,1]
    v_pk_mul_f32 v[98:99], v[98:99], v[32:33] op_sel:[0,1] op_sel_hi:[1,1]
    v_pk_mul_f32 v[100:101], v[100:101], v[32:33] op_sel:[0,1] op_sel_hi:[1,1]
    v_pk_mul_f32 v[102:103], v[102:103], v[32:33] op_sel:[0,1] op_sel_hi:[1,1]
    v_cvt_pk_bf16_f32 v96, v96, v97
    v_cvt_pk_bf16_f32 v97, v98, v99
    v_cvt_pk_bf16_f32 v98, v100, v101
    v_cvt_pk_bf16_f32 v99, v102, v103
    ds_write_b128 v50, v[96:99] offset:4096
    v_pk_mul_f32 v[104:105], v[104:105], v[32:33] op_sel:[0,1] op_sel_hi:[1,1]
    v_pk_mul_f32 v[106:107], v[106:107], v[32:33] op_sel:[0,1] op_sel_hi:[1,1]
    v_pk_mul_f32 v[108:109], v[108:109], v[32:33] op_sel:[0,1] op_sel_hi:[1,1]
    v_pk_mul_f32 v[110:111], v[110:111], v[32:33] op_sel:[0,1] op_sel_hi:[1,1]
    v_cvt_pk_bf16_f32 v104, v104, v105
    v_cvt_pk_bf16_f32 v105, v106, v107
    v_cvt_pk_bf16_f32 v106, v108, v109
    v_cvt_pk_bf16_f32 v107, v110, v111
    ds_write_b128 v50, v[104:107] offset:4608
    v_pk_mul_f32 v[112:113], v[112:113], v[32:33] op_sel:[0,1] op_sel_hi:[1,1]
    v_pk_mul_f32 v[114:115], v[114:115], v[32:33] op_sel:[0,1] op_sel_hi:[1,1]
    v_pk_mul_f32 v[116:117], v[116:117], v[32:33] op_sel:[0,1] op_sel_hi:[1,1]
    v_pk_mul_f32 v[118:119], v[118:119], v[32:33] op_sel:[0,1] op_sel_hi:[1,1]
    v_cvt_pk_bf16_f32 v112, v112, v113
    v_cvt_pk_bf16_f32 v113, v114, v115
    v_cvt_pk_bf16_f32 v114, v116, v117
    v_cvt_pk_bf16_f32 v115, v118, v119
    ds_write_b128 v50, v[112:115] offset:5120
    v_pk_mul_f32 v[120:121], v[120:121], v[32:33] op_sel:[0,1] op_sel_hi:[1,1]
    v_pk_mul_f32 v[122:123], v[122:123], v[32:33] op_sel:[0,1] op_sel_hi:[1,1]
    v_pk_mul_f32 v[124:125], v[124:125], v[32:33] op_sel:[0,1] op_sel_hi:[1,1]
    v_pk_mul_f32 v[126:127], v[126:127], v[32:33] op_sel:[0,1] op_sel_hi:[1,1]
    v_cvt_pk_bf16_f32 v120, v120, v121
    v_cvt_pk_bf16_f32 v121, v122, v123
    v_cvt_pk_bf16_f32 v122, v124, v125
    v_cvt_pk_bf16_f32 v123, v126, v127
    ds_write_b128 v50, v[120:123] offset:5632
    ds_read_b128 a[16:19], v51 offset:4096
    ds_read_b128 a[20:23], v51 offset:5120
    ds_read_b128 a[24:27], v51 offset:6144
    ds_read_b128 a[28:31], v51 offset:7168
    s_add_u32 s82, s62, 0
    s_add_u32 s83, s62, 4096
    v_mul_f32 v9, s57, v9
    v_mfma_f32_16x16x32_bf16 v[0:3], a[144:147], a[96:99], 0
    ds_read_b64_tr_b16 a[222:223], v63 offset:35336
    v_exp_f32 v9, v9
    v_mfma_f32_16x16x32_bf16 v[0:3], a[148:151], a[100:103], v[0:3]
    ds_read_b64_tr_b16 a[224:225], v62 offset:35840
    ds_read_b128 a[148:151], v58 offset:33280
    v_mul_f32 v10, s57, v10
    v_mfma_f32_16x16x32_bf16 v[0:3], a[152:155], a[104:107], v[0:3]
    ds_read_b128 a[144:147], v58 offset:32768
    v_exp_f32 v10, v10
    v_mfma_f32_16x16x32_bf16 v[0:3], a[156:159], a[108:111], v[0:3]
    ds_read_b128 a[156:159], v58 offset:34304
    ds_read_b64_tr_b16 a[230:231], v63 offset:35848
    v_cvt_pk_bf16_f32 v20, v8, v9
    v_mfma_f32_16x16x32_bf16 v[4:7], a[172:175], a[108:111], 0
    ds_read_b64_tr_b16 a[228:229], v62 offset:35848
    s_waitcnt lgkmcnt(7)
    v_mul_f32 v11, s57, v11
    v_mfma_f32_16x16x32_bf16 v[4:7], a[168:171], a[104:107], v[4:7]
    buffer_store_dwordx4 a[0:3], v49, s[36:39], s82 offen offset:0 nt
    v_mfma_f32_16x16x32_bf16 v[4:7], a[164:167], a[100:103], v[4:7]
    ds_read_b128 a[152:155], v58 offset:33792
    v_exp_f32 v11, v11
    v_mfma_f32_16x16x32_bf16 v[4:7], a[160:163], a[96:99], v[4:7]
    s_waitcnt lgkmcnt(15)
    v_mul_f32 v12, s57, v12
    v_cvt_pk_bf16_f32 v21, v10, v11
    v_mfma_f32_16x16x32_bf16 v[192:195], a[176:179], v[16:19], v[192:195]
    ds_read_b128 a[160:163], v59 offset:32768
    v_exp_f32 v12, v12
    v_mfma_f32_16x16x32_bf16 v[196:199], a[180:183], v[16:19], v[196:199]
    ds_read_b128 a[164:167], v59 offset:33280
    ds_read_b64_tr_b16 a[236:237], v62 offset:36360
    v_mul_f32 v13, s57, v13
    v_mfma_f32_16x16x32_bf16 v[200:203], a[184:187], v[16:19], v[200:203]
    ds_read_b64_tr_b16 a[232:233], v62 offset:36352
    v_exp_f32 v13, v13
    v_mfma_f32_16x16x32_bf16 v[204:207], a[188:191], v[16:19], v[204:207]
    ds_read_b64_tr_b16 a[226:227], v63 offset:35840
    v_mul_f32 v14, s57, v14
    v_cvt_pk_bf16_f32 v22, v12, v13
    v_mfma_f32_16x16x32_bf16 v[208:211], a[192:195], v[16:19], v[208:211]
    ds_read_b128 a[172:175], v59 offset:34304
    v_exp_f32 v14, v14
    v_mfma_f32_16x16x32_bf16 v[212:215], a[196:199], v[16:19], v[212:215]
    ds_read_b128 a[168:171], v59 offset:33792
    v_mul_f32 v15, s57, v15
    v_mul_f32 v0, s57, v0
    v_mfma_f32_16x16x32_bf16 v[216:219], a[200:203], v[16:19], v[216:219]
    buffer_store_dwordx4 a[4:7], v49, s[36:39], s82 offen offset:128 nt
    v_mfma_f32_16x16x32_bf16 v[220:223], a[204:207], v[16:19], v[220:223]
    s_waitcnt lgkmcnt(7)
    v_exp_f32 v15, v15
    v_mfma_f32_16x16x32_bf16 v[8:11], a[144:147], a[64:67], 0
    v_cvt_pk_bf16_f32 v23, v14, v15
    v_exp_f32 v0, v0
    v_mfma_f32_16x16x32_bf16 v[8:11], a[148:151], a[68:71], v[8:11]
    ds_read_b64_tr_b16 a[234:235], v63 offset:36352
    v_mul_f32 v1, s57, v1
    v_mfma_f32_16x16x32_bf16 v[8:11], a[152:155], a[72:75], v[8:11]
    v_exp_f32 v1, v1
    v_mfma_f32_16x16x32_bf16 v[8:11], a[156:159], a[76:79], v[8:11]
    v_mul_f32 v2, s57, v2
    v_cvt_pk_bf16_f32 v24, v0, v1
    v_smfmac_f32_16x16x64_bf16 v[40:43], v[28:31], v[16:23], v48
    s_waitcnt lgkmcnt(1)
    v_mfma_f32_16x16x32_bf16 v[12:15], a[172:175], a[76:79], 0
    v_exp_f32 v2, v2
    v_mul_f32 v3, s57, v3
    v_mfma_f32_16x16x32_bf16 v[12:15], a[168:171], a[72:75], v[12:15]
    v_exp_f32 v3, v3
    v_mfma_f32_16x16x32_bf16 v[12:15], a[164:167], a[68:71], v[12:15]
    buffer_store_dwordx4 a[8:11], v49, s[36:39], s82 offen offset:2048 nt
    v_mfma_f32_16x16x32_bf16 v[12:15], a[160:163], a[64:67], v[12:15]
    v_mul_f32 v4, s57, v4
    v_cvt_pk_bf16_f32 v25, v2, v3
    v_mfma_f32_16x16x32_bf16 v[224:227], a[176:179], v[20:23], v[224:227]
    v_exp_f32 v4, v4
    v_mul_f32 v5, s57, v5
    v_mfma_f32_16x16x32_bf16 v[228:231], a[180:183], v[20:23], v[228:231]
    v_exp_f32 v5, v5
    v_mfma_f32_16x16x32_bf16 v[232:235], a[184:187], v[20:23], v[232:235]
    v_mul_f32 v6, s57, v6
    v_cvt_pk_bf16_f32 v26, v4, v5
    v_mfma_f32_16x16x32_bf16 v[236:239], a[188:191], v[20:23], v[236:239]
    v_exp_f32 v6, v6
    v_mfma_f32_16x16x32_bf16 v[240:243], a[192:195], v[20:23], v[240:243]
    ds_read_b64_tr_b16 a[238:239], v63 offset:36360
    v_mul_f32 v7, s57, v7
    v_mfma_f32_16x16x32_bf16 v[244:247], a[196:199], v[20:23], v[244:247]
    v_exp_f32 v7, v7
    v_mfma_f32_16x16x32_bf16 v[248:251], a[200:203], v[20:23], v[248:251]
    v_cvt_pk_bf16_f32 v27, v6, v7
    v_mul_f32 v8, s57, v8
    v_mfma_f32_16x16x32_bf16 v[252:255], a[204:207], v[20:23], v[252:255]
    buffer_store_dwordx4 a[12:15], v49, s[36:39], s82 offen offset:2176 nt
    v_mfma_f32_16x16x32_bf16 v[0:3], a[144:147], a[80:83], 0
    v_exp_f32 v8, v8
    v_mfma_f32_16x16x32_bf16 v[0:3], a[148:151], a[84:87], v[0:3]
    v_mul_f32 v9, s57, v9
    v_mul_f32 v10, s57, v10
    v_mfma_f32_16x16x32_bf16 v[0:3], a[152:155], a[88:91], v[0:3]
    v_exp_f32 v9, v9
    v_mfma_f32_16x16x32_bf16 v[0:3], a[156:159], a[92:95], v[0:3]
    v_cvt_pk_bf16_f32 v16, v8, v9
    v_mul_f32 v12, s57, v12
    v_smfmac_f32_16x16x64_bf16 v[44:47], v[28:31], v[20:27], v48
    v_exp_f32 v10, v10
    v_mfma_f32_16x16x32_bf16 v[4:7], a[172:175], a[92:95], 0
    v_mul_f32 v11, s57, v11
    v_mul_f32 v14, s57, v14
    v_mfma_f32_16x16x32_bf16 v[4:7], a[168:171], a[88:91], v[4:7]
    v_exp_f32 v11, v11
    v_mfma_f32_16x16x32_bf16 v[4:7], a[164:167], a[84:87], v[4:7]
    v_cvt_pk_bf16_f32 v17, v10, v11
    v_mul_f32 v13, s57, v13
    v_mfma_f32_16x16x32_bf16 v[4:7], a[160:163], a[80:83], v[4:7]
    buffer_store_dwordx4 a[16:19], v49, s[36:39], s83 offen offset:0 nt
    v_mfma_f32_16x16x32_bf16 a[112:115], a[176:179], v[24:27], a[112:115]
    v_exp_f32 v12, v12
    v_mfma_f32_16x16x32_bf16 a[116:119], a[180:183], v[24:27], a[116:119]
    v_exp_f32 v13, v13
    v_mfma_f32_16x16x32_bf16 a[120:123], a[184:187], v[24:27], a[120:123]
    ds_read_b64_tr_b16 a[176:177], v60 offset:34816
    v_cvt_pk_bf16_f32 v18, v12, v13
    v_mfma_f32_16x16x32_bf16 a[124:127], a[188:191], v[24:27], a[124:127]
    ds_read_b64_tr_b16 a[182:183], v61 offset:34824
    v_exp_f32 v14, v14
    v_mfma_f32_16x16x32_bf16 a[128:131], a[192:195], v[24:27], a[128:131]
    ds_read_b64_tr_b16 a[188:189], v60 offset:35336
    ds_read_b64_tr_b16 a[190:191], v61 offset:35336
    v_mul_f32 v15, s57, v15
    v_mfma_f32_16x16x32_bf16 a[132:135], a[196:199], v[24:27], a[132:135]
    ds_read_b64_tr_b16 a[184:185], v60 offset:35328
    v_exp_f32 v15, v15
    v_mfma_f32_16x16x32_bf16 a[136:139], a[200:203], v[24:27], a[136:139]
    ds_read_b64_tr_b16 a[186:187], v61 offset:35328
    v_cvt_pk_bf16_f32 v19, v14, v15
    v_mul_f32 v0, s57, v0
    v_mfma_f32_16x16x32_bf16 a[140:143], a[204:207], v[24:27], a[140:143]
    ds_read_b64_tr_b16 a[192:193], v60 offset:35840
    v_exp_f32 v0, v0
    v_mfma_f32_16x16x32_bf16 v[8:11], a[144:147], a[96:99], 0
    buffer_store_dwordx4 a[20:23], v49, s[36:39], s83 offen offset:128 nt
    v_mfma_f32_16x16x32_bf16 v[8:11], a[148:151], a[100:103], v[8:11]
    ds_read_b128 a[144:147], v56 offset:32768
    ds_read_b128 a[148:151], v56 offset:33280
    v_mul_f32 v1, s57, v1
    v_mfma_f32_16x16x32_bf16 v[8:11], a[152:155], a[104:107], v[8:11]
    ds_read_b128 a[152:155], v56 offset:33792
    v_exp_f32 v1, v1
    v_mfma_f32_16x16x32_bf16 v[8:11], a[156:159], a[108:111], v[8:11]
    ds_read_b64_tr_b16 a[196:197], v60 offset:35848
    v_mul_f32 v2, s57, v2
    v_cvt_pk_bf16_f32 v20, v0, v1
    v_mfma_f32_16x16x32_bf16 v[12:15], a[172:175], a[108:111], 0
    ds_read_b64_tr_b16 a[200:201], v60 offset:36352
    v_exp_f32 v2, v2
    v_mfma_f32_16x16x32_bf16 v[12:15], a[168:171], a[104:107], v[12:15]
    ds_read_b128 a[156:159], v56 offset:34304
    ds_read_b128 a[172:175], v57 offset:34304
    v_mul_f32 v3, s57, v3
    v_mfma_f32_16x16x32_bf16 v[12:15], a[164:167], a[100:103], v[12:15]
    ds_read_b64_tr_b16 a[194:195], v61 offset:35840
    ds_read_b64_tr_b16 a[198:199], v61 offset:35848
    v_mul_f32 v4, s57, v4
    v_mfma_f32_16x16x32_bf16 v[12:15], a[160:163], a[96:99], v[12:15]
    s_waitcnt lgkmcnt(15)
    v_exp_f32 v3, v3
    v_mfma_f32_16x16x32_bf16 v[192:195], a[208:211], v[16:19], v[192:195]
    v_cvt_pk_bf16_f32 v21, v2, v3
    v_exp_f32 v4, v4
    v_mfma_f32_16x16x32_bf16 v[196:199], a[212:215], v[16:19], v[196:199]
    buffer_store_dwordx4 a[24:27], v49, s[36:39], s83 offen offset:2048 nt
    v_mfma_f32_16x16x32_bf16 v[200:203], a[216:219], v[16:19], v[200:203]
    ds_read_b128 a[164:167], v57 offset:33280
    ds_read_b64_tr_b16 a[202:203], v61 offset:36352
    v_mul_f32 v5, s57, v5
    v_mfma_f32_16x16x32_bf16 v[204:207], a[220:223], v[16:19], v[204:207]
    v_exp_f32 v5, v5
    v_mul_f32 v6, s57, v6
    v_mfma_f32_16x16x32_bf16 v[208:211], a[224:227], v[16:19], v[208:211]
    v_cvt_pk_bf16_f32 v22, v4, v5
    v_exp_f32 v6, v6
    v_mfma_f32_16x16x32_bf16 v[212:215], a[228:231], v[16:19], v[212:215]
    ds_read_b128 a[168:171], v57 offset:33792
    ds_read_b128 a[160:163], v57 offset:32768
    v_mul_f32 v7, s57, v7
    v_mfma_f32_16x16x32_bf16 v[216:219], a[232:235], v[16:19], v[216:219]
    v_exp_f32 v7, v7
    v_mul_f32 v8, s57, v8
    v_mfma_f32_16x16x32_bf16 v[220:223], a[236:239], v[16:19], v[220:223]
    s_waitcnt lgkmcnt(7)
    v_cvt_pk_bf16_f32 v23, v6, v7
    v_mfma_f32_16x16x32_bf16 v[0:3], a[144:147], a[32:35], 0
    ds_read_b64_tr_b16 a[206:207], v61 offset:36360
    v_exp_f32 v8, v8
    v_mfma_f32_16x16x32_bf16 v[0:3], a[148:151], a[36:39], v[0:3]
    ds_read_b64_tr_b16 a[204:205], v60 offset:36360
    v_mul_f32 v9, s57, v9
    v_mfma_f32_16x16x32_bf16 v[0:3], a[152:155], a[40:43], v[0:3]
    buffer_store_dwordx4 a[28:31], v49, s[36:39], s83 offen offset:2176 nt
    v_mfma_f32_16x16x32_bf16 v[0:3], a[156:159], a[44:47], v[0:3]
    v_exp_f32 v9, v9
    v_mul_f32 v10, s57, v10
    v_smfmac_f32_16x16x64_bf16 v[40:43], v[28:31], v[16:23], v48
    s_waitcnt lgkmcnt(2)
    v_mfma_f32_16x16x32_bf16 v[4:7], a[172:175], a[44:47], 0
    v_cvt_pk_bf16_f32 v24, v8, v9
    v_mul_f32 v11, s57, v11
    v_mfma_f32_16x16x32_bf16 v[4:7], a[168:171], a[40:43], v[4:7]
    v_exp_f32 v10, v10
    v_mfma_f32_16x16x32_bf16 v[4:7], a[164:167], a[36:39], v[4:7]
    v_exp_f32 v11, v11
    v_mfma_f32_16x16x32_bf16 v[4:7], a[160:163], a[32:35], v[4:7]
    v_mul_f32 v12, s57, v12
    v_cvt_pk_bf16_f32 v25, v10, v11
    v_mfma_f32_16x16x32_bf16 v[224:227], a[208:211], v[20:23], v[224:227]
    v_exp_f32 v12, v12
    v_mfma_f32_16x16x32_bf16 v[228:231], a[212:215], v[20:23], v[228:231]
    ds_read_b64_tr_b16 a[178:179], v61 offset:34816
    v_mul_f32 v13, s57, v13
    v_mfma_f32_16x16x32_bf16 v[232:235], a[216:219], v[20:23], v[232:235]
    v_exp_f32 v13, v13
    v_mul_f32 v14, s57, v14
    v_mfma_f32_16x16x32_bf16 v[236:239], a[220:223], v[20:23], v[236:239]
    v_exp_f32 v14, v14
    v_mfma_f32_16x16x32_bf16 v[240:243], a[224:227], v[20:23], v[240:243]
    v_cvt_pk_bf16_f32 v26, v12, v13
    v_mul_f32 v15, s57, v15
    v_mfma_f32_16x16x32_bf16 v[244:247], a[228:231], v[20:23], v[244:247]
    v_exp_f32 v15, v15
    v_mfma_f32_16x16x32_bf16 v[248:251], a[232:235], v[20:23], v[248:251]
    ds_read_b64_tr_b16 a[180:181], v60 offset:34824
    v_cvt_pk_bf16_f32 v27, v14, v15
    v_mfma_f32_16x16x32_bf16 v[252:255], a[236:239], v[20:23], v[252:255]
    v_mul_f32 v0, s57, v0
    v_mul_f32 v1, s57, v1
    v_mfma_f32_16x16x32_bf16 v[8:11], a[144:147], a[48:51], 0
    v_exp_f32 v0, v0
    v_mfma_f32_16x16x32_bf16 v[8:11], a[148:151], a[52:55], v[8:11]
    ds_read_b128 a[144:147], v58 offset:32768
    ds_read_b128 a[148:151], v58 offset:33280
    v_mfma_f32_16x16x32_bf16 v[8:11], a[152:155], a[56:59], v[8:11]
    v_exp_f32 v1, v1
    v_mfma_f32_16x16x32_bf16 v[8:11], a[156:159], a[60:63], v[8:11]
    v_mul_f32 v2, s57, v2
    v_cvt_pk_bf16_f32 v16, v0, v1
    v_smfmac_f32_16x16x64_bf16 v[44:47], v[28:31], v[20:27], v48
    v_exp_f32 v2, v2
    v_mfma_f32_16x16x32_bf16 v[12:15], a[172:175], a[60:63], 0
    ds_read_b128 a[152:155], v58 offset:33792
    ds_read_b128 a[156:159], v58 offset:34304
    v_mul_f32 v3, s57, v3
    v_mfma_f32_16x16x32_bf16 v[12:15], a[168:171], a[56:59], v[12:15]
    ds_read_b128 a[172:175], v59 offset:34304
    v_exp_f32 v3, v3
    v_mfma_f32_16x16x32_bf16 v[12:15], a[164:167], a[52:55], v[12:15]
    ds_read_b128 a[168:171], v59 offset:33792
    v_mul_f32 v4, s57, v4
    v_cvt_pk_bf16_f32 v17, v2, v3
    v_mfma_f32_16x16x32_bf16 v[12:15], a[160:163], a[48:51], v[12:15]
    ds_read_b128 a[160:163], v59 offset:32768
    v_exp_f32 v4, v4
    v_mfma_f32_16x16x32_bf16 a[112:115], a[208:211], v[24:27], a[112:115]
    ds_read_b128 a[164:167], v59 offset:33280
    v_mul_f32 v5, s57, v5
    v_mfma_f32_16x16x32_bf16 a[116:119], a[212:215], v[24:27], a[116:119]
    v_exp_f32 v5, v5
    v_mul_f32 v6, s57, v6
    v_mfma_f32_16x16x32_bf16 a[120:123], a[216:219], v[24:27], a[120:123]
    ds_read_b64_tr_b16 a[208:209], v62 offset:34816
    v_cvt_pk_bf16_f32 v18, v4, v5
    v_mfma_f32_16x16x32_bf16 a[124:127], a[220:223], v[24:27], a[124:127]
    ds_read_b64_tr_b16 a[210:211], v63 offset:34816
    v_exp_f32 v6, v6
    v_mfma_f32_16x16x32_bf16 a[128:131], a[224:227], v[24:27], a[128:131]
    ds_read_b64_tr_b16 a[212:213], v62 offset:34824
    v_mul_f32 v7, s57, v7
    v_mfma_f32_16x16x32_bf16 a[132:135], a[228:231], v[24:27], a[132:135]
    ds_read_b64_tr_b16 a[216:217], v62 offset:35328
    v_exp_f32 v7, v7
    v_mfma_f32_16x16x32_bf16 a[136:139], a[232:235], v[24:27], a[136:139]
    ds_read_b64_tr_b16 a[222:223], v63 offset:35336
    v_cvt_pk_bf16_f32 v19, v6, v7
    v_mul_f32 v8, s57, v8
    v_mfma_f32_16x16x32_bf16 a[140:143], a[236:239], v[24:27], a[140:143]
    ds_read_b64_tr_b16 a[214:215], v63 offset:34824
    ds_read_b64_tr_b16 a[220:221], v62 offset:35336
    s_nop 1
    v_pk_add_f32 v[42:43], v[40:41], v[42:43]
    v_pk_add_f32 v[46:47], v[44:45], v[46:47]
    v_rcp_f32 v40, v42
    v_rcp_f32 v41, v43
    v_rcp_f32 v45, v47
    v_max3_u32 v54, v54, v42, v43
    v_max_u32 v54, v54, v47
    v_min3_u32 v55, v55, v42, v43
    v_min_u32 v55, v55, v47
    v_pk_mul_f32 v[192:193], v[192:193], v[40:41] op_sel:[0,0] op_sel_hi:[1,0]
    v_pk_mul_f32 v[194:195], v[194:195], v[40:41] op_sel:[0,0] op_sel_hi:[1,0]
    v_pk_mul_f32 v[196:197], v[196:197], v[40:41] op_sel:[0,0] op_sel_hi:[1,0]
    v_pk_mul_f32 v[198:199], v[198:199], v[40:41] op_sel:[0,0] op_sel_hi:[1,0]
    v_cvt_pk_bf16_f32 v192, v192, v193
    v_cvt_pk_bf16_f32 v193, v194, v195
    v_cvt_pk_bf16_f32 v194, v196, v197
    v_cvt_pk_bf16_f32 v195, v198, v199
    ds_write_b128 v50, v[192:195] offset:8192
    v_pk_mul_f32 v[200:201], v[200:201], v[40:41] op_sel:[0,0] op_sel_hi:[1,0]
    v_pk_mul_f32 v[202:203], v[202:203], v[40:41] op_sel:[0,0] op_sel_hi:[1,0]
    v_pk_mul_f32 v[204:205], v[204:205], v[40:41] op_sel:[0,0] op_sel_hi:[1,0]
    v_pk_mul_f32 v[206:207], v[206:207], v[40:41] op_sel:[0,0] op_sel_hi:[1,0]
    v_cvt_pk_bf16_f32 v200, v200, v201
    v_cvt_pk_bf16_f32 v201, v202, v203
    v_cvt_pk_bf16_f32 v202, v204, v205
    v_cvt_pk_bf16_f32 v203, v206, v207
    ds_write_b128 v50, v[200:203] offset:8704
    v_pk_mul_f32 v[208:209], v[208:209], v[40:41] op_sel:[0,0] op_sel_hi:[1,0]
    v_pk_mul_f32 v[210:211], v[210:211], v[40:41] op_sel:[0,0] op_sel_hi:[1,0]
    v_pk_mul_f32 v[212:213], v[212:213], v[40:41] op_sel:[0,0] op_sel_hi:[1,0]
    v_pk_mul_f32 v[214:215], v[214:215], v[40:41] op_sel:[0,0] op_sel_hi:[1,0]
    v_cvt_pk_bf16_f32 v208, v208, v209
    v_cvt_pk_bf16_f32 v209, v210, v211
    v_cvt_pk_bf16_f32 v210, v212, v213
    v_cvt_pk_bf16_f32 v211, v214, v215
    ds_write_b128 v50, v[208:211] offset:9216
    v_pk_mul_f32 v[216:217], v[216:217], v[40:41] op_sel:[0,0] op_sel_hi:[1,0]
    v_pk_mul_f32 v[218:219], v[218:219], v[40:41] op_sel:[0,0] op_sel_hi:[1,0]
    v_pk_mul_f32 v[220:221], v[220:221], v[40:41] op_sel:[0,0] op_sel_hi:[1,0]
    v_pk_mul_f32 v[222:223], v[222:223], v[40:41] op_sel:[0,0] op_sel_hi:[1,0]
    v_cvt_pk_bf16_f32 v216, v216, v217
    v_cvt_pk_bf16_f32 v217, v218, v219
    v_cvt_pk_bf16_f32 v218, v220, v221
    v_cvt_pk_bf16_f32 v219, v222, v223
    ds_write_b128 v50, v[216:219] offset:9728
    ds_read_b128 a[64:67], v51 offset:8192
    ds_read_b128 a[68:71], v51 offset:9216
    ds_read_b128 a[72:75], v51 offset:10240
    ds_read_b128 a[76:79], v51 offset:11264
    v_pk_mul_f32 v[224:225], v[224:225], v[40:41] op_sel:[0,1] op_sel_hi:[1,1]
    v_pk_mul_f32 v[226:227], v[226:227], v[40:41] op_sel:[0,1] op_sel_hi:[1,1]
    v_pk_mul_f32 v[228:229], v[228:229], v[40:41] op_sel:[0,1] op_sel_hi:[1,1]
    v_pk_mul_f32 v[230:231], v[230:231], v[40:41] op_sel:[0,1] op_sel_hi:[1,1]
    v_cvt_pk_bf16_f32 v224, v224, v225
    v_cvt_pk_bf16_f32 v225, v226, v227
    v_cvt_pk_bf16_f32 v226, v228, v229
    v_cvt_pk_bf16_f32 v227, v230, v231
    ds_write_b128 v50, v[224:227] offset:12288
    v_pk_mul_f32 v[232:233], v[232:233], v[40:41] op_sel:[0,1] op_sel_hi:[1,1]
    v_pk_mul_f32 v[234:235], v[234:235], v[40:41] op_sel:[0,1] op_sel_hi:[1,1]
    v_pk_mul_f32 v[236:237], v[236:237], v[40:41] op_sel:[0,1] op_sel_hi:[1,1]
    v_pk_mul_f32 v[238:239], v[238:239], v[40:41] op_sel:[0,1] op_sel_hi:[1,1]
    v_cvt_pk_bf16_f32 v232, v232, v233
    v_cvt_pk_bf16_f32 v233, v234, v235
    v_cvt_pk_bf16_f32 v234, v236, v237
    v_cvt_pk_bf16_f32 v235, v238, v239
    ds_write_b128 v50, v[232:235] offset:12800
    v_pk_mul_f32 v[240:241], v[240:241], v[40:41] op_sel:[0,1] op_sel_hi:[1,1]
    v_pk_mul_f32 v[242:243], v[242:243], v[40:41] op_sel:[0,1] op_sel_hi:[1,1]
    v_pk_mul_f32 v[244:245], v[244:245], v[40:41] op_sel:[0,1] op_sel_hi:[1,1]
    v_pk_mul_f32 v[246:247], v[246:247], v[40:41] op_sel:[0,1] op_sel_hi:[1,1]
    v_cvt_pk_bf16_f32 v240, v240, v241
    v_cvt_pk_bf16_f32 v241, v242, v243
    v_cvt_pk_bf16_f32 v242, v244, v245
    v_cvt_pk_bf16_f32 v243, v246, v247
    ds_write_b128 v50, v[240:243] offset:13312
    v_pk_mul_f32 v[248:249], v[248:249], v[40:41] op_sel:[0,1] op_sel_hi:[1,1]
    v_pk_mul_f32 v[250:251], v[250:251], v[40:41] op_sel:[0,1] op_sel_hi:[1,1]
    v_pk_mul_f32 v[252:253], v[252:253], v[40:41] op_sel:[0,1] op_sel_hi:[1,1]
    v_pk_mul_f32 v[254:255], v[254:255], v[40:41] op_sel:[0,1] op_sel_hi:[1,1]
    v_cvt_pk_bf16_f32 v248, v248, v249
    v_cvt_pk_bf16_f32 v249, v250, v251
    v_cvt_pk_bf16_f32 v250, v252, v253
    v_cvt_pk_bf16_f32 v251, v254, v255
    ds_write_b128 v50, v[248:251] offset:13824
    ds_read_b128 a[80:83], v51 offset:12288
    ds_read_b128 a[84:87], v51 offset:13312
    ds_read_b128 a[88:91], v51 offset:14336
    ds_read_b128 a[92:95], v51 offset:15360
    v_accvgpr_read_b32 v64, a112
    v_accvgpr_read_b32 v65, a113
    v_accvgpr_read_b32 v66, a114
    v_accvgpr_read_b32 v67, a115
    v_accvgpr_read_b32 v68, a116
    v_accvgpr_read_b32 v69, a117
    v_accvgpr_read_b32 v70, a118
    v_accvgpr_read_b32 v71, a119
    v_accvgpr_read_b32 v72, a120
    v_accvgpr_read_b32 v73, a121
    v_accvgpr_read_b32 v74, a122
    v_accvgpr_read_b32 v75, a123
    v_accvgpr_read_b32 v76, a124
    v_accvgpr_read_b32 v77, a125
    v_accvgpr_read_b32 v78, a126
    v_accvgpr_read_b32 v79, a127
    v_accvgpr_read_b32 v80, a128
    v_accvgpr_read_b32 v81, a129
    v_accvgpr_read_b32 v82, a130
    v_accvgpr_read_b32 v83, a131
    v_accvgpr_read_b32 v84, a132
    v_accvgpr_read_b32 v85, a133
    v_accvgpr_read_b32 v86, a134
    v_accvgpr_read_b32 v87, a135
    v_accvgpr_read_b32 v88, a136
    v_accvgpr_read_b32 v89, a137
    v_accvgpr_read_b32 v90, a138
    v_accvgpr_read_b32 v91, a139
    v_accvgpr_read_b32 v92, a140
    v_accvgpr_read_b32 v93, a141
    v_accvgpr_read_b32 v94, a142
    v_accvgpr_read_b32 v95, a143
    v_pk_mul_f32 v[64:65], v[64:65], v[44:45] op_sel:[0,1] op_sel_hi:[1,1]
    v_pk_mul_f32 v[66:67], v[66:67], v[44:45] op_sel:[0,1] op_sel_hi:[1,1]
    v_pk_mul_f32 v[68:69], v[68:69], v[44:45] op_sel:[0,1] op_sel_hi:[1,1]
    v_pk_mul_f32 v[70:71], v[70:71], v[44:45] op_sel:[0,1] op_sel_hi:[1,1]
    v_cvt_pk_bf16_f32 v64, v64, v65
    v_cvt_pk_bf16_f32 v65, v66, v67
    v_cvt_pk_bf16_f32 v66, v68, v69
    v_cvt_pk_bf16_f32 v67, v70, v71
    ds_write_b128 v50, v[64:67] offset:16384
    v_pk_mul_f32 v[72:73], v[72:73], v[44:45] op_sel:[0,1] op_sel_hi:[1,1]
    v_pk_mul_f32 v[74:75], v[74:75], v[44:45] op_sel:[0,1] op_sel_hi:[1,1]
    v_pk_mul_f32 v[76:77], v[76:77], v[44:45] op_sel:[0,1] op_sel_hi:[1,1]
    v_pk_mul_f32 v[78:79], v[78:79], v[44:45] op_sel:[0,1] op_sel_hi:[1,1]
    v_cvt_pk_bf16_f32 v72, v72, v73
    v_cvt_pk_bf16_f32 v73, v74, v75
    v_cvt_pk_bf16_f32 v74, v76, v77
    v_cvt_pk_bf16_f32 v75, v78, v79
    ds_write_b128 v50, v[72:75] offset:16896
    v_pk_mul_f32 v[80:81], v[80:81], v[44:45] op_sel:[0,1] op_sel_hi:[1,1]
    v_pk_mul_f32 v[82:83], v[82:83], v[44:45] op_sel:[0,1] op_sel_hi:[1,1]
    v_pk_mul_f32 v[84:85], v[84:85], v[44:45] op_sel:[0,1] op_sel_hi:[1,1]
    v_pk_mul_f32 v[86:87], v[86:87], v[44:45] op_sel:[0,1] op_sel_hi:[1,1]
    v_cvt_pk_bf16_f32 v80, v80, v81
    v_cvt_pk_bf16_f32 v81, v82, v83
    v_cvt_pk_bf16_f32 v82, v84, v85
    v_cvt_pk_bf16_f32 v83, v86, v87
    ds_write_b128 v50, v[80:83] offset:17408
    v_pk_mul_f32 v[88:89], v[88:89], v[44:45] op_sel:[0,1] op_sel_hi:[1,1]
    v_pk_mul_f32 v[90:91], v[90:91], v[44:45] op_sel:[0,1] op_sel_hi:[1,1]
    v_pk_mul_f32 v[92:93], v[92:93], v[44:45] op_sel:[0,1] op_sel_hi:[1,1]
    v_pk_mul_f32 v[94:95], v[94:95], v[44:45] op_sel:[0,1] op_sel_hi:[1,1]
    v_cvt_pk_bf16_f32 v88, v88, v89
    v_cvt_pk_bf16_f32 v89, v90, v91
    v_cvt_pk_bf16_f32 v90, v92, v93
    v_cvt_pk_bf16_f32 v91, v94, v95
    ds_write_b128 v50, v[88:91] offset:17920
    ds_read_b128 a[96:99], v51 offset:16384
    ds_read_b128 a[100:103], v51 offset:17408
    ds_read_b128 a[104:107], v51 offset:18432
    ds_read_b128 a[108:111], v51 offset:19456
    ds_read_b64_tr_b16 a[224:225], v62 offset:35840
    s_waitcnt lgkmcnt(15)
    s_add_u32 s82, s62, 16384
    v_mfma_f32_16x16x32_bf16 v[0:3], a[144:147], a[32:35], 0
    s_add_u32 s83, s62, 20480
    v_exp_f32 v8, v8
    v_mfma_f32_16x16x32_bf16 v[0:3], a[148:151], a[36:39], v[0:3]
    ds_read_b64_tr_b16 a[218:219], v63 offset:35328
    s_add_u32 s84, s62, 24576
    v_mul_f32 v9, s57, v9
    v_mfma_f32_16x16x32_bf16 v[0:3], a[152:155], a[40:43], v[0:3]
    ds_read_b64_tr_b16 a[228:229], v62 offset:35848
    v_exp_f32 v9, v9
    v_mfma_f32_16x16x32_bf16 v[0:3], a[156:159], a[44:47], v[0:3]
    s_waitcnt lgkmcnt(15)
    v_mul_f32 v10, s57, v10
    v_cvt_pk_bf16_f32 v20, v8, v9
    v_mfma_f32_16x16x32_bf16 v[4:7], a[172:175], a[44:47], 0
    s_waitcnt lgkmcnt(3)
    v_exp_f32 v10, v10
    v_mfma_f32_16x16x32_bf16 v[4:7], a[168:171], a[40:43], v[4:7]
    buffer_store_dwordx4 a[64:67], v49, s[36:39], s82 offen offset:0 nt
    v_mfma_f32_16x16x32_bf16 v[4:7], a[164:167], a[36:39], v[4:7]
    ds_read_b64_tr_b16 a[226:227], v63 offset:35840
    ds_read_b64_tr_b16 a[230:231], v63 offset:35848
    v_mul_f32 v11, s57, v11
    v_mfma_f32_16x16x32_bf16 v[4:7], a[160:163], a[32:35], v[4:7]
    ds_read_b64_tr_b16 a[236:237], v62 offset:36360
    s_waitcnt lgkmcnt(15)
    v_mul_f32 v12, s57, v12
    v_mfma_f32_16x16x32_bf16 v[128:131], a[176:179], v[16:19], v[128:131]
    v_exp_f32 v11, v11
    v_mul_f32 v13, s57, v13
    v_mfma_f32_16x16x32_bf16 v[132:135], a[180:183], v[16:19], v[132:135]
    ds_read_b64_tr_b16 a[234:235], v63 offset:36352
    v_exp_f32 v12, v12
    v_mfma_f32_16x16x32_bf16 v[136:139], a[184:187], v[16:19], v[136:139]
    v_cvt_pk_bf16_f32 v21, v10, v11
    v_exp_f32 v13, v13
    v_mfma_f32_16x16x32_bf16 v[140:143], a[188:191], v[16:19], v[140:143]
    v_mul_f32 v14, s57, v14
    v_cvt_pk_bf16_f32 v22, v12, v13
    v_mfma_f32_16x16x32_bf16 v[144:147], a[192:195], v[16:19], v[144:147]
    ds_read_b64_tr_b16 a[232:233], v62 offset:36352
    v_exp_f32 v14, v14
    v_mfma_f32_16x16x32_bf16 v[148:151], a[196:199], v[16:19], v[148:151]
    v_mul_f32 v15, s57, v15
    v_mul_f32 v0, s57, v0
    v_mfma_f32_16x16x32_bf16 v[152:155], a[200:203], v[16:19], v[152:155]
    buffer_store_dwordx4 a[68:71], v49, s[36:39], s82 offen offset:128 nt
    v_mfma_f32_16x16x32_bf16 v[156:159], a[204:207], v[16:19], v[156:159]
    v_exp_f32 v15, v15
    v_mfma_f32_16x16x32_bf16 v[8:11], a[144:147], a[48:51], 0
    v_exp_f32 v0, v0
    v_mfma_f32_16x16x32_bf16 v[8:11], a[148:151], a[52:55], v[8:11]
    v_cvt_pk_bf16_f32 v23, v14, v15
    v_mul_f32 v1, s57, v1
    v_mfma_f32_16x16x32_bf16 v[8:11], a[152:155], a[56:59], v[8:11]
    v_exp_f32 v1, v1
    v_mfma_f32_16x16x32_bf16 v[8:11], a[156:159], a[60:63], v[8:11]
    ds_read_b64_tr_b16 a[238:239], v63 offset:36360
    v_mul_f32 v2, s57, v2
    v_smfmac_f32_16x16x64_bf16 v[36:39], v[28:31], v[16:23], v48
    v_exp_f32 v2, v2
    v_mfma_f32_16x16x32_bf16 v[12:15], a[172:175], a[60:63], 0
    v_cvt_pk_bf16_f32 v16, v0, v1
    v_mul_f32 v3, s57, v3
    v_mfma_f32_16x16x32_bf16 v[12:15], a[168:171], a[56:59], v[12:15]
    v_exp_f32 v3, v3
    v_mul_f32 v4, s57, v4
    v_mfma_f32_16x16x32_bf16 v[12:15], a[164:167], a[52:55], v[12:15]
    buffer_store_dwordx4 a[72:75], v49, s[36:39], s82 offen offset:2048 nt
    v_mfma_f32_16x16x32_bf16 v[12:15], a[160:163], a[48:51], v[12:15]
    v_exp_f32 v4, v4
    v_mfma_f32_16x16x32_bf16 v[160:163], a[176:179], v[20:23], v[160:163]
    v_cvt_pk_bf16_f32 v17, v2, v3
    v_mul_f32 v5, s57, v5
    v_mfma_f32_16x16x32_bf16 v[164:167], a[180:183], v[20:23], v[164:167]
    v_exp_f32 v5, v5
    v_mfma_f32_16x16x32_bf16 v[168:171], a[184:187], v[20:23], v[168:171]
    v_mul_f32 v6, s57, v6
    v_cvt_pk_bf16_f32 v18, v4, v5
    v_mul_f32 v7, s57, v7
    v_mfma_f32_16x16x32_bf16 v[172:175], a[188:191], v[20:23], v[172:175]
    v_exp_f32 v6, v6
    v_mul_f32 v9, s57, v9
    v_mfma_f32_16x16x32_bf16 v[176:179], a[192:195], v[20:23], v[176:179]
    v_exp_f32 v7, v7
    v_mul_f32 v8, s57, v8
    v_mfma_f32_16x16x32_bf16 v[180:183], a[196:199], v[20:23], v[180:183]
    v_cvt_pk_bf16_f32 v19, v6, v7
    v_exp_f32 v8, v8
    v_mfma_f32_16x16x32_bf16 v[184:187], a[200:203], v[20:23], v[184:187]
    s_waitcnt lgkmcnt(0)
    v_mul_f32 v10, s57, v10
    v_mul_f32 v15, s57, v15
    v_mfma_f32_16x16x32_bf16 v[188:191], a[204:207], v[20:23], v[188:191]
    buffer_store_dwordx4 a[76:79], v49, s[36:39], s82 offen offset:2176 nt
    v_mfma_f32_16x16x32_bf16 v[128:131], a[208:211], v[16:19], v[128:131]
    v_exp_f32 v9, v9
    v_mul_f32 v11, s57, v11
    v_mfma_f32_16x16x32_bf16 v[132:135], a[212:215], v[16:19], v[132:135]
    v_exp_f32 v10, v10
    v_mul_f32 v13, s57, v13
    v_mfma_f32_16x16x32_bf16 v[136:139], a[216:219], v[16:19], v[136:139]
    v_cvt_pk_bf16_f32 v20, v8, v9
    v_exp_f32 v13, v13
    v_mfma_f32_16x16x32_bf16 v[140:143], a[220:223], v[16:19], v[140:143]
    v_exp_f32 v11, v11
    v_mul_f32 v12, s57, v12
    v_mfma_f32_16x16x32_bf16 v[144:147], a[224:227], v[16:19], v[144:147]
    v_exp_f32 v12, v12
    v_cvt_pk_bf16_f32 v21, v10, v11
    v_mfma_f32_16x16x32_bf16 v[148:151], a[228:231], v[16:19], v[148:151]
    v_mul_f32 v14, s57, v14
    v_exp_f32 v15, v15
    v_mfma_f32_16x16x32_bf16 v[152:155], a[232:235], v[16:19], v[152:155]
    v_exp_f32 v14, v14
    v_mfma_f32_16x16x32_bf16 v[156:159], a[236:239], v[16:19], v[156:159]
    v_cvt_pk_bf16_f32 v22, v12, v13
    v_cvt_pk_bf16_f32 v23, v14, v15
    s_nop 1
    v_smfmac_f32_16x16x64_bf16 v[36:39], v[28:31], v[16:23], v48
    v_mfma_f32_16x16x32_bf16 v[160:163], a[208:211], v[20:23], v[160:163]
    v_mfma_f32_16x16x32_bf16 v[164:167], a[212:215], v[20:23], v[164:167]
    v_mfma_f32_16x16x32_bf16 v[168:171], a[216:219], v[20:23], v[168:171]
    v_mfma_f32_16x16x32_bf16 v[172:175], a[220:223], v[20:23], v[172:175]
    v_mfma_f32_16x16x32_bf16 v[176:179], a[224:227], v[20:23], v[176:179]
    v_mfma_f32_16x16x32_bf16 v[180:183], a[228:231], v[20:23], v[180:183]
    v_mfma_f32_16x16x32_bf16 v[184:187], a[232:235], v[20:23], v[184:187]
    v_mfma_f32_16x16x32_bf16 v[188:191], a[236:239], v[20:23], v[188:191]
    s_nop 3
    v_pk_add_f32 v[38:39], v[36:37], v[38:39]
    v_rcp_f32 v36, v38
    v_rcp_f32 v37, v39
    v_max3_u32 v54, v54, v38, v39
    v_min3_u32 v55, v55, v38, v39
    s_add_u32 s48, s62, 8192
    s_add_u32 s85, s62, 12288
    v_pk_mul_f32 v[128:129], v[128:129], v[36:37] op_sel:[0,0] op_sel_hi:[1,0]
    v_pk_mul_f32 v[130:131], v[130:131], v[36:37] op_sel:[0,0] op_sel_hi:[1,0]
    v_pk_mul_f32 v[132:133], v[132:133], v[36:37] op_sel:[0,0] op_sel_hi:[1,0]
    v_pk_mul_f32 v[134:135], v[134:135], v[36:37] op_sel:[0,0] op_sel_hi:[1,0]
    v_cvt_pk_bf16_f32 v128, v128, v129
    v_cvt_pk_bf16_f32 v129, v130, v131
    v_cvt_pk_bf16_f32 v130, v132, v133
    v_cvt_pk_bf16_f32 v131, v134, v135
    ds_write_b128 v50, v[128:131] offset:0
    buffer_store_dwordx4 a[80:83], v49, s[36:39], s83 offen offset:0 nt
    v_pk_mul_f32 v[136:137], v[136:137], v[36:37] op_sel:[0,0] op_sel_hi:[1,0]
    v_pk_mul_f32 v[138:139], v[138:139], v[36:37] op_sel:[0,0] op_sel_hi:[1,0]
    v_pk_mul_f32 v[140:141], v[140:141], v[36:37] op_sel:[0,0] op_sel_hi:[1,0]
    v_pk_mul_f32 v[142:143], v[142:143], v[36:37] op_sel:[0,0] op_sel_hi:[1,0]
    v_cvt_pk_bf16_f32 v136, v136, v137
    v_cvt_pk_bf16_f32 v137, v138, v139
    v_cvt_pk_bf16_f32 v138, v140, v141
    v_cvt_pk_bf16_f32 v139, v142, v143
    ds_write_b128 v50, v[136:139] offset:512
    buffer_store_dwordx4 a[84:87], v49, s[36:39], s83 offen offset:128 nt
    v_pk_mul_f32 v[144:145], v[144:145], v[36:37] op_sel:[0,0] op_sel_hi:[1,0]
    v_pk_mul_f32 v[146:147], v[146:147], v[36:37] op_sel:[0,0] op_sel_hi:[1,0]
    v_pk_mul_f32 v[148:149], v[148:149], v[36:37] op_sel:[0,0] op_sel_hi:[1,0]
    v_pk_mul_f32 v[150:151], v[150:151], v[36:37] op_sel:[0,0] op_sel_hi:[1,0]
    v_cvt_pk_bf16_f32 v144, v144, v145
    v_cvt_pk_bf16_f32 v145, v146, v147
    v_cvt_pk_bf16_f32 v146, v148, v149
    v_cvt_pk_bf16_f32 v147, v150, v151
    ds_write_b128 v50, v[144:147] offset:1024
    buffer_store_dwordx4 a[88:91], v49, s[36:39], s83 offen offset:2048 nt
    v_pk_mul_f32 v[152:153], v[152:153], v[36:37] op_sel:[0,0] op_sel_hi:[1,0]
    v_pk_mul_f32 v[154:155], v[154:155], v[36:37] op_sel:[0,0] op_sel_hi:[1,0]
    v_pk_mul_f32 v[156:157], v[156:157], v[36:37] op_sel:[0,0] op_sel_hi:[1,0]
    v_pk_mul_f32 v[158:159], v[158:159], v[36:37] op_sel:[0,0] op_sel_hi:[1,0]
    v_cvt_pk_bf16_f32 v152, v152, v153
    v_cvt_pk_bf16_f32 v153, v154, v155
    v_cvt_pk_bf16_f32 v154, v156, v157
    v_cvt_pk_bf16_f32 v155, v158, v159
    ds_write_b128 v50, v[152:155] offset:1536
    buffer_store_dwordx4 a[92:95], v49, s[36:39], s83 offen offset:2176 nt
    ds_read_b128 a[32:35], v51 offset:0
    ds_read_b128 a[36:39], v51 offset:1024
    ds_read_b128 a[40:43], v51 offset:2048
    ds_read_b128 a[44:47], v51 offset:3072
    v_pk_mul_f32 v[160:161], v[160:161], v[36:37] op_sel:[0,1] op_sel_hi:[1,1]
    v_pk_mul_f32 v[162:163], v[162:163], v[36:37] op_sel:[0,1] op_sel_hi:[1,1]
    v_pk_mul_f32 v[164:165], v[164:165], v[36:37] op_sel:[0,1] op_sel_hi:[1,1]
    v_pk_mul_f32 v[166:167], v[166:167], v[36:37] op_sel:[0,1] op_sel_hi:[1,1]
    v_cvt_pk_bf16_f32 v160, v160, v161
    v_cvt_pk_bf16_f32 v161, v162, v163
    v_cvt_pk_bf16_f32 v162, v164, v165
    v_cvt_pk_bf16_f32 v163, v166, v167
    ds_write_b128 v50, v[160:163] offset:4096
    v_pk_mul_f32 v[168:169], v[168:169], v[36:37] op_sel:[0,1] op_sel_hi:[1,1]
    v_pk_mul_f32 v[170:171], v[170:171], v[36:37] op_sel:[0,1] op_sel_hi:[1,1]
    v_pk_mul_f32 v[172:173], v[172:173], v[36:37] op_sel:[0,1] op_sel_hi:[1,1]
    v_pk_mul_f32 v[174:175], v[174:175], v[36:37] op_sel:[0,1] op_sel_hi:[1,1]
    v_cvt_pk_bf16_f32 v168, v168, v169
    v_cvt_pk_bf16_f32 v169, v170, v171
    v_cvt_pk_bf16_f32 v170, v172, v173
    v_cvt_pk_bf16_f32 v171, v174, v175
    ds_write_b128 v50, v[168:171] offset:4608
    s_waitcnt lgkmcnt(2)
    buffer_store_dwordx4 a[96:99], v49, s[36:39], s84 offen offset:0 nt
    v_pk_mul_f32 v[176:177], v[176:177], v[36:37] op_sel:[0,1] op_sel_hi:[1,1]
    v_pk_mul_f32 v[178:179], v[178:179], v[36:37] op_sel:[0,1] op_sel_hi:[1,1]
    v_pk_mul_f32 v[180:181], v[180:181], v[36:37] op_sel:[0,1] op_sel_hi:[1,1]
    v_pk_mul_f32 v[182:183], v[182:183], v[36:37] op_sel:[0,1] op_sel_hi:[1,1]
    v_cvt_pk_bf16_f32 v176, v176, v177
    v_cvt_pk_bf16_f32 v177, v178, v179
    v_cvt_pk_bf16_f32 v178, v180, v181
    v_cvt_pk_bf16_f32 v179, v182, v183
    ds_write_b128 v50, v[176:179] offset:5120
    buffer_store_dwordx4 a[100:103], v49, s[36:39], s84 offen offset:128 nt
    v_pk_mul_f32 v[184:185], v[184:185], v[36:37] op_sel:[0,1] op_sel_hi:[1,1]
    v_pk_mul_f32 v[186:187], v[186:187], v[36:37] op_sel:[0,1] op_sel_hi:[1,1]
    v_pk_mul_f32 v[188:189], v[188:189], v[36:37] op_sel:[0,1] op_sel_hi:[1,1]
    v_pk_mul_f32 v[190:191], v[190:191], v[36:37] op_sel:[0,1] op_sel_hi:[1,1]
    v_cvt_pk_bf16_f32 v184, v184, v185
    v_cvt_pk_bf16_f32 v185, v186, v187
    v_cvt_pk_bf16_f32 v186, v188, v189
    v_cvt_pk_bf16_f32 v187, v190, v191
    ds_write_b128 v50, v[184:187] offset:5632
    buffer_store_dwordx4 a[104:107], v49, s[36:39], s84 offen offset:2048 nt
    ds_read_b128 a[48:51], v51 offset:4096
    ds_read_b128 a[52:55], v51 offset:5120
    ds_read_b128 a[56:59], v51 offset:6144
    ds_read_b128 a[60:63], v51 offset:7168
    buffer_store_dwordx4 a[108:111], v49, s[36:39], s84 offen offset:2176 nt
    buffer_store_dwordx4 a[32:35], v49, s[36:39], s48 offen offset:0 nt
    buffer_store_dwordx4 a[36:39], v49, s[36:39], s48 offen offset:128 nt
    buffer_store_dwordx4 a[40:43], v49, s[36:39], s48 offen offset:2048 nt
    buffer_store_dwordx4 a[44:47], v49, s[36:39], s48 offen offset:2176 nt
    v_cmp_lt_u32 vcc, s59, v54
    v_cmp_gt_u32 s[70:71], s58, v55
    s_waitcnt lgkmcnt(0)
    buffer_store_dwordx4 a[48:51], v49, s[36:39], s85 offen offset:0 nt
    buffer_store_dwordx4 a[52:55], v49, s[36:39], s85 offen offset:128 nt
    buffer_store_dwordx4 a[56:59], v49, s[36:39], s85 offen offset:2048 nt
    buffer_store_dwordx4 a[60:63], v49, s[36:39], s85 offen offset:2176 nt
    s_lshl_b32 s68, 1, s56
    s_or_b64 vcc, vcc, s[70:71]
    s_cselect_b32 s68, s68, 0
    s_or_b32 s60, s60, s68
    s_branch L_done
L_tail_B:
    v_mfma_f32_16x16x32_bf16 v[0:3], a[144:147], a[16:19], 0
    v_exp_f32 v8, v8
    v_mfma_f32_16x16x32_bf16 v[0:3], a[148:151], a[20:23], v[0:3]
    ds_read_b128 a[144:147], v58 offset:32768
    ds_read_b128 a[148:151], v58 offset:33280
    v_mul_f32 v9, s57, v9
    v_mfma_f32_16x16x32_bf16 v[0:3], a[152:155], a[24:27], v[0:3]
    v_exp_f32 v9, v9
    v_mfma_f32_16x16x32_bf16 v[0:3], a[156:159], a[28:31], v[0:3]
    ds_read_b128 a[152:155], v58 offset:33792
    v_mul_f32 v10, s57, v10
    v_smfmac_f32_16x16x64_bf16 v[40:43], v[28:31], v[16:23], v48
    v_cvt_pk_bf16_f32 v16, v8, v9
    v_exp_f32 v10, v10
    v_mfma_f32_16x16x32_bf16 v[4:7], a[172:175], a[28:31], 0
    ds_read_b128 a[156:159], v58 offset:34304
    v_mul_f32 v11, s57, v11
    v_mfma_f32_16x16x32_bf16 v[4:7], a[168:171], a[24:27], v[4:7]
    ds_read_b128 a[172:175], v59 offset:34304
    v_exp_f32 v11, v11
    v_mfma_f32_16x16x32_bf16 v[4:7], a[164:167], a[20:23], v[4:7]
    ds_read_b128 a[168:171], v59 offset:33792
    v_mul_f32 v12, s57, v12
    v_cvt_pk_bf16_f32 v17, v10, v11
    v_mfma_f32_16x16x32_bf16 v[4:7], a[160:163], a[16:19], v[4:7]
    v_exp_f32 v12, v12
    v_mfma_f32_16x16x32_bf16 v[224:227], a[208:211], v[20:23], v[224:227]
    ds_read_b128 a[164:167], v59 offset:33280
    ds_read_b128 a[160:163], v59 offset:32768
    v_mul_f32 v13, s57, v13
    v_mfma_f32_16x16x32_bf16 v[228:231], a[212:215], v[20:23], v[228:231]
    ds_read_b64_tr_b16 a[208:209], v62 offset:34816
    v_exp_f32 v13, v13
    v_mfma_f32_16x16x32_bf16 v[232:235], a[216:219], v[20:23], v[232:235]
    v_mul_f32 v14, s57, v14
    v_cvt_pk_bf16_f32 v18, v12, v13
    v_mfma_f32_16x16x32_bf16 v[236:239], a[220:223], v[20:23], v[236:239]
    ds_read_b64_tr_b16 a[214:215], v63 offset:34824
    v_exp_f32 v14, v14
    v_mfma_f32_16x16x32_bf16 v[240:243], a[224:227], v[20:23], v[240:243]
    ds_read_b64_tr_b16 a[212:213], v62 offset:34824
    v_mul_f32 v15, s57, v15
    v_mfma_f32_16x16x32_bf16 v[244:247], a[228:231], v[20:23], v[244:247]
    v_exp_f32 v15, v15
    v_mfma_f32_16x16x32_bf16 v[248:251], a[232:235], v[20:23], v[248:251]
    ds_read_b64_tr_b16 a[210:211], v63 offset:34816
    ds_read_b64_tr_b16 a[216:217], v62 offset:35328
    v_cvt_pk_bf16_f32 v19, v14, v15
    v_mfma_f32_16x16x32_bf16 v[252:255], a[236:239], v[20:23], v[252:255]
    ds_read_b64_tr_b16 a[220:221], v62 offset:35336
    s_waitcnt lgkmcnt(10)
    v_mul_f32 v0, s57, v0
    v_mfma_f32_16x16x32_bf16 v[8:11], a[144:147], a[0:3], 0
    v_exp_f32 v0, v0
    v_mfma_f32_16x16x32_bf16 v[8:11], a[148:151], a[4:7], v[8:11]
    ds_read_b64_tr_b16 a[222:223], v63 offset:35336
    ds_read_b64_tr_b16 a[224:225], v62 offset:35840
    v_mul_f32 v1, s57, v1
    v_mfma_f32_16x16x32_bf16 v[8:11], a[152:155], a[8:11], v[8:11]
    v_exp_f32 v1, v1
    v_mfma_f32_16x16x32_bf16 v[8:11], a[156:159], a[12:15], v[8:11]
    ds_read_b64_tr_b16 a[226:227], v63 offset:35840
    s_waitcnt lgkmcnt(9)
    v_mul_f32 v2, s57, v2
    v_mfma_f32_16x16x32_bf16 v[12:15], a[172:175], a[12:15], 0
    v_cvt_pk_bf16_f32 v20, v0, v1
    v_exp_f32 v2, v2
    v_mfma_f32_16x16x32_bf16 v[12:15], a[168:171], a[8:11], v[12:15]
    ds_read_b64_tr_b16 a[228:229], v62 offset:35848
    v_mul_f32 v3, s57, v3
    v_mfma_f32_16x16x32_bf16 v[12:15], a[164:167], a[4:7], v[12:15]
    ds_read_b64_tr_b16 a[230:231], v63 offset:35848
    v_exp_f32 v3, v3
    v_mfma_f32_16x16x32_bf16 v[12:15], a[160:163], a[0:3], v[12:15]
    ds_read_b64_tr_b16 a[232:233], v62 offset:36352
    v_mul_f32 v4, s57, v4
    v_cvt_pk_bf16_f32 v21, v2, v3
    v_mfma_f32_16x16x32_bf16 v[64:67], a[176:179], v[16:19], v[64:67]
    v_exp_f32 v4, v4
    v_mfma_f32_16x16x32_bf16 v[68:71], a[180:183], v[16:19], v[68:71]
    ds_read_b64_tr_b16 a[218:219], v63 offset:35328
    v_mul_f32 v5, s57, v5
    v_mfma_f32_16x16x32_bf16 v[72:75], a[184:187], v[16:19], v[72:75]
    v_exp_f32 v5, v5
    v_mfma_f32_16x16x32_bf16 v[76:79], a[188:191], v[16:19], v[76:79]
    ds_read_b64_tr_b16 a[236:237], v62 offset:36360
    v_mul_f32 v6, s57, v6
    v_cvt_pk_bf16_f32 v22, v4, v5
    v_mfma_f32_16x16x32_bf16 v[80:83], a[192:195], v[16:19], v[80:83]
    v_exp_f32 v6, v6
    v_mfma_f32_16x16x32_bf16 v[84:87], a[196:199], v[16:19], v[84:87]
    ds_read_b64_tr_b16 a[238:239], v63 offset:36360
    v_mul_f32 v7, s57, v7
    v_mfma_f32_16x16x32_bf16 v[88:91], a[200:203], v[16:19], v[88:91]
    ds_read_b64_tr_b16 a[234:235], v63 offset:36352
    v_mul_f32 v8, s57, v8
    v_mfma_f32_16x16x32_bf16 v[92:95], a[204:207], v[16:19], v[92:95]
    v_exp_f32 v7, v7
    v_mfma_f32_16x16x32_bf16 v[0:3], a[144:147], a[16:19], 0
    v_cvt_pk_bf16_f32 v23, v6, v7
    v_exp_f32 v8, v8
    v_mfma_f32_16x16x32_bf16 v[0:3], a[148:151], a[20:23], v[0:3]
    ds_read_b128 a[148:151], v56 offset:33280
    v_mul_f32 v9, s57, v9
    v_mfma_f32_16x16x32_bf16 v[0:3], a[152:155], a[24:27], v[0:3]
    v_exp_f32 v9, v9
    v_mfma_f32_16x16x32_bf16 v[0:3], a[156:159], a[28:31], v[0:3]
    ds_read_b128 a[144:147], v56 offset:32768
    ds_read_b128 a[152:155], v56 offset:33792
    v_mul_f32 v10, s57, v10
    v_smfmac_f32_16x16x64_bf16 v[32:35], v[28:31], v[16:23], v48
    v_cvt_pk_bf16_f32 v16, v8, v9
    v_exp_f32 v10, v10
    v_mfma_f32_16x16x32_bf16 v[4:7], a[172:175], a[28:31], 0
    ds_read_b128 a[156:159], v56 offset:34304
    ds_read_b128 a[172:175], v57 offset:34304
    v_mul_f32 v11, s57, v11
    v_mfma_f32_16x16x32_bf16 v[4:7], a[168:171], a[24:27], v[4:7]
    v_exp_f32 v11, v11
    v_mfma_f32_16x16x32_bf16 v[4:7], a[164:167], a[20:23], v[4:7]
    ds_read_b128 a[168:171], v57 offset:33792
    v_mul_f32 v12, s57, v12
    v_cvt_pk_bf16_f32 v17, v10, v11
    v_mfma_f32_16x16x32_bf16 v[4:7], a[160:163], a[16:19], v[4:7]
    ds_read_b128 a[164:167], v57 offset:33280
    v_exp_f32 v12, v12
    v_mfma_f32_16x16x32_bf16 v[96:99], a[176:179], v[20:23], v[96:99]
    ds_read_b128 a[160:163], v57 offset:32768
    v_mul_f32 v13, s57, v13
    v_mfma_f32_16x16x32_bf16 v[100:103], a[180:183], v[20:23], v[100:103]
    v_exp_f32 v13, v13
    v_mfma_f32_16x16x32_bf16 v[104:107], a[184:187], v[20:23], v[104:107]
    ds_read_b64_tr_b16 a[176:177], v60 offset:34816
    v_mul_f32 v14, s57, v14
    v_cvt_pk_bf16_f32 v18, v12, v13
    v_mfma_f32_16x16x32_bf16 v[108:111], a[188:191], v[20:23], v[108:111]
    v_exp_f32 v14, v14
    v_mfma_f32_16x16x32_bf16 v[112:115], a[192:195], v[20:23], v[112:115]
    ds_read_b64_tr_b16 a[178:179], v61 offset:34816
    ds_read_b64_tr_b16 a[180:181], v60 offset:34824
    v_mul_f32 v15, s57, v15
    v_mfma_f32_16x16x32_bf16 v[116:119], a[196:199], v[20:23], v[116:119]
    v_exp_f32 v15, v15
    v_mfma_f32_16x16x32_bf16 v[120:123], a[200:203], v[20:23], v[120:123]
    ds_read_b64_tr_b16 a[184:185], v60 offset:35328
    v_cvt_pk_bf16_f32 v19, v14, v15
    v_mul_f32 v0, s57, v0
    v_mfma_f32_16x16x32_bf16 v[124:127], a[204:207], v[20:23], v[124:127]
    ds_read_b64_tr_b16 a[186:187], v61 offset:35328
    s_waitcnt lgkmcnt(9)
    v_mfma_f32_16x16x32_bf16 v[8:11], a[144:147], a[64:67], 0
    ds_read_b64_tr_b16 a[188:189], v60 offset:35336
    v_exp_f32 v0, v0
    v_mfma_f32_16x16x32_bf16 v[8:11], a[148:151], a[68:71], v[8:11]
    ds_read_b64_tr_b16 a[182:183], v61 offset:34824
    ds_read_b64_tr_b16 a[190:191], v61 offset:35336
    v_mul_f32 v1, s57, v1
    v_mfma_f32_16x16x32_bf16 v[8:11], a[152:155], a[72:75], v[8:11]
    ds_read_b64_tr_b16 a[194:195], v61 offset:35840
    v_exp_f32 v1, v1
    v_mfma_f32_16x16x32_bf16 v[8:11], a[156:159], a[76:79], v[8:11]
    s_waitcnt lgkmcnt(9)
    v_mul_f32 v2, s57, v2
    v_cvt_pk_bf16_f32 v20, v0, v1
    v_mfma_f32_16x16x32_bf16 v[12:15], a[172:175], a[76:79], 0
    ds_read_b64_tr_b16 a[192:193], v60 offset:35840
    ds_read_b64_tr_b16 a[196:197], v60 offset:35848
    v_mfma_f32_16x16x32_bf16 v[12:15], a[168:171], a[72:75], v[12:15]
    v_exp_f32 v2, v2
    v_mul_f32 v3, s57, v3
    v_mfma_f32_16x16x32_bf16 v[12:15], a[164:167], a[68:71], v[12:15]
    v_exp_f32 v3, v3
    v_mfma_f32_16x16x32_bf16 v[12:15], a[160:163], a[64:67], v[12:15]
    s_waitcnt lgkmcnt(15)
    v_mul_f32 v4, s57, v4
    v_cvt_pk_bf16_f32 v21, v2, v3
    v_mfma_f32_16x16x32_bf16 v[64:67], a[208:211], v[16:19], v[64:67]
    ds_read_b64_tr_b16 a[204:205], v60 offset:36360
    v_exp_f32 v4, v4
    v_mfma_f32_16x16x32_bf16 v[68:71], a[212:215], v[16:19], v[68:71]
    ds_read_b64_tr_b16 a[202:203], v61 offset:36352
    v_mul_f32 v5, s57, v5
    v_mfma_f32_16x16x32_bf16 v[72:75], a[216:219], v[16:19], v[72:75]
    v_exp_f32 v5, v5
    v_mfma_f32_16x16x32_bf16 v[76:79], a[220:223], v[16:19], v[76:79]
    v_mul_f32 v6, s57, v6
    v_cvt_pk_bf16_f32 v22, v4, v5
    v_mfma_f32_16x16x32_bf16 v[80:83], a[224:227], v[16:19], v[80:83]
    v_exp_f32 v6, v6
    v_mfma_f32_16x16x32_bf16 v[84:87], a[228:231], v[16:19], v[84:87]
    ds_read_b64_tr_b16 a[206:207], v61 offset:36360
    v_mul_f32 v7, s57, v7
    v_mfma_f32_16x16x32_bf16 v[88:91], a[232:235], v[16:19], v[88:91]
    v_exp_f32 v7, v7
    v_mul_f32 v8, s57, v8
    v_mfma_f32_16x16x32_bf16 v[92:95], a[236:239], v[16:19], v[92:95]
    ds_read_b64_tr_b16 a[198:199], v61 offset:35848
    v_cvt_pk_bf16_f32 v23, v6, v7
    v_mfma_f32_16x16x32_bf16 v[0:3], a[144:147], a[80:83], 0
    v_exp_f32 v8, v8
    v_mfma_f32_16x16x32_bf16 v[0:3], a[148:151], a[84:87], v[0:3]
    ds_read_b64_tr_b16 a[200:201], v60 offset:36352
    v_mul_f32 v9, s57, v9
    v_mfma_f32_16x16x32_bf16 v[0:3], a[152:155], a[88:91], v[0:3]
    v_exp_f32 v9, v9
    v_mul_f32 v10, s57, v10
    v_mfma_f32_16x16x32_bf16 v[0:3], a[156:159], a[92:95], v[0:3]
    v_exp_f32 v10, v10
    v_smfmac_f32_16x16x64_bf16 v[32:35], v[28:31], v[16:23], v48
    v_cvt_pk_bf16_f32 v16, v8, v9
    v_mfma_f32_16x16x32_bf16 v[4:7], a[172:175], a[92:95], 0
    ds_read_b128 a[172:175], v59 offset:34304
    v_mul_f32 v11, s57, v11
    v_mfma_f32_16x16x32_bf16 v[4:7], a[168:171], a[88:91], v[4:7]
    v_exp_f32 v11, v11
    v_mfma_f32_16x16x32_bf16 v[4:7], a[164:167], a[84:87], v[4:7]
    ds_read_b128 a[168:171], v59 offset:33792
    v_mul_f32 v12, s57, v12
    v_cvt_pk_bf16_f32 v17, v10, v11
    v_mfma_f32_16x16x32_bf16 v[4:7], a[160:163], a[80:83], v[4:7]
    v_exp_f32 v12, v12
    v_mfma_f32_16x16x32_bf16 v[96:99], a[208:211], v[20:23], v[96:99]
    ds_read_b128 a[164:167], v59 offset:33280
    ds_read_b128 a[160:163], v59 offset:32768
    v_mul_f32 v13, s57, v13
    v_mfma_f32_16x16x32_bf16 v[100:103], a[212:215], v[20:23], v[100:103]
    v_exp_f32 v13, v13
    v_mfma_f32_16x16x32_bf16 v[104:107], a[216:219], v[20:23], v[104:107]
    v_mul_f32 v14, s57, v14
    v_cvt_pk_bf16_f32 v18, v12, v13
    v_mfma_f32_16x16x32_bf16 v[108:111], a[220:223], v[20:23], v[108:111]
    ds_read_b64_tr_b16 a[208:209], v62 offset:34816
    v_exp_f32 v14, v14
    v_mfma_f32_16x16x32_bf16 v[112:115], a[224:227], v[20:23], v[112:115]
    ds_read_b64_tr_b16 a[212:213], v62 offset:34824
    v_mul_f32 v15, s57, v15
    v_mfma_f32_16x16x32_bf16 v[116:119], a[228:231], v[20:23], v[116:119]
    v_exp_f32 v15, v15
    v_mfma_f32_16x16x32_bf16 v[120:123], a[232:235], v[20:23], v[120:123]
    ds_read_b64_tr_b16 a[214:215], v63 offset:34824
    v_cvt_pk_bf16_f32 v19, v14, v15
    v_mul_f32 v0, s57, v0
    v_mfma_f32_16x16x32_bf16 v[124:127], a[236:239], v[20:23], v[124:127]
    v_exp_f32 v0, v0
    v_mul_f32 v2, s57, v2
    s_waitcnt vmcnt(8)
    s_nop 0
    v_pk_add_f32 v[34:35], v[32:33], v[34:35]
    v_rcp_f32 v32, v34
    v_rcp_f32 v33, v35
    v_max_u32 v54, v34, v35
    v_min_u32 v55, v34, v35
    v_add_u32 v51, 0xffffb800, v51
    v_pk_mul_f32 v[64:65], v[64:65], v[32:33] op_sel:[0,0] op_sel_hi:[1,0]
    v_pk_mul_f32 v[66:67], v[66:67], v[32:33] op_sel:[0,0] op_sel_hi:[1,0]
    v_pk_mul_f32 v[68:69], v[68:69], v[32:33] op_sel:[0,0] op_sel_hi:[1,0]
    v_pk_mul_f32 v[70:71], v[70:71], v[32:33] op_sel:[0,0] op_sel_hi:[1,0]
    v_cvt_pk_bf16_f32 v64, v64, v65
    v_cvt_pk_bf16_f32 v65, v66, v67
    v_cvt_pk_bf16_f32 v66, v68, v69
    v_cvt_pk_bf16_f32 v67, v70, v71
    ds_write_b128 v50, v[64:67] offset:0
    v_pk_mul_f32 v[72:73], v[72:73], v[32:33] op_sel:[0,0] op_sel_hi:[1,0]
    v_pk_mul_f32 v[74:75], v[74:75], v[32:33] op_sel:[0,0] op_sel_hi:[1,0]
    v_pk_mul_f32 v[76:77], v[76:77], v[32:33] op_sel:[0,0] op_sel_hi:[1,0]
    v_pk_mul_f32 v[78:79], v[78:79], v[32:33] op_sel:[0,0] op_sel_hi:[1,0]
    v_cvt_pk_bf16_f32 v72, v72, v73
    v_cvt_pk_bf16_f32 v73, v74, v75
    v_cvt_pk_bf16_f32 v74, v76, v77
    v_cvt_pk_bf16_f32 v75, v78, v79
    ds_write_b128 v50, v[72:75] offset:512
    v_pk_mul_f32 v[80:81], v[80:81], v[32:33] op_sel:[0,0] op_sel_hi:[1,0]
    v_pk_mul_f32 v[82:83], v[82:83], v[32:33] op_sel:[0,0] op_sel_hi:[1,0]
    v_pk_mul_f32 v[84:85], v[84:85], v[32:33] op_sel:[0,0] op_sel_hi:[1,0]
    v_pk_mul_f32 v[86:87], v[86:87], v[32:33] op_sel:[0,0] op_sel_hi:[1,0]
    v_cvt_pk_bf16_f32 v80, v80, v81
    v_cvt_pk_bf16_f32 v81, v82, v83
    v_cvt_pk_bf16_f32 v82, v84, v85
    v_cvt_pk_bf16_f32 v83, v86, v87
    ds_write_b128 v50, v[80:83] offset:1024
    v_pk_mul_f32 v[88:89], v[88:89], v[32:33] op_sel:[0,0] op_sel_hi:[1,0]
    v_pk_mul_f32 v[90:91], v[90:91], v[32:33] op_sel:[0,0] op_sel_hi:[1,0]
    v_pk_mul_f32 v[92:93], v[92:93], v[32:33] op_sel:[0,0] op_sel_hi:[1,0]
    v_pk_mul_f32 v[94:95], v[94:95], v[32:33] op_sel:[0,0] op_sel_hi:[1,0]
    v_cvt_pk_bf16_f32 v88, v88, v89
    v_cvt_pk_bf16_f32 v89, v90, v91
    v_cvt_pk_bf16_f32 v90, v92, v93
    v_cvt_pk_bf16_f32 v91, v94, v95
    ds_write_b128 v50, v[88:91] offset:1536
    ds_read_b128 a[0:3], v51 offset:0
    ds_read_b128 a[4:7], v51 offset:1024
    ds_read_b128 a[8:11], v51 offset:2048
    ds_read_b128 a[12:15], v51 offset:3072
    v_pk_mul_f32 v[96:97], v[96:97], v[32:33] op_sel:[0,1] op_sel_hi:[1,1]
    v_pk_mul_f32 v[98:99], v[98:99], v[32:33] op_sel:[0,1] op_sel_hi:[1,1]
    v_pk_mul_f32 v[100:101], v[100:101], v[32:33] op_sel:[0,1] op_sel_hi:[1,1]
    v_pk_mul_f32 v[102:103], v[102:103], v[32:33] op_sel:[0,1] op_sel_hi:[1,1]
    v_cvt_pk_bf16_f32 v96, v96, v97
    v_cvt_pk_bf16_f32 v97, v98, v99
    v_cvt_pk_bf16_f32 v98, v100, v101
    v_cvt_pk_bf16_f32 v99, v102, v103
    ds_write_b128 v50, v[96:99] offset:4096
    v_pk_mul_f32 v[104:105], v[104:105], v[32:33] op_sel:[0,1] op_sel_hi:[1,1]
    v_pk_mul_f32 v[106:107], v[106:107], v[32:33] op_sel:[0,1] op_sel_hi:[1,1]
    v_pk_mul_f32 v[108:109], v[108:109], v[32:33] op_sel:[0,1] op_sel_hi:[1,1]
    v_pk_mul_f32 v[110:111], v[110:111], v[32:33] op_sel:[0,1] op_sel_hi:[1,1]
    v_cvt_pk_bf16_f32 v104, v104, v105
    v_cvt_pk_bf16_f32 v105, v106, v107
    v_cvt_pk_bf16_f32 v106, v108, v109
    v_cvt_pk_bf16_f32 v107, v110, v111
    ds_write_b128 v50, v[104:107] offset:4608
    v_pk_mul_f32 v[112:113], v[112:113], v[32:33] op_sel:[0,1] op_sel_hi:[1,1]
    v_pk_mul_f32 v[114:115], v[114:115], v[32:33] op_sel:[0,1] op_sel_hi:[1,1]
    v_pk_mul_f32 v[116:117], v[116:117], v[32:33] op_sel:[0,1] op_sel_hi:[1,1]
    v_pk_mul_f32 v[118:119], v[118:119], v[32:33] op_sel:[0,1] op_sel_hi:[1,1]
    v_cvt_pk_bf16_f32 v112, v112, v113
    v_cvt_pk_bf16_f32 v113, v114, v115
    v_cvt_pk_bf16_f32 v114, v116, v117
    v_cvt_pk_bf16_f32 v115, v118, v119
    ds_write_b128 v50, v[112:115] offset:5120
    v_pk_mul_f32 v[120:121], v[120:121], v[32:33] op_sel:[0,1] op_sel_hi:[1,1]
    v_pk_mul_f32 v[122:123], v[122:123], v[32:33] op_sel:[0,1] op_sel_hi:[1,1]
    v_pk_mul_f32 v[124:125], v[124:125], v[32:33] op_sel:[0,1] op_sel_hi:[1,1]
    v_pk_mul_f32 v[126:127], v[126:127], v[32:33] op_sel:[0,1] op_sel_hi:[1,1]
    v_cvt_pk_bf16_f32 v120, v120, v121
    v_cvt_pk_bf16_f32 v121, v122, v123
    v_cvt_pk_bf16_f32 v122, v124, v125
    v_cvt_pk_bf16_f32 v123, v126, v127
    ds_write_b128 v50, v[120:123] offset:5632
    ds_read_b128 a[16:19], v51 offset:4096
    ds_read_b128 a[20:23], v51 offset:5120
    ds_read_b128 a[24:27], v51 offset:6144
    ds_read_b128 a[28:31], v51 offset:7168
    s_add_u32 s82, s63, 0
    s_add_u32 s83, s63, 4096
    v_mul_f32 v1, s57, v1
    v_mfma_f32_16x16x32_bf16 v[8:11], a[144:147], a[96:99], 0
    ds_read_b128 a[144:147], v58 offset:32768
    v_exp_f32 v1, v1
    v_mfma_f32_16x16x32_bf16 v[8:11], a[148:151], a[100:103], v[8:11]
    ds_read_b128 a[148:151], v58 offset:33280
    v_exp_f32 v2, v2
    v_mfma_f32_16x16x32_bf16 v[8:11], a[152:155], a[104:107], v[8:11]
    ds_read_b128 a[152:155], v58 offset:33792
    v_cvt_pk_bf16_f32 v20, v0, v1
    v_mul_f32 v4, s57, v4
    v_mfma_f32_16x16x32_bf16 v[8:11], a[156:159], a[108:111], v[8:11]
    ds_read_b128 a[156:159], v58 offset:34304
    s_waitcnt lgkmcnt(15)
    v_mul_f32 v3, s57, v3
    v_mfma_f32_16x16x32_bf16 v[192:195], a[176:179], v[16:19], v[192:195]
    s_waitcnt lgkmcnt(4)
    v_exp_f32 v3, v3
    v_mfma_f32_16x16x32_bf16 v[196:199], a[180:183], v[16:19], v[196:199]
    buffer_store_dwordx4 a[0:3], v49, s[36:39], s82 offen offset:0 nt
    v_mfma_f32_16x16x32_bf16 v[200:203], a[184:187], v[16:19], v[200:203]
    v_exp_f32 v4, v4
    v_mul_f32 v5, s57, v5
    v_mfma_f32_16x16x32_bf16 v[204:207], a[188:191], v[16:19], v[204:207]
    ds_read_b64_tr_b16 a[234:235], v63 offset:36352
    v_exp_f32 v5, v5
    v_mfma_f32_16x16x32_bf16 v[208:211], a[192:195], v[16:19], v[208:211]
    v_cvt_pk_bf16_f32 v21, v2, v3
    v_mul_f32 v6, s57, v6
    v_cvt_pk_bf16_f32 v22, v4, v5
    v_mfma_f32_16x16x32_bf16 v[212:215], a[196:199], v[16:19], v[212:215]
    v_exp_f32 v6, v6
    v_mul_f32 v7, s57, v7
    v_mfma_f32_16x16x32_bf16 v[216:219], a[200:203], v[16:19], v[216:219]
    v_exp_f32 v7, v7
    v_mul_f32 v8, s57, v8
    v_mfma_f32_16x16x32_bf16 v[220:223], a[204:207], v[16:19], v[220:223]
    ds_read_b64_tr_b16 a[232:233], v62 offset:36352
    s_waitcnt lgkmcnt(2)
    v_cvt_pk_bf16_f32 v23, v6, v7
    v_mfma_f32_16x16x32_bf16 v[0:3], a[144:147], a[64:67], 0
    ds_read_b64_tr_b16 a[222:223], v63 offset:35336
    ds_read_b64_tr_b16 a[238:239], v63 offset:36360
    v_mfma_f32_16x16x32_bf16 v[0:3], a[148:151], a[68:71], v[0:3]
    v_exp_f32 v8, v8
    v_mfma_f32_16x16x32_bf16 v[0:3], a[152:155], a[72:75], v[0:3]
    buffer_store_dwordx4 a[4:7], v49, s[36:39], s82 offen offset:128 nt
    v_mfma_f32_16x16x32_bf16 v[0:3], a[156:159], a[76:79], v[0:3]
    ds_read_b64_tr_b16 a[210:211], v63 offset:34816
    v_mul_f32 v9, s57, v9
    v_smfmac_f32_16x16x64_bf16 v[40:43], v[28:31], v[16:23], v48
    s_waitcnt lgkmcnt(5)
    v_exp_f32 v9, v9
    v_mfma_f32_16x16x32_bf16 v[4:7], a[172:175], a[76:79], 0
    ds_read_b64_tr_b16 a[226:227], v63 offset:35840
    v_cvt_pk_bf16_f32 v24, v8, v9
    v_mfma_f32_16x16x32_bf16 v[4:7], a[168:171], a[72:75], v[4:7]
    ds_read_b64_tr_b16 a[220:221], v62 offset:35336
    ds_read_b64_tr_b16 a[236:237], v62 offset:36360
    v_mfma_f32_16x16x32_bf16 v[4:7], a[164:167], a[68:71], v[4:7]
    ds_read_b64_tr_b16 a[224:225], v62 offset:35840
    v_mul_f32 v10, s57, v10
    v_mfma_f32_16x16x32_bf16 v[4:7], a[160:163], a[64:67], v[4:7]
    v_exp_f32 v10, v10
    v_mfma_f32_16x16x32_bf16 v[224:227], a[176:179], v[20:23], v[224:227]
    ds_read_b64_tr_b16 a[216:217], v62 offset:35328
    ds_read_b64_tr_b16 a[218:219], v63 offset:35328
    v_mfma_f32_16x16x32_bf16 v[228:231], a[180:183], v[20:23], v[228:231]
    ds_read_b64_tr_b16 a[230:231], v63 offset:35848
    v_mul_f32 v11, s57, v11
    v_mfma_f32_16x16x32_bf16 v[232:235], a[184:187], v[20:23], v[232:235]
    buffer_store_dwordx4 a[8:11], v49, s[36:39], s82 offen offset:2048 nt
    v_mfma_f32_16x16x32_bf16 v[236:239], a[188:191], v[20:23], v[236:239]
    v_exp_f32 v11, v11
    v_mfma_f32_16x16x32_bf16 v[240:243], a[192:195], v[20:23], v[240:243]
    ds_read_b64_tr_b16 a[228:229], v62 offset:35848
    v_cvt_pk_bf16_f32 v25, v10, v11
    v_mfma_f32_16x16x32_bf16 v[244:247], a[196:199], v[20:23], v[244:247]
    v_mul_f32 v0, s57, v0
    v_mul_f32 v1, s57, v1
    v_mfma_f32_16x16x32_bf16 v[248:251], a[200:203], v[20:23], v[248:251]
    v_exp_f32 v0, v0
    v_mfma_f32_16x16x32_bf16 v[252:255], a[204:207], v[20:23], v[252:255]
    v_exp_f32 v1, v1
    v_mfma_f32_16x16x32_bf16 v[8:11], a[144:147], a[80:83], 0
    ds_read_b128 a[144:147], v56 offset:32768
    v_mul_f32 v2, s57, v2
    v_mfma_f32_16x16x32_bf16 v[8:11], a[148:151], a[84:87], v[8:11]
    v_exp_f32 v2, v2
    v_mfma_f32_16x16x32_bf16 v[8:11], a[152:155], a[88:91], v[8:11]
    ds_read_b128 a[148:151], v56 offset:33280
    v_cvt_pk_bf16_f32 v16, v0, v1
    v_mfma_f32_16x16x32_bf16 v[8:11], a[156:159], a[92:95], v[8:11]
    buffer_store_dwordx4 a[12:15], v49, s[36:39], s82 offen offset:2176 nt
    v_smfmac_f32_16x16x64_bf16 v[44:47], v[28:31], v[20:27], v48
    ds_read_b128 a[152:155], v56 offset:33792
    ds_read_b128 a[156:159], v56 offset:34304
    v_mul_f32 v5, s57, v5
    v_mfma_f32_16x16x32_bf16 v[12:15], a[172:175], a[92:95], 0
    ds_read_b128 a[172:175], v57 offset:34304
    v_mul_f32 v3, s57, v3
    v_mul_f32 v4, s57, v4
    v_mfma_f32_16x16x32_bf16 v[12:15], a[168:171], a[88:91], v[12:15]
    ds_read_b128 a[168:171], v57 offset:33792
    v_exp_f32 v3, v3
    v_mfma_f32_16x16x32_bf16 v[12:15], a[164:167], a[84:87], v[12:15]
    v_cvt_pk_bf16_f32 v17, v2, v3
    v_exp_f32 v5, v5
    v_mfma_f32_16x16x32_bf16 v[12:15], a[160:163], a[80:83], v[12:15]
    ds_read_b128 a[164:167], v57 offset:33280
    v_exp_f32 v4, v4
    v_mfma_f32_16x16x16_bf16 a[112:115], a[176:177], v[24:25], a[112:115]
    ds_read_b128 a[160:163], v57 offset:32768
    ds_read_b64_tr_b16 a[178:179], v61 offset:34816
    v_mul_f32 v6, s57, v6
    v_mfma_f32_16x16x16_bf16 a[116:119], a[180:181], v[24:25], a[116:119]
    ds_read_b64_tr_b16 a[176:177], v60 offset:34816
    ds_read_b64_tr_b16 a[180:181], v60 offset:34824
    v_cvt_pk_bf16_f32 v18, v4, v5
    v_mfma_f32_16x16x16_bf16 a[120:123], a[184:185], v[24:25], a[120:123]
    buffer_store_dwordx4 a[16:19], v49, s[36:39], s83 offen offset:0 nt
    v_mfma_f32_16x16x16_bf16 a[124:127], a[188:189], v[24:25], a[124:127]
    v_exp_f32 v6, v6
    v_mul_f32 v7, s57, v7
    v_mfma_f32_16x16x16_bf16 a[128:131], a[192:193], v[24:25], a[128:131]
    ds_read_b64_tr_b16 a[186:187], v61 offset:35328
    v_exp_f32 v7, v7
    v_mfma_f32_16x16x16_bf16 a[132:135], a[196:197], v[24:25], a[132:135]
    ds_read_b64_tr_b16 a[182:183], v61 offset:34824
    ds_read_b64_tr_b16 a[184:185], v60 offset:35328
    ds_read_b64_tr_b16 a[188:189], v60 offset:35336
    v_mfma_f32_16x16x16_bf16 a[136:139], a[200:201], v[24:25], a[136:139]
    ds_read_b64_tr_b16 a[190:191], v61 offset:35336
    v_cvt_pk_bf16_f32 v19, v6, v7
    v_mul_f32 v8, s57, v8
    v_mfma_f32_16x16x16_bf16 a[140:143], a[204:205], v[24:25], a[140:143]
    ds_read_b64_tr_b16 a[192:193], v60 offset:35840
    ds_read_b64_tr_b16 a[198:199], v61 offset:35848
    s_waitcnt lgkmcnt(14)
    v_mfma_f32_16x16x32_bf16 v[0:3], a[144:147], a[32:35], 0
    v_exp_f32 v8, v8
    v_mul_f32 v9, s57, v9
    v_mfma_f32_16x16x32_bf16 v[0:3], a[148:151], a[36:39], v[0:3]
    ds_read_b64_tr_b16 a[196:197], v60 offset:35848
    v_exp_f32 v9, v9
    v_mfma_f32_16x16x32_bf16 v[0:3], a[152:155], a[40:43], v[0:3]
    ds_read_b64_tr_b16 a[194:195], v61 offset:35840
    v_mul_f32 v10, s57, v10
    v_cvt_pk_bf16_f32 v20, v8, v9
    v_mfma_f32_16x16x32_bf16 v[0:3], a[156:159], a[44:47], v[0:3]
    s_waitcnt lgkmcnt(12)
    v_exp_f32 v10, v10
    v_mfma_f32_16x16x32_bf16 v[4:7], a[172:175], a[44:47], 0
    buffer_store_dwordx4 a[20:23], v49, s[36:39], s83 offen offset:128 nt
    v_mfma_f32_16x16x32_bf16 v[4:7], a[168:171], a[40:43], v[4:7]
    ds_write_b128 v51, a[112:115] offset:0
    v_mul_f32 v11, s57, v11
    v_mfma_f32_16x16x32_bf16 v[4:7], a[164:167], a[36:39], v[4:7]
    ds_read_b64_tr_b16 a[200:201], v60 offset:36352
    v_exp_f32 v11, v11
    v_mfma_f32_16x16x32_bf16 v[4:7], a[160:163], a[32:35], v[4:7]
    ds_read_b64_tr_b16 a[204:205], v60 offset:36360
    ds_read_b64_tr_b16 a[206:207], v61 offset:36360
    s_waitcnt lgkmcnt(15)
    v_mul_f32 v12, s57, v12
    v_mfma_f32_16x16x32_bf16 v[192:195], a[208:211], v[16:19], v[192:195]
    v_cvt_pk_bf16_f32 v21, v10, v11
    v_exp_f32 v12, v12
    v_mfma_f32_16x16x32_bf16 v[196:199], a[212:215], v[16:19], v[196:199]
    ds_write_b128 v51, a[128:131] offset:4096
    v_mul_f32 v13, s57, v13
    v_mfma_f32_16x16x32_bf16 v[200:203], a[216:219], v[16:19], v[200:203]
    v_exp_f32 v13, v13
    v_mul_f32 v14, s57, v14
    v_mfma_f32_16x16x32_bf16 v[204:207], a[220:223], v[16:19], v[204:207]
    ds_write_b128 v51, a[136:139] offset:6144
    v_cvt_pk_bf16_f32 v22, v12, v13
    v_mfma_f32_16x16x32_bf16 v[208:211], a[224:227], v[16:19], v[208:211]
    ds_read_b64_tr_b16 a[202:203], v61 offset:36352
    v_exp_f32 v14, v14
    v_mfma_f32_16x16x32_bf16 v[212:215], a[228:231], v[16:19], v[212:215]
    buffer_store_dwordx4 a[24:27], v49, s[36:39], s83 offen offset:2048 nt
    v_mul_f32 v15, s57, v15
    v_mfma_f32_16x16x32_bf16 v[216:219], a[232:235], v[16:19], v[216:219]
    v_exp_f32 v15, v15
    v_mul_f32 v0, s57, v0
    v_add_f32 v47, v45, v47
    v_mfma_f32_16x16x32_bf16 v[220:223], a[236:239], v[16:19], v[220:223]
    v_cvt_pk_bf16_f32 v23, v14, v15
    v_exp_f32 v0, v0
    v_mfma_f32_16x16x32_bf16 v[8:11], a[144:147], a[48:51], 0
    ds_write_b128 v51, a[124:127] offset:3072
    v_mfma_f32_16x16x32_bf16 v[8:11], a[148:151], a[52:55], v[8:11]
    ds_write_b32 v51, v47 offset:20480
    ds_read_b128 a[144:147], v58 offset:32768
    v_mul_f32 v1, s57, v1
    v_mfma_f32_16x16x32_bf16 v[8:11], a[152:155], a[56:59], v[8:11]
    ds_read_b128 a[148:151], v58 offset:33280
    v_exp_f32 v1, v1
    v_mul_f32 v2, s57, v2
    v_mfma_f32_16x16x32_bf16 v[8:11], a[156:159], a[60:63], v[8:11]
    ds_write_b128 v51, a[140:143] offset:7168
    v_smfmac_f32_16x16x64_bf16 v[40:43], v[28:31], v[16:23], v48
    ds_read_b128 a[152:155], v58 offset:33792
    ds_read_b128 a[156:159], v58 offset:34304
    v_cvt_pk_bf16_f32 v16, v0, v1
    v_mfma_f32_16x16x32_bf16 v[12:15], a[172:175], a[60:63], 0
    v_exp_f32 v2, v2
    v_mul_f32 v3, s57, v3
    v_mfma_f32_16x16x32_bf16 v[12:15], a[168:171], a[56:59], v[12:15]
    buffer_store_dwordx4 a[28:31], v49, s[36:39], s83 offen offset:2176 nt
    v_mfma_f32_16x16x32_bf16 v[12:15], a[164:167], a[52:55], v[12:15]
    v_exp_f32 v3, v3
    v_mul_f32 v4, s57, v4
    v_mfma_f32_16x16x32_bf16 v[12:15], a[160:163], a[48:51], v[12:15]
    ds_read_b128 a[172:175], v59 offset:34304
    ds_read_b128 a[164:167], v59 offset:33280
    v_cvt_pk_bf16_f32 v17, v2, v3
    v_mfma_f32_16x16x32_bf16 v[224:227], a[208:211], v[20:23], v[224:227]
    v_exp_f32 v4, v4
    v_mul_f32 v5, s57, v5
    v_mfma_f32_16x16x32_bf16 v[228:231], a[212:215], v[20:23], v[228:231]
    ds_read_b128 a[168:171], v59 offset:33792
    v_exp_f32 v5, v5
    v_mfma_f32_16x16x32_bf16 v[232:235], a[216:219], v[20:23], v[232:235]
    ds_write_b128 v51, a[132:135] offset:5120
    v_mfma_f32_16x16x32_bf16 v[236:239], a[220:223], v[20:23], v[236:239]
    ds_read_b128 a[160:163], v59 offset:32768
    v_mul_f32 v6, s57, v6
    v_cvt_pk_bf16_f32 v18, v4, v5
    v_mfma_f32_16x16x32_bf16 v[240:243], a[224:227], v[20:23], v[240:243]
    v_exp_f32 v6, v6
    v_mul_f32 v7, s57, v7
    v_mfma_f32_16x16x32_bf16 v[244:247], a[228:231], v[20:23], v[244:247]
    ds_write_b128 v51, a[116:119] offset:1024
    v_mfma_f32_16x16x32_bf16 v[248:251], a[232:235], v[20:23], v[248:251]
    v_exp_f32 v7, v7
    v_mul_f32 v8, s57, v8
    v_mfma_f32_16x16x32_bf16 v[252:255], a[236:239], v[20:23], v[252:255]
    ds_write_b128 v51, a[120:123] offset:2048
    s_sub_u32 s68, 86016, s54
    s_lshl_b32 s69, s61, 11
    s_sub_u32 s69, s69, 20480
    v_add_u32 v26, s68, v51
    v_add_u32 v27, 0x12000, v26
    v_add_u32 v24, s69, v26
    v_add_u32 v25, s69, v27
    s_waitcnt lgkmcnt(0)
    s_barrier
    ds_read_b128 v[64:67], v24 offset:0
    ds_read_b128 v[68:71], v24 offset:1024
    ds_read_b128 v[72:75], v24 offset:24576
    ds_read_b128 v[76:79], v24 offset:25600
    ds_read_b128 v[80:83], v24 offset:49152
    ds_read_b128 v[84:87], v24 offset:50176
    ds_read_b128 v[88:91], v25 offset:0
    ds_read_b128 v[92:95], v25 offset:1024
    ds_read_b32 v44, v26 offset:0
    ds_read_b32 v45, v26 offset:24576
    ds_read_b32 v46, v26 offset:49152
    ds_read_b32 v47, v27
    v_pk_add_f32 v[42:43], v[40:41], v[42:43]
    v_rcp_f32 v40, v42
    v_rcp_f32 v41, v43
    v_max3_u32 v54, v54, v42, v43
    v_min3_u32 v55, v55, v42, v43
    v_pk_mul_f32 v[192:193], v[192:193], v[40:41] op_sel:[0,0] op_sel_hi:[1,0]
    v_pk_mul_f32 v[194:195], v[194:195], v[40:41] op_sel:[0,0] op_sel_hi:[1,0]
    v_pk_mul_f32 v[196:197], v[196:197], v[40:41] op_sel:[0,0] op_sel_hi:[1,0]
    v_pk_mul_f32 v[198:199], v[198:199], v[40:41] op_sel:[0,0] op_sel_hi:[1,0]
    v_cvt_pk_bf16_f32 v192, v192, v193
    v_cvt_pk_bf16_f32 v193, v194, v195
    v_cvt_pk_bf16_f32 v194, v196, v197
    v_cvt_pk_bf16_f32 v195, v198, v199
    ds_write_b128 v50, v[192:195] offset:8192
    v_pk_mul_f32 v[200:201], v[200:201], v[40:41] op_sel:[0,0] op_sel_hi:[1,0]
    v_pk_mul_f32 v[202:203], v[202:203], v[40:41] op_sel:[0,0] op_sel_hi:[1,0]
    v_pk_mul_f32 v[204:205], v[204:205], v[40:41] op_sel:[0,0] op_sel_hi:[1,0]
    v_pk_mul_f32 v[206:207], v[206:207], v[40:41] op_sel:[0,0] op_sel_hi:[1,0]
    v_cvt_pk_bf16_f32 v200, v200, v201
    v_cvt_pk_bf16_f32 v201, v202, v203
    v_cvt_pk_bf16_f32 v202, v204, v205
    v_cvt_pk_bf16_f32 v203, v206, v207
    ds_write_b128 v50, v[200:203] offset:8704
    v_pk_mul_f32 v[208:209], v[208:209], v[40:41] op_sel:[0,0] op_sel_hi:[1,0]
    v_pk_mul_f32 v[210:211], v[210:211], v[40:41] op_sel:[0,0] op_sel_hi:[1,0]
    v_pk_mul_f32 v[212:213], v[212:213], v[40:41] op_sel:[0,0] op_sel_hi:[1,0]
    v_pk_mul_f32 v[214:215], v[214:215], v[40:41] op_sel:[0,0] op_sel_hi:[1,0]
    v_cvt_pk_bf16_f32 v208, v208, v209
    v_cvt_pk_bf16_f32 v209, v210, v211
    v_cvt_pk_bf16_f32 v210, v212, v213
    v_cvt_pk_bf16_f32 v211, v214, v215
    ds_write_b128 v50, v[208:211] offset:9216
    v_pk_mul_f32 v[216:217], v[216:217], v[40:41] op_sel:[0,0] op_sel_hi:[1,0]
    v_pk_mul_f32 v[218:219], v[218:219], v[40:41] op_sel:[0,0] op_sel_hi:[1,0]
    v_pk_mul_f32 v[220:221], v[220:221], v[40:41] op_sel:[0,0] op_sel_hi:[1,0]
    v_pk_mul_f32 v[222:223], v[222:223], v[40:41] op_sel:[0,0] op_sel_hi:[1,0]
    v_cvt_pk_bf16_f32 v216, v216, v217
    v_cvt_pk_bf16_f32 v217, v218, v219
    v_cvt_pk_bf16_f32 v218, v220, v221
    v_cvt_pk_bf16_f32 v219, v222, v223
    ds_write_b128 v50, v[216:219] offset:9728
    ds_read_b128 a[64:67], v51 offset:8192
    ds_read_b128 a[68:71], v51 offset:9216
    ds_read_b128 a[72:75], v51 offset:10240
    ds_read_b128 a[76:79], v51 offset:11264
    s_waitcnt lgkmcnt(8)
    v_pk_add_f32 v[46:47], v[44:45], v[46:47]
    v_pk_add_f32 v[64:65], v[64:65], v[72:73]
    v_pk_add_f32 v[66:67], v[66:67], v[74:75]
    v_pk_add_f32 v[68:69], v[68:69], v[76:77]
    v_pk_add_f32 v[70:71], v[70:71], v[78:79]
    v_pk_add_f32 v[80:81], v[80:81], v[88:89]
    v_pk_add_f32 v[82:83], v[82:83], v[90:91]
    v_pk_add_f32 v[84:85], v[84:85], v[92:93]
    v_pk_add_f32 v[86:87], v[86:87], v[94:95]
    v_add_f32 v47, v46, v47
    v_rcp_f32 v45, v47
    v_pk_add_f32 v[64:65], v[64:65], v[80:81]
    v_pk_add_f32 v[66:67], v[66:67], v[82:83]
    v_pk_add_f32 v[68:69], v[68:69], v[84:85]
    v_pk_add_f32 v[70:71], v[70:71], v[86:87]
    v_pk_mul_f32 v[64:65], v[64:65], v[44:45] op_sel:[0,1] op_sel_hi:[1,1]
    v_pk_mul_f32 v[66:67], v[66:67], v[44:45] op_sel:[0,1] op_sel_hi:[1,1]
    v_pk_mul_f32 v[68:69], v[68:69], v[44:45] op_sel:[0,1] op_sel_hi:[1,1]
    v_pk_mul_f32 v[70:71], v[70:71], v[44:45] op_sel:[0,1] op_sel_hi:[1,1]
    v_cvt_pk_bf16_f32 v64, v64, v65
    v_cvt_pk_bf16_f32 v65, v66, v67
    v_cvt_pk_bf16_f32 v66, v68, v69
    v_cvt_pk_bf16_f32 v67, v70, v71
    v_lshlrev_b32 v72, 4, v26
    v_and_b32 v72, 0xf00, v72
    v_bfe_u32 v73, v26, 8, 2
    s_lshl_b32 s68, s61, 6
    v_lshl_add_u32 v72, v73, 4, v72
    s_add_u32 s68, s68, s65
    buffer_store_dwordx4 v[64:67], v72, s[36:39], s68 offen nt
    v_max_u32 v54, v54, v47
    v_min_u32 v55, v55, v47
    v_pk_mul_f32 v[224:225], v[224:225], v[40:41] op_sel:[0,1] op_sel_hi:[1,1]
    v_pk_mul_f32 v[226:227], v[226:227], v[40:41] op_sel:[0,1] op_sel_hi:[1,1]
    v_pk_mul_f32 v[228:229], v[228:229], v[40:41] op_sel:[0,1] op_sel_hi:[1,1]
    v_pk_mul_f32 v[230:231], v[230:231], v[40:41] op_sel:[0,1] op_sel_hi:[1,1]
    v_cvt_pk_bf16_f32 v224, v224, v225
    v_cvt_pk_bf16_f32 v225, v226, v227
    v_cvt_pk_bf16_f32 v226, v228, v229
    v_cvt_pk_bf16_f32 v227, v230, v231
    ds_write_b128 v50, v[224:227] offset:12288
    v_pk_mul_f32 v[232:233], v[232:233], v[40:41] op_sel:[0,1] op_sel_hi:[1,1]
    v_pk_mul_f32 v[234:235], v[234:235], v[40:41] op_sel:[0,1] op_sel_hi:[1,1]
    v_pk_mul_f32 v[236:237], v[236:237], v[40:41] op_sel:[0,1] op_sel_hi:[1,1]
    v_pk_mul_f32 v[238:239], v[238:239], v[40:41] op_sel:[0,1] op_sel_hi:[1,1]
    v_cvt_pk_bf16_f32 v232, v232, v233
    v_cvt_pk_bf16_f32 v233, v234, v235
    v_cvt_pk_bf16_f32 v234, v236, v237
    v_cvt_pk_bf16_f32 v235, v238, v239
    ds_write_b128 v50, v[232:235] offset:12800
    v_pk_mul_f32 v[240:241], v[240:241], v[40:41] op_sel:[0,1] op_sel_hi:[1,1]
    v_pk_mul_f32 v[242:243], v[242:243], v[40:41] op_sel:[0,1] op_sel_hi:[1,1]
    v_pk_mul_f32 v[244:245], v[244:245], v[40:41] op_sel:[0,1] op_sel_hi:[1,1]
    v_pk_mul_f32 v[246:247], v[246:247], v[40:41] op_sel:[0,1] op_sel_hi:[1,1]
    v_cvt_pk_bf16_f32 v240, v240, v241
    v_cvt_pk_bf16_f32 v241, v242, v243
    v_cvt_pk_bf16_f32 v242, v244, v245
    v_cvt_pk_bf16_f32 v243, v246, v247
    ds_write_b128 v50, v[240:243] offset:13312
    v_pk_mul_f32 v[248:249], v[248:249], v[40:41] op_sel:[0,1] op_sel_hi:[1,1]
    v_pk_mul_f32 v[250:251], v[250:251], v[40:41] op_sel:[0,1] op_sel_hi:[1,1]
    v_pk_mul_f32 v[252:253], v[252:253], v[40:41] op_sel:[0,1] op_sel_hi:[1,1]
    v_pk_mul_f32 v[254:255], v[254:255], v[40:41] op_sel:[0,1] op_sel_hi:[1,1]
    v_cvt_pk_bf16_f32 v248, v248, v249
    v_cvt_pk_bf16_f32 v249, v250, v251
    v_cvt_pk_bf16_f32 v250, v252, v253
    v_cvt_pk_bf16_f32 v251, v254, v255
    ds_write_b128 v50, v[248:251] offset:13824
    ds_read_b128 a[80:83], v51 offset:12288
    ds_read_b128 a[84:87], v51 offset:13312
    ds_read_b128 a[88:91], v51 offset:14336
    ds_read_b128 a[92:95], v51 offset:15360
    s_waitcnt lgkmcnt(15)
    s_add_u32 s82, s63, 16384
    v_cvt_pk_bf16_f32 v19, v6, v7
    v_mfma_f32_16x16x32_bf16 v[0:3], a[144:147], a[32:35], 0
    ds_read_b64_tr_b16 a[210:211], v63 offset:34816
    ds_read_b64_tr_b16 a[218:219], v63 offset:35328
    s_add_u32 s83, s63, 20480
    v_mfma_f32_16x16x32_bf16 v[0:3], a[148:151], a[36:39], v[0:3]
    v_exp_f32 v8, v8
    v_mul_f32 v9, s57, v9
    v_mfma_f32_16x16x32_bf16 v[0:3], a[152:155], a[40:43], v[0:3]
    ds_read_b64_tr_b16 a[214:215], v63 offset:34824
    ds_read_b64_tr_b16 a[216:217], v62 offset:35328
    ds_read_b64_tr_b16 a[222:223], v63 offset:35336
    v_mfma_f32_16x16x32_bf16 v[0:3], a[156:159], a[44:47], v[0:3]
    ds_read_b64_tr_b16 a[226:227], v63 offset:35840
    s_waitcnt lgkmcnt(15)
    v_mul_f32 v10, s57, v10
    v_mfma_f32_16x16x32_bf16 v[4:7], a[172:175], a[44:47], 0
    s_waitcnt lgkmcnt(6)
    v_exp_f32 v9, v9
    v_mfma_f32_16x16x32_bf16 v[4:7], a[168:171], a[40:43], v[4:7]
    buffer_store_dwordx4 a[64:67], v49, s[36:39], s82 offen offset:0 nt
    v_mfma_f32_16x16x32_bf16 v[4:7], a[164:167], a[36:39], v[4:7]
    ds_read_b64_tr_b16 a[224:225], v62 offset:35840
    v_cvt_pk_bf16_f32 v20, v8, v9
    v_mul_f32 v11, s57, v11
    v_mfma_f32_16x16x32_bf16 v[4:7], a[160:163], a[32:35], v[4:7]
    s_waitcnt lgkmcnt(15)
    v_exp_f32 v11, v11
    v_mfma_f32_16x16x32_bf16 v[128:131], a[176:179], v[16:19], v[128:131]
    ds_read_b64_tr_b16 a[236:237], v62 offset:36360
    v_exp_f32 v10, v10
    v_mfma_f32_16x16x32_bf16 v[132:135], a[180:183], v[16:19], v[132:135]
    v_mul_f32 v12, s57, v12
    v_cvt_pk_bf16_f32 v21, v10, v11
    v_mul_f32 v13, s57, v13
    v_mfma_f32_16x16x32_bf16 v[136:139], a[184:187], v[16:19], v[136:139]
    v_exp_f32 v12, v12
    v_mul_f32 v14, s57, v14
    v_mfma_f32_16x16x32_bf16 v[140:143], a[188:191], v[16:19], v[140:143]
    ds_read_b64_tr_b16 a[232:233], v62 offset:36352
    v_exp_f32 v13, v13
    v_mfma_f32_16x16x32_bf16 v[144:147], a[192:195], v[16:19], v[144:147]
    ds_read_b64_tr_b16 a[208:209], v62 offset:34816
    ds_read_b64_tr_b16 a[234:235], v63 offset:36352
    v_cvt_pk_bf16_f32 v22, v12, v13
    v_mfma_f32_16x16x32_bf16 v[148:151], a[196:199], v[16:19], v[148:151]
    v_exp_f32 v14, v14
    v_mul_f32 v15, s57, v15
    v_mfma_f32_16x16x32_bf16 v[152:155], a[200:203], v[16:19], v[152:155]
    buffer_store_dwordx4 a[68:71], v49, s[36:39], s82 offen offset:128 nt
    v_mfma_f32_16x16x32_bf16 v[156:159], a[204:207], v[16:19], v[156:159]
    v_exp_f32 v15, v15
    v_mul_f32 v0, s57, v0
    v_mfma_f32_16x16x32_bf16 v[8:11], a[144:147], a[48:51], 0
    ds_read_b64_tr_b16 a[228:229], v62 offset:35848
    ds_read_b64_tr_b16 a[230:231], v63 offset:35848
    v_cvt_pk_bf16_f32 v23, v14, v15
    v_mfma_f32_16x16x32_bf16 v[8:11], a[148:151], a[52:55], v[8:11]
    v_exp_f32 v0, v0
    v_mul_f32 v1, s57, v1
    v_mfma_f32_16x16x32_bf16 v[8:11], a[152:155], a[56:59], v[8:11]
    ds_read_b64_tr_b16 a[212:213], v62 offset:34824
    v_exp_f32 v1, v1
    v_mfma_f32_16x16x32_bf16 v[8:11], a[156:159], a[60:63], v[8:11]
    ds_read_b64_tr_b16 a[238:239], v63 offset:36360
    v_mul_f32 v2, s57, v2
    v_smfmac_f32_16x16x64_bf16 v[36:39], v[28:31], v[16:23], v48
    v_cvt_pk_bf16_f32 v16, v0, v1
    v_exp_f32 v2, v2
    v_mfma_f32_16x16x32_bf16 v[12:15], a[172:175], a[60:63], 0
    ds_read_b64_tr_b16 a[220:221], v62 offset:35336
    v_mul_f32 v3, s57, v3
    v_mfma_f32_16x16x32_bf16 v[12:15], a[168:171], a[56:59], v[12:15]
    v_exp_f32 v3, v3
    v_mfma_f32_16x16x32_bf16 v[12:15], a[164:167], a[52:55], v[12:15]
    buffer_store_dwordx4 a[72:75], v49, s[36:39], s82 offen offset:2048 nt
    v_mfma_f32_16x16x32_bf16 v[12:15], a[160:163], a[48:51], v[12:15]
    v_mul_f32 v4, s57, v4
    v_cvt_pk_bf16_f32 v17, v2, v3
    v_mfma_f32_16x16x32_bf16 v[160:163], a[176:179], v[20:23], v[160:163]
    v_exp_f32 v4, v4
    v_mul_f32 v5, s57, v5
    v_mfma_f32_16x16x32_bf16 v[164:167], a[180:183], v[20:23], v[164:167]
    v_exp_f32 v5, v5
    v_mfma_f32_16x16x32_bf16 v[168:171], a[184:187], v[20:23], v[168:171]
    v_mul_f32 v6, s57, v6
    v_cvt_pk_bf16_f32 v18, v4, v5
    v_mul_f32 v7, s57, v7
    v_mfma_f32_16x16x32_bf16 v[172:175], a[188:191], v[20:23], v[172:175]
    v_exp_f32 v6, v6
    v_mul_f32 v10, s57, v10
    v_mfma_f32_16x16x32_bf16 v[176:179], a[192:195], v[20:23], v[176:179]
    v_exp_f32 v7, v7
    v_mul_f32 v9, s57, v9
    v_mfma_f32_16x16x32_bf16 v[180:183], a[196:199], v[20:23], v[180:183]
    v_cvt_pk_bf16_f32 v19, v6, v7
    v_mul_f32 v8, s57, v8
    v_mul_f32 v11, s57, v11
    v_mfma_f32_16x16x32_bf16 v[184:187], a[200:203], v[20:23], v[184:187]
    s_waitcnt lgkmcnt(0)
    v_exp_f32 v8, v8
    v_mfma_f32_16x16x32_bf16 v[188:191], a[204:207], v[20:23], v[188:191]
    buffer_store_dwordx4 a[76:79], v49, s[36:39], s82 offen offset:2176 nt
    v_mfma_f32_16x16x32_bf16 v[128:131], a[208:211], v[16:19], v[128:131]
    v_exp_f32 v9, v9
    v_mul_f32 v14, s57, v14
    v_mfma_f32_16x16x32_bf16 v[132:135], a[212:215], v[16:19], v[132:135]
    v_cvt_pk_bf16_f32 v20, v8, v9
    v_exp_f32 v11, v11
    v_mfma_f32_16x16x32_bf16 v[136:139], a[216:219], v[16:19], v[136:139]
    v_exp_f32 v10, v10
    v_mul_f32 v13, s57, v13
    v_mfma_f32_16x16x32_bf16 v[140:143], a[220:223], v[16:19], v[140:143]
    v_mul_f32 v12, s57, v12
    v_exp_f32 v13, v13
    v_mfma_f32_16x16x32_bf16 v[144:147], a[224:227], v[16:19], v[144:147]
    v_exp_f32 v12, v12
    v_cvt_pk_bf16_f32 v21, v10, v11
    v_mfma_f32_16x16x32_bf16 v[148:151], a[228:231], v[16:19], v[148:151]
    v_mul_f32 v15, s57, v15
    v_exp_f32 v14, v14
    v_mfma_f32_16x16x32_bf16 v[152:155], a[232:235], v[16:19], v[152:155]
    v_exp_f32 v15, v15
    v_mfma_f32_16x16x32_bf16 v[156:159], a[236:239], v[16:19], v[156:159]
    v_cvt_pk_bf16_f32 v22, v12, v13
    v_cvt_pk_bf16_f32 v23, v14, v15
    s_nop 1
    v_smfmac_f32_16x16x64_bf16 v[36:39], v[28:31], v[16:23], v48
    v_mfma_f32_16x16x32_bf16 v[160:163], a[208:211], v[20:23], v[160:163]
    v_mfma_f32_16x16x32_bf16 v[164:167], a[212:215], v[20:23], v[164:167]
    v_mfma_f32_16x16x32_bf16 v[168:171], a[216:219], v[20:23], v[168:171]
    v_mfma_f32_16x16x32_bf16 v[172:175], a[220:223], v[20:23], v[172:175]
    v_mfma_f32_16x16x32_bf16 v[176:179], a[224:227], v[20:23], v[176:179]
    v_mfma_f32_16x16x32_bf16 v[180:183], a[228:231], v[20:23], v[180:183]
    v_mfma_f32_16x16x32_bf16 v[184:187], a[232:235], v[20:23], v[184:187]
    v_mfma_f32_16x16x32_bf16 v[188:191], a[236:239], v[20:23], v[188:191]
    s_nop 3
    v_pk_add_f32 v[38:39], v[36:37], v[38:39]
    v_rcp_f32 v36, v38
    v_rcp_f32 v37, v39
    v_max3_u32 v54, v54, v38, v39
    v_min3_u32 v55, v55, v38, v39
    s_add_u32 s48, s63, 8192
    s_add_u32 s85, s63, 12288
    v_pk_mul_f32 v[128:129], v[128:129], v[36:37] op_sel:[0,0] op_sel_hi:[1,0]
    v_pk_mul_f32 v[130:131], v[130:131], v[36:37] op_sel:[0,0] op_sel_hi:[1,0]
    v_pk_mul_f32 v[132:133], v[132:133], v[36:37] op_sel:[0,0] op_sel_hi:[1,0]
    v_pk_mul_f32 v[134:135], v[134:135], v[36:37] op_sel:[0,0] op_sel_hi:[1,0]
    v_cvt_pk_bf16_f32 v128, v128, v129
    v_cvt_pk_bf16_f32 v129, v130, v131
    v_cvt_pk_bf16_f32 v130, v132, v133
    v_cvt_pk_bf16_f32 v131, v134, v135
    ds_write_b128 v50, v[128:131] offset:16384
    buffer_store_dwordx4 a[80:83], v49, s[36:39], s83 offen offset:0 nt
    v_pk_mul_f32 v[136:137], v[136:137], v[36:37] op_sel:[0,0] op_sel_hi:[1,0]
    v_pk_mul_f32 v[138:139], v[138:139], v[36:37] op_sel:[0,0] op_sel_hi:[1,0]
    v_pk_mul_f32 v[140:141], v[140:141], v[36:37] op_sel:[0,0] op_sel_hi:[1,0]
    v_pk_mul_f32 v[142:143], v[142:143], v[36:37] op_sel:[0,0] op_sel_hi:[1,0]
    v_cvt_pk_bf16_f32 v136, v136, v137
    v_cvt_pk_bf16_f32 v137, v138, v139
    v_cvt_pk_bf16_f32 v138, v140, v141
    v_cvt_pk_bf16_f32 v139, v142, v143
    ds_write_b128 v50, v[136:139] offset:16896
    buffer_store_dwordx4 a[84:87], v49, s[36:39], s83 offen offset:128 nt
    v_pk_mul_f32 v[144:145], v[144:145], v[36:37] op_sel:[0,0] op_sel_hi:[1,0]
    v_pk_mul_f32 v[146:147], v[146:147], v[36:37] op_sel:[0,0] op_sel_hi:[1,0]
    v_pk_mul_f32 v[148:149], v[148:149], v[36:37] op_sel:[0,0] op_sel_hi:[1,0]
    v_pk_mul_f32 v[150:151], v[150:151], v[36:37] op_sel:[0,0] op_sel_hi:[1,0]
    v_cvt_pk_bf16_f32 v144, v144, v145
    v_cvt_pk_bf16_f32 v145, v146, v147
    v_cvt_pk_bf16_f32 v146, v148, v149
    v_cvt_pk_bf16_f32 v147, v150, v151
    ds_write_b128 v50, v[144:147] offset:17408
    buffer_store_dwordx4 a[88:91], v49, s[36:39], s83 offen offset:2048 nt
    v_pk_mul_f32 v[152:153], v[152:153], v[36:37] op_sel:[0,0] op_sel_hi:[1,0]
    v_pk_mul_f32 v[154:155], v[154:155], v[36:37] op_sel:[0,0] op_sel_hi:[1,0]
    v_pk_mul_f32 v[156:157], v[156:157], v[36:37] op_sel:[0,0] op_sel_hi:[1,0]
    v_pk_mul_f32 v[158:159], v[158:159], v[36:37] op_sel:[0,0] op_sel_hi:[1,0]
    v_cvt_pk_bf16_f32 v152, v152, v153
    v_cvt_pk_bf16_f32 v153, v154, v155
    v_cvt_pk_bf16_f32 v154, v156, v157
    v_cvt_pk_bf16_f32 v155, v158, v159
    ds_write_b128 v50, v[152:155] offset:17920
    buffer_store_dwordx4 a[92:95], v49, s[36:39], s83 offen offset:2176 nt
    ds_read_b128 a[32:35], v51 offset:16384
    ds_read_b128 a[36:39], v51 offset:17408
    ds_read_b128 a[40:43], v51 offset:18432
    ds_read_b128 a[44:47], v51 offset:19456
    v_pk_mul_f32 v[160:161], v[160:161], v[36:37] op_sel:[0,1] op_sel_hi:[1,1]
    v_pk_mul_f32 v[162:163], v[162:163], v[36:37] op_sel:[0,1] op_sel_hi:[1,1]
    v_pk_mul_f32 v[164:165], v[164:165], v[36:37] op_sel:[0,1] op_sel_hi:[1,1]
    v_pk_mul_f32 v[166:167], v[166:167], v[36:37] op_sel:[0,1] op_sel_hi:[1,1]
    v_cvt_pk_bf16_f32 v160, v160, v161
    v_cvt_pk_bf16_f32 v161, v162, v163
    v_cvt_pk_bf16_f32 v162, v164, v165
    v_cvt_pk_bf16_f32 v163, v166, v167
    ds_write_b128 v50, v[160:163] offset:8192
    v_pk_mul_f32 v[168:169], v[168:169], v[36:37] op_sel:[0,1] op_sel_hi:[1,1]
    v_pk_mul_f32 v[170:171], v[170:171], v[36:37] op_sel:[0,1] op_sel_hi:[1,1]
    v_pk_mul_f32 v[172:173], v[172:173], v[36:37] op_sel:[0,1] op_sel_hi:[1,1]
    v_pk_mul_f32 v[174:175], v[174:175], v[36:37] op_sel:[0,1] op_sel_hi:[1,1]
    v_cvt_pk_bf16_f32 v168, v168, v169
    v_cvt_pk_bf16_f32 v169, v170, v171
    v_cvt_pk_bf16_f32 v170, v172, v173
    v_cvt_pk_bf16_f32 v171, v174, v175
    ds_write_b128 v50, v[168:171] offset:8704
    s_waitcnt lgkmcnt(2)
    buffer_store_dwordx4 a[32:35], v49, s[36:39], s48 offen offset:0 nt
    v_pk_mul_f32 v[176:177], v[176:177], v[36:37] op_sel:[0,1] op_sel_hi:[1,1]
    v_pk_mul_f32 v[178:179], v[178:179], v[36:37] op_sel:[0,1] op_sel_hi:[1,1]
    v_pk_mul_f32 v[180:181], v[180:181], v[36:37] op_sel:[0,1] op_sel_hi:[1,1]
    v_pk_mul_f32 v[182:183], v[182:183], v[36:37] op_sel:[0,1] op_sel_hi:[1,1]
    v_cvt_pk_bf16_f32 v176, v176, v177
    v_cvt_pk_bf16_f32 v177, v178, v179
    v_cvt_pk_bf16_f32 v178, v180, v181
    v_cvt_pk_bf16_f32 v179, v182, v183
    ds_write_b128 v50, v[176:179] offset:9216
    buffer_store_dwordx4 a[36:39], v49, s[36:39], s48 offen offset:128 nt
    v_pk_mul_f32 v[184:185], v[184:185], v[36:37] op_sel:[0,1] op_sel_hi:[1,1]
    v_pk_mul_f32 v[186:187], v[186:187], v[36:37] op_sel:[0,1] op_sel_hi:[1,1]
    v_pk_mul_f32 v[188:189], v[188:189], v[36:37] op_sel:[0,1] op_sel_hi:[1,1]
    v_pk_mul_f32 v[190:191], v[190:191], v[36:37] op_sel:[0,1] op_sel_hi:[1,1]
    v_cvt_pk_bf16_f32 v184, v184, v185
    v_cvt_pk_bf16_f32 v185, v186, v187
    v_cvt_pk_bf16_f32 v186, v188, v189
    v_cvt_pk_bf16_f32 v187, v190, v191
    ds_write_b128 v50, v[184:187] offset:9728
    buffer_store_dwordx4 a[40:43], v49, s[36:39], s48 offen offset:2048 nt
    ds_read_b128 a[48:51], v51 offset:8192
    ds_read_b128 a[52:55], v51 offset:9216
    ds_read_b128 a[56:59], v51 offset:10240
    ds_read_b128 a[60:63], v51 offset:11264
    buffer_store_dwordx4 a[44:47], v49, s[36:39], s48 offen offset:2176 nt
    v_cmp_lt_u32 vcc, s59, v54
    v_cmp_gt_u32 s[70:71], s58, v55
    s_waitcnt lgkmcnt(0)
    buffer_store_dwordx4 a[48:51], v49, s[36:39], s85 offen offset:0 nt
    buffer_store_dwordx4 a[52:55], v49, s[36:39], s85 offen offset:128 nt
    buffer_store_dwordx4 a[56:59], v49, s[36:39], s85 offen offset:2048 nt
    buffer_store_dwordx4 a[60:63], v49, s[36:39], s85 offen offset:2176 nt
    s_lshl_b32 s68, 1, s56
    s_or_b64 vcc, vcc, s[70:71]
    s_cselect_b32 s68, s68, 0
    s_or_b32 s60, s60, s68
L_done:
    s_waitcnt vmcnt(0)
    s_barrier
    s_cmp_eq_u32 s60, 0
    s_cbranch_scc1 L_end
L_slow:
    v_mbcnt_lo_u32_b32 v69, -1, 0
    v_mbcnt_hi_u32_b32 v69, -1, v69
    v_and_b32 v64, 15, v69
    v_lshlrev_b32 v64, 8, v64
    v_lshrrev_b32 v70, 4, v69
    v_lshl_add_u32 v64, v70, 4, v64
    v_add_u32 v65, 0x1000, v64
    v_and_b32 v66, 0x1fff, v60
    v_add_u32 v66, s54, v66
    s_mov_b32 s72, 0
L_slow_pass:
    s_lshr_b32 s76, s60, s72
    s_and_b32 s76, s76, 1
    s_cmp_eq_u32 s76, 0
    s_cbranch_scc1 L_slow_next
    s_add_u32 s76, s67, s72
    s_lshl_b32 s73, s76, 17
    s_mul_i32 s78, s76, 217088
    s_add_u32 s76, s66, s72
    s_and_b32 s76, s76, 1
    s_cmp_eq_u32 s76, 0
    s_cselect_b32 s74, 7, 6
    s_lshl_b32 s74, s74, 12
    s_mul_i32 s74, s74, s61
    s_add_u32 s74, s74, s78
    s_mov_b32 s75, 7
    s_cmp_eq_u32 s76, 0
    s_cbranch_scc1 L_slow_own
    s_add_u32 s74, s74, 114688
    s_add_u32 s78, s78, 212992
    s_cmp_eq_u32 s61, 0
    s_cselect_b32 s75, 7, 6
    s_branch L_slow_unit
L_slow_own:
    s_add_u32 s78, s74, 24576
L_slow_unit:
    s_sub_u32 s75, s75, 1
    s_cmp_eq_u32 s75, 6
    s_cselect_b32 s76, s78, s74
    s_cselect_b32 s77, 0, 0x1000
    s_add_u32 s74, s74, s77
    s_mov_b32 s78, s76
    buffer_load_dwordx4 v[72:75], v64, s[20:23], s78 offen offset:0
    buffer_load_dwordx4 v[76:79], v64, s[20:23], s78 offen offset:64
    buffer_load_dwordx4 v[80:83], v64, s[20:23], s78 offen offset:128
    buffer_load_dwordx4 v[84:87], v64, s[20:23], s78 offen offset:192
    v_mov_b32 v67, 0xff800000
    s_mov_b32 s77, s73
    s_mov_b32 s76, 16
L_slow_max:
    buffer_load_dwordx4 v[88:91], v64, s[4:7], s77 offen offset:0
    buffer_load_dwordx4 v[92:95], v64, s[4:7], s77 offen offset:64
    buffer_load_dwordx4 v[96:99], v64, s[4:7], s77 offen offset:128
    buffer_load_dwordx4 v[100:103], v64, s[4:7], s77 offen offset:192
    buffer_load_dwordx4 v[104:107], v65, s[4:7], s77 offen offset:0
    buffer_load_dwordx4 v[108:111], v65, s[4:7], s77 offen offset:64
    buffer_load_dwordx4 v[112:115], v65, s[4:7], s77 offen offset:128
    buffer_load_dwordx4 v[116:119], v65, s[4:7], s77 offen offset:192
    s_waitcnt vmcnt(0)
    v_mfma_f32_16x16x32_bf16 v[120:123], v[88:91], v[72:75], 0
    v_mfma_f32_16x16x32_bf16 v[120:123], v[92:95], v[76:79], v[120:123]
    v_mfma_f32_16x16x32_bf16 v[120:123], v[96:99], v[80:83], v[120:123]
    v_mfma_f32_16x16x32_bf16 v[120:123], v[100:103], v[84:87], v[120:123]
    v_mfma_f32_16x16x32_bf16 v[124:127], v[104:107], v[72:75], 0
    v_mfma_f32_16x16x32_bf16 v[124:127], v[108:111], v[76:79], v[124:127]
    v_mfma_f32_16x16x32_bf16 v[124:127], v[112:115], v[80:83], v[124:127]
    v_mfma_f32_16x16x32_bf16 v[124:127], v[116:119], v[84:87], v[124:127]
    s_nop 15
    v_max3_f32 v67, v67, v120, v121
    v_max3_f32 v67, v67, v122, v123
    v_max3_f32 v67, v67, v124, v125
    v_max3_f32 v67, v67, v126, v127
    s_add_u32 s77, s77, 8192
    s_sub_u32 s76, s76, 1
    s_cmp_lg_u32 s76, 0
    s_cbranch_scc1 L_slow_max
    v_mov_b32 v69, v67
    v_mov_b32 v70, v67
    s_nop 1
    v_permlane32_swap_b32 v69, v70
    s_nop 1
    v_max_f32 v67, v69, v70
    v_mov_b32 v69, v67
    v_mov_b32 v70, v67
    s_nop 1
    v_permlane16_swap_b32 v69, v70
    s_nop 1
    v_max_f32 v67, v69, v70
    v_mul_f32 v67, s57, v67
    v_mov_b32 v68, 0
    v_mov_b32 v132, 0
    v_mov_b32 v133, 0
    v_mov_b32 v134, 0
    v_mov_b32 v135, 0
    v_mov_b32 v136, 0
    v_mov_b32 v137, 0
    v_mov_b32 v138, 0
    v_mov_b32 v139, 0
    v_mov_b32 v140, 0
    v_mov_b32 v141, 0
    v_mov_b32 v142, 0
    v_mov_b32 v143, 0
    v_mov_b32 v144, 0
    v_mov_b32 v145, 0
    v_mov_b32 v146, 0
    v_mov_b32 v147, 0
    v_mov_b32 v148, 0
    v_mov_b32 v149, 0
    v_mov_b32 v150, 0
    v_mov_b32 v151, 0
    v_mov_b32 v152, 0
    v_mov_b32 v153, 0
    v_mov_b32 v154, 0
    v_mov_b32 v155, 0
    v_mov_b32 v156, 0
    v_mov_b32 v157, 0
    v_mov_b32 v158, 0
    v_mov_b32 v159, 0
    v_mov_b32 v160, 0
    v_mov_b32 v161, 0
    v_mov_b32 v162, 0
    v_mov_b32 v163, 0
    s_mov_b32 s77, s73
    s_mov_b32 s76, 16
L_slow_acc:
    buffer_load_dwordx4 v[88:91], v64, s[4:7], s77 offen offset:0
    buffer_load_dwordx4 v[92:95], v64, s[4:7], s77 offen offset:64
    buffer_load_dwordx4 v[96:99], v64, s[4:7], s77 offen offset:128
    buffer_load_dwordx4 v[100:103], v64, s[4:7], s77 offen offset:192
    buffer_load_dwordx4 v[104:107], v65, s[4:7], s77 offen offset:0
    buffer_load_dwordx4 v[108:111], v65, s[4:7], s77 offen offset:64
    buffer_load_dwordx4 v[112:115], v65, s[4:7], s77 offen offset:128
    buffer_load_dwordx4 v[116:119], v65, s[4:7], s77 offen offset:192
    s_add_u32 m0, s54, 0
    s_add_u32 s79, s77, 2048
    buffer_load_dwordx4 v49, s[12:15], s79 offen lds
    s_add_u32 m0, s54, 1024
    s_add_u32 s79, s77, 2176
    buffer_load_dwordx4 v49, s[12:15], s79 offen lds
    s_add_u32 m0, s54, 4096
    s_add_u32 s79, s77, 4096
    buffer_load_dwordx4 v49, s[12:15], s79 offen lds
    s_add_u32 m0, s54, 5120
    s_add_u32 s79, s77, 4224
    buffer_load_dwordx4 v49, s[12:15], s79 offen lds
    s_add_u32 m0, s54, 8192
    s_add_u32 s79, s77, 6144
    buffer_load_dwordx4 v49, s[12:15], s79 offen lds
    s_add_u32 m0, s54, 9216
    s_add_u32 s79, s77, 6272
    buffer_load_dwordx4 v49, s[12:15], s79 offen lds
    s_add_u32 m0, s54, 12288
    s_add_u32 s79, s77, 8192
    buffer_load_dwordx4 v49, s[12:15], s79 offen lds
    s_add_u32 m0, s54, 13312
    s_add_u32 s79, s77, 8320
    buffer_load_dwordx4 v49, s[12:15], s79 offen lds
    s_waitcnt vmcnt(0)
    ds_read_b64_tr_b16 v[164:165], v66 offset:0
    ds_read_b64_tr_b16 v[166:167], v66 offset:8192
    ds_read_b64_tr_b16 v[168:169], v66 offset:8
    ds_read_b64_tr_b16 v[170:171], v66 offset:8200
    ds_read_b64_tr_b16 v[172:173], v66 offset:512
    ds_read_b64_tr_b16 v[174:175], v66 offset:8704
    ds_read_b64_tr_b16 v[176:177], v66 offset:520
    ds_read_b64_tr_b16 v[178:179], v66 offset:8712
    ds_read_b64_tr_b16 v[180:181], v66 offset:1024
    ds_read_b64_tr_b16 v[182:183], v66 offset:9216
    ds_read_b64_tr_b16 v[184:185], v66 offset:1032
    ds_read_b64_tr_b16 v[186:187], v66 offset:9224
    ds_read_b64_tr_b16 v[188:189], v66 offset:1536
    ds_read_b64_tr_b16 v[190:191], v66 offset:9728
    ds_read_b64_tr_b16 v[192:193], v66 offset:1544
    ds_read_b64_tr_b16 v[194:195], v66 offset:9736
    v_mfma_f32_16x16x32_bf16 v[120:123], v[88:91], v[72:75], 0
    v_mfma_f32_16x16x32_bf16 v[120:123], v[92:95], v[76:79], v[120:123]
    v_mfma_f32_16x16x32_bf16 v[120:123], v[96:99], v[80:83], v[120:123]
    v_mfma_f32_16x16x32_bf16 v[120:123], v[100:103], v[84:87], v[120:123]
    v_mfma_f32_16x16x32_bf16 v[124:127], v[104:107], v[72:75], 0
    v_mfma_f32_16x16x32_bf16 v[124:127], v[108:111], v[76:79], v[124:127]
    v_mfma_f32_16x16x32_bf16 v[124:127], v[112:115], v[80:83], v[124:127]
    v_mfma_f32_16x16x32_bf16 v[124:127], v[116:119], v[84:87], v[124:127]
    s_nop 15
    v_fma_f32 v120, v120, s57, -v67
    v_fma_f32 v121, v121, s57, -v67
    v_fma_f32 v122, v122, s57, -v67
    v_fma_f32 v123, v123, s57, -v67
    v_fma_f32 v124, v124, s57, -v67
    v_fma_f32 v125, v125, s57, -v67
    v_fma_f32 v126, v126, s57, -v67
    v_fma_f32 v127, v127, s57, -v67
    v_exp_f32 v120, v120
    v_exp_f32 v121, v121
    v_exp_f32 v122, v122
    v_exp_f32 v123, v123
    v_exp_f32 v124, v124
    v_exp_f32 v125, v125
    v_exp_f32 v126, v126
    v_exp_f32 v127, v127
    s_nop 0
    v_add_f32 v68, v68, v120
    v_add_f32 v68, v68, v121
    v_add_f32 v68, v68, v122
    v_add_f32 v68, v68, v123
    v_add_f32 v68, v68, v124
    v_add_f32 v68, v68, v125
    v_add_f32 v68, v68, v126
    v_add_f32 v68, v68, v127
    v_cvt_pk_bf16_f32 v128, v120, v121
    v_cvt_pk_bf16_f32 v129, v122, v123
    v_cvt_pk_bf16_f32 v130, v124, v125
    v_cvt_pk_bf16_f32 v131, v126, v127
    s_waitcnt lgkmcnt(0)
    s_nop 1
    v_mfma_f32_16x16x32_bf16 v[132:135], v[164:167], v[128:131], v[132:135]
    v_mfma_f32_16x16x32_bf16 v[136:139], v[168:171], v[128:131], v[136:139]
    v_mfma_f32_16x16x32_bf16 v[140:143], v[172:175], v[128:131], v[140:143]
    v_mfma_f32_16x16x32_bf16 v[144:147], v[176:179], v[128:131], v[144:147]
    v_mfma_f32_16x16x32_bf16 v[148:151], v[180:183], v[128:131], v[148:151]
    v_mfma_f32_16x16x32_bf16 v[152:155], v[184:187], v[128:131], v[152:155]
    v_mfma_f32_16x16x32_bf16 v[156:159], v[188:191], v[128:131], v[156:159]
    v_mfma_f32_16x16x32_bf16 v[160:163], v[192:195], v[128:131], v[160:163]
    s_add_u32 s77, s77, 8192
    s_sub_u32 s76, s76, 1
    s_cmp_lg_u32 s76, 0
    s_cbranch_scc1 L_slow_acc
    v_mov_b32 v69, v68
    v_mov_b32 v70, v68
    s_nop 1
    v_permlane32_swap_b32 v69, v70
    s_nop 1
    v_add_f32 v68, v69, v70
    v_mov_b32 v69, v68
    v_mov_b32 v70, v68
    s_nop 1
    v_permlane16_swap_b32 v69, v70
    s_nop 1
    v_add_f32 v68, v69, v70
    v_rcp_f32 v68, v68
    s_nop 7
    v_mul_f32 v132, v132, v68
    v_mul_f32 v133, v133, v68
    v_mul_f32 v134, v134, v68
    v_mul_f32 v135, v135, v68
    v_mul_f32 v136, v136, v68
    v_mul_f32 v137, v137, v68
    v_mul_f32 v138, v138, v68
    v_mul_f32 v139, v139, v68
    v_mul_f32 v140, v140, v68
    v_mul_f32 v141, v141, v68
    v_mul_f32 v142, v142, v68
    v_mul_f32 v143, v143, v68
    v_mul_f32 v144, v144, v68
    v_mul_f32 v145, v145, v68
    v_mul_f32 v146, v146, v68
    v_mul_f32 v147, v147, v68
    v_mul_f32 v148, v148, v68
    v_mul_f32 v149, v149, v68
    v_mul_f32 v150, v150, v68
    v_mul_f32 v151, v151, v68
    v_mul_f32 v152, v152, v68
    v_mul_f32 v153, v153, v68
    v_mul_f32 v154, v154, v68
    v_mul_f32 v155, v155, v68
    v_mul_f32 v156, v156, v68
    v_mul_f32 v157, v157, v68
    v_mul_f32 v158, v158, v68
    v_mul_f32 v159, v159, v68
    v_mul_f32 v160, v160, v68
    v_mul_f32 v161, v161, v68
    v_mul_f32 v162, v162, v68
    v_mul_f32 v163, v163, v68
    v_cvt_pk_bf16_f32 v132, v132, v133
    v_cvt_pk_bf16_f32 v133, v134, v135
    v_cvt_pk_bf16_f32 v134, v136, v137
    v_cvt_pk_bf16_f32 v135, v138, v139
    v_cvt_pk_bf16_f32 v140, v140, v141
    v_cvt_pk_bf16_f32 v141, v142, v143
    v_cvt_pk_bf16_f32 v142, v144, v145
    v_cvt_pk_bf16_f32 v143, v146, v147
    v_cvt_pk_bf16_f32 v148, v148, v149
    v_cvt_pk_bf16_f32 v149, v150, v151
    v_cvt_pk_bf16_f32 v150, v152, v153
    v_cvt_pk_bf16_f32 v151, v154, v155
    v_cvt_pk_bf16_f32 v156, v156, v157
    v_cvt_pk_bf16_f32 v157, v158, v159
    v_cvt_pk_bf16_f32 v158, v160, v161
    v_cvt_pk_bf16_f32 v159, v162, v163
    buffer_store_dwordx4 v[132:135], v64, s[36:39], s78 offen offset:0
    buffer_store_dwordx4 v[140:143], v64, s[36:39], s78 offen offset:64
    buffer_store_dwordx4 v[148:151], v64, s[36:39], s78 offen offset:128
    buffer_store_dwordx4 v[156:159], v64, s[36:39], s78 offen offset:192
    s_waitcnt vmcnt(0)
    s_cmp_lg_u32 s75, 0
    s_cbranch_scc1 L_slow_unit
L_slow_next:
    s_add_u32 s72, s72, 1
    s_cmp_lt_u32 s72, 4
    s_cbranch_scc1 L_slow_pass
L_end:
s_endpgm
.section .rodata,"a"
.p2align 6
.amdhsa_kernel standalone__mha_softmax__near_ridge_kernel
  .amdhsa_next_free_vgpr 512
  .amdhsa_next_free_sgpr 102
  .amdhsa_accum_offset 256
  .amdhsa_group_segment_fixed_size 0
  .amdhsa_kernarg_size 48
  .amdhsa_user_sgpr_count 2
  .amdhsa_user_sgpr_kernarg_segment_ptr 1
  .amdhsa_system_sgpr_workgroup_id_x 1
.end_amdhsa_kernel
```
